```python
import torch

def _softmax(x, axis=-1):
    return torch.softmax(x, dim=axis)
def _gelu(x):
    return torch.nn.functional.gelu(x, approximate="tanh")
def _silu(x):
    return torch.nn.functional.silu(x)
def _sigmoid(x):
    return torch.sigmoid(x)
def _layernorm(x, axis=-1, eps=1e-5):
    m = x.mean(dim=axis, keepdim=True)
    v = x.var(dim=axis, keepdim=True, unbiased=False)
    return (x - m) / torch.sqrt(v + eps)
def _scatter_add(tgt, idx, src, axis=0):
    return tgt.clone().index_add_(axis, idx, src)
def _segment_sum(src, seg, n):
    out = torch.zeros((n,) + src.shape[1:], dtype=src.dtype)
    return out.index_add_(0, seg, src)
def _pad(x, pw):
    flat = tuple(v for pair in reversed(pw) for v in pair)
    return torch.nn.functional.pad(x, flat)

kernel_name = 'interleave_layers__linear_attn_block__mixer_token_mlp__prompt'

def setup_inputs():

    _w = (lambda a: (lambda t: t.to(torch.bfloat16) if t.is_floating_point() else t)(torch.as_tensor(a)))
    def _A_setup():
        B, S, D = 1, 2048, 512
        return {
            "x": _w((lambda *s: torch.randn(*s, dtype=torch.bfloat16) * 0.05)(B, S, D)),
            "wqkv": _w((lambda *s: torch.randn(*s, dtype=torch.bfloat16) * 0.05)(D, 3 * D)),
            "wo": _w((lambda *s: torch.randn(*s, dtype=torch.bfloat16) * 0.05)(D, D)),
        }
    _A_in = _A_setup()

    def _B_setup():
        B, S, D, F = 1, 2048, 512, 1792
        return {
            "x": _w((lambda *s: torch.randn(*s, dtype=torch.bfloat16) * 0.05)(B, S, D)),
            "w1": _w((lambda *s: torch.randn(*s, dtype=torch.bfloat16) * 0.8)(S, F) * (S ** -0.5)),
            "b1": _w((lambda *s: torch.randn(*s, dtype=torch.bfloat16) * 12.8)(F) * 0.02),
            "w2": _w((lambda *s: torch.randn(*s, dtype=torch.bfloat16) * 0.4)(F, S) * (F ** -0.5)),
            "b2": _w((lambda *s: torch.randn(*s, dtype=torch.bfloat16) * 3.2)(S) * 0.02),
        }
    _B_in = _B_setup()

    return {
        "A_x": _A_in["x"],
        "A_wqkv": _A_in["wqkv"],
        "A_wo": _A_in["wo"],
        "B_x": _B_in["x"],
        "B_w1": _B_in["w1"],
        "B_b1": _B_in["b1"],
        "B_w2": _B_in["w2"],
        "B_b2": _B_in["b2"],
    }

def reference(A_x, A_wqkv, A_wo, B_x, B_w1, B_b1, B_w2, B_b2):
    def _A_ref(x, wqkv, wo):
        B, S, D = x.shape
        H = 32; Dh = D // H
        qkv = (lambda x, *d: x.permute(*d))((x @ wqkv).reshape(B, S, 3, H, Dh), 2, 0, 3, 1, 4)
        q, k, v = qkv[0], qkv[1], qkv[2]
        phi = lambda t: torch.where(t > 0, t + 1, torch.exp(t)) + 1e-6
        pq, pk = phi(q), phi(k)
        kv = torch.einsum("bhsd,bhse->bhde", pk, v)
        z = torch.einsum("bhsd->bhd", pk)
        num = torch.einsum("bhqd,bhde->bhqe", pq, kv)
        den = torch.einsum("bhqd,bhd->bhq", pq, z)[..., None] + 1e-6
        o = num / den
        return (lambda x, *d: x.permute(*d))(o, 0, 2, 1, 3).reshape(B, S, D) @ wo

    def _B_ref(x, w1, b1, w2, b2):
        B, S, D = x.shape
        h = _layernorm(x, axis=-1)
        u = torch.einsum("bsd,sf->bdf", h, w1) + b1
        u = _gelu(u)
        y = torch.einsum("bdf,fs->bds", u, w2) + b2
        return (lambda x, *d: x.permute(*d))(y, 0, 2, 1)

    x = A_x
    x = x + _A_ref(_layernorm(x, axis=-1), A_wqkv, A_wo)
    x = x + _B_ref(_layernorm(x, axis=-1), B_w1, B_b1, B_w2, B_b2)
    x = x + _A_ref(_layernorm(x, axis=-1), A_wqkv, A_wo)
    x = x + _B_ref(_layernorm(x, axis=-1), B_w1, B_b1, B_w2, B_b2)
    return x
```

```asm
; @launch grid=(256,1,1) block=(256,1,1) lds=163840
.amdgcn_target "amdgcn-amd-amdhsa--gfx950"
.text
.globl interleave_layers__linear_attn_block__mixer_token_mlp__prompt_kernel
.p2align 8
.type interleave_layers__linear_attn_block__mixer_token_mlp__prompt_kernel,@function
interleave_layers__linear_attn_block__mixer_token_mlp__prompt_kernel:
    s_cmp_ge_u32 s2, 256
    s_cbranch_scc1 L_end
    s_load_dwordx16 s[8:23], s[0:1], 0
    s_load_dwordx4 s[24:27], s[0:1], 64
    s_load_dwordx2 s[28:29], s[0:1], 80
    v_and_b32 v1, 63, v0
    v_lshrrev_b32 v7, 6, v0
    v_lshlrev_b32 v2, 4, v1
    v_readfirstlane_b32 s3, v7
    v_lshrrev_b32 v4, 5, v1
    v_bfe_u32 v7, v1, 2, 2
    v_lshl_add_u32 v7, v4, 2, v7
    v_lshlrev_b32 v7, 6, v7
    v_bfe_u32 v8, v1, 4, 1
    v_lshl_add_u32 v7, v8, 5, v7
    v_and_b32 v8, 3, v1
    v_lshl_add_u32 v3, v8, 3, v7
    s_and_b32 s72, s2, 7
    s_lshr_b32 s73, s2, 3
    s_lshr_b32 s74, s72, 1
    s_and_b32 s75, s72, 1
    s_and_b32 s84, s3, 1
    s_lshr_b32 s85, s3, 1
    s_mul_i32 s79, s3, 40960
    s_lshl_b32 s80, s85, 5
    v_xor_b32 v5, s80, v3
    s_lshl_b32 s80, s85, 8
    v_xor_b32 v6, s80, v2
    s_mov_b32 s86, -1
    s_mov_b32 s87, 0
    s_mov_b32 s88, 0xffff0000
    s_mov_b32 s89, 0xffff0000
    s_and_b32 s82, s73, 3
    s_lshr_b32 s83, s73, 2
    s_and_b32 s76, s73, 7
    s_lshr_b32 s77, s73, 3
    s_lshl_b32 s80, s72, 2
    s_add_u32 s77, s77, s80
    s_mul_i32 s78, s74, 7
    s_add_u32 s78, s78, s83
    s_lshl_b32 s91, s74, 4
    s_lshl_b32 s81, s82, 2
    s_add_u32 s91, s91, s81
    s_add_u32 s91, s91, s3
    s_lshl_b32 s90, s75, 3
    s_add_u32 s90, s90, s83
    s_mov_b32 s74, s74
    s_mov_b32 s72, s75
    s_lshl_b32 s75, s72, 2
    s_add_u32 s75, s75, s82
    s_mul_i32 s98, s3, 1835008
    s_lshl_b32 s81, s78, 7
    s_add_u32 s98, s98, s81
    s_mul_i32 s99, s3, 1835008
    s_lshl_b32 s81, s77, 7
    s_add_u32 s99, s99, s81
    s_lshl_b32 s101, s3, 17
    s_lshl_b32 s81, s76, 7
    s_add_u32 s101, s101, s81
    v_bfe_u32 v7, v1, 2, 3
    v_and_b32 v8, 3, v1
    v_lshl_add_u32 v8, v4, 2, v8
    v_lshlrev_b32 v8, 4, v8
    v_mul_u32_u24 v28, 3584, v7
    v_add_u32 v28, v28, v8
    v_mul_u32_u24 v29, 4096, v7
    v_add_u32 v29, v29, v8
    v_mul_u32_u24 v30, 1024, v7
    v_add_u32 v30, v30, v8
    s_waitcnt lgkmcnt(0)
    s_mov_b32 s32, s8
    s_and_b32 s33, s9, 0xffff
    s_mov_b32 s34, 2097152
    s_mov_b32 s35, 0x20000
    s_mov_b32 s36, s10
    s_and_b32 s37, s11, 0xffff
    s_mov_b32 s38, 1572864
    s_mov_b32 s39, 0x20000
    s_mov_b32 s40, s12
    s_and_b32 s41, s13, 0xffff
    s_mov_b32 s42, 524288
    s_mov_b32 s43, 0x20000
    s_mov_b32 s44, s16
    s_and_b32 s45, s17, 0xffff
    s_mov_b32 s46, 7340032
    s_mov_b32 s47, 0x20000
    s_mov_b32 s48, s18
    s_and_b32 s49, s19, 0xffff
    s_mov_b32 s50, 3584
    s_mov_b32 s51, 0x20000
    s_mov_b32 s52, s20
    s_and_b32 s53, s21, 0xffff
    s_mov_b32 s54, 7340032
    s_mov_b32 s55, 0x20000
    s_mov_b32 s56, s22
    s_and_b32 s57, s23, 0xffff
    s_mov_b32 s58, 4096
    s_mov_b32 s59, 0x20000
    s_mov_b32 s60, s24
    s_and_b32 s61, s25, 0xffff
    s_mov_b32 s62, 2097152
    s_mov_b32 s63, 0x20000
    s_mov_b32 s64, s26
    s_and_b32 s65, s27, 0xffff
    s_mov_b32 s66, 256
    s_mov_b32 s67, 0x20000
    s_mov_b32 s68, s28
    s_and_b32 s69, s29, 0xffff
    s_mov_b32 s70, 20971520
    s_mov_b32 s71, 0x20000
    s_cmp_ge_u32 s73, 28
    s_cselect_b32 s46, 0, s46
    s_cselect_b32 s50, 0, s50
    s_mov_b32 s5, s45
    s_mov_b32 s6, 7340032
    s_mov_b32 s7, 0x20000
    s_getpc_b64 s[28:29]
L_pc:
    v_lshlrev_b32 v7, 7, v1
    s_lshl_b32 s80, s73, 11
    s_lshl_b32 s81, s3, 9
    s_add_u32 s80, s80, s81
    v_add_u32 v7, s80, v7
    v_min_u32 v7, L_end-L_pc, v7
    s_mov_b64 exec, 15
    global_load_dword v31, v7, s[28:29]
    s_mov_b64 exec, -1
    v_lshlrev_b32 v7, 7, v1
    v_mov_b32 v9, 1073741824
    v_cmp_gt_u32 vcc, 32, v1
    s_nop 1
    v_cndmask_b32 v7, v9, v7, vcc
    s_lshr_b32 s82, s73, 2
    s_lshl_b32 s80, s91, 15
    s_lshl_b32 s81, s82, 12
    s_add_u32 s80, s80, s81
    buffer_load_dword v31, v7, s[32:35], s80 offen
    v_lshrrev_b32 v7, 4, v1
    v_mul_u32_u24 v7, 3072, v7
    v_bfe_u32 v8, v1, 2, 2
    v_cmp_gt_u32 vcc, 3, v8
    v_lshl_add_u32 v7, v8, 10, v7
    v_and_b32 v8, 3, v1
    v_lshl_add_u32 v7, v8, 7, v7
    v_mov_b32 v9, 1073741824
    v_cndmask_b32 v7, v9, v7, vcc
    s_mul_i32 s80, s73, 49152
    s_mul_i32 s81, s3, 12288
    s_add_u32 s80, s80, s81
    s_lshl_b32 s81, s72, 9
    s_add_u32 s80, s80, s81
    buffer_load_dword v31, v7, s[36:39], s80 offen
    v_lshrrev_b32 v7, 3, v1
    v_and_b32 v8, 7, v1
    v_xor_b32 v8, v8, v7
    v_lshlrev_b32 v7, 10, v7
    v_lshl_add_u32 v18, v8, 4, v7
    v_xor_b32 v19, 16, v18
    s_lshl_b32 s92, s91, 15
    s_add_u32 m0, s79, 24576
    s_add_u32 s80, s92, 0
    buffer_load_dwordx4 v18, s[32:35], s80 offen lds
    s_add_u32 m0, s79, 25600
    s_add_u32 s80, s92, 8192
    buffer_load_dwordx4 v19, s[32:35], s80 offen lds
    s_add_u32 m0, s79, 26624
    s_add_u32 s80, s92, 16384
    buffer_load_dwordx4 v18, s[32:35], s80 offen lds
    s_add_u32 m0, s79, 27648
    s_add_u32 s80, s92, 24576
    buffer_load_dwordx4 v19, s[32:35], s80 offen lds
    s_add_u32 m0, s79, 28672
    s_add_u32 s80, s92, 128
    buffer_load_dwordx4 v18, s[32:35], s80 offen lds
    s_add_u32 m0, s79, 29696
    s_add_u32 s80, s92, 8320
    buffer_load_dwordx4 v19, s[32:35], s80 offen lds
    s_add_u32 m0, s79, 30720
    s_add_u32 s80, s92, 16512
    buffer_load_dwordx4 v18, s[32:35], s80 offen lds
    s_add_u32 m0, s79, 31744
    s_add_u32 s80, s92, 24704
    buffer_load_dwordx4 v19, s[32:35], s80 offen lds
    s_add_u32 m0, s79, 32768
    s_add_u32 s80, s92, 256
    buffer_load_dwordx4 v18, s[32:35], s80 offen lds
    s_add_u32 m0, s79, 33792
    s_add_u32 s80, s92, 8448
    buffer_load_dwordx4 v19, s[32:35], s80 offen lds
    s_add_u32 m0, s79, 34816
    s_add_u32 s80, s92, 16640
    buffer_load_dwordx4 v18, s[32:35], s80 offen lds
    s_add_u32 m0, s79, 35840
    s_add_u32 s80, s92, 24832
    buffer_load_dwordx4 v19, s[32:35], s80 offen lds
    s_add_u32 m0, s79, 36864
    s_add_u32 s80, s92, 384
    buffer_load_dwordx4 v18, s[32:35], s80 offen lds
    s_add_u32 m0, s79, 37888
    s_add_u32 s80, s92, 8576
    buffer_load_dwordx4 v19, s[32:35], s80 offen lds
    s_add_u32 m0, s79, 38912
    s_add_u32 s80, s92, 16768
    buffer_load_dwordx4 v18, s[32:35], s80 offen lds
    s_add_u32 m0, s79, 39936
    s_add_u32 s80, s92, 24960
    buffer_load_dwordx4 v19, s[32:35], s80 offen lds
    v_lshrrev_b32 v7, 2, v1
    v_mul_u32_u24 v7, 3072, v7
    v_and_b32 v8, 3, v1
    v_lshl_add_u32 v254, v8, 4, v7
    s_mul_i32 s94, s3, 49152
    s_lshl_b32 s81, s90, 6
    s_add_u32 s94, s94, s81
    s_mul_i32 s95, s3, 3072
    s_add_u32 m0, s95, 0
    s_add_u32 s83, s94, 0
    buffer_load_dwordx4 v254, s[36:39], s83 offen offset:1024 lds
    s_add_u32 m0, s95, 0
    s_add_u32 s83, s94, 0
    buffer_load_dwordx4 v254, s[36:39], s83 offen offset:2048 lds
    s_add_u32 m0, s95, 0
    s_add_u32 s83, s94, 0
    buffer_load_dwordx4 v254, s[36:39], s83 offen offset:0 lds
    s_add_u32 m0, s95, 12288
    s_add_u32 s83, s94, 196608
    buffer_load_dwordx4 v254, s[36:39], s83 offen offset:1024 lds
    s_add_u32 m0, s95, 12288
    s_add_u32 s83, s94, 196608
    buffer_load_dwordx4 v254, s[36:39], s83 offen offset:2048 lds
    s_add_u32 m0, s95, 12288
    s_add_u32 s83, s94, 196608
    buffer_load_dwordx4 v254, s[36:39], s83 offen offset:0 lds
    s_add_u32 m0, s95, 40960
    s_add_u32 s83, s94, 393216
    buffer_load_dwordx4 v254, s[36:39], s83 offen offset:1024 lds
    s_add_u32 m0, s95, 40960
    s_add_u32 s83, s94, 393216
    buffer_load_dwordx4 v254, s[36:39], s83 offen offset:2048 lds
    s_add_u32 m0, s95, 40960
    s_add_u32 s83, s94, 393216
    buffer_load_dwordx4 v254, s[36:39], s83 offen offset:0 lds
    s_add_u32 m0, s95, 53248
    s_add_u32 s83, s94, 589824
    buffer_load_dwordx4 v254, s[36:39], s83 offen offset:1024 lds
    s_add_u32 m0, s95, 53248
    s_add_u32 s83, s94, 589824
    buffer_load_dwordx4 v254, s[36:39], s83 offen offset:2048 lds
    s_add_u32 m0, s95, 53248
    s_add_u32 s83, s94, 589824
    buffer_load_dwordx4 v254, s[36:39], s83 offen offset:0 lds
    s_lshl_b32 s4, s2, 8
    v_add_u32 v7, s4, v0
    v_lshlrev_b32 v7, 3, v7
    v_mov_b32 v22, -1
    v_mov_b32 v23, -1
    s_mov_b32 s5, 15728640
    buffer_store_dwordx2 v[22:23], v7, s[68:71], s5 offen sc1
    s_lshl_b32 s4, s2, 7
    v_add_u32 v7, s4, v0
    v_lshlrev_b32 v7, 2, v7
    v_mov_b32 v8, 1073741824
    v_cmp_gt_u32 vcc, 128, v0
    s_nop 1
    v_cndmask_b32 v7, v8, v7, vcc
    v_mov_b32 v25, 0
    s_mov_b32 s5, 14680064
    buffer_store_dword v25, v7, s[68:71], s5 offen sc1
    v_cmp_gt_u32 vcc, 32, v0
    v_lshlrev_b32 v7, 3, v0
    s_nop 0
    v_cndmask_b32 v7, v8, v7, vcc
    v_mov_b32 v24, 0
    s_mul_i32 s5, s2, 256
    s_add_u32 s5, s5, 16777216
    buffer_store_dwordx2 v[24:25], v7, s[68:71], s5 offen sc1
    v_mov_b32 v232, 0x3f803f80
    v_mov_b32 v240, 0
    v_mov_b32 v233, 0x3f803f80
    v_mov_b32 v241, 0
    v_mov_b32 v234, 0x3f803f80
    v_mov_b32 v242, 0
    v_mov_b32 v235, 0x3f803f80
    v_mov_b32 v243, 0
    v_and_b32 v7, 7, v1
    v_bfe_u32 v8, v1, 3, 2
    v_lshlrev_b32 v9, 10, v8
    v_lshl_add_u32 v9, v7, 7, v9
    s_add_u32 s80, s79, 24576
    v_add_u32 v9, s80, v9
    v_and_b32 v8, 1, v8
    v_xor_b32 v7, v7, v8
    v_xor_b32 v7, v7, v4
    v_xor_b32 v8, 0, v7
    v_lshl_add_u32 v160, v8, 4, v9
    v_xor_b32 v8, 2, v7
    v_lshl_add_u32 v161, v8, 4, v9
    v_xor_b32 v8, 4, v7
    v_lshl_add_u32 v162, v8, 4, v9
    v_xor_b32 v8, 6, v7
    v_lshl_add_u32 v163, v8, 4, v9
    v_add_u32 v168, s80, v2
    v_add_u32 v169, s95, v3
    v_add_u32 v170, 81920, v169
    v_bfe_u32 v7, v1, 4, 1
    v_and_b32 v8, 15, v1
    v_cmp_eq_u32 vcc, v7, v8
    s_nop 1
    v_cndmask_b32 v172, 0, v232, vcc
    v_cndmask_b32 v173, 0, v232, vcc
    v_cndmask_b32 v174, 0, v232, vcc
    v_cndmask_b32 v175, 0, v232, vcc
    v_lshl_add_u32 v244, v4, 8, v3
    v_add_u32 v245, 81920, v244
    s_waitcnt vmcnt(15)
    ds_read_b128 v[32:35], v160 offset:0
    ds_read_b128 v[36:39], v161 offset:0
    ds_read_b128 v[40:43], v162 offset:0
    ds_read_b128 v[44:47], v163 offset:0
    ds_read_b128 v[48:51], v160 offset:4096
    ds_read_b128 v[52:55], v161 offset:4096
    ds_read_b128 v[56:59], v162 offset:4096
    ds_read_b128 v[60:63], v163 offset:4096
    ds_read_b128 v[64:67], v160 offset:8192
    ds_read_b128 v[68:71], v161 offset:8192
    ds_read_b128 v[72:75], v162 offset:8192
    ds_read_b128 v[76:79], v163 offset:8192
    ds_read_b128 v[80:83], v160 offset:12288
    ds_read_b128 v[84:87], v161 offset:12288
    ds_read_b128 v[88:91], v162 offset:12288
    ds_read_b128 v[92:95], v163 offset:12288
    v_mov_b32 v156, -1
    v_mov_b32 v157, -1
    v_mov_b32 v158, -1
    v_mov_b32 v159, -1
    s_lshl_b32 s80, s91, 15
    s_lshl_b32 s81, s90, 11
    s_add_u32 s80, s80, s81
    s_add_u32 s80, s80, 2097152
    buffer_store_dwordx4 v[156:159], v2, s[68:71], s80 offen sc1
    s_lshl_b32 s80, s91, 15
    s_lshl_b32 s81, s90, 11
    s_add_u32 s80, s80, s81
    s_add_u32 s80, s80, 2098176
    buffer_store_dwordx4 v[156:159], v2, s[68:71], s80 offen sc1
    s_lshl_b32 s80, s76, 18
    s_lshl_b32 s81, s85, 17
    s_add_u32 s80, s80, s81
    s_lshl_b32 s81, s77, 12
    s_add_u32 s80, s80, s81
    s_lshl_b32 s81, s84, 11
    s_add_u32 s80, s80, s81
    s_add_u32 s80, s80, 6291456
    buffer_store_dwordx4 v[156:159], v2, s[68:71], s80 offen sc1
    s_lshl_b32 s80, s76, 18
    s_lshl_b32 s81, s85, 17
    s_add_u32 s80, s80, s81
    s_lshl_b32 s81, s77, 12
    s_add_u32 s80, s80, s81
    s_lshl_b32 s81, s84, 11
    s_add_u32 s80, s80, s81
    s_add_u32 s80, s80, 6292480
    buffer_store_dwordx4 v[156:159], v2, s[68:71], s80 offen sc1
    s_mul_i32 s80, s75, 229376
    s_lshl_b32 s81, s78, 12
    s_add_u32 s80, s80, s81
    s_lshl_b32 s81, s84, 11
    s_add_u32 s80, s80, s81
    s_lshl_b32 s81, s85, 10
    s_add_u32 s80, s80, s81
    s_add_u32 s80, s80, 10485760
    s_cmp_ge_u32 s73, 28
    s_cselect_b32 s80, 1073741824, s80
    buffer_store_dwordx4 v[156:159], v2, s[68:71], s80 offen sc1
    s_mul_i32 s80, s75, 229376
    s_lshl_b32 s81, s78, 12
    s_add_u32 s80, s80, s81
    s_lshl_b32 s81, s84, 11
    s_add_u32 s80, s80, s81
    s_lshl_b32 s81, s85, 10
    s_add_u32 s80, s80, s81
    s_add_u32 s80, s80, 10600448
    s_cmp_ge_u32 s73, 28
    s_cselect_b32 s80, 1073741824, s80
    buffer_store_dwordx4 v[156:159], v2, s[68:71], s80 offen sc1
    s_lshl_b32 s80, s77, 16
    s_lshl_b32 s81, s84, 15
    s_add_u32 s80, s80, s81
    s_lshl_b32 s81, s76, 12
    s_add_u32 s80, s80, s81
    s_lshl_b32 s81, s85, 10
    s_add_u32 s80, s80, s81
    buffer_store_dwordx4 v[156:159], v2, s[68:71], s80 offen sc1
    s_lshl_b32 s80, s77, 16
    s_lshl_b32 s81, s84, 15
    s_add_u32 s80, s80, s81
    s_lshl_b32 s81, s76, 12
    s_add_u32 s80, s80, s81
    s_lshl_b32 s81, s85, 10
    s_add_u32 s80, s80, s81
    s_add_u32 s80, s80, 2048
    buffer_store_dwordx4 v[156:159], v2, s[68:71], s80 offen sc1
    s_lshl_b32 s80, s77, 13
    s_lshl_b32 s81, s84, 12
    s_add_u32 s80, s80, s81
    s_lshl_b32 s81, s76, 9
    s_add_u32 s80, s80, s81
    s_lshl_b32 s81, s85, 8
    s_add_u32 s80, s80, s81
    s_add_u32 s80, s80, 16252928
    s_mov_b64 exec, 0xffff
    buffer_store_dwordx4 v[156:159], v2, s[68:71], s80 offen sc1
    s_mov_b64 exec, -1
    s_waitcnt lgkmcnt(15)
    v_dot2c_f32_bf16 v240, v32, v232
    v_dot2c_f32_bf16 v242, v32, v32
    v_dot2c_f32_bf16 v241, v33, v232
    v_dot2c_f32_bf16 v243, v33, v33
    v_dot2c_f32_bf16 v240, v34, v232
    v_dot2c_f32_bf16 v242, v34, v34
    v_dot2c_f32_bf16 v241, v35, v232
    v_dot2c_f32_bf16 v243, v35, v35
    s_waitcnt lgkmcnt(14)
    v_dot2c_f32_bf16 v240, v36, v232
    v_dot2c_f32_bf16 v242, v36, v36
    v_dot2c_f32_bf16 v241, v37, v232
    v_dot2c_f32_bf16 v243, v37, v37
    v_dot2c_f32_bf16 v240, v38, v232
    v_dot2c_f32_bf16 v242, v38, v38
    v_dot2c_f32_bf16 v241, v39, v232
    v_dot2c_f32_bf16 v243, v39, v39
    s_waitcnt lgkmcnt(13)
    v_dot2c_f32_bf16 v240, v40, v232
    v_dot2c_f32_bf16 v242, v40, v40
    v_dot2c_f32_bf16 v241, v41, v232
    v_dot2c_f32_bf16 v243, v41, v41
    v_dot2c_f32_bf16 v240, v42, v232
    v_dot2c_f32_bf16 v242, v42, v42
    v_dot2c_f32_bf16 v241, v43, v232
    v_dot2c_f32_bf16 v243, v43, v43
    s_waitcnt lgkmcnt(12)
    v_dot2c_f32_bf16 v240, v44, v232
    v_dot2c_f32_bf16 v242, v44, v44
    v_dot2c_f32_bf16 v241, v45, v232
    v_dot2c_f32_bf16 v243, v45, v45
    v_dot2c_f32_bf16 v240, v46, v232
    v_dot2c_f32_bf16 v242, v46, v46
    v_dot2c_f32_bf16 v241, v47, v232
    v_dot2c_f32_bf16 v243, v47, v47
    s_waitcnt lgkmcnt(11)
    v_dot2c_f32_bf16 v240, v48, v232
    v_dot2c_f32_bf16 v242, v48, v48
    v_dot2c_f32_bf16 v241, v49, v232
    v_dot2c_f32_bf16 v243, v49, v49
    v_dot2c_f32_bf16 v240, v50, v232
    v_dot2c_f32_bf16 v242, v50, v50
    v_dot2c_f32_bf16 v241, v51, v232
    v_dot2c_f32_bf16 v243, v51, v51
    s_waitcnt lgkmcnt(10)
    v_dot2c_f32_bf16 v240, v52, v232
    v_dot2c_f32_bf16 v242, v52, v52
    v_dot2c_f32_bf16 v241, v53, v232
    v_dot2c_f32_bf16 v243, v53, v53
    v_dot2c_f32_bf16 v240, v54, v232
    v_dot2c_f32_bf16 v242, v54, v54
    v_dot2c_f32_bf16 v241, v55, v232
    v_dot2c_f32_bf16 v243, v55, v55
    s_waitcnt lgkmcnt(9)
    v_dot2c_f32_bf16 v240, v56, v232
    v_dot2c_f32_bf16 v242, v56, v56
    v_dot2c_f32_bf16 v241, v57, v232
    v_dot2c_f32_bf16 v243, v57, v57
    v_dot2c_f32_bf16 v240, v58, v232
    v_dot2c_f32_bf16 v242, v58, v58
    v_dot2c_f32_bf16 v241, v59, v232
    v_dot2c_f32_bf16 v243, v59, v59
    s_waitcnt lgkmcnt(8)
    v_dot2c_f32_bf16 v240, v60, v232
    v_dot2c_f32_bf16 v242, v60, v60
    v_dot2c_f32_bf16 v241, v61, v232
    v_dot2c_f32_bf16 v243, v61, v61
    v_dot2c_f32_bf16 v240, v62, v232
    v_dot2c_f32_bf16 v242, v62, v62
    v_dot2c_f32_bf16 v241, v63, v232
    v_dot2c_f32_bf16 v243, v63, v63
    s_waitcnt lgkmcnt(7)
    v_dot2c_f32_bf16 v240, v64, v232
    v_dot2c_f32_bf16 v242, v64, v64
    v_dot2c_f32_bf16 v241, v65, v232
    v_dot2c_f32_bf16 v243, v65, v65
    v_dot2c_f32_bf16 v240, v66, v232
    v_dot2c_f32_bf16 v242, v66, v66
    v_dot2c_f32_bf16 v241, v67, v232
    v_dot2c_f32_bf16 v243, v67, v67
    s_waitcnt lgkmcnt(6)
    v_dot2c_f32_bf16 v240, v68, v232
    v_dot2c_f32_bf16 v242, v68, v68
    v_dot2c_f32_bf16 v241, v69, v232
    v_dot2c_f32_bf16 v243, v69, v69
    v_dot2c_f32_bf16 v240, v70, v232
    v_dot2c_f32_bf16 v242, v70, v70
    v_dot2c_f32_bf16 v241, v71, v232
    v_dot2c_f32_bf16 v243, v71, v71
    s_waitcnt lgkmcnt(5)
    v_dot2c_f32_bf16 v240, v72, v232
    v_dot2c_f32_bf16 v242, v72, v72
    v_dot2c_f32_bf16 v241, v73, v232
    v_dot2c_f32_bf16 v243, v73, v73
    v_dot2c_f32_bf16 v240, v74, v232
    v_dot2c_f32_bf16 v242, v74, v74
    v_dot2c_f32_bf16 v241, v75, v232
    v_dot2c_f32_bf16 v243, v75, v75
    s_waitcnt lgkmcnt(4)
    v_dot2c_f32_bf16 v240, v76, v232
    v_dot2c_f32_bf16 v242, v76, v76
    v_dot2c_f32_bf16 v241, v77, v232
    v_dot2c_f32_bf16 v243, v77, v77
    v_dot2c_f32_bf16 v240, v78, v232
    v_dot2c_f32_bf16 v242, v78, v78
    v_dot2c_f32_bf16 v241, v79, v232
    v_dot2c_f32_bf16 v243, v79, v79
    s_waitcnt lgkmcnt(3)
    v_dot2c_f32_bf16 v240, v80, v232
    v_dot2c_f32_bf16 v242, v80, v80
    v_dot2c_f32_bf16 v241, v81, v232
    v_dot2c_f32_bf16 v243, v81, v81
    v_dot2c_f32_bf16 v240, v82, v232
    v_dot2c_f32_bf16 v242, v82, v82
    v_dot2c_f32_bf16 v241, v83, v232
    v_dot2c_f32_bf16 v243, v83, v83
    s_waitcnt lgkmcnt(2)
    v_dot2c_f32_bf16 v240, v84, v232
    v_dot2c_f32_bf16 v242, v84, v84
    v_dot2c_f32_bf16 v241, v85, v232
    v_dot2c_f32_bf16 v243, v85, v85
    v_dot2c_f32_bf16 v240, v86, v232
    v_dot2c_f32_bf16 v242, v86, v86
    v_dot2c_f32_bf16 v241, v87, v232
    v_dot2c_f32_bf16 v243, v87, v87
    s_waitcnt lgkmcnt(1)
    v_dot2c_f32_bf16 v240, v88, v232
    v_dot2c_f32_bf16 v242, v88, v88
    v_dot2c_f32_bf16 v241, v89, v232
    v_dot2c_f32_bf16 v243, v89, v89
    v_dot2c_f32_bf16 v240, v90, v232
    v_dot2c_f32_bf16 v242, v90, v90
    v_dot2c_f32_bf16 v241, v91, v232
    v_dot2c_f32_bf16 v243, v91, v91
    s_waitcnt lgkmcnt(0)
    v_dot2c_f32_bf16 v240, v92, v232
    v_dot2c_f32_bf16 v242, v92, v92
    v_dot2c_f32_bf16 v241, v93, v232
    v_dot2c_f32_bf16 v243, v93, v93
    v_dot2c_f32_bf16 v240, v94, v232
    v_dot2c_f32_bf16 v242, v94, v94
    v_dot2c_f32_bf16 v241, v95, v232
    v_dot2c_f32_bf16 v243, v95, v95
    s_waitcnt vmcnt(12)
    ds_read_b64_tr_b16 v[208:209], v169 offset:0
    ds_read_b64_tr_b16 v[210:211], v169 offset:512
    ds_read_b64_tr_b16 v[212:213], v169 offset:1024
    ds_read_b64_tr_b16 v[214:215], v169 offset:1536
    ds_read_b64_tr_b16 v[216:217], v169 offset:2048
    ds_read_b64_tr_b16 v[218:219], v169 offset:2560
    ds_read_b64_tr_b16 v[220:221], v169 offset:12288
    ds_read_b64_tr_b16 v[222:223], v169 offset:12800
    ds_read_b64_tr_b16 v[224:225], v169 offset:13312
    ds_read_b64_tr_b16 v[226:227], v169 offset:13824
    s_waitcnt lgkmcnt(8)
    v_mfma_f32_16x16x32_bf16 v[236:239], v[172:175], v[208:211], 0
    ds_read_b64_tr_b16 v[228:229], v169 offset:14336
    ds_read_b64_tr_b16 v[230:231], v169 offset:14848
    s_add_u32 s80, s92, 512
    buffer_load_dwordx4 v[96:99], v18, s[32:35], s80 offen
    s_waitcnt lgkmcnt(8)
    v_mfma_f32_16x16x32_bf16 v[246:249], v[172:175], v[212:215], 0
    ds_read_b64_tr_b16 v[208:209], v169 offset:40960
    ds_read_b64_tr_b16 v[210:211], v169 offset:41472
    s_add_u32 s80, s92, 8704
    buffer_load_dwordx4 v[100:103], v19, s[32:35], s80 offen
    s_waitcnt lgkmcnt(8)
    v_mfma_f32_16x16x32_bf16 v[250:253], v[172:175], v[216:219], 0
    ds_read_b64_tr_b16 v[212:213], v169 offset:41984
    ds_read_b64_tr_b16 v[214:215], v169 offset:42496
    s_add_u32 s80, s92, 16896
    buffer_load_dwordx4 v[104:107], v18, s[32:35], s80 offen
    s_waitcnt lgkmcnt(8)
    v_mfma_f32_16x16x32_bf16 v[236:239], v[172:175], v[220:223], v[236:239]
    ds_read_b64_tr_b16 v[216:217], v169 offset:43008
    ds_read_b64_tr_b16 v[218:219], v169 offset:43520
    s_add_u32 s80, s92, 25088
    buffer_load_dwordx4 v[108:111], v19, s[32:35], s80 offen
    s_waitcnt lgkmcnt(8)
    v_mfma_f32_16x16x32_bf16 v[246:249], v[172:175], v[224:227], v[246:249]
    ds_read_b64_tr_b16 v[220:221], v169 offset:53248
    ds_read_b64_tr_b16 v[222:223], v169 offset:53760
    s_add_u32 s80, s92, 640
    buffer_load_dwordx4 v[112:115], v18, s[32:35], s80 offen
    s_waitcnt lgkmcnt(8)
    v_mfma_f32_16x16x32_bf16 v[250:253], v[172:175], v[228:231], v[250:253]
    ds_read_b64_tr_b16 v[224:225], v169 offset:54272
    ds_read_b64_tr_b16 v[226:227], v169 offset:54784
    s_add_u32 s80, s92, 8832
    buffer_load_dwordx4 v[116:119], v19, s[32:35], s80 offen
    s_waitcnt lgkmcnt(8)
    v_mfma_f32_16x16x32_bf16 v[236:239], v[172:175], v[208:211], v[236:239]
    ds_read_b64_tr_b16 v[228:229], v169 offset:55296
    ds_read_b64_tr_b16 v[230:231], v169 offset:55808
    s_add_u32 s80, s92, 17024
    buffer_load_dwordx4 v[120:123], v18, s[32:35], s80 offen
    s_waitcnt lgkmcnt(8)
    v_mfma_f32_16x16x32_bf16 v[246:249], v[172:175], v[212:215], v[246:249]
    s_add_u32 s80, s92, 25216
    buffer_load_dwordx4 v[124:127], v19, s[32:35], s80 offen
    s_waitcnt lgkmcnt(6)
    v_mfma_f32_16x16x32_bf16 v[250:253], v[172:175], v[216:219], v[250:253]
    s_add_u32 s80, s92, 768
    buffer_load_dwordx4 v[128:131], v18, s[32:35], s80 offen
    s_waitcnt lgkmcnt(4)
    v_mfma_f32_16x16x32_bf16 v[236:239], v[172:175], v[220:223], v[236:239]
    s_add_u32 s80, s92, 8960
    buffer_load_dwordx4 v[132:135], v19, s[32:35], s80 offen
    s_waitcnt lgkmcnt(2)
    v_mfma_f32_16x16x32_bf16 v[246:249], v[172:175], v[224:227], v[246:249]
    s_add_u32 s80, s92, 17152
    buffer_load_dwordx4 v[136:139], v18, s[32:35], s80 offen
    s_waitcnt lgkmcnt(0)
    v_mfma_f32_16x16x32_bf16 v[250:253], v[172:175], v[228:231], v[250:253]
    s_add_u32 s80, s92, 25344
    buffer_load_dwordx4 v[140:143], v19, s[32:35], s80 offen
    s_and_b32 s80, s2, 7
    s_lshl_b32 s80, s80, 5
    s_cmp_eq_u32 s3, 0
    s_cselect_b32 s80, s80, 4096
    s_getreg_b32 s82, hwreg(HW_REG_XCC_ID, 0, 4)
    s_mul_i32 s31, s82, s82
    s_lshl_b32 s31, s31, 10
    s_add_u32 s31, s31, s82
    s_lshl_b32 s31, s31, 8
    s_add_u32 s31, s31, 1
    s_waitcnt vmcnt(21)
    s_barrier
    v_mov_b32 v9, s31
    s_mov_b64 exec, 1
    buffer_atomic_add v9, off, s[64:67], s80
    s_mov_b64 exec, -1
    s_add_u32 s80, s79, 24576
    v_add_u32 v20, s80, v2
    ds_read_b64_tr_b16 v[208:209], v244 offset:1024
    ds_read_b64_tr_b16 v[210:211], v244 offset:1280
    ds_read_b64_tr_b16 v[212:213], v244 offset:2048
    ds_read_b64_tr_b16 v[214:215], v244 offset:2304
    ds_read_b64_tr_b16 v[216:217], v244 offset:0
    ds_read_b64_tr_b16 v[218:219], v244 offset:256
    ds_read_b64_tr_b16 v[220:221], v244 offset:4096
    ds_read_b64_tr_b16 v[222:223], v244 offset:4352
    ds_read_b64_tr_b16 v[224:225], v244 offset:5120
    ds_read_b64_tr_b16 v[226:227], v244 offset:5376
    s_waitcnt lgkmcnt(8)
    v_mfma_f32_32x32x16_bf16 v[160:175], v[32:35], v[208:211], 0
    ds_read_b64_tr_b16 v[228:229], v244 offset:3072
    ds_read_b64_tr_b16 v[230:231], v244 offset:3328
    s_add_u32 s80, s92, 896
    buffer_load_dwordx4 v[144:147], v18, s[32:35], s80 offen
    s_waitcnt lgkmcnt(8)
    v_mfma_f32_32x32x16_bf16 v[176:191], v[32:35], v[212:215], 0
    ds_read_b64_tr_b16 v[208:209], v244 offset:7168
    ds_read_b64_tr_b16 v[210:211], v244 offset:7424
    s_add_u32 s80, s92, 9088
    buffer_load_dwordx4 v[148:151], v19, s[32:35], s80 offen
    s_waitcnt lgkmcnt(8)
    v_mfma_f32_32x32x16_bf16 v[192:207], v[216:219], v[32:35], 0
    ds_read_b64_tr_b16 v[212:213], v244 offset:8192
    ds_read_b64_tr_b16 v[214:215], v244 offset:8448
    s_waitcnt lgkmcnt(8)
    v_mfma_f32_32x32x16_bf16 v[160:175], v[36:39], v[220:223], v[160:175]
    ds_read_b64_tr_b16 v[216:217], v244 offset:6144
    ds_read_b64_tr_b16 v[218:219], v244 offset:6400
    s_add_u32 s80, s92, 17280
    buffer_load_dwordx4 v[152:155], v18, s[32:35], s80 offen
    s_waitcnt lgkmcnt(8)
    v_mfma_f32_32x32x16_bf16 v[176:191], v[36:39], v[224:227], v[176:191]
    ds_read_b64_tr_b16 v[220:221], v244 offset:10240
    ds_read_b64_tr_b16 v[222:223], v244 offset:10496
    s_add_u32 s80, s92, 25472
    buffer_load_dwordx4 v[156:159], v19, s[32:35], s80 offen
    s_waitcnt lgkmcnt(8)
    v_mfma_f32_32x32x16_bf16 v[192:207], v[228:231], v[36:39], v[192:207]
    ds_read_b64_tr_b16 v[224:225], v244 offset:11264
    ds_read_b64_tr_b16 v[226:227], v244 offset:11520
    s_waitcnt lgkmcnt(8)
    v_mfma_f32_32x32x16_bf16 v[160:175], v[40:43], v[208:211], v[160:175]
    ds_read_b64_tr_b16 v[228:229], v244 offset:9216
    ds_read_b64_tr_b16 v[230:231], v244 offset:9472
    s_add_u32 m0, s95, 81920
    s_add_u32 s83, s94, 786432
    buffer_load_dwordx4 v254, s[36:39], s83 offen offset:1024 lds
    s_waitcnt lgkmcnt(8)
    v_mfma_f32_32x32x16_bf16 v[176:191], v[40:43], v[212:215], v[176:191]
    ds_read_b64_tr_b16 v[208:209], v244 offset:13312
    ds_read_b64_tr_b16 v[210:211], v244 offset:13568
    s_add_u32 m0, s95, 81920
    s_add_u32 s83, s94, 786432
    buffer_load_dwordx4 v254, s[36:39], s83 offen offset:2048 lds
    s_waitcnt lgkmcnt(8)
    v_mfma_f32_32x32x16_bf16 v[192:207], v[216:219], v[40:43], v[192:207]
    ds_read_b64_tr_b16 v[212:213], v244 offset:14336
    ds_read_b64_tr_b16 v[214:215], v244 offset:14592
    s_waitcnt lgkmcnt(8)
    v_mfma_f32_32x32x16_bf16 v[160:175], v[44:47], v[220:223], v[160:175]
    ds_read_b64_tr_b16 v[216:217], v244 offset:12288
    ds_read_b64_tr_b16 v[218:219], v244 offset:12544
    s_add_u32 m0, s95, 81920
    s_add_u32 s83, s94, 786432
    buffer_load_dwordx4 v254, s[36:39], s83 offen offset:0 lds
    s_waitcnt lgkmcnt(8)
    v_mfma_f32_32x32x16_bf16 v[176:191], v[44:47], v[224:227], v[176:191]
    ds_read_b64_tr_b16 v[220:221], v244 offset:16384
    ds_read_b64_tr_b16 v[222:223], v244 offset:16640
    s_add_u32 m0, s95, 94208
    s_add_u32 s83, s94, 983040
    buffer_load_dwordx4 v254, s[36:39], s83 offen offset:1024 lds
    s_waitcnt lgkmcnt(8)
    v_mfma_f32_32x32x16_bf16 v[192:207], v[228:231], v[44:47], v[192:207]
    ds_read_b64_tr_b16 v[224:225], v244 offset:17408
    ds_read_b64_tr_b16 v[226:227], v244 offset:17664
    s_waitcnt lgkmcnt(8)
    v_mfma_f32_32x32x16_bf16 v[160:175], v[48:51], v[208:211], v[160:175]
    ds_read_b64_tr_b16 v[228:229], v244 offset:15360
    ds_read_b64_tr_b16 v[230:231], v244 offset:15616
    s_add_u32 m0, s95, 94208
    s_add_u32 s83, s94, 983040
    buffer_load_dwordx4 v254, s[36:39], s83 offen offset:2048 lds
    s_waitcnt lgkmcnt(8)
    v_mfma_f32_32x32x16_bf16 v[176:191], v[48:51], v[212:215], v[176:191]
    ds_read_b64_tr_b16 v[208:209], v244 offset:19456
    ds_read_b64_tr_b16 v[210:211], v244 offset:19712
    s_add_u32 m0, s95, 94208
    s_add_u32 s83, s94, 983040
    buffer_load_dwordx4 v254, s[36:39], s83 offen offset:0 lds
    s_waitcnt lgkmcnt(8)
    v_mfma_f32_32x32x16_bf16 v[192:207], v[216:219], v[48:51], v[192:207]
    ds_read_b64_tr_b16 v[212:213], v244 offset:20480
    ds_read_b64_tr_b16 v[214:215], v244 offset:20736
    s_waitcnt lgkmcnt(8)
    v_mfma_f32_32x32x16_bf16 v[160:175], v[52:55], v[220:223], v[160:175]
    ds_read_b64_tr_b16 v[216:217], v244 offset:18432
    ds_read_b64_tr_b16 v[218:219], v244 offset:18688
    s_add_u32 m0, s95, 122880
    s_add_u32 s83, s94, 1179648
    buffer_load_dwordx4 v254, s[36:39], s83 offen offset:1024 lds
    s_waitcnt lgkmcnt(8)
    v_mfma_f32_32x32x16_bf16 v[176:191], v[52:55], v[224:227], v[176:191]
    ds_read_b64_tr_b16 v[220:221], v244 offset:22528
    ds_read_b64_tr_b16 v[222:223], v244 offset:22784
    s_add_u32 m0, s95, 122880
    s_add_u32 s83, s94, 1179648
    buffer_load_dwordx4 v254, s[36:39], s83 offen offset:2048 lds
    s_waitcnt lgkmcnt(8)
    v_mfma_f32_32x32x16_bf16 v[192:207], v[228:231], v[52:55], v[192:207]
    ds_read_b64_tr_b16 v[224:225], v244 offset:23552
    ds_read_b64_tr_b16 v[226:227], v244 offset:23808
    s_waitcnt lgkmcnt(8)
    v_mfma_f32_32x32x16_bf16 v[160:175], v[56:59], v[208:211], v[160:175]
    ds_read_b64_tr_b16 v[228:229], v244 offset:21504
    ds_read_b64_tr_b16 v[230:231], v244 offset:21760
    s_add_u32 m0, s95, 122880
    s_add_u32 s83, s94, 1179648
    buffer_load_dwordx4 v254, s[36:39], s83 offen offset:0 lds
    s_waitcnt lgkmcnt(8)
    v_mfma_f32_32x32x16_bf16 v[176:191], v[56:59], v[212:215], v[176:191]
    ds_read_b64_tr_b16 v[208:209], v244 offset:41984
    ds_read_b64_tr_b16 v[210:211], v244 offset:42240
    s_add_u32 m0, s95, 135168
    s_add_u32 s83, s94, 1376256
    buffer_load_dwordx4 v254, s[36:39], s83 offen offset:1024 lds
    s_waitcnt lgkmcnt(8)
    v_mfma_f32_32x32x16_bf16 v[192:207], v[216:219], v[56:59], v[192:207]
    ds_read_b64_tr_b16 v[212:213], v244 offset:43008
    ds_read_b64_tr_b16 v[214:215], v244 offset:43264
    s_waitcnt lgkmcnt(8)
    v_mfma_f32_32x32x16_bf16 v[160:175], v[60:63], v[220:223], v[160:175]
    ds_read_b64_tr_b16 v[216:217], v244 offset:40960
    ds_read_b64_tr_b16 v[218:219], v244 offset:41216
    s_add_u32 m0, s95, 135168
    s_add_u32 s83, s94, 1376256
    buffer_load_dwordx4 v254, s[36:39], s83 offen offset:2048 lds
    s_waitcnt lgkmcnt(8)
    v_mfma_f32_32x32x16_bf16 v[176:191], v[60:63], v[224:227], v[176:191]
    ds_read_b64_tr_b16 v[220:221], v244 offset:45056
    ds_read_b64_tr_b16 v[222:223], v244 offset:45312
    s_add_u32 m0, s95, 135168
    s_add_u32 s83, s94, 1376256
    buffer_load_dwordx4 v254, s[36:39], s83 offen offset:0 lds
    s_waitcnt lgkmcnt(8)
    v_mfma_f32_32x32x16_bf16 v[192:207], v[228:231], v[60:63], v[192:207]
    ds_read_b64_tr_b16 v[224:225], v244 offset:46080
    ds_read_b64_tr_b16 v[226:227], v244 offset:46336
    s_waitcnt lgkmcnt(8)
    v_mfma_f32_32x32x16_bf16 v[160:175], v[64:67], v[208:211], v[160:175]
    ds_read_b64_tr_b16 v[228:229], v244 offset:44032
    ds_read_b64_tr_b16 v[230:231], v244 offset:44288
    v_lshlrev_b32 v7, 3, v4
    s_lshl_b32 s80, s78, 7
    s_lshl_b32 s81, s84, 6
    s_add_u32 s80, s80, s81
    s_lshl_b32 s81, s85, 5
    s_add_u32 s80, s80, s81
    buffer_load_dwordx2 v[14:15], v7, s[48:51], s80 offen
    buffer_load_dwordx2 v[16:17], v7, s[48:51], s80 offen offset:16
    v_and_b32 v7, 31, v1
    v_lshlrev_b32 v7, 1, v7
    s_lshl_b32 s80, s77, 7
    s_lshl_b32 s81, s84, 6
    s_add_u32 s80, s80, s81
    buffer_load_ushort v13, v7, s[56:59], s80 offen
    s_mov_b32 s5, s45
    v_lshlrev_b32 v7, 7, v1
    v_mov_b32 v9, 1073741824
    v_cmp_gt_u32 vcc, 56, v1
    s_nop 1
    v_cndmask_b32 v7, v9, v7, vcc
    s_mov_b32 s4, s44
    s_mul_i32 s80, s2, 28672
    s_mul_i32 s81, s3, 7168
    s_add_u32 s80, s80, s81
    buffer_load_dword v31, v7, s[4:7], s80 offen
    v_lshlrev_b32 v7, 7, v1
    v_mov_b32 v9, 1073741824
    v_cmp_gt_u32 vcc, 4, v1
    s_nop 1
    v_cndmask_b32 v7, v9, v7, vcc
    s_lshl_b32 s80, s2, 11
    s_lshl_b32 s81, s3, 9
    s_add_u32 s80, s80, s81
    buffer_load_dword v31, v7, s[40:43], s80 offen
    s_waitcnt lgkmcnt(8)
    v_mfma_f32_32x32x16_bf16 v[176:191], v[64:67], v[212:215], v[176:191]
    ds_read_b64_tr_b16 v[208:209], v244 offset:48128
    ds_read_b64_tr_b16 v[210:211], v244 offset:48384
    s_waitcnt vmcnt(26)
    ds_write_b128 v20, v[124:127] offset:7168
    s_waitcnt lgkmcnt(9)
    v_mfma_f32_32x32x16_bf16 v[192:207], v[216:219], v[64:67], v[192:207]
    ds_read_b64_tr_b16 v[212:213], v244 offset:49152
    ds_read_b64_tr_b16 v[214:215], v244 offset:49408
    s_waitcnt lgkmcnt(9)
    v_mfma_f32_32x32x16_bf16 v[160:175], v[68:71], v[220:223], v[160:175]
    ds_read_b64_tr_b16 v[216:217], v244 offset:47104
    ds_read_b64_tr_b16 v[218:219], v244 offset:47360
    s_waitcnt vmcnt(25)
    ds_write_b128 v20, v[128:131] offset:8192
    s_waitcnt lgkmcnt(10)
    v_mfma_f32_32x32x16_bf16 v[176:191], v[68:71], v[224:227], v[176:191]
    ds_read_b64_tr_b16 v[220:221], v244 offset:51200
    ds_read_b64_tr_b16 v[222:223], v244 offset:51456
    s_waitcnt vmcnt(24)
    ds_write_b128 v20, v[132:135] offset:9216
    s_waitcnt lgkmcnt(11)
    v_mfma_f32_32x32x16_bf16 v[192:207], v[228:231], v[68:71], v[192:207]
    ds_read_b64_tr_b16 v[224:225], v244 offset:52224
    ds_read_b64_tr_b16 v[226:227], v244 offset:52480
    ds_write_b128 v20, v[96:99] offset:0
    s_waitcnt lgkmcnt(12)
    v_mfma_f32_32x32x16_bf16 v[160:175], v[72:75], v[208:211], v[160:175]
    ds_read_b64_tr_b16 v[228:229], v244 offset:50176
    ds_read_b64_tr_b16 v[230:231], v244 offset:50432
    s_waitcnt vmcnt(23)
    ds_write_b128 v20, v[136:139] offset:10240
    s_waitcnt lgkmcnt(12)
    v_mfma_f32_32x32x16_bf16 v[176:191], v[72:75], v[212:215], v[176:191]
    ds_read_b64_tr_b16 v[208:209], v244 offset:54272
    ds_read_b64_tr_b16 v[210:211], v244 offset:54528
    s_waitcnt vmcnt(22)
    ds_write_b128 v20, v[140:143] offset:11264
    s_waitcnt lgkmcnt(13)
    v_mfma_f32_32x32x16_bf16 v[192:207], v[216:219], v[72:75], v[192:207]
    ds_read_b64_tr_b16 v[212:213], v244 offset:55296
    ds_read_b64_tr_b16 v[214:215], v244 offset:55552
    ds_write_b128 v20, v[100:103] offset:1024
    s_waitcnt lgkmcnt(13)
    v_mfma_f32_32x32x16_bf16 v[160:175], v[76:79], v[220:223], v[160:175]
    ds_read_b64_tr_b16 v[216:217], v244 offset:53248
    ds_read_b64_tr_b16 v[218:219], v244 offset:53504
    s_waitcnt vmcnt(20)
    ds_write_b128 v20, v[144:147] offset:12288
    s_waitcnt lgkmcnt(13)
    v_mfma_f32_32x32x16_bf16 v[176:191], v[76:79], v[224:227], v[176:191]
    ds_read_b64_tr_b16 v[220:221], v244 offset:57344
    ds_read_b64_tr_b16 v[222:223], v244 offset:57600
    s_waitcnt vmcnt(19)
    ds_write_b128 v20, v[148:151] offset:13312
    s_waitcnt lgkmcnt(13)
    v_mfma_f32_32x32x16_bf16 v[192:207], v[228:231], v[76:79], v[192:207]
    ds_read_b64_tr_b16 v[224:225], v244 offset:58368
    ds_read_b64_tr_b16 v[226:227], v244 offset:58624
    ds_write_b128 v20, v[104:107] offset:2048
    s_waitcnt lgkmcnt(13)
    v_mfma_f32_32x32x16_bf16 v[160:175], v[80:83], v[208:211], v[160:175]
    ds_read_b64_tr_b16 v[228:229], v244 offset:56320
    ds_read_b64_tr_b16 v[230:231], v244 offset:56576
    s_waitcnt vmcnt(18)
    ds_write_b128 v20, v[152:155] offset:14336
    s_waitcnt lgkmcnt(13)
    v_mfma_f32_32x32x16_bf16 v[176:191], v[80:83], v[212:215], v[176:191]
    ds_read_b64_tr_b16 v[208:209], v244 offset:60416
    ds_read_b64_tr_b16 v[210:211], v244 offset:60672
    s_waitcnt vmcnt(17)
    ds_write_b128 v20, v[156:159] offset:15360
    s_waitcnt lgkmcnt(13)
    v_mfma_f32_32x32x16_bf16 v[192:207], v[216:219], v[80:83], v[192:207]
    ds_read_b64_tr_b16 v[212:213], v244 offset:61440
    ds_read_b64_tr_b16 v[214:215], v244 offset:61696
    ds_write_b128 v20, v[108:111] offset:3072
    s_waitcnt lgkmcnt(13)
    v_mfma_f32_32x32x16_bf16 v[160:175], v[84:87], v[220:223], v[160:175]
    ds_read_b64_tr_b16 v[216:217], v244 offset:59392
    ds_read_b64_tr_b16 v[218:219], v244 offset:59648
    s_waitcnt lgkmcnt(12)
    v_mfma_f32_32x32x16_bf16 v[176:191], v[84:87], v[224:227], v[176:191]
    ds_read_b64_tr_b16 v[220:221], v244 offset:63488
    ds_read_b64_tr_b16 v[222:223], v244 offset:63744
    s_waitcnt lgkmcnt(11)
    v_mfma_f32_32x32x16_bf16 v[192:207], v[228:231], v[84:87], v[192:207]
    ds_read_b64_tr_b16 v[224:225], v244 offset:64512
    ds_read_b64_tr_b16 v[226:227], v244 offset:64768
    ds_write_b128 v20, v[112:115] offset:4096
    s_waitcnt lgkmcnt(11)
    v_mfma_f32_32x32x16_bf16 v[160:175], v[88:91], v[208:211], v[160:175]
    ds_read_b64_tr_b16 v[228:229], v244 offset:62464
    ds_read_b64_tr_b16 v[230:231], v244 offset:62720
    s_waitcnt lgkmcnt(10)
    v_mfma_f32_32x32x16_bf16 v[176:191], v[88:91], v[212:215], v[176:191]
    s_waitcnt lgkmcnt(7)
    v_mfma_f32_32x32x16_bf16 v[192:207], v[216:219], v[88:91], v[192:207]
    ds_write_b128 v20, v[116:119] offset:5120
    s_waitcnt lgkmcnt(6)
    v_mfma_f32_32x32x16_bf16 v[160:175], v[92:95], v[220:223], v[160:175]
    s_waitcnt lgkmcnt(4)
    v_mfma_f32_32x32x16_bf16 v[176:191], v[92:95], v[224:227], v[176:191]
    s_waitcnt lgkmcnt(1)
    v_mfma_f32_32x32x16_bf16 v[192:207], v[228:231], v[92:95], v[192:207]
    ds_write_b128 v20, v[120:123] offset:6144
    v_and_b32 v7, 7, v1
    v_bfe_u32 v8, v1, 3, 2
    v_lshlrev_b32 v9, 10, v8
    v_lshl_add_u32 v9, v7, 7, v9
    s_add_u32 s80, s79, 24576
    v_add_u32 v9, s80, v9
    v_and_b32 v8, 1, v8
    v_xor_b32 v7, v7, v8
    v_xor_b32 v7, v7, v4
    v_xor_b32 v8, 0, v7
    v_lshl_add_u32 v32, v8, 4, v9
    v_xor_b32 v8, 2, v7
    v_lshl_add_u32 v33, v8, 4, v9
    v_xor_b32 v8, 4, v7
    v_lshl_add_u32 v34, v8, 4, v9
    v_xor_b32 v8, 6, v7
    v_lshl_add_u32 v35, v8, 4, v9
    v_add_u32 v40, s80, v2
    v_add_u32 v41, s95, v3
    v_add_u32 v42, 81920, v41
    v_bfe_u32 v7, v1, 4, 1
    v_and_b32 v8, 15, v1
    v_cmp_eq_u32 vcc, v7, v8
    s_nop 1
    v_cndmask_b32 v44, 0, v232, vcc
    v_cndmask_b32 v45, 0, v232, vcc
    v_cndmask_b32 v46, 0, v232, vcc
    v_cndmask_b32 v47, 0, v232, vcc
    s_waitcnt lgkmcnt(0)
    ds_read_b128 v[96:99], v32 offset:0
    ds_read_b128 v[100:103], v33 offset:0
    ds_read_b128 v[104:107], v34 offset:0
    ds_read_b128 v[108:111], v35 offset:0
    ds_read_b128 v[112:115], v32 offset:4096
    ds_read_b128 v[116:119], v33 offset:4096
    ds_read_b128 v[120:123], v34 offset:4096
    ds_read_b128 v[124:127], v35 offset:4096
    ds_read_b128 v[128:131], v32 offset:8192
    ds_read_b128 v[132:135], v33 offset:8192
    ds_read_b128 v[136:139], v34 offset:8192
    ds_read_b128 v[140:143], v35 offset:8192
    ds_read_b128 v[144:147], v32 offset:12288
    ds_read_b128 v[148:151], v33 offset:12288
    ds_read_b128 v[152:155], v34 offset:12288
    ds_read_b128 v[156:159], v35 offset:12288
    s_waitcnt vmcnt(5)
    ds_read_b64_tr_b16 v[208:209], v42 offset:0
    ds_read_b64_tr_b16 v[210:211], v42 offset:512
    ds_read_b64_tr_b16 v[212:213], v42 offset:1024
    ds_read_b64_tr_b16 v[214:215], v42 offset:1536
    ds_read_b64_tr_b16 v[216:217], v42 offset:2048
    ds_read_b64_tr_b16 v[218:219], v42 offset:2560
    ds_read_b64_tr_b16 v[220:221], v42 offset:12288
    ds_read_b64_tr_b16 v[222:223], v42 offset:12800
    ds_read_b64_tr_b16 v[224:225], v42 offset:13312
    ds_read_b64_tr_b16 v[226:227], v42 offset:13824
    s_waitcnt lgkmcnt(8)
    v_mfma_f32_16x16x32_bf16 v[236:239], v[44:47], v[208:211], v[236:239]
    ds_read_b64_tr_b16 v[228:229], v42 offset:14336
    ds_read_b64_tr_b16 v[230:231], v42 offset:14848
    s_waitcnt lgkmcnt(8)
    v_mfma_f32_16x16x32_bf16 v[246:249], v[44:47], v[212:215], v[246:249]
    ds_read_b64_tr_b16 v[208:209], v42 offset:40960
    ds_read_b64_tr_b16 v[210:211], v42 offset:41472
    s_waitcnt lgkmcnt(8)
    v_mfma_f32_16x16x32_bf16 v[250:253], v[44:47], v[216:219], v[250:253]
    ds_read_b64_tr_b16 v[212:213], v42 offset:41984
    ds_read_b64_tr_b16 v[214:215], v42 offset:42496
    s_waitcnt lgkmcnt(8)
    v_mfma_f32_16x16x32_bf16 v[236:239], v[44:47], v[220:223], v[236:239]
    ds_read_b64_tr_b16 v[216:217], v42 offset:43008
    ds_read_b64_tr_b16 v[218:219], v42 offset:43520
    s_waitcnt lgkmcnt(8)
    v_mfma_f32_16x16x32_bf16 v[246:249], v[44:47], v[224:227], v[246:249]
    ds_read_b64_tr_b16 v[220:221], v42 offset:53248
    ds_read_b64_tr_b16 v[222:223], v42 offset:53760
    s_waitcnt lgkmcnt(8)
    v_mfma_f32_16x16x32_bf16 v[250:253], v[44:47], v[228:231], v[250:253]
    ds_read_b64_tr_b16 v[224:225], v42 offset:54272
    ds_read_b64_tr_b16 v[226:227], v42 offset:54784
    s_waitcnt lgkmcnt(8)
    v_mfma_f32_16x16x32_bf16 v[236:239], v[44:47], v[208:211], v[236:239]
    ds_read_b64_tr_b16 v[228:229], v42 offset:55296
    ds_read_b64_tr_b16 v[230:231], v42 offset:55808
    s_waitcnt lgkmcnt(8)
    v_mfma_f32_16x16x32_bf16 v[246:249], v[44:47], v[212:215], v[246:249]
    s_waitcnt lgkmcnt(6)
    v_mfma_f32_16x16x32_bf16 v[250:253], v[44:47], v[216:219], v[250:253]
    s_waitcnt lgkmcnt(4)
    v_mfma_f32_16x16x32_bf16 v[236:239], v[44:47], v[220:223], v[236:239]
    s_waitcnt lgkmcnt(2)
    v_mfma_f32_16x16x32_bf16 v[246:249], v[44:47], v[224:227], v[246:249]
    s_waitcnt lgkmcnt(0)
    v_mfma_f32_16x16x32_bf16 v[250:253], v[44:47], v[228:231], v[250:253]
    v_dot2c_f32_bf16 v240, v96, v232
    v_dot2c_f32_bf16 v242, v96, v96
    v_dot2c_f32_bf16 v241, v97, v232
    v_dot2c_f32_bf16 v243, v97, v97
    v_dot2c_f32_bf16 v240, v98, v232
    v_dot2c_f32_bf16 v242, v98, v98
    v_dot2c_f32_bf16 v241, v99, v232
    v_dot2c_f32_bf16 v243, v99, v99
    v_dot2c_f32_bf16 v240, v100, v232
    v_dot2c_f32_bf16 v242, v100, v100
    v_dot2c_f32_bf16 v241, v101, v232
    v_dot2c_f32_bf16 v243, v101, v101
    v_dot2c_f32_bf16 v240, v102, v232
    v_dot2c_f32_bf16 v242, v102, v102
    v_dot2c_f32_bf16 v241, v103, v232
    v_dot2c_f32_bf16 v243, v103, v103
    v_dot2c_f32_bf16 v240, v104, v232
    v_dot2c_f32_bf16 v242, v104, v104
    v_dot2c_f32_bf16 v241, v105, v232
    v_dot2c_f32_bf16 v243, v105, v105
    v_dot2c_f32_bf16 v240, v106, v232
    v_dot2c_f32_bf16 v242, v106, v106
    v_dot2c_f32_bf16 v241, v107, v232
    v_dot2c_f32_bf16 v243, v107, v107
    v_dot2c_f32_bf16 v240, v108, v232
    v_dot2c_f32_bf16 v242, v108, v108
    v_dot2c_f32_bf16 v241, v109, v232
    v_dot2c_f32_bf16 v243, v109, v109
    v_dot2c_f32_bf16 v240, v110, v232
    v_dot2c_f32_bf16 v242, v110, v110
    v_dot2c_f32_bf16 v241, v111, v232
    v_dot2c_f32_bf16 v243, v111, v111
    v_dot2c_f32_bf16 v240, v112, v232
    v_dot2c_f32_bf16 v242, v112, v112
    v_dot2c_f32_bf16 v241, v113, v232
    v_dot2c_f32_bf16 v243, v113, v113
    v_dot2c_f32_bf16 v240, v114, v232
    v_dot2c_f32_bf16 v242, v114, v114
    v_dot2c_f32_bf16 v241, v115, v232
    v_dot2c_f32_bf16 v243, v115, v115
    v_dot2c_f32_bf16 v240, v116, v232
    v_dot2c_f32_bf16 v242, v116, v116
    v_dot2c_f32_bf16 v241, v117, v232
    v_dot2c_f32_bf16 v243, v117, v117
    v_dot2c_f32_bf16 v240, v118, v232
    v_dot2c_f32_bf16 v242, v118, v118
    v_dot2c_f32_bf16 v241, v119, v232
    v_dot2c_f32_bf16 v243, v119, v119
    v_dot2c_f32_bf16 v240, v120, v232
    v_dot2c_f32_bf16 v242, v120, v120
    v_dot2c_f32_bf16 v241, v121, v232
    v_dot2c_f32_bf16 v243, v121, v121
    v_dot2c_f32_bf16 v240, v122, v232
    v_dot2c_f32_bf16 v242, v122, v122
    v_dot2c_f32_bf16 v241, v123, v232
    v_dot2c_f32_bf16 v243, v123, v123
    v_dot2c_f32_bf16 v240, v124, v232
    v_dot2c_f32_bf16 v242, v124, v124
    v_dot2c_f32_bf16 v241, v125, v232
    v_dot2c_f32_bf16 v243, v125, v125
    v_dot2c_f32_bf16 v240, v126, v232
    v_dot2c_f32_bf16 v242, v126, v126
    v_dot2c_f32_bf16 v241, v127, v232
    v_dot2c_f32_bf16 v243, v127, v127
    v_dot2c_f32_bf16 v240, v128, v232
    v_dot2c_f32_bf16 v242, v128, v128
    v_dot2c_f32_bf16 v241, v129, v232
    v_dot2c_f32_bf16 v243, v129, v129
    v_dot2c_f32_bf16 v240, v130, v232
    v_dot2c_f32_bf16 v242, v130, v130
    v_dot2c_f32_bf16 v241, v131, v232
    v_dot2c_f32_bf16 v243, v131, v131
    v_dot2c_f32_bf16 v240, v132, v232
    v_dot2c_f32_bf16 v242, v132, v132
    v_dot2c_f32_bf16 v241, v133, v232
    v_dot2c_f32_bf16 v243, v133, v133
    v_dot2c_f32_bf16 v240, v134, v232
    v_dot2c_f32_bf16 v242, v134, v134
    v_dot2c_f32_bf16 v241, v135, v232
    v_dot2c_f32_bf16 v243, v135, v135
    v_dot2c_f32_bf16 v240, v136, v232
    v_dot2c_f32_bf16 v242, v136, v136
    v_dot2c_f32_bf16 v241, v137, v232
    v_dot2c_f32_bf16 v243, v137, v137
    v_dot2c_f32_bf16 v240, v138, v232
    v_dot2c_f32_bf16 v242, v138, v138
    v_dot2c_f32_bf16 v241, v139, v232
    v_dot2c_f32_bf16 v243, v139, v139
    v_dot2c_f32_bf16 v240, v140, v232
    v_dot2c_f32_bf16 v242, v140, v140
    v_dot2c_f32_bf16 v241, v141, v232
    v_dot2c_f32_bf16 v243, v141, v141
    v_dot2c_f32_bf16 v240, v142, v232
    v_dot2c_f32_bf16 v242, v142, v142
    v_dot2c_f32_bf16 v241, v143, v232
    v_dot2c_f32_bf16 v243, v143, v143
    v_dot2c_f32_bf16 v240, v144, v232
    v_dot2c_f32_bf16 v242, v144, v144
    v_dot2c_f32_bf16 v241, v145, v232
    v_dot2c_f32_bf16 v243, v145, v145
    v_dot2c_f32_bf16 v240, v146, v232
    v_dot2c_f32_bf16 v242, v146, v146
    v_dot2c_f32_bf16 v241, v147, v232
    v_dot2c_f32_bf16 v243, v147, v147
    v_dot2c_f32_bf16 v240, v148, v232
    v_dot2c_f32_bf16 v242, v148, v148
    v_dot2c_f32_bf16 v241, v149, v232
    v_dot2c_f32_bf16 v243, v149, v149
    v_dot2c_f32_bf16 v240, v150, v232
    v_dot2c_f32_bf16 v242, v150, v150
    v_dot2c_f32_bf16 v241, v151, v232
    v_dot2c_f32_bf16 v243, v151, v151
    v_dot2c_f32_bf16 v240, v152, v232
    v_dot2c_f32_bf16 v242, v152, v152
    v_dot2c_f32_bf16 v241, v153, v232
    v_dot2c_f32_bf16 v243, v153, v153
    v_dot2c_f32_bf16 v240, v154, v232
    v_dot2c_f32_bf16 v242, v154, v154
    v_dot2c_f32_bf16 v241, v155, v232
    v_dot2c_f32_bf16 v243, v155, v155
    v_dot2c_f32_bf16 v240, v156, v232
    v_dot2c_f32_bf16 v242, v156, v156
    v_dot2c_f32_bf16 v241, v157, v232
    v_dot2c_f32_bf16 v243, v157, v157
    v_dot2c_f32_bf16 v240, v158, v232
    v_dot2c_f32_bf16 v242, v158, v158
    v_dot2c_f32_bf16 v241, v159, v232
    v_dot2c_f32_bf16 v243, v159, v159
    s_nop 1
    v_add_f32 v240, v240, v241
    v_add_f32 v241, v242, v243
    v_mov_b32 v7, v240
    s_nop 1
    v_permlane32_swap_b32 v240, v7
    v_add_f32 v240, v240, v7
    v_mov_b32 v8, v241
    s_nop 1
    v_permlane32_swap_b32 v241, v8
    v_add_f32 v241, v241, v8
    v_lshlrev_b32 v7, 2, v1
    v_add_u32 v8, s79, v7
    v_add_u32 v9, 32768, v8
    s_mov_b64 exec, 0xffff
    ds_write2_b32 v9, v236, v237 offset0:0 offset1:16
    ds_write2_b32 v9, v246, v247 offset0:32 offset1:48
    ds_write2_b32 v9, v250, v251 offset0:64 offset1:80
    s_mov_b64 exec, -1
    v_and_b32 v7, 31, v1
    v_lshlrev_b32 v7, 2, v7
    v_add_u32 v8, 114688, v7
    v_add_u32 v7, 32768, v7
    s_waitcnt lgkmcnt(0)
    s_barrier
    ds_read_b32 v48, v7 offset:0
    ds_read_b32 v52, v7 offset:128
    ds_read_b32 v56, v7 offset:256
    ds_read_b32 v49, v7 offset:40960
    ds_read_b32 v53, v7 offset:41088
    ds_read_b32 v57, v7 offset:41216
    ds_read_b32 v50, v8 offset:0
    ds_read_b32 v54, v8 offset:128
    ds_read_b32 v58, v8 offset:256
    ds_read_b32 v51, v8 offset:40960
    ds_read_b32 v55, v8 offset:41088
    ds_read_b32 v59, v8 offset:41216
    ds_read_b64_tr_b16 v[208:209], v245 offset:1024
    ds_read_b64_tr_b16 v[210:211], v245 offset:1280
    ds_read_b64_tr_b16 v[212:213], v245 offset:2048
    ds_read_b64_tr_b16 v[214:215], v245 offset:2304
    ds_read_b64_tr_b16 v[216:217], v245 offset:4096
    ds_read_b64_tr_b16 v[218:219], v245 offset:4352
    ds_read_b64_tr_b16 v[220:221], v245 offset:5120
    ds_read_b64_tr_b16 v[222:223], v245 offset:5376
    ds_read_b64_tr_b16 v[224:225], v245 offset:7168
    ds_read_b64_tr_b16 v[226:227], v245 offset:7424
    s_waitcnt lgkmcnt(8)
    v_mfma_f32_32x32x16_bf16 v[160:175], v[96:99], v[208:211], v[160:175]
    ds_read_b64_tr_b16 v[228:229], v245 offset:8192
    ds_read_b64_tr_b16 v[230:231], v245 offset:8448
    v_and_b32 v18, 7, v1
    v_lshlrev_b32 v18, 5, v18
    s_mov_b32 s97, 0
    buffer_load_dword v254, v18, s[64:67], s97 offen sc1
    s_mul_i32 s80, s2, 112
    s_mul_i32 s81, s3, 28
    s_add_u32 s80, s80, s81
    v_add_u32 v7, s80, v1
    v_lshrrev_b32 v8, 5, v7
    v_and_b32 v7, 31, v7
    v_mul_u32_u24 v9, 9363, v8
    v_lshrrev_b32 v9, 21, v9
    v_mul_u32_u24 v9, 224, v9
    v_sub_u32 v8, v8, v9
    v_lshl_add_u32 v9, v9, 1, v8
    v_cmp_gt_u32 vcc, 128, v8
    s_nop 1
    v_cndmask_b32 v8, 64, 0, vcc
    v_lshl_add_u32 v9, v8, 1, v9
    v_lshlrev_b32 v9, 12, v9
    v_lshl_add_u32 v7, v7, 7, v9
    s_mov_b64 exec, 0xfffffff
    buffer_load_dword v31, v7, s[52:55], 0 offen
    s_mov_b64 exec, -1
    v_add_f32 v48, v48, v49
    s_waitcnt lgkmcnt(8)
    v_mfma_f32_32x32x16_bf16 v[176:191], v[96:99], v[212:215], v[176:191]
    ds_read_b64_tr_b16 v[208:209], v245 offset:10240
    ds_read_b64_tr_b16 v[210:211], v245 offset:10496
    s_lshr_b32 s82, s91, 2
    s_and_b32 s83, s82, 7
    s_mul_i32 s80, s83, 3072
    s_add_u32 s80, s80, s79
    v_add_u32 v79, s80, v2
    ds_read_b128 v[80:83], v79 offset:0
    ds_read_b128 v[84:87], v79 offset:1024
    ds_read_b128 v[88:91], v79 offset:2048
    v_add_f32 v50, v50, v51
    v_add_f32 v10, v48, v50
    s_waitcnt lgkmcnt(11)
    v_mfma_f32_32x32x16_bf16 v[160:175], v[100:103], v[216:219], v[160:175]
    ds_read_b64_tr_b16 v[212:213], v245 offset:11264
    ds_read_b64_tr_b16 v[214:215], v245 offset:11520
    v_add_f32 v52, v52, v53
    v_add_f32 v54, v54, v55
    v_add_f32 v11, v52, v54
    v_add_f32 v56, v56, v57
    s_waitcnt lgkmcnt(11)
    v_mfma_f32_32x32x16_bf16 v[176:191], v[100:103], v[220:223], v[176:191]
    ds_read_b64_tr_b16 v[216:217], v245 offset:13312
    ds_read_b64_tr_b16 v[218:219], v245 offset:13568
    s_lshr_b32 s82, s91, 2
    s_mul_i32 s80, s90, 98304
    s_mul_i32 s81, s3, 24576
    s_add_u32 s80, s80, s81
    s_mul_i32 s81, s82, 3072
    s_add_u32 s80, s80, s81
    s_add_u32 s80, s80, 18874368
    s_cmp_lt_u32 s82, 8
    s_cselect_b32 s80, s80, 1073741824
    s_waitcnt lgkmcnt(4)
    buffer_store_dwordx4 v[80:83], v2, s[68:71], s80 offen offset:0 sc1
    buffer_store_dwordx4 v[84:87], v2, s[68:71], s80 offen offset:1024 sc1
    buffer_store_dwordx4 v[88:91], v2, s[68:71], s80 offen offset:2048 sc1
    v_add_f32 v58, v58, v59
    v_add_f32 v12, v56, v58
    v_mfma_f32_32x32x16_bf16 v[160:175], v[104:107], v[224:227], v[160:175]
    ds_read_b64_tr_b16 v[220:221], v245 offset:14336
    ds_read_b64_tr_b16 v[222:223], v245 offset:14592
    v_mul_f32 v240, 0xbb000000, v240
    v_mul_f32 v242, 0x3b000000, v241
    v_fma_f32 v242, -v240, v240, v242
    v_max_f32 v242, 0, v242
    v_mfma_f32_32x32x16_bf16 v[176:191], v[104:107], v[228:231], v[176:191]
    ds_read_b64_tr_b16 v[224:225], v245 offset:16384
    ds_read_b64_tr_b16 v[226:227], v245 offset:16640
    v_add_f32 v242, 0x3727c5ac, v242
    v_rsq_f32 v242, v242
    v_mfma_f32_32x32x16_bf16 v[160:175], v[108:111], v[208:211], v[160:175]
    ds_read_b64_tr_b16 v[228:229], v245 offset:17408
    ds_read_b64_tr_b16 v[230:231], v245 offset:17664
    v_and_b32 v246, 31, v1
    v_lshlrev_b32 v246, 2, v246
    v_add_u32 v246, s79, v246
    v_mul_f32 v243, 0x3fb8aa3b, v242
    s_waitcnt lgkmcnt(8)
    v_mfma_f32_32x32x16_bf16 v[176:191], v[108:111], v[212:215], v[176:191]
    ds_read_b64_tr_b16 v[208:209], v245 offset:19456
    ds_read_b64_tr_b16 v[210:211], v245 offset:19712
    ds_write_b32 v246, v243 offset:33920
    v_cvt_pk_bf16_f32 v8, v240, v240
    s_waitcnt lgkmcnt(9)
    v_mfma_f32_32x32x16_bf16 v[160:175], v[112:115], v[216:219], v[160:175]
    ds_read_b64_tr_b16 v[212:213], v245 offset:20480
    ds_read_b64_tr_b16 v[214:215], v245 offset:20736
    v_and_b32 v9, 0xffff0000, v8
    v_sub_f32 v9, v240, v9
    v_cvt_pk_bf16_f32 v9, v240, v9
    v_and_b32 v8, 0xffff, v8
    s_waitcnt lgkmcnt(9)
    v_mfma_f32_32x32x16_bf16 v[176:191], v[112:115], v[220:223], v[176:191]
    ds_read_b64_tr_b16 v[216:217], v245 offset:22528
    ds_read_b64_tr_b16 v[218:219], v245 offset:22784
    v_cndmask_b32 v236, 0, v9, s[86:87]
    v_cndmask_b32 v237, 0, v8, s[86:87]
    s_waitcnt lgkmcnt(9)
    v_mfma_f32_32x32x16_bf16 v[160:175], v[116:119], v[224:227], v[160:175]
    ds_read_b64_tr_b16 v[220:221], v245 offset:23552
    ds_read_b64_tr_b16 v[222:223], v245 offset:23808
    v_mov_b32 v238, 0
    v_mov_b32 v239, 0
    v_lshlrev_b32 v8, 4, v4
    v_add_u32 v8, s79, v8
    s_waitcnt lgkmcnt(9)
    v_mfma_f32_32x32x16_bf16 v[176:191], v[116:119], v[228:231], v[176:191]
    ds_read_b64_tr_b16 v[224:225], v245 offset:41984
    ds_read_b64_tr_b16 v[226:227], v245 offset:42240
    s_lshl_b32 s80, s90, 10
    s_add_u32 s80, s80, 20447232
    s_and_b32 s82, s91, 63
    s_cmp_eq_u32 s82, 0
    s_cselect_b32 s80, s80, 1073741824
    buffer_store_dwordx3 v[10:12], v2, s[68:71], s80 offen sc1
    s_waitcnt lgkmcnt(8)
    ds_read_b128 v[48:51], v8 offset:33920
    v_mfma_f32_32x32x16_bf16 v[160:175], v[120:123], v[208:211], v[160:175]
    ds_read_b64_tr_b16 v[228:229], v245 offset:43008
    ds_read_b64_tr_b16 v[230:231], v245 offset:43264
    ds_read_b128 v[52:55], v8 offset:33952
    ds_read_b128 v[56:59], v8 offset:33984
    ds_read_b128 v[60:63], v8 offset:34016
    v_mov_b32 v246, 0x358637bd
    s_waitcnt lgkmcnt(12)
    v_mfma_f32_32x32x16_bf16 v[176:191], v[120:123], v[212:215], v[176:191]
    ds_read_b64_tr_b16 v[208:209], v245 offset:45056
    ds_read_b64_tr_b16 v[210:211], v245 offset:45312
    v_mov_b32 v247, 0x3f317218
    v_lshlrev_b32 v248, 3, v1
    s_waitcnt lgkmcnt(12)
    v_mfma_f32_32x32x16_bf16 v[160:175], v[124:127], v[216:219], v[160:175]
    ds_read_b64_tr_b16 v[212:213], v245 offset:46080
    ds_read_b64_tr_b16 v[214:215], v245 offset:46336
    v_add_u32 v249, s79, v248
    v_lshlrev_b32 v250, 2, v1
    v_add_u32 v251, s79, v250
    s_lshl_b32 s80, s3, 9
    s_add_u32 s80, s80, 34816
    v_add_u32 v252, s80, v248
    s_waitcnt lgkmcnt(12)
    v_mfma_f32_32x32x16_bf16 v[176:191], v[124:127], v[220:223], v[176:191]
    ds_read_b64_tr_b16 v[216:217], v245 offset:48128
    ds_read_b64_tr_b16 v[218:219], v245 offset:48384
    v_add_u32 v248, 81920, v252
    v_add_u32 v253, 34048, v250
    s_waitcnt lgkmcnt(12)
    v_mfma_f32_32x32x16_bf16 v[160:175], v[128:131], v[224:227], v[160:175]
    ds_read_b64_tr_b16 v[220:221], v245 offset:49152
    ds_read_b64_tr_b16 v[222:223], v245 offset:49408
    v_add_u32 v9, 81920, v253
    s_mul_i32 s93, s90, 2304
    s_add_u32 s93, s93, 14680064
    s_lshl_b32 s92, s3, 9
    s_add_u32 s92, s92, s93
    s_add_u32 s93, s93, 2048
    s_waitcnt lgkmcnt(11)
    v_mfma_f32_32x32x16_bf16 v[176:191], v[128:131], v[228:231], v[176:191]
    ds_read_b64_tr_b16 v[224:225], v245 offset:51200
    ds_read_b64_tr_b16 v[226:227], v245 offset:51456
    s_cmp_eq_u32 s3, 0
    s_cselect_b32 s93, s93, 1073741824
    v_cvt_pk_bf16_f32 v64, v10, v10
    s_waitcnt lgkmcnt(8)
    v_mfma_f32_32x32x16_bf16 v[160:175], v[132:135], v[208:211], v[160:175]
    ds_read_b64_tr_b16 v[228:229], v245 offset:52224
    ds_read_b64_tr_b16 v[230:231], v245 offset:52480
    v_and_b32 v65, 0xffff0000, v64
    v_sub_f32 v65, v10, v65
    v_cvt_pk_bf16_f32 v65, v65, 0
    v_cvt_pk_bf16_f32 v66, v11, v11
    s_waitcnt lgkmcnt(8)
    v_mfma_f32_32x32x16_bf16 v[176:191], v[132:135], v[212:215], v[176:191]
    ds_read_b64_tr_b16 v[208:209], v245 offset:54272
    ds_read_b64_tr_b16 v[210:211], v245 offset:54528
    v_and_b32 v67, 0xffff0000, v66
    v_sub_f32 v67, v11, v67
    s_waitcnt lgkmcnt(8)
    v_mfma_f32_32x32x16_bf16 v[160:175], v[136:139], v[216:219], v[160:175]
    ds_read_b64_tr_b16 v[212:213], v245 offset:55296
    ds_read_b64_tr_b16 v[214:215], v245 offset:55552
    v_cvt_pk_bf16_f32 v67, v67, 0
    v_cvt_pk_bf16_f32 v68, v12, v12
    v_and_b32 v69, 0xffff0000, v68
    v_sub_f32 v69, v12, v69
    s_waitcnt lgkmcnt(8)
    v_mfma_f32_32x32x16_bf16 v[176:191], v[136:139], v[220:223], v[176:191]
    ds_read_b64_tr_b16 v[216:217], v245 offset:57344
    ds_read_b64_tr_b16 v[218:219], v245 offset:57600
    v_cvt_pk_bf16_f32 v69, v69, 0
    v_mov_b32 v70, 0
    s_waitcnt lgkmcnt(8)
    v_mfma_f32_32x32x16_bf16 v[160:175], v[140:143], v[224:227], v[160:175]
    ds_read_b64_tr_b16 v[220:221], v245 offset:58368
    ds_read_b64_tr_b16 v[222:223], v245 offset:58624
    v_mov_b32 v71, 0
    s_waitcnt lgkmcnt(8)
    v_mfma_f32_32x32x16_bf16 v[176:191], v[140:143], v[228:231], v[176:191]
    ds_read_b64_tr_b16 v[224:225], v245 offset:60416
    ds_read_b64_tr_b16 v[226:227], v245 offset:60672
    s_waitcnt lgkmcnt(8)
    v_mfma_f32_32x32x16_bf16 v[160:175], v[144:147], v[208:211], v[160:175]
    ds_read_b64_tr_b16 v[228:229], v245 offset:61440
    ds_read_b64_tr_b16 v[230:231], v245 offset:61696
    s_waitcnt lgkmcnt(8)
    v_mfma_f32_32x32x16_bf16 v[176:191], v[144:147], v[212:215], v[176:191]
    ds_read_b64_tr_b16 v[208:209], v245 offset:63488
    ds_read_b64_tr_b16 v[210:211], v245 offset:63744
    s_waitcnt lgkmcnt(8)
    v_mfma_f32_32x32x16_bf16 v[160:175], v[148:151], v[216:219], v[160:175]
    ds_read_b64_tr_b16 v[212:213], v245 offset:64512
    ds_read_b64_tr_b16 v[214:215], v245 offset:64768
    s_waitcnt lgkmcnt(8)
    v_mfma_f32_32x32x16_bf16 v[176:191], v[148:151], v[220:223], v[176:191]
    s_waitcnt lgkmcnt(6)
    v_mfma_f32_32x32x16_bf16 v[160:175], v[152:155], v[224:227], v[160:175]
    s_waitcnt lgkmcnt(4)
    v_mfma_f32_32x32x16_bf16 v[176:191], v[152:155], v[228:231], v[176:191]
    s_waitcnt lgkmcnt(2)
    v_mfma_f32_32x32x16_bf16 v[160:175], v[156:159], v[208:211], v[160:175]
    s_waitcnt lgkmcnt(0)
    v_mfma_f32_32x32x16_bf16 v[176:191], v[156:159], v[212:215], v[176:191]
    v_mfma_f32_32x32x16_bf16 v[160:175], v[236:239], v[66:69], v[160:175]
    v_mfma_f32_32x32x16_bf16 v[176:191], v[236:239], v[68:71], v[176:191]
    v_mfma_f32_32x32x16_bf16 v[192:207], v[64:67], v[236:239], v[192:207]
    s_waitcnt lgkmcnt(0)
    s_nop 8
    v_pk_mul_f32 v[160:161], v[160:161], v[48:49]
    v_pk_mul_f32 v[162:163], v[162:163], v[50:51]
    v_pk_mul_f32 v[164:165], v[164:165], v[52:53]
    v_pk_mul_f32 v[166:167], v[166:167], v[54:55]
    v_pk_mul_f32 v[168:169], v[168:169], v[56:57]
    v_pk_mul_f32 v[170:171], v[170:171], v[58:59]
    v_pk_mul_f32 v[172:173], v[172:173], v[60:61]
    v_pk_mul_f32 v[174:175], v[174:175], v[62:63]
    v_exp_f32_e64 v32, v160 clamp
    v_pk_mul_f32 v[176:177], v[176:177], v[48:49]
    v_max_f32 v160, 0, v160
    v_exp_f32_e64 v33, v161 clamp
    v_max_f32 v161, 0, v161
    v_exp_f32_e64 v34, v162 clamp
    v_pk_mul_f32 v[178:179], v[178:179], v[50:51]
    v_max_f32 v162, 0, v162
    v_exp_f32_e64 v35, v163 clamp
    v_max_f32 v163, 0, v163
    v_exp_f32_e64 v36, v164 clamp
    v_pk_mul_f32 v[180:181], v[180:181], v[52:53]
    v_max_f32 v164, 0, v164
    v_exp_f32_e64 v37, v165 clamp
    v_max_f32 v165, 0, v165
    v_exp_f32_e64 v38, v166 clamp
    v_pk_mul_f32 v[182:183], v[182:183], v[54:55]
    v_max_f32 v166, 0, v166
    v_exp_f32_e64 v39, v167 clamp
    v_max_f32 v167, 0, v167
    v_exp_f32_e64 v40, v168 clamp
    v_pk_mul_f32 v[184:185], v[184:185], v[56:57]
    v_max_f32 v168, 0, v168
    v_exp_f32_e64 v41, v169 clamp
    v_max_f32 v169, 0, v169
    v_exp_f32_e64 v42, v170 clamp
    v_pk_mul_f32 v[186:187], v[186:187], v[58:59]
    v_max_f32 v170, 0, v170
    v_exp_f32_e64 v43, v171 clamp
    v_max_f32 v171, 0, v171
    v_exp_f32_e64 v44, v172 clamp
    v_pk_mul_f32 v[188:189], v[188:189], v[60:61]
    v_max_f32 v172, 0, v172
    v_exp_f32_e64 v45, v173 clamp
    v_max_f32 v173, 0, v173
    v_exp_f32_e64 v46, v174 clamp
    v_pk_mul_f32 v[190:191], v[190:191], v[62:63]
    v_max_f32 v174, 0, v174
    v_exp_f32_e64 v47, v175 clamp
    v_max_f32 v175, 0, v175
    v_pk_add_f32 v[32:33], v[32:33], v[246:247] op_sel:[0,0] op_sel_hi:[1,0]
    v_pk_add_f32 v[34:35], v[34:35], v[246:247] op_sel:[0,0] op_sel_hi:[1,0]
    v_pk_add_f32 v[36:37], v[36:37], v[246:247] op_sel:[0,0] op_sel_hi:[1,0]
    v_pk_add_f32 v[38:39], v[38:39], v[246:247] op_sel:[0,0] op_sel_hi:[1,0]
    v_pk_add_f32 v[40:41], v[40:41], v[246:247] op_sel:[0,0] op_sel_hi:[1,0]
    v_pk_add_f32 v[42:43], v[42:43], v[246:247] op_sel:[0,0] op_sel_hi:[1,0]
    v_pk_add_f32 v[44:45], v[44:45], v[246:247] op_sel:[0,0] op_sel_hi:[1,0]
    v_pk_add_f32 v[46:47], v[46:47], v[246:247] op_sel:[0,0] op_sel_hi:[1,0]
    v_cvt_pk_bf16_f32 v88, v176, v177
    v_cvt_pk_bf16_f32 v89, v178, v179
    v_cvt_pk_bf16_f32 v90, v180, v181
    v_cvt_pk_bf16_f32 v91, v182, v183
    v_cvt_pk_bf16_f32 v92, v184, v185
    v_cvt_pk_bf16_f32 v93, v186, v187
    v_cvt_pk_bf16_f32 v94, v188, v189
    v_cvt_pk_bf16_f32 v95, v190, v191
    v_pk_fma_f32 v[160:161], v[160:161], v[246:247], v[32:33] op_sel:[0,1,0] op_sel_hi:[1,1,1]
    v_pk_fma_f32 v[162:163], v[162:163], v[246:247], v[34:35] op_sel:[0,1,0] op_sel_hi:[1,1,1]
    v_pk_fma_f32 v[164:165], v[164:165], v[246:247], v[36:37] op_sel:[0,1,0] op_sel_hi:[1,1,1]
    v_pk_fma_f32 v[166:167], v[166:167], v[246:247], v[38:39] op_sel:[0,1,0] op_sel_hi:[1,1,1]
    v_pk_fma_f32 v[168:169], v[168:169], v[246:247], v[40:41] op_sel:[0,1,0] op_sel_hi:[1,1,1]
    v_pk_fma_f32 v[170:171], v[170:171], v[246:247], v[42:43] op_sel:[0,1,0] op_sel_hi:[1,1,1]
    v_pk_fma_f32 v[172:173], v[172:173], v[246:247], v[44:45] op_sel:[0,1,0] op_sel_hi:[1,1,1]
    v_pk_fma_f32 v[174:175], v[174:175], v[246:247], v[46:47] op_sel:[0,1,0] op_sel_hi:[1,1,1]
    v_cvt_pk_bf16_f32 v80, v160, v161
    v_cvt_pk_bf16_f32 v81, v162, v163
    v_cvt_pk_bf16_f32 v82, v164, v165
    v_cvt_pk_bf16_f32 v83, v166, v167
    v_cvt_pk_bf16_f32 v84, v168, v169
    v_cvt_pk_bf16_f32 v85, v170, v171
    v_cvt_pk_bf16_f32 v86, v172, v173
    v_cvt_pk_bf16_f32 v87, v174, v175
    v_mfma_f32_32x32x16_bf16 v[160:175], v[80:83], v[88:91], 0
    s_nop 0
    v_mfma_f32_32x32x16_bf16 v[160:175], v[84:87], v[92:95], v[160:175]
    v_mfma_f32_32x32x16_bf16 v[176:191], v[232:235], v[80:83], 0
    v_mfma_f32_32x32x16_bf16 v[176:191], v[232:235], v[84:87], v[176:191]
    ds_read_b64_tr_b16 v[208:209], v245 offset:0
    ds_read_b64_tr_b16 v[210:211], v245 offset:256
    ds_read_b64_tr_b16 v[212:213], v245 offset:3072
    ds_read_b64_tr_b16 v[214:215], v245 offset:3328
    ds_read_b64_tr_b16 v[216:217], v245 offset:6144
    ds_read_b64_tr_b16 v[218:219], v245 offset:6400
    ds_read_b64_tr_b16 v[220:221], v245 offset:9216
    ds_read_b64_tr_b16 v[222:223], v245 offset:9472
    ds_read_b64_tr_b16 v[224:225], v245 offset:12288
    ds_read_b64_tr_b16 v[226:227], v245 offset:12544
    s_waitcnt lgkmcnt(8)
    v_mfma_f32_32x32x16_bf16 v[192:207], v[208:211], v[96:99], v[192:207]
    ds_read_b64_tr_b16 v[228:229], v245 offset:15360
    ds_read_b64_tr_b16 v[230:231], v245 offset:15616
    s_waitcnt lgkmcnt(8)
    v_mfma_f32_32x32x16_bf16 v[192:207], v[212:215], v[100:103], v[192:207]
    ds_read_b64_tr_b16 v[208:209], v245 offset:18432
    ds_read_b64_tr_b16 v[210:211], v245 offset:18688
    v_cndmask_b32 v48, v160, v168, s[88:89]
    v_cndmask_b32 v49, v161, v169, s[88:89]
    ds_write_b64 v249, v[48:49] offset:34816
    v_cndmask_b32 v50, v162, v170, s[88:89]
    v_cndmask_b32 v51, v163, v171, s[88:89]
    ds_write_b64 v249, v[50:51] offset:35328
    v_cndmask_b32 v52, v164, v172, s[88:89]
    v_cndmask_b32 v53, v165, v173, s[88:89]
    ds_write_b64 v249, v[52:53] offset:35840
    v_cndmask_b32 v54, v166, v174, s[88:89]
    v_cndmask_b32 v55, v167, v175, s[88:89]
    ds_write_b64 v249, v[54:55] offset:36352
    ds_write_b32 v251, v176 offset:34048
    s_waitcnt lgkmcnt(13)
    v_mfma_f32_32x32x16_bf16 v[192:207], v[216:219], v[104:107], v[192:207]
    ds_read_b64_tr_b16 v[212:213], v245 offset:21504
    ds_read_b64_tr_b16 v[214:215], v245 offset:21760
    s_waitcnt lgkmcnt(2)
    s_barrier
    ds_read_b64 v[160:161], v252 offset:0
    ds_read_b64 v[162:163], v252 offset:40960
    ds_read_b64 v[164:165], v248 offset:0
    ds_read_b64 v[166:167], v248 offset:40960
    ds_read_b32 v168, v253 offset:0
    ds_read_b32 v169, v253 offset:40960
    ds_read_b32 v170, v9 offset:0
    ds_read_b32 v171, v9 offset:40960
    v_mfma_f32_32x32x16_bf16 v[192:207], v[220:223], v[108:111], v[192:207]
    ds_read_b64_tr_b16 v[216:217], v245 offset:40960
    ds_read_b64_tr_b16 v[218:219], v245 offset:41216
    v_mfma_f32_32x32x16_bf16 v[192:207], v[224:227], v[112:115], v[192:207]
    ds_read_b64_tr_b16 v[220:221], v245 offset:44032
    ds_read_b64_tr_b16 v[222:223], v245 offset:44288
    s_waitcnt lgkmcnt(4)
    v_add_f32 v160, v160, v162
    v_add_f32 v164, v164, v166
    v_add_f32 v168, v168, v170
    v_add_f32 v161, v161, v163
    v_add_f32 v165, v165, v167
    v_add_f32 v169, v169, v171
    v_add_f32 v160, v160, v164
    v_add_f32 v161, v161, v165
    v_add_f32 v168, v168, v169
    v_mul_f32 v160, v160, v247
    v_mul_f32 v161, v161, v247
    v_mov_b32 v8, 32
    s_waitcnt vmcnt(5)
    v_cmp_lt_u32_sdwa vcc, v254, v8 src0_sel:BYTE_0 src1_sel:DWORD
    s_nop 1
    s_cbranch_vccz L_rdy_1
    s_mov_b32 s96, 0
L_spin_2:
    s_mov_b64 exec, vcc
    buffer_load_dword v254, v18, s[64:67], s97 offen sc1
    s_add_u32 s96, s96, 1
    s_waitcnt vmcnt(0)
    v_cmp_lt_u32_sdwa vcc, v254, v8 src0_sel:BYTE_0 src1_sel:DWORD
    s_nop 1
    s_cbranch_vccz L_out_3
    s_cmp_lt_u32 s96, 50000
    s_cbranch_scc1 L_spin_2
L_out_3:
    s_mov_b64 exec, -1
L_rdy_1:
    s_and_b32 s80, s2, 7
    v_readlane_b32 s80, v254, s80
    s_lshl_b32 s31, s31, 5
    s_cmp_eq_u32 s80, s31
    s_cselect_b32 s30, 1, 0
    buffer_atomic_add_f32 v160, v250, s[68:71], s92 offen
    buffer_atomic_add_f32 v161, v250, s[68:71], s92 offen offset:256
    s_mov_b64 exec, s[86:87]
    buffer_atomic_add_f32 v168, v250, s[68:71], s93 offen
    s_mov_b64 exec, -1
    v_mfma_f32_32x32x16_bf16 v[192:207], v[228:231], v[116:119], v[192:207]
    ds_read_b64_tr_b16 v[224:225], v245 offset:47104
    ds_read_b64_tr_b16 v[226:227], v245 offset:47360
    s_add_u32 m0, s79, 24576
    s_add_u32 s83, s98, 0
    buffer_load_dwordx4 v28, s[44:47], s83 offen lds
    s_add_u32 m0, s79, 25600
    s_add_u32 s83, s98, 28672
    buffer_load_dwordx4 v28, s[44:47], s83 offen lds
    v_mfma_f32_32x32x16_bf16 v[192:207], v[208:211], v[120:123], v[192:207]
    ds_read_b64_tr_b16 v[228:229], v245 offset:50176
    ds_read_b64_tr_b16 v[230:231], v245 offset:50432
    s_add_u32 m0, s79, 26624
    s_add_u32 s83, s98, 57344
    buffer_load_dwordx4 v28, s[44:47], s83 offen lds
    s_add_u32 m0, s79, 27648
    s_add_u32 s83, s98, 86016
    buffer_load_dwordx4 v28, s[44:47], s83 offen lds
    v_mfma_f32_32x32x16_bf16 v[192:207], v[212:215], v[124:127], v[192:207]
    ds_read_b64_tr_b16 v[208:209], v245 offset:53248
    ds_read_b64_tr_b16 v[210:211], v245 offset:53504
    s_add_u32 m0, s79, 28672
    s_add_u32 s83, s98, 114688
    buffer_load_dwordx4 v28, s[44:47], s83 offen lds
    s_add_u32 m0, s79, 29696
    s_add_u32 s83, s98, 143360
    buffer_load_dwordx4 v28, s[44:47], s83 offen lds
    s_waitcnt lgkmcnt(8)
    v_mfma_f32_32x32x16_bf16 v[192:207], v[216:219], v[128:131], v[192:207]
    ds_read_b64_tr_b16 v[212:213], v245 offset:56320
    ds_read_b64_tr_b16 v[214:215], v245 offset:56576
    s_add_u32 m0, s79, 30720
    s_add_u32 s83, s98, 172032
    buffer_load_dwordx4 v28, s[44:47], s83 offen lds
    s_add_u32 m0, s79, 31744
    s_add_u32 s83, s98, 200704
    buffer_load_dwordx4 v28, s[44:47], s83 offen lds
    s_waitcnt lgkmcnt(8)
    v_mfma_f32_32x32x16_bf16 v[192:207], v[220:223], v[132:135], v[192:207]
    ds_read_b64_tr_b16 v[216:217], v245 offset:59392
    ds_read_b64_tr_b16 v[218:219], v245 offset:59648
    s_add_u32 m0, s79, 36864
    s_add_u32 s83, s98, 229376
    buffer_load_dwordx4 v28, s[44:47], s83 offen lds
    s_add_u32 m0, s79, 37888
    s_add_u32 s83, s98, 258048
    buffer_load_dwordx4 v28, s[44:47], s83 offen lds
    s_waitcnt lgkmcnt(8)
    v_mfma_f32_32x32x16_bf16 v[192:207], v[224:227], v[136:139], v[192:207]
    ds_read_b64_tr_b16 v[220:221], v245 offset:62464
    ds_read_b64_tr_b16 v[222:223], v245 offset:62720
    s_add_u32 m0, s79, 38912
    s_add_u32 s83, s98, 286720
    buffer_load_dwordx4 v28, s[44:47], s83 offen lds
    s_add_u32 m0, s79, 39936
    s_add_u32 s83, s98, 315392
    buffer_load_dwordx4 v28, s[44:47], s83 offen lds
    s_waitcnt lgkmcnt(8)
    v_mfma_f32_32x32x16_bf16 v[192:207], v[228:231], v[140:143], v[192:207]
    s_waitcnt lgkmcnt(6)
    v_mfma_f32_32x32x16_bf16 v[192:207], v[208:211], v[144:147], v[192:207]
    s_waitcnt lgkmcnt(4)
    v_mfma_f32_32x32x16_bf16 v[192:207], v[212:215], v[148:151], v[192:207]
    s_waitcnt lgkmcnt(2)
    v_mfma_f32_32x32x16_bf16 v[192:207], v[216:219], v[152:155], v[192:207]
    s_waitcnt lgkmcnt(0)
    v_mfma_f32_32x32x16_bf16 v[192:207], v[220:223], v[156:159], v[192:207]
    s_lshl_b32 s92, s91, 15
    s_lshl_b32 s81, s90, 11
    s_add_u32 s92, s92, s81
    s_add_u32 s92, s92, 2097152
    s_lshr_b32 s82, s91, 2
    s_lshl_b32 s93, s90, 11
    s_lshl_b32 s81, s82, 7
    s_add_u32 s93, s93, s81
    s_add_u32 s93, s93, 16777216
    s_nop 2
    v_pk_mul_f32 v[96:97], v[192:193], v[242:243] op_sel:[0,1] op_sel_hi:[1,1]
    v_pk_mul_f32 v[98:99], v[194:195], v[242:243] op_sel:[0,1] op_sel_hi:[1,1]
    v_pk_mul_f32 v[100:101], v[196:197], v[242:243] op_sel:[0,1] op_sel_hi:[1,1]
    v_pk_mul_f32 v[102:103], v[198:199], v[242:243] op_sel:[0,1] op_sel_hi:[1,1]
    v_pk_mul_f32 v[104:105], v[200:201], v[242:243] op_sel:[0,1] op_sel_hi:[1,1]
    v_pk_mul_f32 v[106:107], v[202:203], v[242:243] op_sel:[0,1] op_sel_hi:[1,1]
    v_pk_mul_f32 v[108:109], v[204:205], v[242:243] op_sel:[0,1] op_sel_hi:[1,1]
    v_pk_mul_f32 v[110:111], v[206:207], v[242:243] op_sel:[0,1] op_sel_hi:[1,1]
    v_exp_f32_e64 v96, v96 clamp
    v_max_f32 v192, 0, v192
    v_exp_f32_e64 v97, v97 clamp
    v_max_f32 v193, 0, v193
    v_exp_f32_e64 v98, v98 clamp
    v_max_f32 v194, 0, v194
    v_exp_f32_e64 v99, v99 clamp
    v_max_f32 v195, 0, v195
    v_exp_f32_e64 v100, v100 clamp
    v_max_f32 v196, 0, v196
    v_exp_f32_e64 v101, v101 clamp
    v_max_f32 v197, 0, v197
    v_exp_f32_e64 v102, v102 clamp
    v_max_f32 v198, 0, v198
    v_exp_f32_e64 v103, v103 clamp
    v_max_f32 v199, 0, v199
    v_exp_f32_e64 v104, v104 clamp
    v_max_f32 v200, 0, v200
    v_exp_f32_e64 v105, v105 clamp
    v_max_f32 v201, 0, v201
    v_exp_f32_e64 v106, v106 clamp
    v_max_f32 v202, 0, v202
    v_exp_f32_e64 v107, v107 clamp
    v_max_f32 v203, 0, v203
    v_exp_f32_e64 v108, v108 clamp
    v_max_f32 v204, 0, v204
    v_exp_f32_e64 v109, v109 clamp
    v_max_f32 v205, 0, v205
    v_exp_f32_e64 v110, v110 clamp
    v_max_f32 v206, 0, v206
    v_exp_f32_e64 v111, v111 clamp
    v_max_f32 v207, 0, v207
    v_mov_b32 v9, 1
    s_cmp_eq_u32 s3, 0
    s_cselect_b32 s93, s93, 1073741824
    s_waitcnt vmcnt(12)
    s_barrier
    s_mov_b64 exec, 1
    buffer_store_dword v9, off, s[68:71], s93 sc1
    s_mov_b64 exec, -1
    v_pk_add_f32 v[96:97], v[96:97], v[246:247] op_sel:[0,0] op_sel_hi:[1,0]
    v_pk_add_f32 v[98:99], v[98:99], v[246:247] op_sel:[0,0] op_sel_hi:[1,0]
    v_pk_add_f32 v[100:101], v[100:101], v[246:247] op_sel:[0,0] op_sel_hi:[1,0]
    v_pk_add_f32 v[102:103], v[102:103], v[246:247] op_sel:[0,0] op_sel_hi:[1,0]
    v_pk_add_f32 v[104:105], v[104:105], v[246:247] op_sel:[0,0] op_sel_hi:[1,0]
    v_pk_add_f32 v[106:107], v[106:107], v[246:247] op_sel:[0,0] op_sel_hi:[1,0]
    v_pk_add_f32 v[108:109], v[108:109], v[246:247] op_sel:[0,0] op_sel_hi:[1,0]
    v_pk_add_f32 v[110:111], v[110:111], v[246:247] op_sel:[0,0] op_sel_hi:[1,0]
    v_pk_fma_f32 v[192:193], v[192:193], v[242:243], v[96:97] op_sel:[0,0,0] op_sel_hi:[1,0,1]
    v_pk_fma_f32 v[194:195], v[194:195], v[242:243], v[98:99] op_sel:[0,0,0] op_sel_hi:[1,0,1]
    v_pk_fma_f32 v[196:197], v[196:197], v[242:243], v[100:101] op_sel:[0,0,0] op_sel_hi:[1,0,1]
    v_pk_fma_f32 v[198:199], v[198:199], v[242:243], v[102:103] op_sel:[0,0,0] op_sel_hi:[1,0,1]
    v_pk_fma_f32 v[200:201], v[200:201], v[242:243], v[104:105] op_sel:[0,0,0] op_sel_hi:[1,0,1]
    v_pk_fma_f32 v[202:203], v[202:203], v[242:243], v[106:107] op_sel:[0,0,0] op_sel_hi:[1,0,1]
    v_pk_fma_f32 v[204:205], v[204:205], v[242:243], v[108:109] op_sel:[0,0,0] op_sel_hi:[1,0,1]
    v_pk_fma_f32 v[206:207], v[206:207], v[242:243], v[110:111] op_sel:[0,0,0] op_sel_hi:[1,0,1]
    v_cvt_pk_bf16_f32 v176, v192, v193
    v_cvt_pk_bf16_f32 v177, v194, v195
    v_cvt_pk_bf16_f32 v178, v196, v197
    v_cvt_pk_bf16_f32 v179, v198, v199
    v_cvt_pk_bf16_f32 v180, v200, v201
    v_cvt_pk_bf16_f32 v181, v202, v203
    v_cvt_pk_bf16_f32 v182, v204, v205
    v_cvt_pk_bf16_f32 v183, v206, v207
    buffer_store_dwordx4 v[176:179], v2, s[68:71], s92 offen sc1
    buffer_store_dwordx4 v[180:183], v2, s[68:71], s92 offen offset:1024 sc1
    s_add_u32 m0, s79, 0
    s_add_u32 s83, s101, 0
    buffer_load_dwordx4 v30, s[40:43], s83 offen lds
    s_add_u32 m0, s79, 1024
    s_add_u32 s83, s101, 8192
    buffer_load_dwordx4 v30, s[40:43], s83 offen lds
    s_add_u32 m0, s79, 2048
    s_add_u32 s83, s101, 16384
    buffer_load_dwordx4 v30, s[40:43], s83 offen lds
    s_add_u32 m0, s79, 3072
    s_add_u32 s83, s101, 24576
    buffer_load_dwordx4 v30, s[40:43], s83 offen lds
    s_add_u32 m0, s79, 4096
    s_add_u32 s83, s101, 32768
    buffer_load_dwordx4 v30, s[40:43], s83 offen lds
    s_add_u32 m0, s79, 5120
    s_add_u32 s83, s101, 40960
    buffer_load_dwordx4 v30, s[40:43], s83 offen lds
    s_add_u32 m0, s79, 6144
    s_add_u32 s83, s101, 49152
    buffer_load_dwordx4 v30, s[40:43], s83 offen lds
    s_add_u32 m0, s79, 7168
    s_add_u32 s83, s101, 57344
    buffer_load_dwordx4 v30, s[40:43], s83 offen lds
    s_add_u32 m0, s79, 8192
    s_add_u32 s83, s101, 65536
    buffer_load_dwordx4 v30, s[40:43], s83 offen lds
    s_add_u32 m0, s79, 9216
    s_add_u32 s83, s101, 73728
    buffer_load_dwordx4 v30, s[40:43], s83 offen lds
    s_add_u32 m0, s79, 10240
    s_add_u32 s83, s101, 81920
    buffer_load_dwordx4 v30, s[40:43], s83 offen lds
    s_add_u32 m0, s79, 11264
    s_add_u32 s83, s101, 90112
    buffer_load_dwordx4 v30, s[40:43], s83 offen lds
    s_add_u32 m0, s79, 12288
    s_add_u32 s83, s101, 98304
    buffer_load_dwordx4 v30, s[40:43], s83 offen lds
    s_add_u32 m0, s79, 13312
    s_add_u32 s83, s101, 106496
    buffer_load_dwordx4 v30, s[40:43], s83 offen lds
    s_add_u32 m0, s79, 14336
    s_add_u32 s83, s101, 114688
    buffer_load_dwordx4 v30, s[40:43], s83 offen lds
    s_add_u32 m0, s79, 15360
    s_add_u32 s83, s101, 122880
    buffer_load_dwordx4 v30, s[40:43], s83 offen lds
    s_add_u32 m0, s79, 16384
    s_add_u32 s83, s98, 344064
    buffer_load_dwordx4 v28, s[44:47], s83 offen lds
    s_add_u32 m0, s79, 17408
    s_add_u32 s83, s98, 372736
    buffer_load_dwordx4 v28, s[44:47], s83 offen lds
    s_add_u32 m0, s79, 18432
    s_add_u32 s83, s98, 401408
    buffer_load_dwordx4 v28, s[44:47], s83 offen lds
    s_add_u32 m0, s79, 19456
    s_add_u32 s83, s98, 430080
    buffer_load_dwordx4 v28, s[44:47], s83 offen lds
    s_add_u32 m0, s79, 20480
    s_add_u32 s83, s98, 458752
    buffer_load_dwordx4 v28, s[44:47], s83 offen lds
    s_add_u32 m0, s79, 21504
    s_add_u32 s83, s98, 487424
    buffer_load_dwordx4 v28, s[44:47], s83 offen lds
    s_add_u32 m0, s79, 22528
    s_add_u32 s83, s98, 516096
    buffer_load_dwordx4 v28, s[44:47], s83 offen lds
    s_add_u32 m0, s79, 23552
    s_add_u32 s83, s98, 544768
    buffer_load_dwordx4 v28, s[44:47], s83 offen lds
    s_add_u32 m0, s79, 32768
    s_add_u32 s83, s98, 573440
    buffer_load_dwordx4 v28, s[44:47], s83 offen lds
    s_add_u32 m0, s79, 33792
    s_add_u32 s83, s98, 602112
    buffer_load_dwordx4 v28, s[44:47], s83 offen lds
    s_add_u32 m0, s79, 34816
    s_add_u32 s83, s98, 630784
    buffer_load_dwordx4 v28, s[44:47], s83 offen lds
    s_add_u32 m0, s79, 35840
    s_add_u32 s83, s98, 659456
    buffer_load_dwordx4 v28, s[44:47], s83 offen lds
    s_lshl_b32 s80, s84, 9
    s_add_u32 s80, s80, s79
    v_add_u32 v7, s80, v5
    s_xor_b32 s80, s80, 512
    v_add_u32 v8, s80, v5
    s_waitcnt vmcnt(41)
    ds_read_b64_tr_b16 a[0:1], v7 offset:24576
    ds_read_b64_tr_b16 a[2:3], v7 offset:25600
    ds_read_b64_tr_b16 a[4:5], v8 offset:24576
    ds_read_b64_tr_b16 a[6:7], v8 offset:25600
    s_waitcnt vmcnt(39)
    ds_read_b64_tr_b16 a[8:9], v7 offset:26624
    ds_read_b64_tr_b16 a[10:11], v7 offset:27648
    ds_read_b64_tr_b16 a[12:13], v8 offset:26624
    ds_read_b64_tr_b16 a[14:15], v8 offset:27648
    s_waitcnt vmcnt(37)
    ds_read_b64_tr_b16 a[16:17], v7 offset:28672
    ds_read_b64_tr_b16 a[18:19], v7 offset:29696
    ds_read_b64_tr_b16 a[20:21], v8 offset:28672
    ds_read_b64_tr_b16 a[22:23], v8 offset:29696
    s_waitcnt vmcnt(35)
    ds_read_b64_tr_b16 a[24:25], v7 offset:30720
    ds_read_b64_tr_b16 a[26:27], v7 offset:31744
    ds_read_b64_tr_b16 a[28:29], v8 offset:30720
    ds_read_b64_tr_b16 a[30:31], v8 offset:31744
    s_waitcnt vmcnt(33)
    ds_read_b64_tr_b16 a[32:33], v7 offset:36864
    ds_read_b64_tr_b16 a[34:35], v7 offset:37888
    ds_read_b64_tr_b16 a[36:37], v8 offset:36864
    ds_read_b64_tr_b16 a[38:39], v8 offset:37888
    s_waitcnt vmcnt(31)
    ds_read_b64_tr_b16 a[40:41], v7 offset:38912
    ds_read_b64_tr_b16 a[42:43], v7 offset:39936
    ds_read_b64_tr_b16 a[44:45], v8 offset:38912
    ds_read_b64_tr_b16 a[46:47], v8 offset:39936
    s_waitcnt lgkmcnt(0)
    v_and_b32 v7, 31, v1
    v_lshlrev_b32 v7, 10, v7
    v_lshl_add_u32 v7, v4, 4, v7
    s_lshl_b32 s80, s77, 16
    s_lshl_b32 s81, s84, 15
    s_add_u32 s80, s80, s81
    s_lshl_b32 s81, s76, 7
    s_add_u32 s80, s80, s81
    s_lshl_b32 s81, s85, 5
    s_add_u32 s80, s80, s81
    buffer_load_dwordx4 v[20:23], v7, s[32:35], s80 offen
    buffer_load_dwordx4 v[24:27], v7, s[32:35], s80 offen offset:64
    s_xor_b32 s80, s84, 0
    s_lshl_b32 s92, s77, 16
    s_lshl_b32 s81, s80, 15
    s_add_u32 s92, s92, s81
    s_lshl_b32 s81, s3, 13
    s_add_u32 s92, s92, s81
    s_add_u32 s92, s92, 2097152
    s_xor_b32 s80, s84, 1
    s_lshl_b32 s93, s77, 16
    s_lshl_b32 s81, s80, 15
    s_add_u32 s93, s93, s81
    s_lshl_b32 s81, s3, 13
    s_add_u32 s93, s93, s81
    s_add_u32 s93, s93, 2097152
    v_lshlrev_b32 v250, 2, v1
    v_bfe_u32 v251, v1, 4, 1
    v_xor_b32 v251, 1, v251
    v_lshlrev_b32 v251, 6, v251
    v_lshl_add_u32 v251, v4, 4, v251
    v_add_u32 v248, s79, v5
    s_mul_i32 s94, s3, 9216
    s_add_u32 s94, s94, 14680064
    v_and_b32 v7, 63, v1
    v_lshlrev_b32 v7, 7, v7
    s_lshl_b32 s97, s3, 13
    s_add_u32 s97, s97, 16777216
    buffer_load_dword v8, v7, s[68:71], s97 offen sc1
    s_waitcnt vmcnt(0)
    v_cmp_gt_u32 vcc, 1, v8
    s_nop 1
    s_cbranch_vccz L_rdy_4
    s_mov_b32 s96, 0
L_spin_5:
    s_mov_b64 exec, vcc
    buffer_load_dword v8, v7, s[68:71], s97 offen sc1
    s_add_u32 s96, s96, 1
    s_waitcnt vmcnt(0)
    v_cmp_gt_u32 vcc, 1, v8
    s_nop 1
    s_cbranch_vccz L_out_6
    s_cmp_lt_u32 s96, 50000
    s_cbranch_scc1 L_spin_5
L_out_6:
    s_mov_b64 exec, -1
L_rdy_4:
    buffer_load_dword v128, v250, s[68:71], s94 offen offset:0 sc1
    buffer_load_dword v129, v250, s[68:71], s94 offen offset:256 sc1
    buffer_load_dword v130, v250, s[68:71], s94 offen offset:512 sc1
    buffer_load_dword v131, v250, s[68:71], s94 offen offset:768 sc1
    buffer_load_dword v132, v250, s[68:71], s94 offen offset:1024 sc1
    buffer_load_dword v133, v250, s[68:71], s94 offen offset:1280 sc1
    buffer_load_dword v134, v250, s[68:71], s94 offen offset:1536 sc1
    buffer_load_dword v135, v250, s[68:71], s94 offen offset:1792 sc1
    buffer_load_dwordx4 v[160:163], v251, s[68:71], s94 offen offset:2048 sc1
    buffer_load_dwordx4 v[164:167], v251, s[68:71], s94 offen offset:2080 sc1
    s_add_u32 s94, s94, 2304
    buffer_load_dword v136, v250, s[68:71], s94 offen offset:0 sc1
    buffer_load_dword v137, v250, s[68:71], s94 offen offset:256 sc1
    buffer_load_dword v138, v250, s[68:71], s94 offen offset:512 sc1
    buffer_load_dword v139, v250, s[68:71], s94 offen offset:768 sc1
    buffer_load_dword v140, v250, s[68:71], s94 offen offset:1024 sc1
    buffer_load_dword v141, v250, s[68:71], s94 offen offset:1280 sc1
    buffer_load_dword v142, v250, s[68:71], s94 offen offset:1536 sc1
    buffer_load_dword v143, v250, s[68:71], s94 offen offset:1792 sc1
    buffer_load_dwordx4 v[168:171], v251, s[68:71], s94 offen offset:2048 sc1
    buffer_load_dwordx4 v[172:175], v251, s[68:71], s94 offen offset:2080 sc1
    s_add_u32 s94, s94, 2304
    buffer_load_dword v144, v250, s[68:71], s94 offen offset:0 sc1
    buffer_load_dword v145, v250, s[68:71], s94 offen offset:256 sc1
    buffer_load_dword v146, v250, s[68:71], s94 offen offset:512 sc1
    buffer_load_dword v147, v250, s[68:71], s94 offen offset:768 sc1
    buffer_load_dword v148, v250, s[68:71], s94 offen offset:1024 sc1
    buffer_load_dword v149, v250, s[68:71], s94 offen offset:1280 sc1
    buffer_load_dword v150, v250, s[68:71], s94 offen offset:1536 sc1
    buffer_load_dword v151, v250, s[68:71], s94 offen offset:1792 sc1
    buffer_load_dwordx4 v[176:179], v251, s[68:71], s94 offen offset:2048 sc1
    buffer_load_dwordx4 v[180:183], v251, s[68:71], s94 offen offset:2080 sc1
    s_add_u32 s94, s94, 2304
    buffer_load_dword v152, v250, s[68:71], s94 offen offset:0 sc1
    buffer_load_dword v153, v250, s[68:71], s94 offen offset:256 sc1
    buffer_load_dword v154, v250, s[68:71], s94 offen offset:512 sc1
    buffer_load_dword v155, v250, s[68:71], s94 offen offset:768 sc1
    buffer_load_dword v156, v250, s[68:71], s94 offen offset:1024 sc1
    buffer_load_dword v157, v250, s[68:71], s94 offen offset:1280 sc1
    buffer_load_dword v158, v250, s[68:71], s94 offen offset:1536 sc1
    buffer_load_dword v159, v250, s[68:71], s94 offen offset:1792 sc1
    buffer_load_dwordx4 v[184:187], v251, s[68:71], s94 offen offset:2048 sc1
    buffer_load_dwordx4 v[188:191], v251, s[68:71], s94 offen offset:2080 sc1
    buffer_load_dwordx4 v[64:67], v2, s[68:71], s93 offen offset:0 sc1
    buffer_load_dwordx4 v[32:35], v2, s[68:71], s92 offen offset:0 sc1
    buffer_load_dwordx4 v[68:71], v2, s[68:71], s93 offen offset:1024 sc1
    buffer_load_dwordx4 v[36:39], v2, s[68:71], s92 offen offset:1024 sc1
    buffer_load_dwordx4 v[72:75], v2, s[68:71], s93 offen offset:2048 sc1
    buffer_load_dwordx4 v[40:43], v2, s[68:71], s92 offen offset:2048 sc1
    buffer_load_dwordx4 v[76:79], v2, s[68:71], s93 offen offset:3072 sc1
    buffer_load_dwordx4 v[44:47], v2, s[68:71], s92 offen offset:3072 sc1
    s_add_u32 s93, s93, 4096
    buffer_load_dwordx4 v[80:83], v2, s[68:71], s93 offen offset:0 sc1
    s_add_u32 s92, s92, 4096
    buffer_load_dwordx4 v[48:51], v2, s[68:71], s92 offen offset:0 sc1
    buffer_load_dwordx4 v[84:87], v2, s[68:71], s93 offen offset:1024 sc1
    buffer_load_dwordx4 v[52:55], v2, s[68:71], s92 offen offset:1024 sc1
    buffer_load_dwordx4 v[88:91], v2, s[68:71], s93 offen offset:2048 sc1
    buffer_load_dwordx4 v[56:59], v2, s[68:71], s92 offen offset:2048 sc1
    buffer_load_dwordx4 v[92:95], v2, s[68:71], s93 offen offset:3072 sc1
    buffer_load_dwordx4 v[60:63], v2, s[68:71], s92 offen offset:3072 sc1
    s_lshl_b32 s80, s84, 9
    s_add_u32 s80, s80, s79
    v_add_u32 v7, s80, v5
    s_xor_b32 s80, s80, 512
    v_add_u32 v8, s80, v5
    ds_read_b64_tr_b16 a[48:49], v7 offset:16384
    ds_read_b64_tr_b16 a[50:51], v7 offset:17408
    ds_read_b64_tr_b16 a[52:53], v8 offset:16384
    ds_read_b64_tr_b16 a[54:55], v8 offset:17408
    ds_read_b64_tr_b16 a[56:57], v7 offset:18432
    ds_read_b64_tr_b16 a[58:59], v7 offset:19456
    ds_read_b64_tr_b16 a[60:61], v8 offset:18432
    ds_read_b64_tr_b16 a[62:63], v8 offset:19456
    ds_read_b64_tr_b16 a[64:65], v7 offset:20480
    ds_read_b64_tr_b16 a[66:67], v7 offset:21504
    ds_read_b64_tr_b16 a[68:69], v8 offset:20480
    ds_read_b64_tr_b16 a[70:71], v8 offset:21504
    ds_read_b64_tr_b16 a[72:73], v7 offset:22528
    ds_read_b64_tr_b16 a[74:75], v7 offset:23552
    ds_read_b64_tr_b16 a[76:77], v8 offset:22528
    ds_read_b64_tr_b16 a[78:79], v8 offset:23552
    ds_read_b64_tr_b16 a[80:81], v7 offset:32768
    ds_read_b64_tr_b16 a[82:83], v7 offset:33792
    ds_read_b64_tr_b16 a[84:85], v8 offset:32768
    ds_read_b64_tr_b16 a[86:87], v8 offset:33792
    ds_read_b64_tr_b16 a[88:89], v7 offset:34816
    ds_read_b64_tr_b16 a[90:91], v7 offset:35840
    ds_read_b64_tr_b16 a[92:93], v8 offset:34816
    ds_read_b64_tr_b16 a[94:95], v8 offset:35840
    s_waitcnt lgkmcnt(0)
    v_permlane32_swap_b32 v20, v22
    v_permlane32_swap_b32 v21, v23
    v_permlane32_swap_b32 v24, v26
    v_permlane32_swap_b32 v25, v27
    s_add_u32 s80, s79, 0
    v_add_u32 v252, s80, v2
    s_xor_b32 s80, s3, 1
    s_mul_i32 s80, s80, 40960
    s_add_u32 s80, s80, 0
    v_add_u32 v253, s80, v2
    s_xor_b32 s80, s3, 2
    s_mul_i32 s80, s80, 40960
    s_add_u32 s80, s80, 4096
    v_add_u32 v254, s80, v2
    s_xor_b32 s80, s3, 3
    s_mul_i32 s80, s80, 40960
    s_add_u32 s80, s80, 8192
    v_add_u32 v0, s80, v2
    s_waitcnt vmcnt(46)
    v_cvt_pk_bf16_f32 v128, v128, v129
    v_cvt_pk_bf16_f32 v160, v160, v161
    v_cvt_pk_bf16_f32 v129, v130, v131
    v_cvt_pk_bf16_f32 v161, v162, v163
    v_cvt_pk_bf16_f32 v130, v132, v133
    v_cvt_pk_bf16_f32 v162, v164, v165
    v_cvt_pk_bf16_f32 v131, v134, v135
    v_cvt_pk_bf16_f32 v163, v166, v167
    v_cndmask_b32 v96, v128, v160, s[88:89]
    v_cndmask_b32 v100, v160, v128, s[88:89]
    v_cndmask_b32 v97, v129, v161, s[88:89]
    v_cndmask_b32 v101, v161, v129, s[88:89]
    v_cndmask_b32 v98, v130, v162, s[88:89]
    v_cndmask_b32 v102, v162, v130, s[88:89]
    v_cndmask_b32 v99, v131, v163, s[88:89]
    v_cndmask_b32 v103, v163, v131, s[88:89]
    s_waitcnt vmcnt(36)
    v_cvt_pk_bf16_f32 v136, v136, v137
    v_cvt_pk_bf16_f32 v168, v168, v169
    v_cvt_pk_bf16_f32 v137, v138, v139
    v_cvt_pk_bf16_f32 v169, v170, v171
    v_cvt_pk_bf16_f32 v138, v140, v141
    v_cvt_pk_bf16_f32 v170, v172, v173
    v_cvt_pk_bf16_f32 v139, v142, v143
    v_cvt_pk_bf16_f32 v171, v174, v175
    v_cndmask_b32 v104, v136, v168, s[88:89]
    v_cndmask_b32 v108, v168, v136, s[88:89]
    v_cndmask_b32 v105, v137, v169, s[88:89]
    v_cndmask_b32 v109, v169, v137, s[88:89]
    v_cndmask_b32 v106, v138, v170, s[88:89]
    v_cndmask_b32 v110, v170, v138, s[88:89]
    v_cndmask_b32 v107, v139, v171, s[88:89]
    v_cndmask_b32 v111, v171, v139, s[88:89]
    s_waitcnt vmcnt(26)
    v_cvt_pk_bf16_f32 v144, v144, v145
    v_cvt_pk_bf16_f32 v176, v176, v177
    v_cvt_pk_bf16_f32 v145, v146, v147
    v_cvt_pk_bf16_f32 v177, v178, v179
    v_cvt_pk_bf16_f32 v146, v148, v149
    v_cvt_pk_bf16_f32 v178, v180, v181
    v_cvt_pk_bf16_f32 v147, v150, v151
    v_cvt_pk_bf16_f32 v179, v182, v183
    v_cndmask_b32 v112, v144, v176, s[88:89]
    v_cndmask_b32 v116, v176, v144, s[88:89]
    v_cndmask_b32 v113, v145, v177, s[88:89]
    v_cndmask_b32 v117, v177, v145, s[88:89]
    v_cndmask_b32 v114, v146, v178, s[88:89]
    v_cndmask_b32 v118, v178, v146, s[88:89]
    v_cndmask_b32 v115, v147, v179, s[88:89]
    v_cndmask_b32 v119, v179, v147, s[88:89]
    s_waitcnt vmcnt(16)
    v_cvt_pk_bf16_f32 v152, v152, v153
    v_cvt_pk_bf16_f32 v184, v184, v185
    v_cvt_pk_bf16_f32 v153, v154, v155
    v_cvt_pk_bf16_f32 v185, v186, v187
    v_cvt_pk_bf16_f32 v154, v156, v157
    v_cvt_pk_bf16_f32 v186, v188, v189
    v_cvt_pk_bf16_f32 v155, v158, v159
    v_cvt_pk_bf16_f32 v187, v190, v191
    v_cndmask_b32 v120, v152, v184, s[88:89]
    v_cndmask_b32 v124, v184, v152, s[88:89]
    v_cndmask_b32 v121, v153, v185, s[88:89]
    v_cndmask_b32 v125, v185, v153, s[88:89]
    v_cndmask_b32 v122, v154, v186, s[88:89]
    v_cndmask_b32 v126, v186, v154, s[88:89]
    v_cndmask_b32 v123, v155, v187, s[88:89]
    v_cndmask_b32 v127, v187, v155, s[88:89]
    ds_read_b64_tr_b16 v[232:233], v248 offset:0
    ds_read_b64_tr_b16 v[234:235], v248 offset:1024
    ds_read_b64_tr_b16 v[236:237], v248 offset:512
    ds_read_b64_tr_b16 v[238:239], v248 offset:1536
    s_waitcnt vmcnt(12)
    v_max3_u32 v9, v32, v64, v36
    v_max_u32 v9, v9, v68
    v_cmp_eq_u32 vcc, -1, v9
    s_nop 1
    s_cbranch_vccnz L_redo_7
L_back_8:
    v_mfma_f32_32x32x16_bf16 v[192:207], v[96:99], v[64:67], 0
    v_mfma_f32_32x32x16_bf16 v[208:223], v[96:99], v[32:35], 0
    s_nop 10
    v_add_f32 v200, 0x358637bd, v200
    v_rcp_f32 v200, v200
    s_nop 0
    v_mul_f32 v192, v192, v200
    v_mul_f32 v193, v193, v200
    v_mul_f32 v194, v194, v200
    v_mul_f32 v195, v195, v200
    v_mul_f32 v196, v196, v200
    v_mul_f32 v197, v197, v200
    v_mul_f32 v198, v198, v200
    v_mul_f32 v199, v199, v200
    v_cvt_pk_bf16_f32 v224, v192, v193
    v_cvt_pk_bf16_f32 v225, v194, v195
    v_cvt_pk_bf16_f32 v226, v196, v197
    v_cvt_pk_bf16_f32 v227, v198, v199
    ds_read_b64_tr_b16 v[240:241], v248 offset:2048
    ds_read_b64_tr_b16 v[242:243], v248 offset:3072
    ds_read_b64_tr_b16 v[244:245], v248 offset:2560
    ds_read_b64_tr_b16 v[246:247], v248 offset:3584
    v_mfma_f32_32x32x16_bf16 v[192:207], v[100:103], v[68:71], 0
    v_add_f32 v216, 0x358637bd, v216
    v_rcp_f32 v216, v216
    s_waitcnt lgkmcnt(4)
    v_mfma_f32_32x32x16_bf16 v[160:175], v[232:235], v[224:227], 0
    v_mul_f32 v208, v208, v216
    v_mul_f32 v209, v209, v216
    v_mul_f32 v210, v210, v216
    v_mul_f32 v211, v211, v216
    v_mul_f32 v212, v212, v216
    v_mul_f32 v213, v213, v216
    v_mfma_f32_32x32x16_bf16 v[176:191], v[236:239], v[224:227], 0
    v_mul_f32 v214, v214, v216
    v_mul_f32 v215, v215, v216
    v_cvt_pk_bf16_f32 v228, v208, v209
    v_cvt_pk_bf16_f32 v229, v210, v211
    v_cvt_pk_bf16_f32 v230, v212, v213
    v_cvt_pk_bf16_f32 v231, v214, v215
    s_add_u32 m0, s79, 16384
    s_add_u32 s83, s98, 688128
    buffer_load_dwordx4 v28, s[44:47], s83 offen lds
    s_add_u32 m0, s79, 17408
    s_add_u32 s83, s98, 716800
    buffer_load_dwordx4 v28, s[44:47], s83 offen lds
    v_mfma_f32_32x32x16_bf16 v[208:223], v[100:103], v[36:39], 0
    v_add_f32 v192, 0x358637bd, v192
    v_rcp_f32 v192, v192
    v_mfma_f32_32x32x16_bf16 v[128:143], v[232:235], v[228:231], 0
    v_mul_f32 v200, v200, v192
    v_mul_f32 v201, v201, v192
    v_mul_f32 v202, v202, v192
    v_mul_f32 v203, v203, v192
    v_mul_f32 v204, v204, v192
    v_mul_f32 v205, v205, v192
    v_mfma_f32_32x32x16_bf16 v[144:159], v[236:239], v[228:231], 0
    v_mul_f32 v206, v206, v192
    v_mul_f32 v207, v207, v192
    v_cvt_pk_bf16_f32 v224, v200, v201
    v_cvt_pk_bf16_f32 v225, v202, v203
    v_cvt_pk_bf16_f32 v226, v204, v205
    v_cvt_pk_bf16_f32 v227, v206, v207
    ds_read_b64_tr_b16 v[232:233], v248 offset:4096
    ds_read_b64_tr_b16 v[234:235], v248 offset:5120
    ds_read_b64_tr_b16 v[236:237], v248 offset:4608
    ds_read_b64_tr_b16 v[238:239], v248 offset:5632
    s_add_u32 m0, s79, 18432
    s_add_u32 s83, s98, 745472
    buffer_load_dwordx4 v28, s[44:47], s83 offen lds
    s_add_u32 m0, s79, 19456
    s_add_u32 s83, s98, 774144
    buffer_load_dwordx4 v28, s[44:47], s83 offen lds
    s_waitcnt vmcnt(12)
    v_max3_u32 v9, v40, v72, v44
    v_max_u32 v9, v9, v76
    v_cmp_eq_u32 vcc, -1, v9
    s_nop 1
    s_cbranch_vccnz L_redo_9
L_back_10:
    v_mfma_f32_32x32x16_bf16 v[192:207], v[104:107], v[72:75], 0
    v_add_f32 v208, 0x358637bd, v208
    v_rcp_f32 v208, v208
    s_waitcnt lgkmcnt(4)
    v_mfma_f32_32x32x16_bf16 v[160:175], v[240:243], v[224:227], v[160:175]
    v_mul_f32 v216, v216, v208
    v_mul_f32 v217, v217, v208
    v_mul_f32 v218, v218, v208
    v_mul_f32 v219, v219, v208
    v_mul_f32 v220, v220, v208
    v_mul_f32 v221, v221, v208
    v_mfma_f32_32x32x16_bf16 v[176:191], v[244:247], v[224:227], v[176:191]
    v_mul_f32 v222, v222, v208
    v_mul_f32 v223, v223, v208
    v_cvt_pk_bf16_f32 v228, v216, v217
    v_cvt_pk_bf16_f32 v229, v218, v219
    v_cvt_pk_bf16_f32 v230, v220, v221
    v_cvt_pk_bf16_f32 v231, v222, v223
    s_add_u32 m0, s79, 20480
    s_add_u32 s83, s98, 802816
    buffer_load_dwordx4 v28, s[44:47], s83 offen lds
    s_add_u32 m0, s79, 21504
    s_add_u32 s83, s98, 831488
    buffer_load_dwordx4 v28, s[44:47], s83 offen lds
    v_mfma_f32_32x32x16_bf16 v[208:223], v[104:107], v[40:43], 0
    v_add_f32 v200, 0x358637bd, v200
    v_rcp_f32 v200, v200
    v_mfma_f32_32x32x16_bf16 v[128:143], v[240:243], v[228:231], v[128:143]
    v_mul_f32 v192, v192, v200
    v_mul_f32 v193, v193, v200
    v_mul_f32 v194, v194, v200
    v_mul_f32 v195, v195, v200
    v_mul_f32 v196, v196, v200
    v_mul_f32 v197, v197, v200
    v_mfma_f32_32x32x16_bf16 v[144:159], v[244:247], v[228:231], v[144:159]
    v_mul_f32 v198, v198, v200
    v_mul_f32 v199, v199, v200
    v_cvt_pk_bf16_f32 v224, v192, v193
    v_cvt_pk_bf16_f32 v225, v194, v195
    v_cvt_pk_bf16_f32 v226, v196, v197
    v_cvt_pk_bf16_f32 v227, v198, v199
    ds_read_b64_tr_b16 v[240:241], v248 offset:6144
    ds_read_b64_tr_b16 v[242:243], v248 offset:7168
    ds_read_b64_tr_b16 v[244:245], v248 offset:6656
    ds_read_b64_tr_b16 v[246:247], v248 offset:7680
    s_add_u32 m0, s79, 22528
    s_add_u32 s83, s98, 860160
    buffer_load_dwordx4 v28, s[44:47], s83 offen lds
    s_add_u32 m0, s79, 23552
    s_add_u32 s83, s98, 888832
    buffer_load_dwordx4 v28, s[44:47], s83 offen lds
    v_mfma_f32_32x32x16_bf16 v[192:207], v[108:111], v[76:79], 0
    v_add_f32 v216, 0x358637bd, v216
    v_rcp_f32 v216, v216
    s_waitcnt lgkmcnt(4)
    v_mfma_f32_32x32x16_bf16 v[160:175], v[232:235], v[224:227], v[160:175]
    v_mul_f32 v208, v208, v216
    v_mul_f32 v209, v209, v216
    v_mul_f32 v210, v210, v216
    v_mul_f32 v211, v211, v216
    v_mul_f32 v212, v212, v216
    v_mul_f32 v213, v213, v216
    v_mfma_f32_32x32x16_bf16 v[176:191], v[236:239], v[224:227], v[176:191]
    v_mul_f32 v214, v214, v216
    v_mul_f32 v215, v215, v216
    v_cvt_pk_bf16_f32 v228, v208, v209
    v_cvt_pk_bf16_f32 v229, v210, v211
    v_cvt_pk_bf16_f32 v230, v212, v213
    v_cvt_pk_bf16_f32 v231, v214, v215
    s_add_u32 m0, s79, 24576
    s_add_u32 s83, s98, 917504
    buffer_load_dwordx4 v28, s[44:47], s83 offen lds
    s_add_u32 m0, s79, 25600
    s_add_u32 s83, s98, 946176
    buffer_load_dwordx4 v28, s[44:47], s83 offen lds
    v_mfma_f32_32x32x16_bf16 v[208:223], v[108:111], v[44:47], 0
    v_add_f32 v192, 0x358637bd, v192
    v_rcp_f32 v192, v192
    v_mfma_f32_32x32x16_bf16 v[128:143], v[232:235], v[228:231], v[128:143]
    v_mul_f32 v200, v200, v192
    v_mul_f32 v201, v201, v192
    v_mul_f32 v202, v202, v192
    v_mul_f32 v203, v203, v192
    v_mul_f32 v204, v204, v192
    v_mul_f32 v205, v205, v192
    v_mfma_f32_32x32x16_bf16 v[144:159], v[236:239], v[228:231], v[144:159]
    v_mul_f32 v206, v206, v192
    v_mul_f32 v207, v207, v192
    v_cvt_pk_bf16_f32 v224, v200, v201
    v_cvt_pk_bf16_f32 v225, v202, v203
    v_cvt_pk_bf16_f32 v226, v204, v205
    v_cvt_pk_bf16_f32 v227, v206, v207
    ds_read_b64_tr_b16 v[32:33], v248 offset:8192
    ds_read_b64_tr_b16 v[34:35], v248 offset:9216
    ds_read_b64_tr_b16 v[64:65], v248 offset:8704
    ds_read_b64_tr_b16 v[66:67], v248 offset:9728
    s_add_u32 m0, s79, 26624
    s_add_u32 s83, s98, 974848
    buffer_load_dwordx4 v28, s[44:47], s83 offen lds
    s_add_u32 m0, s79, 27648
    s_add_u32 s83, s98, 1003520
    buffer_load_dwordx4 v28, s[44:47], s83 offen lds
    s_waitcnt vmcnt(16)
    v_max3_u32 v9, v48, v80, v52
    v_max_u32 v9, v9, v84
    v_cmp_eq_u32 vcc, -1, v9
    s_nop 1
    s_cbranch_vccnz L_redo_11
L_back_12:
    v_mfma_f32_32x32x16_bf16 v[192:207], v[112:115], v[80:83], 0
    v_add_f32 v208, 0x358637bd, v208
    v_rcp_f32 v208, v208
    s_waitcnt lgkmcnt(4)
    v_mfma_f32_32x32x16_bf16 v[160:175], v[240:243], v[224:227], v[160:175]
    v_mul_f32 v216, v216, v208
    v_mul_f32 v217, v217, v208
    v_mul_f32 v218, v218, v208
    v_mul_f32 v219, v219, v208
    v_mul_f32 v220, v220, v208
    v_mul_f32 v221, v221, v208
    v_mfma_f32_32x32x16_bf16 v[176:191], v[244:247], v[224:227], v[176:191]
    v_mul_f32 v222, v222, v208
    v_mul_f32 v223, v223, v208
    v_cvt_pk_bf16_f32 v228, v216, v217
    v_cvt_pk_bf16_f32 v229, v218, v219
    v_cvt_pk_bf16_f32 v230, v220, v221
    v_cvt_pk_bf16_f32 v231, v222, v223
    ds_read_b64_tr_b16 v[36:37], v248 offset:10240
    ds_read_b64_tr_b16 v[38:39], v248 offset:11264
    ds_read_b64_tr_b16 v[68:69], v248 offset:10752
    ds_read_b64_tr_b16 v[70:71], v248 offset:11776
    s_add_u32 m0, s79, 28672
    s_add_u32 s83, s98, 1032192
    buffer_load_dwordx4 v28, s[44:47], s83 offen lds
    s_add_u32 m0, s79, 29696
    s_add_u32 s83, s98, 1060864
    buffer_load_dwordx4 v28, s[44:47], s83 offen lds
    v_mfma_f32_32x32x16_bf16 v[208:223], v[116:119], v[84:87], 0
    v_add_f32 v200, 0x358637bd, v200
    v_rcp_f32 v200, v200
    v_mfma_f32_32x32x16_bf16 v[128:143], v[240:243], v[228:231], v[128:143]
    v_mul_f32 v192, v192, v200
    v_mul_f32 v193, v193, v200
    v_mul_f32 v194, v194, v200
    v_mul_f32 v195, v195, v200
    v_mul_f32 v196, v196, v200
    v_mul_f32 v197, v197, v200
    v_mfma_f32_32x32x16_bf16 v[144:159], v[244:247], v[228:231], v[144:159]
    v_mul_f32 v198, v198, v200
    v_mul_f32 v199, v199, v200
    v_cvt_pk_bf16_f32 v224, v192, v193
    v_cvt_pk_bf16_f32 v225, v194, v195
    v_cvt_pk_bf16_f32 v226, v196, v197
    v_cvt_pk_bf16_f32 v227, v198, v199
    ds_read_b64_tr_b16 v[40:41], v248 offset:12288
    ds_read_b64_tr_b16 v[42:43], v248 offset:13312
    ds_read_b64_tr_b16 v[72:73], v248 offset:12800
    ds_read_b64_tr_b16 v[74:75], v248 offset:13824
    s_add_u32 m0, s79, 30720
    s_add_u32 s83, s98, 1089536
    buffer_load_dwordx4 v28, s[44:47], s83 offen lds
    s_add_u32 m0, s79, 31744
    s_add_u32 s83, s98, 1118208
    buffer_load_dwordx4 v28, s[44:47], s83 offen lds
    s_waitcnt vmcnt(16)
    v_max3_u32 v9, v56, v88, v60
    v_max_u32 v9, v9, v92
    v_cmp_eq_u32 vcc, -1, v9
    s_nop 1
    s_cbranch_vccnz L_redo_13
L_back_14:
    v_mfma_f32_32x32x16_bf16 v[192:207], v[120:123], v[88:91], 0
    v_add_f32 v208, 0x358637bd, v208
    v_rcp_f32 v208, v208
    s_waitcnt lgkmcnt(8)
    v_mfma_f32_32x32x16_bf16 v[160:175], v[32:35], v[224:227], v[160:175]
    v_mul_f32 v216, v216, v208
    v_mul_f32 v217, v217, v208
    v_mul_f32 v218, v218, v208
    v_mul_f32 v219, v219, v208
    v_mul_f32 v220, v220, v208
    v_mul_f32 v221, v221, v208
    v_mfma_f32_32x32x16_bf16 v[176:191], v[64:67], v[224:227], v[176:191]
    v_mul_f32 v222, v222, v208
    v_mul_f32 v223, v223, v208
    v_cvt_pk_bf16_f32 v228, v216, v217
    v_cvt_pk_bf16_f32 v229, v218, v219
    v_cvt_pk_bf16_f32 v230, v220, v221
    v_cvt_pk_bf16_f32 v231, v222, v223
    ds_read_b64_tr_b16 v[44:45], v248 offset:14336
    ds_read_b64_tr_b16 v[46:47], v248 offset:15360
    ds_read_b64_tr_b16 v[76:77], v248 offset:14848
    ds_read_b64_tr_b16 v[78:79], v248 offset:15872
    s_add_u32 m0, s79, 32768
    s_add_u32 s83, s98, 1146880
    buffer_load_dwordx4 v28, s[44:47], s83 offen lds
    s_add_u32 m0, s79, 33792
    s_add_u32 s83, s98, 1175552
    buffer_load_dwordx4 v28, s[44:47], s83 offen lds
    v_mfma_f32_32x32x16_bf16 v[208:223], v[124:127], v[92:95], 0
    v_add_f32 v200, 0x358637bd, v200
    v_rcp_f32 v200, v200
    s_waitcnt lgkmcnt(8)
    v_mfma_f32_32x32x16_bf16 v[160:175], v[36:39], v[228:231], v[160:175]
    v_mul_f32 v192, v192, v200
    v_mul_f32 v193, v193, v200
    v_mul_f32 v194, v194, v200
    v_mul_f32 v195, v195, v200
    v_mul_f32 v196, v196, v200
    v_mul_f32 v197, v197, v200
    v_mfma_f32_32x32x16_bf16 v[176:191], v[68:71], v[228:231], v[176:191]
    v_mul_f32 v198, v198, v200
    v_mul_f32 v199, v199, v200
    v_cvt_pk_bf16_f32 v224, v192, v193
    v_cvt_pk_bf16_f32 v225, v194, v195
    v_cvt_pk_bf16_f32 v226, v196, v197
    v_cvt_pk_bf16_f32 v227, v198, v199
    s_add_u32 m0, s79, 34816
    s_add_u32 s83, s98, 1204224
    buffer_load_dwordx4 v28, s[44:47], s83 offen lds
    v_mfma_f32_32x32x16_bf16 v[192:207], v[112:115], v[48:51], 0
    v_add_f32 v208, 0x358637bd, v208
    v_rcp_f32 v208, v208
    s_waitcnt lgkmcnt(4)
    v_mfma_f32_32x32x16_bf16 v[160:175], v[40:43], v[224:227], v[160:175]
    v_mul_f32 v216, v216, v208
    v_mul_f32 v217, v217, v208
    v_mul_f32 v218, v218, v208
    v_mul_f32 v219, v219, v208
    v_mul_f32 v220, v220, v208
    v_mul_f32 v221, v221, v208
    v_mfma_f32_32x32x16_bf16 v[176:191], v[72:75], v[224:227], v[176:191]
    v_mul_f32 v222, v222, v208
    v_mul_f32 v223, v223, v208
    v_cvt_pk_bf16_f32 v228, v216, v217
    v_cvt_pk_bf16_f32 v229, v218, v219
    v_cvt_pk_bf16_f32 v230, v220, v221
    v_cvt_pk_bf16_f32 v231, v222, v223
    s_add_u32 m0, s79, 35840
    s_add_u32 s83, s98, 1232896
    buffer_load_dwordx4 v28, s[44:47], s83 offen lds
    v_mfma_f32_32x32x16_bf16 v[208:223], v[116:119], v[52:55], 0
    v_add_f32 v200, 0x358637bd, v200
    v_rcp_f32 v200, v200
    s_waitcnt lgkmcnt(0)
    v_mfma_f32_32x32x16_bf16 v[160:175], v[44:47], v[228:231], v[160:175]
    v_mul_f32 v192, v192, v200
    v_mul_f32 v193, v193, v200
    v_mul_f32 v194, v194, v200
    v_mul_f32 v195, v195, v200
    v_mul_f32 v196, v196, v200
    v_mul_f32 v197, v197, v200
    v_mfma_f32_32x32x16_bf16 v[176:191], v[76:79], v[228:231], v[176:191]
    v_mul_f32 v198, v198, v200
    v_mul_f32 v199, v199, v200
    v_cvt_pk_bf16_f32 v224, v192, v193
    v_cvt_pk_bf16_f32 v225, v194, v195
    v_cvt_pk_bf16_f32 v226, v196, v197
    v_cvt_pk_bf16_f32 v227, v198, v199
    s_add_u32 m0, s79, 36864
    s_add_u32 s83, s98, 1261568
    buffer_load_dwordx4 v28, s[44:47], s83 offen lds
    v_mfma_f32_32x32x16_bf16 v[192:207], v[120:123], v[56:59], 0
    v_add_f32 v208, 0x358637bd, v208
    v_rcp_f32 v208, v208
    v_mfma_f32_32x32x16_bf16 v[128:143], v[32:35], v[224:227], v[128:143]
    v_mul_f32 v216, v216, v208
    v_mul_f32 v217, v217, v208
    v_mul_f32 v218, v218, v208
    v_mul_f32 v219, v219, v208
    v_mul_f32 v220, v220, v208
    v_mul_f32 v221, v221, v208
    v_mfma_f32_32x32x16_bf16 v[144:159], v[64:67], v[224:227], v[144:159]
    v_mul_f32 v222, v222, v208
    ds_write_b128 v252, v[160:163] offset:0
    v_mul_f32 v223, v223, v208
    v_cvt_pk_bf16_f32 v228, v216, v217
    ds_write_b128 v252, v[164:167] offset:1024
    v_cvt_pk_bf16_f32 v229, v218, v219
    v_cvt_pk_bf16_f32 v230, v220, v221
    ds_write_b128 v252, v[176:179] offset:2048
    v_cvt_pk_bf16_f32 v231, v222, v223
    s_add_u32 m0, s79, 37888
    s_add_u32 s83, s98, 1290240
    buffer_load_dwordx4 v28, s[44:47], s83 offen lds
    v_mfma_f32_32x32x16_bf16 v[208:223], v[124:127], v[60:63], 0
    v_add_f32 v200, 0x358637bd, v200
    v_rcp_f32 v200, v200
    v_mfma_f32_32x32x16_bf16 v[128:143], v[36:39], v[228:231], v[128:143]
    v_mul_f32 v192, v192, v200
    v_mul_f32 v193, v193, v200
    v_mul_f32 v194, v194, v200
    v_mul_f32 v195, v195, v200
    v_mul_f32 v196, v196, v200
    v_mul_f32 v197, v197, v200
    v_mfma_f32_32x32x16_bf16 v[144:159], v[68:71], v[228:231], v[144:159]
    v_mul_f32 v198, v198, v200
    ds_write_b128 v252, v[180:183] offset:3072
    v_mul_f32 v199, v199, v200
    v_cvt_pk_bf16_f32 v224, v192, v193
    ds_write_b128 v252, v[168:171] offset:8192
    v_cvt_pk_bf16_f32 v225, v194, v195
    v_cvt_pk_bf16_f32 v226, v196, v197
    ds_write_b128 v252, v[172:175] offset:9216
    v_cvt_pk_bf16_f32 v227, v198, v199
    s_add_u32 m0, s79, 38912
    s_add_u32 s83, s98, 1318912
    buffer_load_dwordx4 v28, s[44:47], s83 offen lds
    v_add_f32 v208, 0x358637bd, v208
    v_rcp_f32 v208, v208
    v_mfma_f32_32x32x16_bf16 v[128:143], v[40:43], v[224:227], v[128:143]
    v_mul_f32 v216, v216, v208
    v_mul_f32 v217, v217, v208
    v_mul_f32 v218, v218, v208
    v_mul_f32 v219, v219, v208
    v_mul_f32 v220, v220, v208
    v_mul_f32 v221, v221, v208
    v_mfma_f32_32x32x16_bf16 v[144:159], v[72:75], v[224:227], v[144:159]
    v_mul_f32 v222, v222, v208
    ds_write_b128 v252, v[184:187] offset:10240
    v_mul_f32 v223, v223, v208
    v_cvt_pk_bf16_f32 v228, v216, v217
    ds_write_b128 v252, v[188:191] offset:11264
    v_cvt_pk_bf16_f32 v229, v218, v219
    v_cvt_pk_bf16_f32 v230, v220, v221
    v_cvt_pk_bf16_f32 v231, v222, v223
    s_add_u32 m0, s79, 39936
    s_add_u32 s83, s98, 1347584
    buffer_load_dwordx4 v28, s[44:47], s83 offen lds
    v_mfma_f32_32x32x16_bf16 v[128:143], v[44:47], v[228:231], v[128:143]
    v_mfma_f32_32x32x16_bf16 v[144:159], v[76:79], v[228:231], v[144:159]
    s_mul_i32 s80, s2, 112
    s_mul_i32 s81, s3, 28
    s_add_u32 s80, s80, s81
    v_add_u32 v7, s80, v1
    v_lshrrev_b32 v8, 5, v7
    v_and_b32 v7, 31, v7
    v_mul_u32_u24 v9, 9363, v8
    v_lshrrev_b32 v9, 21, v9
    v_mul_u32_u24 v9, 224, v9
    v_sub_u32 v8, v8, v9
    v_lshl_add_u32 v9, v9, 1, v8
    v_cmp_gt_u32 vcc, 128, v8
    s_nop 1
    v_cndmask_b32 v8, 48, 0, vcc
    v_add_u32 v9, 128, v9
    v_lshl_add_u32 v9, v8, 1, v9
    v_lshlrev_b32 v9, 12, v9
    v_lshl_add_u32 v7, v7, 7, v9
    s_mov_b64 exec, 0xfffffff
    buffer_load_dword v31, v7, s[52:55], 0 offen
    s_mov_b64 exec, -1
    v_lshlrev_b32 v32, 16, v20
    v_and_b32 v33, 0xffff0000, v20
    v_lshlrev_b32 v34, 16, v21
    v_and_b32 v35, 0xffff0000, v21
    v_lshlrev_b32 v36, 16, v22
    v_and_b32 v37, 0xffff0000, v22
    v_lshlrev_b32 v38, 16, v23
    v_and_b32 v39, 0xffff0000, v23
    v_lshlrev_b32 v40, 16, v24
    v_and_b32 v41, 0xffff0000, v24
    v_lshlrev_b32 v42, 16, v25
    v_and_b32 v43, 0xffff0000, v25
    v_lshlrev_b32 v44, 16, v26
    v_and_b32 v45, 0xffff0000, v26
    v_lshlrev_b32 v46, 16, v27
    v_and_b32 v47, 0xffff0000, v27
    ds_write_b128 v252, v[136:139] offset:4096
    v_and_b32 v250, 31, v1
    v_lshlrev_b32 v251, 3, v250
    s_lshl_b32 s92, s77, 13
    s_lshl_b32 s81, s84, 12
    s_add_u32 s92, s92, s81
    s_add_u32 s92, s92, 15728640
    s_lshl_b32 s93, s76, 9
    s_lshl_b32 s81, s85, 8
    s_add_u32 s93, s93, s81
    s_add_u32 s93, s93, s92
    v_mov_b32 v243, 0x3f803f80
    ds_write_b128 v252, v[140:143] offset:5120
    v_mov_b32 v244, 0
    v_mov_b32 v245, 0
    v_mov_b32 v246, 0
    v_mov_b32 v247, 0
    v_pk_add_f32 v[32:33], v[32:33], v[128:129]
    ds_write_b128 v252, v[152:155] offset:6144
    v_pk_add_f32 v[34:35], v[34:35], v[130:131]
    v_pk_add_f32 v[36:37], v[36:37], v[132:133]
    v_pk_add_f32 v[38:39], v[38:39], v[134:135]
    v_pk_add_f32 v[40:41], v[40:41], v[144:145]
    v_pk_add_f32 v[42:43], v[42:43], v[146:147]
    ds_write_b128 v252, v[156:159] offset:7168
    v_pk_add_f32 v[44:45], v[44:45], v[148:149]
    v_pk_add_f32 v[46:47], v[46:47], v[150:151]
    s_waitcnt lgkmcnt(0)
    s_barrier
    ds_read_b128 v[192:195], v253 offset:0
    ds_read_b128 v[196:199], v253 offset:1024
    ds_read_b128 v[200:203], v253 offset:2048
    ds_read_b128 v[204:207], v253 offset:3072
    ds_read_b128 v[208:211], v254 offset:0
    ds_read_b128 v[212:215], v254 offset:1024
    ds_read_b128 v[216:219], v254 offset:2048
    ds_read_b128 v[220:223], v254 offset:3072
    ds_read_b128 v[224:227], v0 offset:0
    ds_read_b128 v[228:231], v0 offset:1024
    ds_read_b128 v[232:235], v0 offset:2048
    ds_read_b128 v[236:239], v0 offset:3072
    s_waitcnt lgkmcnt(8)
    v_pk_add_f32 v[192:193], v[192:193], v[32:33]
    v_pk_add_f32 v[194:195], v[194:195], v[34:35]
    v_pk_add_f32 v[196:197], v[196:197], v[36:37]
    v_pk_add_f32 v[198:199], v[198:199], v[38:39]
    v_pk_add_f32 v[200:201], v[200:201], v[40:41]
    v_pk_add_f32 v[202:203], v[202:203], v[42:43]
    v_pk_add_f32 v[204:205], v[204:205], v[44:45]
    v_pk_add_f32 v[206:207], v[206:207], v[46:47]
    s_waitcnt lgkmcnt(4)
    v_pk_add_f32 v[192:193], v[192:193], v[208:209]
    v_pk_add_f32 v[194:195], v[194:195], v[210:211]
    v_pk_add_f32 v[196:197], v[196:197], v[212:213]
    v_pk_add_f32 v[198:199], v[198:199], v[214:215]
    v_pk_add_f32 v[200:201], v[200:201], v[216:217]
    v_pk_add_f32 v[202:203], v[202:203], v[218:219]
    v_pk_add_f32 v[204:205], v[204:205], v[220:221]
    v_pk_add_f32 v[206:207], v[206:207], v[222:223]
    s_waitcnt lgkmcnt(0)
    v_pk_add_f32 v[192:193], v[192:193], v[224:225]
    v_pk_add_f32 v[194:195], v[194:195], v[226:227]
    v_pk_add_f32 v[196:197], v[196:197], v[228:229]
    v_pk_add_f32 v[198:199], v[198:199], v[230:231]
    v_pk_add_f32 v[200:201], v[200:201], v[232:233]
    v_pk_add_f32 v[202:203], v[202:203], v[234:235]
    v_pk_add_f32 v[204:205], v[204:205], v[236:237]
    v_pk_add_f32 v[206:207], v[206:207], v[238:239]
    v_cvt_pk_bf16_f32 v20, v192, v193
    v_cvt_pk_bf16_f32 v21, v194, v195
    v_cvt_pk_bf16_f32 v22, v196, v197
    v_cvt_pk_bf16_f32 v23, v198, v199
    v_cvt_pk_bf16_f32 v24, v200, v201
    v_cvt_pk_bf16_f32 v25, v202, v203
    v_cvt_pk_bf16_f32 v26, v204, v205
    v_cvt_pk_bf16_f32 v27, v206, v207
    v_dot2c_f32_bf16 v244, v20, v243
    v_dot2c_f32_bf16 v245, v20, v20
    v_dot2c_f32_bf16 v246, v21, v243
    v_dot2c_f32_bf16 v247, v21, v21
    v_dot2c_f32_bf16 v244, v22, v243
    v_dot2c_f32_bf16 v245, v22, v22
    v_dot2c_f32_bf16 v246, v23, v243
    v_dot2c_f32_bf16 v247, v23, v23
    v_dot2c_f32_bf16 v244, v24, v243
    v_dot2c_f32_bf16 v245, v24, v24
    v_dot2c_f32_bf16 v246, v25, v243
    v_dot2c_f32_bf16 v247, v25, v25
    v_dot2c_f32_bf16 v244, v26, v243
    v_dot2c_f32_bf16 v245, v26, v26
    v_dot2c_f32_bf16 v246, v27, v243
    v_dot2c_f32_bf16 v247, v27, v27
    s_nop 2
    v_pk_add_f32 v[208:209], v[244:245], v[246:247]
    v_mov_b32 v210, v208
    v_mov_b32 v211, v209
    s_nop 0
    v_permlane32_swap_b32 v208, v210
    v_permlane32_swap_b32 v209, v211
    v_pk_add_f32 v[208:209], v[208:209], v[210:211]
    v_and_b32 v209, 0x7fffffff, v209
    s_mov_b64 exec, s[86:87]
    s_cmp_eq_u32 s30, 1
    s_cselect_b32 s82, s93, 1073741824
    s_cselect_b32 s83, 1073741824, s93
    buffer_store_dwordx2 v[208:209], v251, s[68:71], s82 offen
    buffer_store_dwordx2 v[208:209], v251, s[68:71], s83 offen sc1
    s_mov_b64 exec, -1
    v_lshlrev_b32 v192, 16, v20
    v_and_b32 v193, 0xffff0000, v20
    v_lshlrev_b32 v194, 16, v21
    v_and_b32 v195, 0xffff0000, v21
    v_lshlrev_b32 v196, 16, v22
    v_and_b32 v197, 0xffff0000, v22
    v_lshlrev_b32 v198, 16, v23
    v_and_b32 v199, 0xffff0000, v23
    v_lshlrev_b32 v200, 16, v24
    v_and_b32 v201, 0xffff0000, v24
    v_lshlrev_b32 v202, 16, v25
    v_and_b32 v203, 0xffff0000, v25
    v_lshlrev_b32 v204, 16, v26
    v_and_b32 v205, 0xffff0000, v26
    v_lshlrev_b32 v206, 16, v27
    v_and_b32 v207, 0xffff0000, v27
    v_lshl_add_u32 v249, v4, 11, v251
    v_bfe_u32 v240, v1, 1, 3
    v_xor_b32 v240, v240, v4
    s_lshl_b32 s80, s85, 2
    v_xor_b32 v240, s80, v240
    v_lshlrev_b32 v240, 3, v240
    v_lshl_add_u32 v240, v250, 6, v240
    s_mul_i32 s80, s84, 40960
    s_add_u32 s80, s80, 12288
    v_add_u32 v240, s80, v240
    v_xor_b32 v241, 16, v240
    v_add_u32 v245, 81920, v240
    v_add_u32 v246, 81920, v241
    v_bfe_u32 v242, v1, 3, 1
    v_lshl_add_u32 v242, v4, 1, v242
    v_lshlrev_b32 v242, 3, v242
    v_xor_b32 v242, v242, v3
    s_add_u32 s80, s79, 12288
    v_add_u32 v242, s80, v242
    v_xor_b32 v248, 32, v242
    s_lshl_b32 s94, s76, 18
    s_lshl_b32 s81, s85, 17
    s_add_u32 s94, s94, s81
    s_lshl_b32 s81, s77, 12
    s_add_u32 s94, s94, s81
    s_lshl_b32 s81, s84, 11
    s_add_u32 s94, s94, s81
    s_add_u32 s94, s94, 6291456
    v_mov_b32 v244, 0x3b000054
    s_lshl_b32 s80, s84, 9
    s_add_u32 s80, s80, s79
    v_add_u32 v7, s80, v5
    s_xor_b32 s80, s80, 512
    v_add_u32 v8, s80, v5
    s_waitcnt vmcnt(25)
    ds_read_b64_tr_b16 a[96:97], v7 offset:16384
    ds_read_b64_tr_b16 a[98:99], v7 offset:17408
    ds_read_b64_tr_b16 a[100:101], v8 offset:16384
    ds_read_b64_tr_b16 a[102:103], v8 offset:17408
    s_waitcnt vmcnt(23)
    ds_read_b64_tr_b16 a[104:105], v7 offset:18432
    ds_read_b64_tr_b16 a[106:107], v7 offset:19456
    ds_read_b64_tr_b16 a[108:109], v8 offset:18432
    ds_read_b64_tr_b16 a[110:111], v8 offset:19456
    s_waitcnt vmcnt(21)
    ds_read_b64_tr_b16 a[112:113], v7 offset:20480
    ds_read_b64_tr_b16 a[114:115], v7 offset:21504
    ds_read_b64_tr_b16 a[116:117], v8 offset:20480
    ds_read_b64_tr_b16 a[118:119], v8 offset:21504
    s_waitcnt vmcnt(19)
    ds_read_b64_tr_b16 a[120:121], v7 offset:22528
    ds_read_b64_tr_b16 a[122:123], v7 offset:23552
    ds_read_b64_tr_b16 a[124:125], v8 offset:22528
    ds_read_b64_tr_b16 a[126:127], v8 offset:23552
    s_waitcnt vmcnt(17)
    ds_read_b64_tr_b16 a[128:129], v7 offset:24576
    ds_read_b64_tr_b16 a[130:131], v7 offset:25600
    ds_read_b64_tr_b16 a[132:133], v8 offset:24576
    ds_read_b64_tr_b16 a[134:135], v8 offset:25600
    s_waitcnt vmcnt(15)
    ds_read_b64_tr_b16 a[136:137], v7 offset:26624
    ds_read_b64_tr_b16 a[138:139], v7 offset:27648
    ds_read_b64_tr_b16 a[140:141], v8 offset:26624
    ds_read_b64_tr_b16 a[142:143], v8 offset:27648
    s_waitcnt vmcnt(13)
    ds_read_b64_tr_b16 a[144:145], v7 offset:28672
    ds_read_b64_tr_b16 a[146:147], v7 offset:29696
    ds_read_b64_tr_b16 a[148:149], v8 offset:28672
    ds_read_b64_tr_b16 a[150:151], v8 offset:29696
    s_waitcnt vmcnt(11)
    ds_read_b64_tr_b16 a[152:153], v7 offset:30720
    ds_read_b64_tr_b16 a[154:155], v7 offset:31744
    ds_read_b64_tr_b16 a[156:157], v8 offset:30720
    ds_read_b64_tr_b16 a[158:159], v8 offset:31744
    s_waitcnt vmcnt(9)
    ds_read_b64_tr_b16 a[160:161], v7 offset:32768
    ds_read_b64_tr_b16 a[162:163], v7 offset:33792
    ds_read_b64_tr_b16 a[164:165], v8 offset:32768
    ds_read_b64_tr_b16 a[166:167], v8 offset:33792
    s_waitcnt vmcnt(7)
    ds_read_b64_tr_b16 a[168:169], v7 offset:34816
    ds_read_b64_tr_b16 a[170:171], v7 offset:35840
    ds_read_b64_tr_b16 a[172:173], v8 offset:34816
    ds_read_b64_tr_b16 a[174:175], v8 offset:35840
    s_waitcnt vmcnt(5)
    ds_read_b64_tr_b16 a[176:177], v7 offset:36864
    ds_read_b64_tr_b16 a[178:179], v7 offset:37888
    ds_read_b64_tr_b16 a[180:181], v8 offset:36864
    ds_read_b64_tr_b16 a[182:183], v8 offset:37888
    s_waitcnt vmcnt(3)
    ds_read_b64_tr_b16 a[184:185], v7 offset:38912
    ds_read_b64_tr_b16 a[186:187], v7 offset:39936
    ds_read_b64_tr_b16 a[188:189], v8 offset:38912
    ds_read_b64_tr_b16 a[190:191], v8 offset:39936
    s_waitcnt lgkmcnt(0)
    s_add_u32 m0, s79, 16384
    s_add_u32 s83, s98, 1376256
    buffer_load_dwordx4 v28, s[44:47], s83 offen lds
    s_add_u32 m0, s79, 17408
    s_add_u32 s83, s98, 1404928
    buffer_load_dwordx4 v28, s[44:47], s83 offen lds
    s_add_u32 m0, s79, 18432
    s_add_u32 s83, s98, 1433600
    buffer_load_dwordx4 v28, s[44:47], s83 offen lds
    s_add_u32 m0, s79, 19456
    s_add_u32 s83, s98, 1462272
    buffer_load_dwordx4 v28, s[44:47], s83 offen lds
    s_add_u32 m0, s79, 20480
    s_add_u32 s83, s98, 1490944
    buffer_load_dwordx4 v28, s[44:47], s83 offen lds
    s_add_u32 m0, s79, 21504
    s_add_u32 s83, s98, 1519616
    buffer_load_dwordx4 v28, s[44:47], s83 offen lds
    s_mov_b32 s96, 0
L_xp_15:
    buffer_load_dwordx2 v[212:213], v249, s[68:71], s92 offen offset:0 sc1
    buffer_load_dwordx2 v[214:215], v249, s[68:71], s92 offen offset:256 sc1
    buffer_load_dwordx2 v[216:217], v249, s[68:71], s92 offen offset:512 sc1
    buffer_load_dwordx2 v[218:219], v249, s[68:71], s92 offen offset:768 sc1
    buffer_load_dwordx2 v[220:221], v249, s[68:71], s92 offen offset:1024 sc1
    buffer_load_dwordx2 v[222:223], v249, s[68:71], s92 offen offset:1280 sc1
    buffer_load_dwordx2 v[224:225], v249, s[68:71], s92 offen offset:1536 sc1
    buffer_load_dwordx2 v[226:227], v249, s[68:71], s92 offen offset:1792 sc1
    s_waitcnt vmcnt(0)
    v_max_u32 v7, v213, v215
    v_max3_u32 v7, v7, v217, v219
    v_max3_u32 v7, v7, v221, v223
    v_max3_u32 v7, v7, v225, v227
    v_cmp_eq_u32 vcc, -1, v7
    s_add_u32 s96, s96, 1
    s_nop 0
    s_cbranch_vccz L_xd_16
    s_cmp_lt_u32 s96, 50000
    s_cbranch_scc1 L_xp_15
L_xd_16:
    s_add_u32 m0, s79, 22528
    s_add_u32 s83, s98, 1548288
    buffer_load_dwordx4 v28, s[44:47], s83 offen lds
    s_add_u32 m0, s79, 23552
    s_add_u32 s83, s98, 1576960
    buffer_load_dwordx4 v28, s[44:47], s83 offen lds
    s_add_u32 m0, s79, 24576
    s_add_u32 s83, s98, 1605632
    buffer_load_dwordx4 v28, s[44:47], s83 offen lds
    s_add_u32 m0, s79, 25600
    s_add_u32 s83, s98, 1634304
    buffer_load_dwordx4 v28, s[44:47], s83 offen lds
    s_add_u32 m0, s79, 26624
    s_add_u32 s83, s98, 1662976
    buffer_load_dwordx4 v28, s[44:47], s83 offen lds
    s_add_u32 m0, s79, 27648
    s_add_u32 s83, s98, 1691648
    buffer_load_dwordx4 v28, s[44:47], s83 offen lds
    s_add_u32 m0, s79, 28672
    s_add_u32 s83, s98, 1720320
    buffer_load_dwordx4 v28, s[44:47], s83 offen lds
    s_add_u32 m0, s79, 29696
    s_add_u32 s83, s98, 1748992
    buffer_load_dwordx4 v28, s[44:47], s83 offen lds
    s_add_u32 m0, s79, 30720
    s_add_u32 s83, s98, 1777664
    buffer_load_dwordx4 v28, s[44:47], s83 offen lds
    s_add_u32 m0, s79, 31744
    s_add_u32 s83, s98, 1806336
    buffer_load_dwordx4 v28, s[44:47], s83 offen lds
    v_pk_add_f32 v[212:213], v[212:213], v[220:221]
    v_pk_add_f32 v[214:215], v[214:215], v[222:223]
    v_pk_add_f32 v[216:217], v[216:217], v[224:225]
    v_pk_add_f32 v[218:219], v[218:219], v[226:227]
    v_pk_add_f32 v[212:213], v[212:213], v[216:217]
    v_pk_add_f32 v[214:215], v[214:215], v[218:219]
    v_pk_add_f32 v[212:213], v[212:213], v[214:215]
    v_mov_b32 v214, v212
    v_mov_b32 v215, v213
    s_nop 0
    v_permlane32_swap_b32 v212, v214
    v_permlane32_swap_b32 v213, v215
    v_pk_add_f32 v[212:213], v[212:213], v[214:215]
    v_mul_f32 v212, 0xbb000000, v212
    v_mul_f32 v213, v244, v213
    v_mul_f32 v214, 0x3f800054, v212
    v_fma_f32 v213, -v212, v214, v213
    v_max_f32 v213, 0, v213
    v_add_f32 v213, 0x2edbe6ff, v213
    v_rsq_f32 v213, v213
    s_nop 0
    v_mul_f32 v212, v212, v213
    v_pk_fma_f32 v[192:193], v[192:193], v[212:213], v[212:213] op_sel:[0,1,0] op_sel_hi:[1,1,0]
    v_pk_fma_f32 v[194:195], v[194:195], v[212:213], v[212:213] op_sel:[0,1,0] op_sel_hi:[1,1,0]
    v_pk_fma_f32 v[196:197], v[196:197], v[212:213], v[212:213] op_sel:[0,1,0] op_sel_hi:[1,1,0]
    v_pk_fma_f32 v[198:199], v[198:199], v[212:213], v[212:213] op_sel:[0,1,0] op_sel_hi:[1,1,0]
    v_pk_fma_f32 v[200:201], v[200:201], v[212:213], v[212:213] op_sel:[0,1,0] op_sel_hi:[1,1,0]
    v_pk_fma_f32 v[202:203], v[202:203], v[212:213], v[212:213] op_sel:[0,1,0] op_sel_hi:[1,1,0]
    v_pk_fma_f32 v[204:205], v[204:205], v[212:213], v[212:213] op_sel:[0,1,0] op_sel_hi:[1,1,0]
    v_pk_fma_f32 v[206:207], v[206:207], v[212:213], v[212:213] op_sel:[0,1,0] op_sel_hi:[1,1,0]
    v_cvt_pk_bf16_f32 v192, v192, v193
    v_cvt_pk_bf16_f32 v193, v194, v195
    v_cvt_pk_bf16_f32 v194, v196, v197
    v_cvt_pk_bf16_f32 v195, v198, v199
    ds_write_b64 v240, v[192:193]
    ds_write_b64 v241, v[194:195]
    v_cvt_pk_bf16_f32 v196, v200, v201
    v_cvt_pk_bf16_f32 v197, v202, v203
    v_cvt_pk_bf16_f32 v198, v204, v205
    v_cvt_pk_bf16_f32 v199, v206, v207
    ds_write_b64 v245, v[196:197]
    ds_write_b64 v246, v[198:199]
    s_add_u32 m0, s79, 32768
    s_add_u32 s83, s99, 1114112
    buffer_load_dwordx4 v29, s[52:55], s83 offen lds
    s_add_u32 m0, s79, 33792
    s_add_u32 s83, s99, 1146880
    buffer_load_dwordx4 v29, s[52:55], s83 offen lds
    s_add_u32 m0, s79, 34816
    s_add_u32 s83, s99, 1179648
    buffer_load_dwordx4 v29, s[52:55], s83 offen lds
    s_add_u32 m0, s79, 35840
    s_add_u32 s83, s99, 1212416
    buffer_load_dwordx4 v29, s[52:55], s83 offen lds
    s_waitcnt lgkmcnt(0)
    s_barrier
    ds_read_b64_tr_b16 v[208:209], v242 offset:0
    ds_read_b64_tr_b16 v[210:211], v248 offset:512
    ds_read_b64_tr_b16 v[212:213], v242 offset:1024
    ds_read_b64_tr_b16 v[214:215], v248 offset:1536
    s_add_u32 m0, s79, 38912
    s_add_u32 s83, s99, 1048576
    buffer_load_dwordx4 v29, s[52:55], s83 offen lds
    s_add_u32 m0, s79, 39936
    s_add_u32 s83, s99, 1081344
    buffer_load_dwordx4 v29, s[52:55], s83 offen lds
    s_waitcnt lgkmcnt(2)
    buffer_store_dwordx4 v[208:211], v2, s[68:71], s94 offen sc1
    s_waitcnt lgkmcnt(0)
    buffer_store_dwordx4 v[212:215], v2, s[68:71], s94 offen offset:1024 sc1
    s_add_u32 m0, s79, 0
    s_add_u32 s83, s99, 0
    buffer_load_dwordx4 v29, s[52:55], s83 offen lds
    s_add_u32 m0, s79, 1024
    s_add_u32 s83, s99, 32768
    buffer_load_dwordx4 v29, s[52:55], s83 offen lds
    s_add_u32 m0, s79, 2048
    s_add_u32 s83, s99, 65536
    buffer_load_dwordx4 v29, s[52:55], s83 offen lds
    s_add_u32 m0, s79, 3072
    s_add_u32 s83, s99, 98304
    buffer_load_dwordx4 v29, s[52:55], s83 offen lds
    s_add_u32 m0, s79, 4096
    s_add_u32 s83, s99, 131072
    buffer_load_dwordx4 v29, s[52:55], s83 offen lds
    s_add_u32 m0, s79, 5120
    s_add_u32 s83, s99, 163840
    buffer_load_dwordx4 v29, s[52:55], s83 offen lds
    s_add_u32 m0, s79, 6144
    s_add_u32 s83, s99, 196608
    buffer_load_dwordx4 v29, s[52:55], s83 offen lds
    s_add_u32 m0, s79, 7168
    s_add_u32 s83, s99, 229376
    buffer_load_dwordx4 v29, s[52:55], s83 offen lds
    s_add_u32 m0, s79, 8192
    s_add_u32 s83, s99, 262144
    buffer_load_dwordx4 v29, s[52:55], s83 offen lds
    s_add_u32 m0, s79, 9216
    s_add_u32 s83, s99, 294912
    buffer_load_dwordx4 v29, s[52:55], s83 offen lds
    s_add_u32 m0, s79, 10240
    s_add_u32 s83, s99, 327680
    buffer_load_dwordx4 v29, s[52:55], s83 offen lds
    s_add_u32 m0, s79, 11264
    s_add_u32 s83, s99, 360448
    buffer_load_dwordx4 v29, s[52:55], s83 offen lds
    s_add_u32 m0, s79, 12288
    s_add_u32 s83, s99, 393216
    buffer_load_dwordx4 v29, s[52:55], s83 offen lds
    s_add_u32 m0, s79, 13312
    s_add_u32 s83, s99, 425984
    buffer_load_dwordx4 v29, s[52:55], s83 offen lds
    s_add_u32 m0, s79, 14336
    s_add_u32 s83, s99, 458752
    buffer_load_dwordx4 v29, s[52:55], s83 offen lds
    s_add_u32 m0, s79, 15360
    s_add_u32 s83, s99, 491520
    buffer_load_dwordx4 v29, s[52:55], s83 offen lds
    s_lshl_b32 s80, s84, 9
    s_add_u32 s80, s80, s79
    v_add_u32 v7, s80, v5
    s_xor_b32 s80, s80, 512
    v_add_u32 v8, s80, v5
    ds_read_b64_tr_b16 a[192:193], v7 offset:16384
    ds_read_b64_tr_b16 a[194:195], v7 offset:17408
    ds_read_b64_tr_b16 a[196:197], v8 offset:16384
    ds_read_b64_tr_b16 a[198:199], v8 offset:17408
    ds_read_b64_tr_b16 a[200:201], v7 offset:18432
    ds_read_b64_tr_b16 a[202:203], v7 offset:19456
    ds_read_b64_tr_b16 a[204:205], v8 offset:18432
    ds_read_b64_tr_b16 a[206:207], v8 offset:19456
    ds_read_b64_tr_b16 a[208:209], v7 offset:20480
    ds_read_b64_tr_b16 a[210:211], v7 offset:21504
    ds_read_b64_tr_b16 a[212:213], v8 offset:20480
    ds_read_b64_tr_b16 a[214:215], v8 offset:21504
    s_waitcnt vmcnt(32)
    ds_read_b64_tr_b16 a[216:217], v7 offset:22528
    ds_read_b64_tr_b16 a[218:219], v7 offset:23552
    ds_read_b64_tr_b16 a[220:221], v8 offset:22528
    ds_read_b64_tr_b16 a[222:223], v8 offset:23552
    s_waitcnt vmcnt(30)
    ds_read_b64_tr_b16 a[224:225], v7 offset:24576
    ds_read_b64_tr_b16 a[226:227], v7 offset:25600
    ds_read_b64_tr_b16 a[228:229], v8 offset:24576
    ds_read_b64_tr_b16 a[230:231], v8 offset:25600
    s_waitcnt vmcnt(28)
    ds_read_b64_tr_b16 a[232:233], v7 offset:26624
    ds_read_b64_tr_b16 a[234:235], v7 offset:27648
    ds_read_b64_tr_b16 a[236:237], v8 offset:26624
    ds_read_b64_tr_b16 a[238:239], v8 offset:27648
    s_waitcnt vmcnt(26)
    ds_read_b64_tr_b16 a[240:241], v7 offset:28672
    ds_read_b64_tr_b16 a[242:243], v7 offset:29696
    ds_read_b64_tr_b16 a[244:245], v8 offset:28672
    ds_read_b64_tr_b16 a[246:247], v8 offset:29696
    s_waitcnt vmcnt(24)
    ds_read_b64_tr_b16 a[248:249], v7 offset:30720
    ds_read_b64_tr_b16 a[250:251], v7 offset:31744
    ds_read_b64_tr_b16 a[252:253], v8 offset:30720
    ds_read_b64_tr_b16 a[254:255], v8 offset:31744
    s_lshl_b32 s80, s84, 9
    s_add_u32 s80, s80, s79
    v_add_u32 v7, s80, v3
    s_xor_b32 s80, s80, 512
    v_add_u32 v8, s80, v3
    s_waitcnt vmcnt(22)
    ds_read_b64_tr_b16 v[32:33], v7 offset:32768
    ds_read_b64_tr_b16 v[34:35], v7 offset:33792
    ds_read_b64_tr_b16 v[36:37], v8 offset:32768
    ds_read_b64_tr_b16 v[38:39], v8 offset:33792
    s_waitcnt vmcnt(20)
    ds_read_b64_tr_b16 v[40:41], v7 offset:34816
    ds_read_b64_tr_b16 v[42:43], v7 offset:35840
    ds_read_b64_tr_b16 v[44:45], v8 offset:34816
    ds_read_b64_tr_b16 v[46:47], v8 offset:35840
    s_waitcnt lgkmcnt(0)
    s_add_u32 s80, s79, 32768
    v_add_u32 v252, s80, v2
    s_xor_b32 s80, s3, 1
    s_mul_i32 s80, s80, 40960
    s_add_u32 s80, s80, 32768
    v_add_u32 v253, s80, v2
    s_xor_b32 s80, s3, 2
    s_mul_i32 s80, s80, 40960
    s_add_u32 s80, s80, 34816
    v_add_u32 v254, s80, v2
    s_xor_b32 s80, s3, 3
    s_mul_i32 s80, s80, 40960
    s_add_u32 s80, s80, 36864
    v_add_u32 v0, s80, v2
    s_cmp_ge_u32 s73, 28
    s_nop 0
    s_cbranch_scc1 L_nop3_17
    v_and_b32 v251, 7, v1
    v_lshlrev_b32 v251, 12, v251
    s_lshl_b32 s97, s75, 18
    s_lshl_b32 s81, s3, 15
    s_add_u32 s97, s97, s81
    s_add_u32 s97, s97, 6426608
    v_mov_b32 v160, 0xbdd2d3e8
    v_mov_b32 v161, 0xc0135761
    v_mov_b32 v162, 1.0
    v_mov_b32 v31, 0xc0135761
    s_lshl_b32 s100, s75, 18
    s_lshl_b32 s81, s3, 15
    s_add_u32 s100, s100, s81
    s_add_u32 s100, s100, 6291456
    buffer_load_dwordx4 v[184:187], v2, s[68:71], s100 offen offset:0 sc1
    buffer_load_dwordx4 v[188:191], v2, s[68:71], s100 offen offset:1024 sc1
    buffer_load_dwordx4 v[192:195], v2, s[68:71], s100 offen offset:2048 sc1
    buffer_load_dwordx4 v[196:199], v2, s[68:71], s100 offen offset:3072 sc1
    s_add_u32 s100, s100, 4096
    buffer_load_dwordx4 v[200:203], v2, s[68:71], s100 offen offset:0 sc1
    buffer_load_dwordx4 v[204:207], v2, s[68:71], s100 offen offset:1024 sc1
    buffer_load_dwordx4 v[208:211], v2, s[68:71], s100 offen offset:2048 sc1
    buffer_load_dwordx4 v[212:215], v2, s[68:71], s100 offen offset:3072 sc1
    s_add_u32 s100, s100, 4096
    buffer_load_dwordx4 v[216:219], v2, s[68:71], s100 offen offset:0 sc1
    buffer_load_dwordx4 v[220:223], v2, s[68:71], s100 offen offset:1024 sc1
    buffer_load_dwordx4 v[224:227], v2, s[68:71], s100 offen offset:2048 sc1
    buffer_load_dwordx4 v[228:231], v2, s[68:71], s100 offen offset:3072 sc1
    s_add_u32 s100, s100, 4096
    buffer_load_dwordx4 v[232:235], v2, s[68:71], s100 offen offset:0 sc1
    buffer_load_dwordx4 v[236:239], v2, s[68:71], s100 offen offset:1024 sc1
    buffer_load_dwordx4 v[240:243], v2, s[68:71], s100 offen offset:2048 sc1
    buffer_load_dwordx4 v[244:247], v2, s[68:71], s100 offen offset:3072 sc1
    s_add_u32 s100, s100, 4096
    buffer_load_dwordx4 v[120:123], v2, s[68:71], s100 offen offset:0 sc1
    buffer_load_dwordx4 v[124:127], v2, s[68:71], s100 offen offset:1024 sc1
    v_and_b32 v251, 7, v1
    v_min_u32 v251, 6, v251
    v_lshlrev_b32 v251, 12, v251
    s_mul_i32 s97, s76, 229376
    s_mul_i32 s81, s3, 28672
    s_add_u32 s97, s97, s81
    s_add_u32 s97, s97, 10489840
    s_waitcnt vmcnt(14)
    v_max3_u32 v9, v184, v188, v192
    v_max_u32 v9, v9, v196
    v_cmp_eq_u32 vcc, -1, v9
    s_cbranch_vccnz L_redo_19
L_back_20:
    v_mfma_f32_32x32x16_bf16 v[144:159], a[4:7], v[184:187], 0
    v_mfma_f32_32x32x16_bf16 v[128:143], a[0:3], v[184:187], 0
    buffer_load_dwordx4 v[184:187], v2, s[68:71], s100 offen offset:2048 sc1
    s_add_u32 m0, s79, 34816
    s_add_u32 s83, s99, 1769472
    buffer_load_dwordx4 v29, s[52:55], s83 offen lds
    v_mfma_f32_32x32x16_bf16 v[144:159], a[12:15], v[188:191], v[144:159]
    v_mfma_f32_32x32x16_bf16 v[128:143], a[8:11], v[188:191], v[128:143]
    buffer_load_dwordx4 v[188:191], v2, s[68:71], s100 offen offset:3072 sc1
    v_mfma_f32_32x32x16_bf16 v[144:159], a[20:23], v[192:195], v[144:159]
    v_mfma_f32_32x32x16_bf16 v[128:143], a[16:19], v[192:195], v[128:143]
    s_add_u32 s100, s100, 4096
    buffer_load_dwordx4 v[192:195], v2, s[68:71], s100 offen offset:0 sc1
    s_add_u32 m0, s79, 35840
    s_add_u32 s83, s99, 1802240
    buffer_load_dwordx4 v29, s[52:55], s83 offen lds
    v_mfma_f32_32x32x16_bf16 v[144:159], a[28:31], v[196:199], v[144:159]
    s_waitcnt vmcnt(15)
    v_max3_u32 v9, v200, v204, v208
    v_max_u32 v9, v9, v212
    v_cmp_eq_u32 vcc, -1, v9
    v_mfma_f32_32x32x16_bf16 v[128:143], a[24:27], v[196:199], v[128:143]
    s_cbranch_vccnz L_redo_21
L_back_22:
    buffer_load_dwordx4 v[196:199], v2, s[68:71], s100 offen offset:1024 sc1
    v_mfma_f32_32x32x16_bf16 v[144:159], a[36:39], v[200:203], v[144:159]
    v_mfma_f32_32x32x16_bf16 v[128:143], a[32:35], v[200:203], v[128:143]
    buffer_load_dwordx4 v[200:203], v2, s[68:71], s100 offen offset:2048 sc1
    s_add_u32 m0, s79, 16384
    s_add_u32 s83, s99, 1245184
    buffer_load_dwordx4 v29, s[52:55], s83 offen lds
    v_mfma_f32_32x32x16_bf16 v[144:159], a[44:47], v[204:207], v[144:159]
    v_mfma_f32_32x32x16_bf16 v[128:143], a[40:43], v[204:207], v[128:143]
    buffer_load_dwordx4 v[204:207], v2, s[68:71], s100 offen offset:3072 sc1
    v_mfma_f32_32x32x16_bf16 v[144:159], a[52:55], v[208:211], v[144:159]
    v_mfma_f32_32x32x16_bf16 v[128:143], a[48:51], v[208:211], v[128:143]
    s_add_u32 s100, s100, 4096
    buffer_load_dwordx4 v[208:211], v2, s[68:71], s100 offen offset:0 sc1
    s_add_u32 m0, s79, 17408
    s_add_u32 s83, s99, 1277952
    buffer_load_dwordx4 v29, s[52:55], s83 offen lds
    v_mfma_f32_32x32x16_bf16 v[144:159], a[60:63], v[212:215], v[144:159]
    s_waitcnt vmcnt(17)
    v_max3_u32 v9, v216, v220, v224
    v_max_u32 v9, v9, v228
    v_cmp_eq_u32 vcc, -1, v9
    v_mfma_f32_32x32x16_bf16 v[128:143], a[56:59], v[212:215], v[128:143]
    s_cbranch_vccnz L_redo_23
L_back_24:
    buffer_load_dwordx4 v[212:215], v2, s[68:71], s100 offen offset:1024 sc1
    v_mfma_f32_32x32x16_bf16 v[144:159], a[68:71], v[216:219], v[144:159]
    v_mfma_f32_32x32x16_bf16 v[128:143], a[64:67], v[216:219], v[128:143]
    buffer_load_dwordx4 v[216:219], v2, s[68:71], s100 offen offset:2048 sc1
    s_add_u32 m0, s79, 18432
    s_add_u32 s83, s99, 1310720
    buffer_load_dwordx4 v29, s[52:55], s83 offen lds
    v_mfma_f32_32x32x16_bf16 v[144:159], a[76:79], v[220:223], v[144:159]
    v_mfma_f32_32x32x16_bf16 v[128:143], a[72:75], v[220:223], v[128:143]
    buffer_load_dwordx4 v[220:223], v2, s[68:71], s100 offen offset:3072 sc1
    v_mfma_f32_32x32x16_bf16 v[144:159], a[84:87], v[224:227], v[144:159]
    v_mfma_f32_32x32x16_bf16 v[128:143], a[80:83], v[224:227], v[128:143]
    s_add_u32 s100, s100, 4096
    buffer_load_dwordx4 v[224:227], v2, s[68:71], s100 offen offset:0 sc1
    s_add_u32 m0, s79, 19456
    s_add_u32 s83, s99, 1343488
    buffer_load_dwordx4 v29, s[52:55], s83 offen lds
    v_mfma_f32_32x32x16_bf16 v[144:159], a[92:95], v[228:231], v[144:159]
    s_waitcnt vmcnt(19)
    v_max3_u32 v9, v232, v236, v240
    v_max_u32 v9, v9, v244
    v_cmp_eq_u32 vcc, -1, v9
    v_mfma_f32_32x32x16_bf16 v[128:143], a[88:91], v[228:231], v[128:143]
    s_cbranch_vccnz L_redo_25
L_back_26:
    buffer_load_dwordx4 v[228:231], v2, s[68:71], s100 offen offset:1024 sc1
    v_mfma_f32_32x32x16_bf16 v[144:159], a[100:103], v[232:235], v[144:159]
    v_mfma_f32_32x32x16_bf16 v[128:143], a[96:99], v[232:235], v[128:143]
    buffer_load_dwordx4 v[232:235], v2, s[68:71], s100 offen offset:2048 sc1
    s_add_u32 m0, s79, 20480
    s_add_u32 s83, s99, 1376256
    buffer_load_dwordx4 v29, s[52:55], s83 offen lds
    v_mfma_f32_32x32x16_bf16 v[144:159], a[108:111], v[236:239], v[144:159]
    v_mfma_f32_32x32x16_bf16 v[128:143], a[104:107], v[236:239], v[128:143]
    buffer_load_dwordx4 v[236:239], v2, s[68:71], s100 offen offset:3072 sc1
    v_mfma_f32_32x32x16_bf16 v[144:159], a[116:119], v[240:243], v[144:159]
    v_mfma_f32_32x32x16_bf16 v[128:143], a[112:115], v[240:243], v[128:143]
    s_lshl_b32 s100, s75, 18
    s_lshl_b32 s81, s3, 15
    s_add_u32 s100, s100, s81
    s_add_u32 s100, s100, 6422528
    buffer_load_dwordx4 v[240:243], v2, s[68:71], s100 offen offset:0 sc1
    s_add_u32 m0, s79, 21504
    s_add_u32 s83, s99, 1409024
    buffer_load_dwordx4 v29, s[52:55], s83 offen lds
    v_mfma_f32_32x32x16_bf16 v[144:159], a[124:127], v[244:247], v[144:159]
    s_waitcnt vmcnt(20)
    v_max3_u32 v9, v120, v124, v184
    v_max_u32 v9, v9, v188
    v_cmp_eq_u32 vcc, -1, v9
    v_mfma_f32_32x32x16_bf16 v[128:143], a[120:123], v[244:247], v[128:143]
    s_cbranch_vccnz L_redo_27
L_back_28:
    buffer_load_dwordx4 v[244:247], v2, s[68:71], s100 offen offset:1024 sc1
    v_mfma_f32_32x32x16_bf16 v[144:159], a[132:135], v[120:123], v[144:159]
    v_mfma_f32_32x32x16_bf16 v[128:143], a[128:131], v[120:123], v[128:143]
    buffer_load_dwordx4 v[120:123], v2, s[68:71], s100 offen offset:2048 sc1
    s_add_u32 m0, s79, 22528
    s_add_u32 s83, s99, 1441792
    buffer_load_dwordx4 v29, s[52:55], s83 offen lds
    v_mfma_f32_32x32x16_bf16 v[144:159], a[140:143], v[124:127], v[144:159]
    v_mfma_f32_32x32x16_bf16 v[128:143], a[136:139], v[124:127], v[128:143]
    buffer_load_dwordx4 v[124:127], v2, s[68:71], s100 offen offset:3072 sc1
    v_mfma_f32_32x32x16_bf16 v[144:159], a[148:151], v[184:187], v[144:159]
    v_mfma_f32_32x32x16_bf16 v[128:143], a[144:147], v[184:187], v[128:143]
    s_add_u32 s100, s100, 4096
    buffer_load_dwordx4 v[184:187], v2, s[68:71], s100 offen offset:0 sc1
    s_add_u32 m0, s79, 23552
    s_add_u32 s83, s99, 1474560
    buffer_load_dwordx4 v29, s[52:55], s83 offen lds
    v_mfma_f32_32x32x16_bf16 v[144:159], a[156:159], v[188:191], v[144:159]
    s_waitcnt vmcnt(20)
    v_max3_u32 v9, v192, v196, v200
    v_max_u32 v9, v9, v204
    v_cmp_eq_u32 vcc, -1, v9
    v_mfma_f32_32x32x16_bf16 v[128:143], a[152:155], v[188:191], v[128:143]
    s_cbranch_vccnz L_redo_29
L_back_30:
    buffer_load_dwordx4 v[188:191], v2, s[68:71], s100 offen offset:1024 sc1
    v_mfma_f32_32x32x16_bf16 v[144:159], a[164:167], v[192:195], v[144:159]
    v_mfma_f32_32x32x16_bf16 v[128:143], a[160:163], v[192:195], v[128:143]
    buffer_load_dwordx4 v[192:195], v2, s[68:71], s100 offen offset:2048 sc1
    s_add_u32 m0, s79, 24576
    s_add_u32 s83, s99, 1507328
    buffer_load_dwordx4 v29, s[52:55], s83 offen lds
    s_lshl_b32 s80, s84, 9
    s_add_u32 s80, s80, s79
    v_add_u32 v7, s80, v3
    s_xor_b32 s80, s80, 512
    v_add_u32 v8, s80, v3
    ds_read_b64_tr_b16 v[112:113], v7 offset:34816
    ds_read_b64_tr_b16 v[114:115], v7 offset:35840
    ds_read_b64_tr_b16 v[116:117], v8 offset:34816
    ds_read_b64_tr_b16 v[118:119], v8 offset:35840
    v_mfma_f32_32x32x16_bf16 v[144:159], a[172:175], v[196:199], v[144:159]
    v_mfma_f32_32x32x16_bf16 v[128:143], a[168:171], v[196:199], v[128:143]
    buffer_load_dwordx4 v[196:199], v2, s[68:71], s100 offen offset:3072 sc1
    v_mfma_f32_32x32x16_bf16 v[144:159], a[180:183], v[200:203], v[144:159]
    v_mfma_f32_32x32x16_bf16 v[128:143], a[176:179], v[200:203], v[128:143]
    s_add_u32 s100, s100, 4096
    buffer_load_dwordx4 v[200:203], v2, s[68:71], s100 offen offset:0 sc1
    s_add_u32 m0, s79, 25600
    s_add_u32 s83, s99, 1540096
    buffer_load_dwordx4 v29, s[52:55], s83 offen lds
    v_mfma_f32_32x32x16_bf16 v[144:159], a[188:191], v[204:207], v[144:159]
    s_waitcnt vmcnt(20)
    v_max3_u32 v9, v208, v212, v216
    v_max_u32 v9, v9, v220
    v_cmp_eq_u32 vcc, -1, v9
    v_mfma_f32_32x32x16_bf16 v[128:143], a[184:187], v[204:207], v[128:143]
    s_cbranch_vccnz L_redo_31
L_back_32:
    buffer_load_dwordx4 v[204:207], v2, s[68:71], s100 offen offset:1024 sc1
    v_mfma_f32_32x32x16_bf16 v[144:159], a[196:199], v[208:211], v[144:159]
    v_mfma_f32_32x32x16_bf16 v[128:143], a[192:195], v[208:211], v[128:143]
    buffer_load_dwordx4 v[208:211], v2, s[68:71], s100 offen offset:2048 sc1
    s_add_u32 m0, s79, 26624
    s_add_u32 s83, s99, 1572864
    buffer_load_dwordx4 v29, s[52:55], s83 offen lds
    v_mfma_f32_32x32x16_bf16 v[144:159], a[204:207], v[212:215], v[144:159]
    v_mfma_f32_32x32x16_bf16 v[128:143], a[200:203], v[212:215], v[128:143]
    buffer_load_dwordx4 v[212:215], v2, s[68:71], s100 offen offset:3072 sc1
    v_mfma_f32_32x32x16_bf16 v[144:159], a[212:215], v[216:219], v[144:159]
    v_mfma_f32_32x32x16_bf16 v[128:143], a[208:211], v[216:219], v[128:143]
    s_add_u32 s100, s100, 4096
    buffer_load_dwordx4 v[216:219], v2, s[68:71], s100 offen offset:0 sc1
    s_add_u32 m0, s79, 27648
    s_add_u32 s83, s99, 1605632
    buffer_load_dwordx4 v29, s[52:55], s83 offen lds
    v_mfma_f32_32x32x16_bf16 v[144:159], a[220:223], v[220:223], v[144:159]
    s_waitcnt vmcnt(20)
    v_max3_u32 v9, v224, v228, v232
    v_max_u32 v9, v9, v236
    v_cmp_eq_u32 vcc, -1, v9
    v_mfma_f32_32x32x16_bf16 v[128:143], a[216:219], v[220:223], v[128:143]
    s_cbranch_vccnz L_redo_33
L_back_34:
    buffer_load_dwordx4 v[220:223], v2, s[68:71], s100 offen offset:1024 sc1
    v_mfma_f32_32x32x16_bf16 v[144:159], a[228:231], v[224:227], v[144:159]
    v_mfma_f32_32x32x16_bf16 v[144:159], a[236:239], v[228:231], v[144:159]
    v_mfma_f32_32x32x16_bf16 v[144:159], a[244:247], v[232:235], v[144:159]
    v_mfma_f32_32x32x16_bf16 v[144:159], a[252:255], v[236:239], v[144:159]
    v_mfma_f32_32x32x16_bf16 v[128:143], a[224:227], v[224:227], v[128:143]
    v_lshlrev_b32 v176, 16, v14
    v_and_b32 v177, 0xffff0000, v14
    v_lshlrev_b32 v178, 16, v15
    v_and_b32 v179, 0xffff0000, v15
    v_lshlrev_b32 v180, 16, v16
    v_and_b32 v181, 0xffff0000, v16
    v_lshlrev_b32 v182, 16, v17
    v_and_b32 v183, 0xffff0000, v17
    buffer_load_dwordx4 v[224:227], v2, s[68:71], s100 offen offset:2048 sc1
    s_add_u32 m0, s79, 28672
    s_add_u32 s83, s99, 1638400
    buffer_load_dwordx4 v29, s[52:55], s83 offen lds
    v_mfma_f32_32x32x16_bf16 v[128:143], a[232:235], v[228:231], v[128:143]
    ds_write_b128 v252, v[144:147] offset:0
    buffer_load_dwordx4 v[228:231], v2, s[68:71], s100 offen offset:3072 sc1
    s_add_u32 m0, s79, 29696
    s_add_u32 s83, s99, 1671168
    buffer_load_dwordx4 v29, s[52:55], s83 offen lds
    v_mfma_f32_32x32x16_bf16 v[128:143], a[240:243], v[232:235], v[128:143]
    ds_write_b128 v252, v[148:151] offset:1024
    s_add_u32 s100, s100, 4096
    buffer_load_dwordx4 v[232:235], v2, s[68:71], s100 offen offset:0 sc1
    s_add_u32 m0, s79, 30720
    s_add_u32 s83, s99, 1703936
    buffer_load_dwordx4 v29, s[52:55], s83 offen lds
    v_mfma_f32_32x32x16_bf16 v[128:143], a[248:251], v[236:239], v[128:143]
    ds_write_b128 v252, v[152:155] offset:4096
    buffer_load_dwordx4 v[236:239], v2, s[68:71], s100 offen offset:1024 sc1
    s_add_u32 m0, s79, 31744
    s_add_u32 s83, s99, 1736704
    buffer_load_dwordx4 v29, s[52:55], s83 offen lds
    ds_write_b128 v252, v[156:159] offset:5120
    s_nop 5
    ds_write_b128 v252, v[136:139] offset:2048
    ds_write_b128 v252, v[140:143] offset:3072
    s_mul_i32 s93, s75, 229376
    s_lshl_b32 s81, s78, 12
    s_add_u32 s93, s93, s81
    s_lshl_b32 s81, s84, 11
    s_add_u32 s93, s93, s81
    s_lshl_b32 s81, s85, 10
    s_add_u32 s93, s93, s81
    s_add_u32 s93, s93, 10485760
    v_pk_add_f32 v[176:177], v[176:177], v[128:129]
    v_pk_add_f32 v[178:179], v[178:179], v[130:131]
    v_pk_add_f32 v[180:181], v[180:181], v[132:133]
    v_pk_add_f32 v[182:183], v[182:183], v[134:135]
    s_waitcnt lgkmcnt(0)
    s_barrier
    ds_read_b128 v[136:139], v253 offset:0
    ds_read_b128 v[140:143], v253 offset:1024
    ds_read_b128 v[144:147], v254 offset:0
    ds_read_b128 v[148:151], v254 offset:1024
    ds_read_b128 v[152:155], v0 offset:0
    ds_read_b128 v[156:159], v0 offset:1024
    s_waitcnt lgkmcnt(4)
    v_pk_add_f32 v[176:177], v[176:177], v[136:137]
    v_pk_add_f32 v[178:179], v[178:179], v[138:139]
    v_pk_add_f32 v[180:181], v[180:181], v[140:141]
    v_pk_add_f32 v[182:183], v[182:183], v[142:143]
    s_waitcnt lgkmcnt(0)
    s_barrier
    v_pk_add_f32 v[144:145], v[144:145], v[152:153]
    v_pk_add_f32 v[146:147], v[146:147], v[154:155]
    v_pk_add_f32 v[148:149], v[148:149], v[156:157]
    v_pk_add_f32 v[150:151], v[150:151], v[158:159]
    v_pk_add_f32 v[176:177], v[176:177], v[144:145]
    v_pk_add_f32 v[178:179], v[178:179], v[146:147]
    v_pk_add_f32 v[180:181], v[180:181], v[148:149]
    v_pk_add_f32 v[182:183], v[182:183], v[150:151]
    v_pk_mul_f32 v[128:129], v[176:177], v[176:177]
    v_pk_mul_f32 v[130:131], v[178:179], v[178:179]
    v_pk_mul_f32 v[132:133], v[180:181], v[180:181]
    v_pk_mul_f32 v[134:135], v[182:183], v[182:183]
    v_pk_fma_f32 v[128:129], v[128:129], v[160:161], v[160:161] op_sel:[0,0,1] op_sel_hi:[1,0,1]
    v_pk_fma_f32 v[130:131], v[130:131], v[160:161], v[160:161] op_sel:[0,0,1] op_sel_hi:[1,0,1]
    v_pk_fma_f32 v[132:133], v[132:133], v[160:161], v[160:161] op_sel:[0,0,1] op_sel_hi:[1,0,1]
    v_pk_fma_f32 v[134:135], v[134:135], v[160:161], v[160:161] op_sel:[0,0,1] op_sel_hi:[1,0,1]
    v_pk_mul_f32 v[128:129], v[128:129], v[176:177]
    v_pk_mul_f32 v[130:131], v[130:131], v[178:179]
    v_pk_mul_f32 v[132:133], v[132:133], v[180:181]
    v_pk_mul_f32 v[134:135], v[134:135], v[182:183]
    v_exp_f32 v128, v128
    v_exp_f32 v129, v129
    v_exp_f32 v130, v130
    v_exp_f32 v131, v131
    v_exp_f32 v132, v132
    v_exp_f32 v133, v133
    v_exp_f32 v134, v134
    v_exp_f32 v135, v135
    v_pk_add_f32 v[128:129], v[128:129], v[162:163] op_sel:[0,0] op_sel_hi:[1,0]
    v_pk_add_f32 v[130:131], v[130:131], v[162:163] op_sel:[0,0] op_sel_hi:[1,0]
    v_pk_add_f32 v[132:133], v[132:133], v[162:163] op_sel:[0,0] op_sel_hi:[1,0]
    v_pk_add_f32 v[134:135], v[134:135], v[162:163] op_sel:[0,0] op_sel_hi:[1,0]
    v_rcp_f32 v128, v128
    v_rcp_f32 v129, v129
    v_rcp_f32 v130, v130
    v_rcp_f32 v131, v131
    v_rcp_f32 v132, v132
    v_rcp_f32 v133, v133
    v_rcp_f32 v134, v134
    v_rcp_f32 v135, v135
    v_pk_mul_f32 v[176:177], v[176:177], v[128:129]
    v_pk_mul_f32 v[178:179], v[178:179], v[130:131]
    v_pk_mul_f32 v[180:181], v[180:181], v[132:133]
    v_pk_mul_f32 v[182:183], v[182:183], v[134:135]
    v_cvt_pk_bf16_f32 v176, v176, v177
    v_cvt_pk_bf16_f32 v177, v178, v179
    v_cvt_pk_bf16_f32 v178, v180, v181
    v_cvt_pk_bf16_f32 v179, v182, v183
    buffer_store_dwordx4 v[176:179], v2, s[68:71], s93 offen sc1
    s_lshl_b32 s80, s84, 9
    s_add_u32 s80, s80, s79
    v_add_u32 v7, s80, v3
    s_xor_b32 s80, s80, 512
    v_add_u32 v8, s80, v3
    ds_read_b64_tr_b16 v[48:49], v7 offset:16384
    ds_read_b64_tr_b16 v[50:51], v7 offset:17408
    ds_read_b64_tr_b16 v[52:53], v8 offset:16384
    ds_read_b64_tr_b16 v[54:55], v8 offset:17408
    ds_read_b64_tr_b16 v[56:57], v7 offset:18432
    ds_read_b64_tr_b16 v[58:59], v7 offset:19456
    ds_read_b64_tr_b16 v[60:61], v8 offset:18432
    ds_read_b64_tr_b16 v[62:63], v8 offset:19456
    s_waitcnt vmcnt(28)
    ds_read_b64_tr_b16 v[64:65], v7 offset:20480
    ds_read_b64_tr_b16 v[66:67], v7 offset:21504
    ds_read_b64_tr_b16 v[68:69], v8 offset:20480
    ds_read_b64_tr_b16 v[70:71], v8 offset:21504
    s_waitcnt vmcnt(22)
    ds_read_b64_tr_b16 v[72:73], v7 offset:22528
    ds_read_b64_tr_b16 v[74:75], v7 offset:23552
    ds_read_b64_tr_b16 v[76:77], v8 offset:22528
    ds_read_b64_tr_b16 v[78:79], v8 offset:23552
    s_waitcnt vmcnt(16)
    ds_read_b64_tr_b16 v[80:81], v7 offset:24576
    ds_read_b64_tr_b16 v[82:83], v7 offset:25600
    ds_read_b64_tr_b16 v[84:85], v8 offset:24576
    ds_read_b64_tr_b16 v[86:87], v8 offset:25600
    s_waitcnt vmcnt(10)
    ds_read_b64_tr_b16 v[88:89], v7 offset:26624
    ds_read_b64_tr_b16 v[90:91], v7 offset:27648
    ds_read_b64_tr_b16 v[92:93], v8 offset:26624
    ds_read_b64_tr_b16 v[94:95], v8 offset:27648
    s_waitcnt vmcnt(5)
    ds_read_b64_tr_b16 v[96:97], v7 offset:28672
    ds_read_b64_tr_b16 v[98:99], v7 offset:29696
    ds_read_b64_tr_b16 v[100:101], v8 offset:28672
    ds_read_b64_tr_b16 v[102:103], v8 offset:29696
    s_waitcnt vmcnt(1)
    ds_read_b64_tr_b16 v[104:105], v7 offset:30720
    ds_read_b64_tr_b16 v[106:107], v7 offset:31744
    ds_read_b64_tr_b16 v[108:109], v8 offset:30720
    ds_read_b64_tr_b16 v[110:111], v8 offset:31744
    s_waitcnt lgkmcnt(0)
    v_max3_u32 v9, v240, v244, v120
    v_max_u32 v9, v9, v124
    v_cmp_eq_u32 vcc, -1, v9
    s_cbranch_vccnz L_redo_35
L_back_36:
    v_mfma_f32_32x32x16_bf16 v[144:159], a[4:7], v[240:243], 0
    v_mfma_f32_32x32x16_bf16 v[128:143], a[0:3], v[240:243], 0
    buffer_load_dwordx4 v[240:243], v2, s[68:71], s100 offen offset:2048 sc1
    v_mfma_f32_32x32x16_bf16 v[144:159], a[12:15], v[244:247], v[144:159]
    v_mfma_f32_32x32x16_bf16 v[128:143], a[8:11], v[244:247], v[128:143]
    buffer_load_dwordx4 v[244:247], v2, s[68:71], s100 offen offset:3072 sc1
    v_mfma_f32_32x32x16_bf16 v[144:159], a[20:23], v[120:123], v[144:159]
    v_mfma_f32_32x32x16_bf16 v[128:143], a[16:19], v[120:123], v[128:143]
    s_add_u32 s100, s100, 4096
    buffer_load_dwordx4 v[120:123], v2, s[68:71], s100 offen offset:0 sc1
    v_mfma_f32_32x32x16_bf16 v[144:159], a[28:31], v[124:127], v[144:159]
    v_max3_u32 v9, v184, v188, v192
    v_max_u32 v9, v9, v196
    v_cmp_eq_u32 vcc, -1, v9
    v_mfma_f32_32x32x16_bf16 v[128:143], a[24:27], v[124:127], v[128:143]
    s_cbranch_vccnz L_redo_37
L_back_38:
    buffer_load_dwordx4 v[124:127], v2, s[68:71], s100 offen offset:1024 sc1
    v_mfma_f32_32x32x16_bf16 v[144:159], a[36:39], v[184:187], v[144:159]
    v_mfma_f32_32x32x16_bf16 v[128:143], a[32:35], v[184:187], v[128:143]
    buffer_load_dwordx4 v[184:187], v2, s[68:71], s100 offen offset:2048 sc1
    v_mfma_f32_32x32x16_bf16 v[144:159], a[44:47], v[188:191], v[144:159]
    v_mfma_f32_32x32x16_bf16 v[128:143], a[40:43], v[188:191], v[128:143]
    buffer_load_dwordx4 v[188:191], v2, s[68:71], s100 offen offset:3072 sc1
    v_mfma_f32_32x32x16_bf16 v[144:159], a[52:55], v[192:195], v[144:159]
    v_mfma_f32_32x32x16_bf16 v[128:143], a[48:51], v[192:195], v[128:143]
    s_add_u32 s100, s100, 4096
    buffer_load_dwordx4 v[192:195], v2, s[68:71], s100 offen offset:0 sc1
    v_mfma_f32_32x32x16_bf16 v[144:159], a[60:63], v[196:199], v[144:159]
    v_max3_u32 v9, v200, v204, v208
    v_max_u32 v9, v9, v212
    v_cmp_eq_u32 vcc, -1, v9
    v_mfma_f32_32x32x16_bf16 v[128:143], a[56:59], v[196:199], v[128:143]
    s_cbranch_vccnz L_redo_39
L_back_40:
    buffer_load_dwordx4 v[196:199], v2, s[68:71], s100 offen offset:1024 sc1
    v_mfma_f32_32x32x16_bf16 v[144:159], a[68:71], v[200:203], v[144:159]
    v_mfma_f32_32x32x16_bf16 v[128:143], a[64:67], v[200:203], v[128:143]
    buffer_load_dwordx4 v[200:203], v2, s[68:71], s100 offen offset:2048 sc1
    v_mfma_f32_32x32x16_bf16 v[144:159], a[76:79], v[204:207], v[144:159]
    v_mfma_f32_32x32x16_bf16 v[128:143], a[72:75], v[204:207], v[128:143]
    buffer_load_dwordx4 v[204:207], v2, s[68:71], s100 offen offset:3072 sc1
    v_mfma_f32_32x32x16_bf16 v[144:159], a[84:87], v[208:211], v[144:159]
    v_mfma_f32_32x32x16_bf16 v[128:143], a[80:83], v[208:211], v[128:143]
    s_add_u32 s100, s100, 4096
    buffer_load_dwordx4 v[208:211], v2, s[68:71], s100 offen offset:0 sc1
    v_mfma_f32_32x32x16_bf16 v[144:159], a[92:95], v[212:215], v[144:159]
    v_max3_u32 v9, v216, v220, v224
    v_max_u32 v9, v9, v228
    v_cmp_eq_u32 vcc, -1, v9
    v_mfma_f32_32x32x16_bf16 v[128:143], a[88:91], v[212:215], v[128:143]
    s_cbranch_vccnz L_redo_41
L_back_42:
    buffer_load_dwordx4 v[212:215], v2, s[68:71], s100 offen offset:1024 sc1
    v_mfma_f32_32x32x16_bf16 v[144:159], a[100:103], v[216:219], v[144:159]
    v_mfma_f32_32x32x16_bf16 v[128:143], a[96:99], v[216:219], v[128:143]
    buffer_load_dwordx4 v[216:219], v2, s[68:71], s100 offen offset:2048 sc1
    s_add_u32 m0, s79, 16384
    s_add_u32 s83, s99, 524288
    buffer_load_dwordx4 v29, s[52:55], s83 offen lds
    v_mfma_f32_32x32x16_bf16 v[144:159], a[108:111], v[220:223], v[144:159]
    v_mfma_f32_32x32x16_bf16 v[128:143], a[104:107], v[220:223], v[128:143]
    buffer_load_dwordx4 v[220:223], v2, s[68:71], s100 offen offset:3072 sc1
    s_add_u32 m0, s79, 17408
    s_add_u32 s83, s99, 557056
    buffer_load_dwordx4 v29, s[52:55], s83 offen lds
    v_mfma_f32_32x32x16_bf16 v[144:159], a[116:119], v[224:227], v[144:159]
    v_mfma_f32_32x32x16_bf16 v[128:143], a[112:115], v[224:227], v[128:143]
    s_add_u32 m0, s79, 18432
    s_add_u32 s83, s99, 589824
    buffer_load_dwordx4 v29, s[52:55], s83 offen lds
    v_mfma_f32_32x32x16_bf16 v[144:159], a[124:127], v[228:231], v[144:159]
    s_waitcnt vmcnt(15)
    v_max3_u32 v9, v232, v236, v240
    v_max_u32 v9, v9, v244
    v_cmp_eq_u32 vcc, -1, v9
    v_mfma_f32_32x32x16_bf16 v[128:143], a[120:123], v[228:231], v[128:143]
    s_cbranch_vccnz L_redo_43
L_back_44:
    s_add_u32 m0, s79, 19456
    s_add_u32 s83, s99, 622592
    buffer_load_dwordx4 v29, s[52:55], s83 offen lds
    v_mfma_f32_32x32x16_bf16 v[144:159], a[132:135], v[232:235], v[144:159]
    v_mfma_f32_32x32x16_bf16 v[128:143], a[128:131], v[232:235], v[128:143]
    s_add_u32 m0, s79, 20480
    s_add_u32 s83, s99, 655360
    buffer_load_dwordx4 v29, s[52:55], s83 offen lds
    v_mfma_f32_32x32x16_bf16 v[144:159], a[140:143], v[236:239], v[144:159]
    v_mfma_f32_32x32x16_bf16 v[128:143], a[136:139], v[236:239], v[128:143]
    s_add_u32 m0, s79, 21504
    s_add_u32 s83, s99, 688128
    buffer_load_dwordx4 v29, s[52:55], s83 offen lds
    v_mfma_f32_32x32x16_bf16 v[144:159], a[148:151], v[240:243], v[144:159]
    v_mfma_f32_32x32x16_bf16 v[128:143], a[144:147], v[240:243], v[128:143]
    s_add_u32 m0, s79, 22528
    s_add_u32 s83, s99, 720896
    buffer_load_dwordx4 v29, s[52:55], s83 offen lds
    v_mfma_f32_32x32x16_bf16 v[144:159], a[156:159], v[244:247], v[144:159]
    s_waitcnt vmcnt(15)
    v_max3_u32 v9, v120, v124, v184
    v_max_u32 v9, v9, v188
    v_cmp_eq_u32 vcc, -1, v9
    v_mfma_f32_32x32x16_bf16 v[128:143], a[152:155], v[244:247], v[128:143]
    s_cbranch_vccnz L_redo_45
L_back_46:
    s_add_u32 m0, s79, 23552
    s_add_u32 s83, s99, 753664
    buffer_load_dwordx4 v29, s[52:55], s83 offen lds
    v_mfma_f32_32x32x16_bf16 v[144:159], a[164:167], v[120:123], v[144:159]
    v_mfma_f32_32x32x16_bf16 v[128:143], a[160:163], v[120:123], v[128:143]
    s_add_u32 m0, s79, 24576
    s_add_u32 s83, s99, 786432
    buffer_load_dwordx4 v29, s[52:55], s83 offen lds
    v_mfma_f32_32x32x16_bf16 v[144:159], a[172:175], v[124:127], v[144:159]
    v_mfma_f32_32x32x16_bf16 v[128:143], a[168:171], v[124:127], v[128:143]
    s_add_u32 m0, s79, 25600
    s_add_u32 s83, s99, 819200
    buffer_load_dwordx4 v29, s[52:55], s83 offen lds
    v_mfma_f32_32x32x16_bf16 v[144:159], a[180:183], v[184:187], v[144:159]
    v_mfma_f32_32x32x16_bf16 v[128:143], a[176:179], v[184:187], v[128:143]
    s_add_u32 m0, s79, 26624
    s_add_u32 s83, s99, 851968
    buffer_load_dwordx4 v29, s[52:55], s83 offen lds
    v_mfma_f32_32x32x16_bf16 v[144:159], a[188:191], v[188:191], v[144:159]
    s_waitcnt vmcnt(15)
    v_max3_u32 v9, v192, v196, v200
    v_max_u32 v9, v9, v204
    v_cmp_eq_u32 vcc, -1, v9
    v_mfma_f32_32x32x16_bf16 v[128:143], a[184:187], v[188:191], v[128:143]
    s_cbranch_vccnz L_redo_47
L_back_48:
    s_add_u32 m0, s79, 27648
    s_add_u32 s83, s99, 884736
    buffer_load_dwordx4 v29, s[52:55], s83 offen lds
    v_mfma_f32_32x32x16_bf16 v[144:159], a[196:199], v[192:195], v[144:159]
    v_mfma_f32_32x32x16_bf16 v[128:143], a[192:195], v[192:195], v[128:143]
    s_add_u32 m0, s79, 28672
    s_add_u32 s83, s99, 917504
    buffer_load_dwordx4 v29, s[52:55], s83 offen lds
    v_mfma_f32_32x32x16_bf16 v[144:159], a[204:207], v[196:199], v[144:159]
    v_mfma_f32_32x32x16_bf16 v[128:143], a[200:203], v[196:199], v[128:143]
    s_add_u32 m0, s79, 29696
    s_add_u32 s83, s99, 950272
    buffer_load_dwordx4 v29, s[52:55], s83 offen lds
    v_mfma_f32_32x32x16_bf16 v[144:159], a[212:215], v[200:203], v[144:159]
    v_mfma_f32_32x32x16_bf16 v[128:143], a[208:211], v[200:203], v[128:143]
    s_add_u32 m0, s79, 30720
    s_add_u32 s83, s99, 983040
    buffer_load_dwordx4 v29, s[52:55], s83 offen lds
    v_mfma_f32_32x32x16_bf16 v[144:159], a[220:223], v[204:207], v[144:159]
    s_waitcnt vmcnt(14)
    v_max3_u32 v9, v208, v212, v216
    v_max_u32 v9, v9, v220
    v_cmp_eq_u32 vcc, -1, v9
    v_mfma_f32_32x32x16_bf16 v[128:143], a[216:219], v[204:207], v[128:143]
    s_cbranch_vccnz L_redo_49
L_back_50:
    s_add_u32 m0, s79, 31744
    s_add_u32 s83, s99, 1015808
    buffer_load_dwordx4 v29, s[52:55], s83 offen lds
    v_mfma_f32_32x32x16_bf16 v[144:159], a[228:231], v[208:211], v[144:159]
    v_mfma_f32_32x32x16_bf16 v[144:159], a[236:239], v[212:215], v[144:159]
    v_mfma_f32_32x32x16_bf16 v[144:159], a[244:247], v[216:219], v[144:159]
    v_mfma_f32_32x32x16_bf16 v[144:159], a[252:255], v[220:223], v[144:159]
    v_mfma_f32_32x32x16_bf16 v[128:143], a[224:227], v[208:211], v[128:143]
    v_lshlrev_b32 v176, 16, v14
    v_and_b32 v177, 0xffff0000, v14
    v_lshlrev_b32 v178, 16, v15
    v_and_b32 v179, 0xffff0000, v15
    v_lshlrev_b32 v180, 16, v16
    v_and_b32 v181, 0xffff0000, v16
    v_lshlrev_b32 v182, 16, v17
    v_and_b32 v183, 0xffff0000, v17
    s_mul_i32 s100, s76, 229376
    s_mul_i32 s81, s3, 28672
    s_add_u32 s100, s100, s81
    s_add_u32 s100, s100, 10485760
    buffer_load_dwordx4 v[224:227], v6, s[68:71], s100 offen offset:0 sc1
    buffer_load_dwordx4 v[228:231], v6, s[68:71], s100 offen offset:1024 sc1
    v_mfma_f32_32x32x16_bf16 v[128:143], a[232:235], v[212:215], v[128:143]
    ds_write_b128 v252, v[144:147] offset:0
    buffer_load_dwordx4 v[232:235], v6, s[68:71], s100 offen offset:2048 sc1
    buffer_load_dwordx4 v[236:239], v6, s[68:71], s100 offen offset:3072 sc1
    v_mfma_f32_32x32x16_bf16 v[128:143], a[240:243], v[216:219], v[128:143]
    ds_write_b128 v252, v[148:151] offset:1024
    s_add_u32 s100, s100, 4096
    buffer_load_dwordx4 v[240:243], v6, s[68:71], s100 offen offset:0 sc1
    buffer_load_dwordx4 v[244:247], v6, s[68:71], s100 offen offset:1024 sc1
    v_mfma_f32_32x32x16_bf16 v[128:143], a[248:251], v[220:223], v[128:143]
    ds_write_b128 v252, v[152:155] offset:4096
    buffer_load_dwordx4 v[120:123], v6, s[68:71], s100 offen offset:2048 sc1
    buffer_load_dwordx4 v[124:127], v6, s[68:71], s100 offen offset:3072 sc1
    ds_write_b128 v252, v[156:159] offset:5120
    s_nop 7
    ds_write_b128 v252, v[136:139] offset:2048
    ds_write_b128 v252, v[140:143] offset:3072
    s_add_u32 s100, s100, 4096
    buffer_load_dwordx4 v[184:187], v6, s[68:71], s100 offen offset:0 sc1
    buffer_load_dwordx4 v[188:191], v6, s[68:71], s100 offen offset:1024 sc1
    buffer_load_dwordx4 v[192:195], v6, s[68:71], s100 offen offset:2048 sc1
    buffer_load_dwordx4 v[196:199], v6, s[68:71], s100 offen offset:3072 sc1
    s_mul_i32 s93, s75, 229376
    s_lshl_b32 s81, s78, 12
    s_add_u32 s93, s93, s81
    s_lshl_b32 s81, s84, 11
    s_add_u32 s93, s93, s81
    s_lshl_b32 s81, s85, 10
    s_add_u32 s93, s93, s81
    s_add_u32 s93, s93, 10600448
    v_pk_add_f32 v[176:177], v[176:177], v[128:129]
    v_pk_add_f32 v[178:179], v[178:179], v[130:131]
    v_pk_add_f32 v[180:181], v[180:181], v[132:133]
    v_pk_add_f32 v[182:183], v[182:183], v[134:135]
    s_waitcnt lgkmcnt(0)
    s_barrier
    ds_read_b128 v[136:139], v253 offset:0
    ds_read_b128 v[140:143], v253 offset:1024
    ds_read_b128 v[144:147], v254 offset:0
    ds_read_b128 v[148:151], v254 offset:1024
    ds_read_b128 v[152:155], v0 offset:0
    ds_read_b128 v[156:159], v0 offset:1024
    s_waitcnt lgkmcnt(4)
    v_pk_add_f32 v[176:177], v[176:177], v[136:137]
    v_pk_add_f32 v[178:179], v[178:179], v[138:139]
    v_pk_add_f32 v[180:181], v[180:181], v[140:141]
    v_pk_add_f32 v[182:183], v[182:183], v[142:143]
    s_waitcnt lgkmcnt(0)
    s_barrier
    v_pk_add_f32 v[144:145], v[144:145], v[152:153]
    v_pk_add_f32 v[146:147], v[146:147], v[154:155]
    v_pk_add_f32 v[148:149], v[148:149], v[156:157]
    v_pk_add_f32 v[150:151], v[150:151], v[158:159]
    v_pk_add_f32 v[176:177], v[176:177], v[144:145]
    v_pk_add_f32 v[178:179], v[178:179], v[146:147]
    v_pk_add_f32 v[180:181], v[180:181], v[148:149]
    v_pk_add_f32 v[182:183], v[182:183], v[150:151]
    v_pk_mul_f32 v[128:129], v[176:177], v[176:177]
    v_pk_mul_f32 v[130:131], v[178:179], v[178:179]
    v_pk_mul_f32 v[132:133], v[180:181], v[180:181]
    v_pk_mul_f32 v[134:135], v[182:183], v[182:183]
    v_pk_fma_f32 v[128:129], v[128:129], v[160:161], v[160:161] op_sel:[0,0,1] op_sel_hi:[1,0,1]
    v_pk_fma_f32 v[130:131], v[130:131], v[160:161], v[160:161] op_sel:[0,0,1] op_sel_hi:[1,0,1]
    v_pk_fma_f32 v[132:133], v[132:133], v[160:161], v[160:161] op_sel:[0,0,1] op_sel_hi:[1,0,1]
    v_pk_fma_f32 v[134:135], v[134:135], v[160:161], v[160:161] op_sel:[0,0,1] op_sel_hi:[1,0,1]
    v_pk_mul_f32 v[128:129], v[128:129], v[176:177]
    v_pk_mul_f32 v[130:131], v[130:131], v[178:179]
    v_pk_mul_f32 v[132:133], v[132:133], v[180:181]
    v_pk_mul_f32 v[134:135], v[134:135], v[182:183]
    v_exp_f32 v128, v128
    v_exp_f32 v129, v129
    v_exp_f32 v130, v130
    v_exp_f32 v131, v131
    v_exp_f32 v132, v132
    v_exp_f32 v133, v133
    v_exp_f32 v134, v134
    v_exp_f32 v135, v135
    v_pk_add_f32 v[128:129], v[128:129], v[162:163] op_sel:[0,0] op_sel_hi:[1,0]
    v_pk_add_f32 v[130:131], v[130:131], v[162:163] op_sel:[0,0] op_sel_hi:[1,0]
    v_pk_add_f32 v[132:133], v[132:133], v[162:163] op_sel:[0,0] op_sel_hi:[1,0]
    v_pk_add_f32 v[134:135], v[134:135], v[162:163] op_sel:[0,0] op_sel_hi:[1,0]
    v_rcp_f32 v128, v128
    v_rcp_f32 v129, v129
    v_rcp_f32 v130, v130
    v_rcp_f32 v131, v131
    v_rcp_f32 v132, v132
    v_rcp_f32 v133, v133
    v_rcp_f32 v134, v134
    v_rcp_f32 v135, v135
    v_pk_mul_f32 v[176:177], v[176:177], v[128:129]
    v_pk_mul_f32 v[178:179], v[178:179], v[130:131]
    v_pk_mul_f32 v[180:181], v[180:181], v[132:133]
    v_pk_mul_f32 v[182:183], v[182:183], v[134:135]
    v_cvt_pk_bf16_f32 v176, v176, v177
    v_cvt_pk_bf16_f32 v177, v178, v179
    v_cvt_pk_bf16_f32 v178, v180, v181
    v_cvt_pk_bf16_f32 v179, v182, v183
    buffer_store_dwordx4 v[176:179], v2, s[68:71], s93 offen sc1
    s_add_u32 s100, s100, 4096
    buffer_load_dwordx4 v[200:203], v6, s[68:71], s100 offen offset:0 sc1
    buffer_load_dwordx4 v[204:207], v6, s[68:71], s100 offen offset:1024 sc1
    buffer_load_dwordx4 v[208:211], v6, s[68:71], s100 offen offset:2048 sc1
    buffer_load_dwordx4 v[212:215], v6, s[68:71], s100 offen offset:3072 sc1
    s_add_u32 s100, s100, 4096
    buffer_load_dwordx4 v[216:219], v6, s[68:71], s100 offen offset:0 sc1
    buffer_load_dwordx4 v[220:223], v6, s[68:71], s100 offen offset:1024 sc1
    s_branch L_p4_18
L_nop3_17:
    s_add_u32 m0, s79, 34816
    s_add_u32 s83, s99, 1769472
    buffer_load_dwordx4 v29, s[52:55], s83 offen lds
    s_add_u32 m0, s79, 35840
    s_add_u32 s83, s99, 1802240
    buffer_load_dwordx4 v29, s[52:55], s83 offen lds
    s_add_u32 m0, s79, 16384
    s_add_u32 s83, s99, 1245184
    buffer_load_dwordx4 v29, s[52:55], s83 offen lds
    s_add_u32 m0, s79, 17408
    s_add_u32 s83, s99, 1277952
    buffer_load_dwordx4 v29, s[52:55], s83 offen lds
    s_add_u32 m0, s79, 18432
    s_add_u32 s83, s99, 1310720
    buffer_load_dwordx4 v29, s[52:55], s83 offen lds
    s_add_u32 m0, s79, 19456
    s_add_u32 s83, s99, 1343488
    buffer_load_dwordx4 v29, s[52:55], s83 offen lds
    s_add_u32 m0, s79, 20480
    s_add_u32 s83, s99, 1376256
    buffer_load_dwordx4 v29, s[52:55], s83 offen lds
    s_add_u32 m0, s79, 21504
    s_add_u32 s83, s99, 1409024
    buffer_load_dwordx4 v29, s[52:55], s83 offen lds
    s_add_u32 m0, s79, 22528
    s_add_u32 s83, s99, 1441792
    buffer_load_dwordx4 v29, s[52:55], s83 offen lds
    s_add_u32 m0, s79, 23552
    s_add_u32 s83, s99, 1474560
    buffer_load_dwordx4 v29, s[52:55], s83 offen lds
    s_add_u32 m0, s79, 24576
    s_add_u32 s83, s99, 1507328
    buffer_load_dwordx4 v29, s[52:55], s83 offen lds
    s_add_u32 m0, s79, 25600
    s_add_u32 s83, s99, 1540096
    buffer_load_dwordx4 v29, s[52:55], s83 offen lds
    s_add_u32 m0, s79, 26624
    s_add_u32 s83, s99, 1572864
    buffer_load_dwordx4 v29, s[52:55], s83 offen lds
    s_add_u32 m0, s79, 27648
    s_add_u32 s83, s99, 1605632
    buffer_load_dwordx4 v29, s[52:55], s83 offen lds
    s_add_u32 m0, s79, 28672
    s_add_u32 s83, s99, 1638400
    buffer_load_dwordx4 v29, s[52:55], s83 offen lds
    s_add_u32 m0, s79, 29696
    s_add_u32 s83, s99, 1671168
    buffer_load_dwordx4 v29, s[52:55], s83 offen lds
    s_add_u32 m0, s79, 30720
    s_add_u32 s83, s99, 1703936
    buffer_load_dwordx4 v29, s[52:55], s83 offen lds
    s_add_u32 m0, s79, 31744
    s_add_u32 s83, s99, 1736704
    buffer_load_dwordx4 v29, s[52:55], s83 offen lds
    s_lshl_b32 s80, s84, 9
    s_add_u32 s80, s80, s79
    v_add_u32 v7, s80, v3
    s_xor_b32 s80, s80, 512
    v_add_u32 v8, s80, v3
    s_waitcnt vmcnt(16)
    ds_read_b64_tr_b16 v[112:113], v7 offset:34816
    ds_read_b64_tr_b16 v[114:115], v7 offset:35840
    ds_read_b64_tr_b16 v[116:117], v8 offset:34816
    ds_read_b64_tr_b16 v[118:119], v8 offset:35840
    s_waitcnt vmcnt(14)
    ds_read_b64_tr_b16 v[48:49], v7 offset:16384
    ds_read_b64_tr_b16 v[50:51], v7 offset:17408
    ds_read_b64_tr_b16 v[52:53], v8 offset:16384
    ds_read_b64_tr_b16 v[54:55], v8 offset:17408
    s_waitcnt vmcnt(12)
    ds_read_b64_tr_b16 v[56:57], v7 offset:18432
    ds_read_b64_tr_b16 v[58:59], v7 offset:19456
    ds_read_b64_tr_b16 v[60:61], v8 offset:18432
    ds_read_b64_tr_b16 v[62:63], v8 offset:19456
    s_waitcnt vmcnt(10)
    ds_read_b64_tr_b16 v[64:65], v7 offset:20480
    ds_read_b64_tr_b16 v[66:67], v7 offset:21504
    ds_read_b64_tr_b16 v[68:69], v8 offset:20480
    ds_read_b64_tr_b16 v[70:71], v8 offset:21504
    s_waitcnt vmcnt(8)
    ds_read_b64_tr_b16 v[72:73], v7 offset:22528
    ds_read_b64_tr_b16 v[74:75], v7 offset:23552
    ds_read_b64_tr_b16 v[76:77], v8 offset:22528
    ds_read_b64_tr_b16 v[78:79], v8 offset:23552
    s_waitcnt vmcnt(6)
    ds_read_b64_tr_b16 v[80:81], v7 offset:24576
    ds_read_b64_tr_b16 v[82:83], v7 offset:25600
    ds_read_b64_tr_b16 v[84:85], v8 offset:24576
    ds_read_b64_tr_b16 v[86:87], v8 offset:25600
    s_waitcnt vmcnt(4)
    ds_read_b64_tr_b16 v[88:89], v7 offset:26624
    ds_read_b64_tr_b16 v[90:91], v7 offset:27648
    ds_read_b64_tr_b16 v[92:93], v8 offset:26624
    ds_read_b64_tr_b16 v[94:95], v8 offset:27648
    s_waitcnt vmcnt(2)
    ds_read_b64_tr_b16 v[96:97], v7 offset:28672
    ds_read_b64_tr_b16 v[98:99], v7 offset:29696
    ds_read_b64_tr_b16 v[100:101], v8 offset:28672
    ds_read_b64_tr_b16 v[102:103], v8 offset:29696
    s_waitcnt vmcnt(0)
    ds_read_b64_tr_b16 v[104:105], v7 offset:30720
    ds_read_b64_tr_b16 v[106:107], v7 offset:31744
    ds_read_b64_tr_b16 v[108:109], v8 offset:30720
    ds_read_b64_tr_b16 v[110:111], v8 offset:31744
    s_waitcnt lgkmcnt(0)
    s_add_u32 m0, s79, 16384
    s_add_u32 s83, s99, 524288
    buffer_load_dwordx4 v29, s[52:55], s83 offen lds
    s_add_u32 m0, s79, 17408
    s_add_u32 s83, s99, 557056
    buffer_load_dwordx4 v29, s[52:55], s83 offen lds
    s_add_u32 m0, s79, 18432
    s_add_u32 s83, s99, 589824
    buffer_load_dwordx4 v29, s[52:55], s83 offen lds
    s_add_u32 m0, s79, 19456
    s_add_u32 s83, s99, 622592
    buffer_load_dwordx4 v29, s[52:55], s83 offen lds
    s_add_u32 m0, s79, 20480
    s_add_u32 s83, s99, 655360
    buffer_load_dwordx4 v29, s[52:55], s83 offen lds
    s_add_u32 m0, s79, 21504
    s_add_u32 s83, s99, 688128
    buffer_load_dwordx4 v29, s[52:55], s83 offen lds
    s_add_u32 m0, s79, 22528
    s_add_u32 s83, s99, 720896
    buffer_load_dwordx4 v29, s[52:55], s83 offen lds
    s_add_u32 m0, s79, 23552
    s_add_u32 s83, s99, 753664
    buffer_load_dwordx4 v29, s[52:55], s83 offen lds
    s_add_u32 m0, s79, 24576
    s_add_u32 s83, s99, 786432
    buffer_load_dwordx4 v29, s[52:55], s83 offen lds
    s_add_u32 m0, s79, 25600
    s_add_u32 s83, s99, 819200
    buffer_load_dwordx4 v29, s[52:55], s83 offen lds
    s_add_u32 m0, s79, 26624
    s_add_u32 s83, s99, 851968
    buffer_load_dwordx4 v29, s[52:55], s83 offen lds
    s_add_u32 m0, s79, 27648
    s_add_u32 s83, s99, 884736
    buffer_load_dwordx4 v29, s[52:55], s83 offen lds
    s_add_u32 m0, s79, 28672
    s_add_u32 s83, s99, 917504
    buffer_load_dwordx4 v29, s[52:55], s83 offen lds
    s_add_u32 m0, s79, 29696
    s_add_u32 s83, s99, 950272
    buffer_load_dwordx4 v29, s[52:55], s83 offen lds
    s_add_u32 m0, s79, 30720
    s_add_u32 s83, s99, 983040
    buffer_load_dwordx4 v29, s[52:55], s83 offen lds
    s_add_u32 m0, s79, 31744
    s_add_u32 s83, s99, 1015808
    buffer_load_dwordx4 v29, s[52:55], s83 offen lds
    v_and_b32 v251, 7, v1
    v_min_u32 v251, 6, v251
    v_lshlrev_b32 v251, 12, v251
    s_mul_i32 s97, s76, 229376
    s_mul_i32 s81, s3, 28672
    s_add_u32 s97, s97, s81
    s_add_u32 s97, s97, 10489840
    buffer_load_dword v250, v251, s[68:71], s97 offen sc1
    s_waitcnt vmcnt(0)
    v_cmp_eq_u32 vcc, -1, v250
    s_nop 1
    s_cbranch_vccz L_rdy_51
    s_mov_b32 s96, 0
L_spin_52:
    s_mov_b64 exec, vcc
    buffer_load_dword v250, v251, s[68:71], s97 offen sc1
    s_add_u32 s96, s96, 1
    s_waitcnt vmcnt(0)
    v_cmp_eq_u32 vcc, -1, v250
    s_nop 1
    s_cbranch_vccz L_out_53
    s_cmp_lt_u32 s96, 50000
    s_cbranch_scc1 L_spin_52
L_out_53:
    s_mov_b64 exec, -1
L_rdy_51:
    s_waitcnt vmcnt(0)
    s_mul_i32 s100, s76, 229376
    s_mul_i32 s81, s3, 28672
    s_add_u32 s100, s100, s81
    s_add_u32 s100, s100, 10485760
    buffer_load_dwordx4 v[224:227], v6, s[68:71], s100 offen offset:0 sc1
    buffer_load_dwordx4 v[228:231], v6, s[68:71], s100 offen offset:1024 sc1
    buffer_load_dwordx4 v[232:235], v6, s[68:71], s100 offen offset:2048 sc1
    buffer_load_dwordx4 v[236:239], v6, s[68:71], s100 offen offset:3072 sc1
    s_add_u32 s100, s100, 4096
    buffer_load_dwordx4 v[240:243], v6, s[68:71], s100 offen offset:0 sc1
    buffer_load_dwordx4 v[244:247], v6, s[68:71], s100 offen offset:1024 sc1
    buffer_load_dwordx4 v[120:123], v6, s[68:71], s100 offen offset:2048 sc1
    buffer_load_dwordx4 v[124:127], v6, s[68:71], s100 offen offset:3072 sc1
    s_add_u32 s100, s100, 4096
    buffer_load_dwordx4 v[184:187], v6, s[68:71], s100 offen offset:0 sc1
    buffer_load_dwordx4 v[188:191], v6, s[68:71], s100 offen offset:1024 sc1
    buffer_load_dwordx4 v[192:195], v6, s[68:71], s100 offen offset:2048 sc1
    buffer_load_dwordx4 v[196:199], v6, s[68:71], s100 offen offset:3072 sc1
    s_add_u32 s100, s100, 4096
    buffer_load_dwordx4 v[200:203], v6, s[68:71], s100 offen offset:0 sc1
    buffer_load_dwordx4 v[204:207], v6, s[68:71], s100 offen offset:1024 sc1
    buffer_load_dwordx4 v[208:211], v6, s[68:71], s100 offen offset:2048 sc1
    buffer_load_dwordx4 v[212:215], v6, s[68:71], s100 offen offset:3072 sc1
    s_add_u32 s100, s100, 4096
    buffer_load_dwordx4 v[216:219], v6, s[68:71], s100 offen offset:0 sc1
    buffer_load_dwordx4 v[220:223], v6, s[68:71], s100 offen offset:1024 sc1
    s_waitcnt vmcnt(0)
L_p4_18:
    s_lshl_b32 s80, s84, 9
    s_add_u32 s80, s80, s79
    v_add_u32 v249, s80, v3
    s_xor_b32 s80, s80, 512
    v_add_u32 v248, s80, v3
    s_add_u32 s97, s97, 114688
    v_lshlrev_b32 v13, 16, v13
    ds_read_b64_tr_b16 v[160:161], v248 offset:0
    ds_read_b64_tr_b16 v[162:163], v248 offset:1024
    ds_read_b64_tr_b16 v[164:165], v249 offset:0
    ds_read_b64_tr_b16 v[166:167], v249 offset:1024
    ds_read_b64_tr_b16 v[168:169], v248 offset:2048
    ds_read_b64_tr_b16 v[170:171], v248 offset:3072
    s_waitcnt vmcnt(15)
    v_max3_u32 v9, v224, v228, v232
    v_max_u32 v9, v9, v236
    v_cmp_eq_u32 vcc, -1, v9
    s_cbranch_vccnz L_redo_54
L_back_55:
    s_waitcnt lgkmcnt(4)
    v_mfma_f32_32x32x16_bf16 v[144:159], v[224:227], v[160:163], 0
    ds_read_b64_tr_b16 v[172:173], v249 offset:2048
    ds_read_b64_tr_b16 v[174:175], v249 offset:3072
    s_waitcnt lgkmcnt(4)
    v_mfma_f32_32x32x16_bf16 v[128:143], v[224:227], v[164:167], 0
    ds_read_b64_tr_b16 v[160:161], v248 offset:4096
    ds_read_b64_tr_b16 v[162:163], v248 offset:5120
    buffer_load_dwordx4 v[224:227], v6, s[68:71], s100 offen offset:2048 sc1
    s_waitcnt lgkmcnt(4)
    v_mfma_f32_32x32x16_bf16 v[144:159], v[228:231], v[168:171], v[144:159]
    ds_read_b64_tr_b16 v[164:165], v249 offset:4096
    ds_read_b64_tr_b16 v[166:167], v249 offset:5120
    s_waitcnt lgkmcnt(4)
    v_mfma_f32_32x32x16_bf16 v[128:143], v[228:231], v[172:175], v[128:143]
    ds_read_b64_tr_b16 v[168:169], v248 offset:6144
    ds_read_b64_tr_b16 v[170:171], v248 offset:7168
    buffer_load_dwordx4 v[228:231], v6, s[68:71], s100 offen offset:3072 sc1
    s_waitcnt lgkmcnt(4)
    v_mfma_f32_32x32x16_bf16 v[144:159], v[232:235], v[160:163], v[144:159]
    ds_read_b64_tr_b16 v[172:173], v249 offset:6144
    ds_read_b64_tr_b16 v[174:175], v249 offset:7168
    s_waitcnt lgkmcnt(4)
    v_mfma_f32_32x32x16_bf16 v[128:143], v[232:235], v[164:167], v[128:143]
    ds_read_b64_tr_b16 v[160:161], v248 offset:8192
    ds_read_b64_tr_b16 v[162:163], v248 offset:9216
    s_add_u32 s100, s100, 4096
    buffer_load_dwordx4 v[232:235], v6, s[68:71], s100 offen offset:0 sc1
    s_waitcnt lgkmcnt(4)
    v_mfma_f32_32x32x16_bf16 v[144:159], v[236:239], v[168:171], v[144:159]
    ds_read_b64_tr_b16 v[164:165], v249 offset:8192
    ds_read_b64_tr_b16 v[166:167], v249 offset:9216
    s_waitcnt vmcnt(14)
    v_max3_u32 v9, v240, v244, v120
    v_max_u32 v9, v9, v124
    v_cmp_eq_u32 vcc, -1, v9
    s_waitcnt lgkmcnt(4)
    v_mfma_f32_32x32x16_bf16 v[128:143], v[236:239], v[172:175], v[128:143]
    ds_read_b64_tr_b16 v[168:169], v248 offset:10240
    ds_read_b64_tr_b16 v[170:171], v248 offset:11264
    s_cbranch_vccnz L_redo_56
L_back_57:
    buffer_load_dwordx4 v[236:239], v6, s[68:71], s100 offen offset:1024 sc1
    s_waitcnt lgkmcnt(4)
    v_mfma_f32_32x32x16_bf16 v[144:159], v[240:243], v[160:163], v[144:159]
    ds_read_b64_tr_b16 v[172:173], v249 offset:10240
    ds_read_b64_tr_b16 v[174:175], v249 offset:11264
    s_waitcnt lgkmcnt(4)
    v_mfma_f32_32x32x16_bf16 v[128:143], v[240:243], v[164:167], v[128:143]
    ds_read_b64_tr_b16 v[160:161], v248 offset:12288
    ds_read_b64_tr_b16 v[162:163], v248 offset:13312
    buffer_load_dwordx4 v[240:243], v6, s[68:71], s100 offen offset:2048 sc1
    s_waitcnt lgkmcnt(4)
    v_mfma_f32_32x32x16_bf16 v[144:159], v[244:247], v[168:171], v[144:159]
    ds_read_b64_tr_b16 v[164:165], v249 offset:12288
    ds_read_b64_tr_b16 v[166:167], v249 offset:13312
    s_waitcnt lgkmcnt(4)
    v_mfma_f32_32x32x16_bf16 v[128:143], v[244:247], v[172:175], v[128:143]
    ds_read_b64_tr_b16 v[168:169], v248 offset:14336
    ds_read_b64_tr_b16 v[170:171], v248 offset:15360
    buffer_load_dwordx4 v[244:247], v6, s[68:71], s100 offen offset:3072 sc1
    s_waitcnt lgkmcnt(4)
    v_mfma_f32_32x32x16_bf16 v[144:159], v[120:123], v[160:163], v[144:159]
    ds_read_b64_tr_b16 v[172:173], v249 offset:14336
    ds_read_b64_tr_b16 v[174:175], v249 offset:15360
    s_waitcnt lgkmcnt(4)
    v_mfma_f32_32x32x16_bf16 v[128:143], v[120:123], v[164:167], v[128:143]
    ds_read_b64_tr_b16 v[160:161], v248 offset:16384
    ds_read_b64_tr_b16 v[162:163], v248 offset:17408
    s_add_u32 s100, s100, 4096
    buffer_load_dwordx4 v[120:123], v6, s[68:71], s100 offen offset:0 sc1
    s_waitcnt lgkmcnt(4)
    v_mfma_f32_32x32x16_bf16 v[144:159], v[124:127], v[168:171], v[144:159]
    ds_read_b64_tr_b16 v[164:165], v249 offset:16384
    ds_read_b64_tr_b16 v[166:167], v249 offset:17408
    s_waitcnt vmcnt(14)
    v_max3_u32 v9, v184, v188, v192
    v_max_u32 v9, v9, v196
    v_cmp_eq_u32 vcc, -1, v9
    s_waitcnt lgkmcnt(4)
    v_mfma_f32_32x32x16_bf16 v[128:143], v[124:127], v[172:175], v[128:143]
    ds_read_b64_tr_b16 v[168:169], v248 offset:18432
    ds_read_b64_tr_b16 v[170:171], v248 offset:19456
    s_cbranch_vccnz L_redo_58
L_back_59:
    buffer_load_dwordx4 v[124:127], v6, s[68:71], s100 offen offset:1024 sc1
    s_waitcnt lgkmcnt(4)
    v_mfma_f32_32x32x16_bf16 v[144:159], v[184:187], v[160:163], v[144:159]
    ds_read_b64_tr_b16 v[172:173], v249 offset:18432
    ds_read_b64_tr_b16 v[174:175], v249 offset:19456
    s_waitcnt lgkmcnt(4)
    v_mfma_f32_32x32x16_bf16 v[128:143], v[184:187], v[164:167], v[128:143]
    ds_read_b64_tr_b16 v[160:161], v248 offset:20480
    ds_read_b64_tr_b16 v[162:163], v248 offset:21504
    buffer_load_dwordx4 v[184:187], v6, s[68:71], s100 offen offset:2048 sc1
    s_waitcnt lgkmcnt(4)
    v_mfma_f32_32x32x16_bf16 v[144:159], v[188:191], v[168:171], v[144:159]
    ds_read_b64_tr_b16 v[164:165], v249 offset:20480
    ds_read_b64_tr_b16 v[166:167], v249 offset:21504
    s_waitcnt lgkmcnt(4)
    v_mfma_f32_32x32x16_bf16 v[128:143], v[188:191], v[172:175], v[128:143]
    ds_read_b64_tr_b16 v[168:169], v248 offset:22528
    ds_read_b64_tr_b16 v[170:171], v248 offset:23552
    buffer_load_dwordx4 v[188:191], v6, s[68:71], s100 offen offset:3072 sc1
    s_waitcnt lgkmcnt(4)
    v_mfma_f32_32x32x16_bf16 v[144:159], v[192:195], v[160:163], v[144:159]
    ds_read_b64_tr_b16 v[172:173], v249 offset:22528
    ds_read_b64_tr_b16 v[174:175], v249 offset:23552
    s_waitcnt lgkmcnt(4)
    v_mfma_f32_32x32x16_bf16 v[128:143], v[192:195], v[164:167], v[128:143]
    ds_read_b64_tr_b16 v[160:161], v248 offset:24576
    ds_read_b64_tr_b16 v[162:163], v248 offset:25600
    s_waitcnt lgkmcnt(4)
    v_mfma_f32_32x32x16_bf16 v[144:159], v[196:199], v[168:171], v[144:159]
    ds_read_b64_tr_b16 v[164:165], v249 offset:24576
    ds_read_b64_tr_b16 v[166:167], v249 offset:25600
    s_waitcnt vmcnt(12)
    v_max3_u32 v9, v200, v204, v208
    v_max_u32 v9, v9, v212
    v_cmp_eq_u32 vcc, -1, v9
    s_waitcnt lgkmcnt(4)
    v_mfma_f32_32x32x16_bf16 v[128:143], v[196:199], v[172:175], v[128:143]
    ds_read_b64_tr_b16 v[168:169], v248 offset:26624
    ds_read_b64_tr_b16 v[170:171], v248 offset:27648
    s_cbranch_vccnz L_redo_60
L_back_61:
    s_waitcnt lgkmcnt(4)
    v_mfma_f32_32x32x16_bf16 v[144:159], v[200:203], v[160:163], v[144:159]
    ds_read_b64_tr_b16 v[172:173], v249 offset:26624
    ds_read_b64_tr_b16 v[174:175], v249 offset:27648
    s_waitcnt lgkmcnt(4)
    v_mfma_f32_32x32x16_bf16 v[128:143], v[200:203], v[164:167], v[128:143]
    ds_read_b64_tr_b16 v[160:161], v248 offset:28672
    ds_read_b64_tr_b16 v[162:163], v248 offset:29696
    v_mov_b32 v176, -1
    v_mov_b32 v177, -1
    v_mov_b32 v178, -1
    v_mov_b32 v179, -1
    s_waitcnt lgkmcnt(4)
    v_mfma_f32_32x32x16_bf16 v[144:159], v[204:207], v[168:171], v[144:159]
    ds_read_b64_tr_b16 v[164:165], v249 offset:28672
    ds_read_b64_tr_b16 v[166:167], v249 offset:29696
    s_waitcnt lgkmcnt(4)
    v_mfma_f32_32x32x16_bf16 v[128:143], v[204:207], v[172:175], v[128:143]
    ds_read_b64_tr_b16 v[168:169], v248 offset:30720
    ds_read_b64_tr_b16 v[170:171], v248 offset:31744
    s_lshl_b32 s80, s91, 15
    s_lshl_b32 s81, s90, 11
    s_add_u32 s80, s80, s81
    s_add_u32 s80, s80, 4194304
    buffer_store_dwordx4 v[176:179], v2, s[68:71], s80 offen sc1
    s_waitcnt lgkmcnt(4)
    v_mfma_f32_32x32x16_bf16 v[144:159], v[208:211], v[160:163], v[144:159]
    ds_read_b64_tr_b16 v[172:173], v249 offset:30720
    ds_read_b64_tr_b16 v[174:175], v249 offset:31744
    s_waitcnt lgkmcnt(4)
    v_mfma_f32_32x32x16_bf16 v[128:143], v[208:211], v[164:167], v[128:143]
    ds_read_b64_tr_b16 v[160:161], v248 offset:38912
    ds_read_b64_tr_b16 v[162:163], v248 offset:39936
    s_lshl_b32 s80, s91, 15
    s_lshl_b32 s81, s90, 11
    s_add_u32 s80, s80, s81
    s_add_u32 s80, s80, 4195328
    buffer_store_dwordx4 v[176:179], v2, s[68:71], s80 offen sc1
    s_waitcnt lgkmcnt(4)
    v_mfma_f32_32x32x16_bf16 v[144:159], v[212:215], v[168:171], v[144:159]
    ds_read_b64_tr_b16 v[164:165], v249 offset:38912
    ds_read_b64_tr_b16 v[166:167], v249 offset:39936
    s_waitcnt vmcnt(10)
    v_max3_u32 v9, v216, v220, v224
    v_max_u32 v9, v9, v228
    v_cmp_eq_u32 vcc, -1, v9
    s_waitcnt lgkmcnt(4)
    v_mfma_f32_32x32x16_bf16 v[128:143], v[212:215], v[172:175], v[128:143]
    s_cbranch_vccnz L_redo_62
L_back_63:
    s_lshl_b32 s80, s76, 18
    s_lshl_b32 s81, s85, 17
    s_add_u32 s80, s80, s81
    s_lshl_b32 s81, s77, 12
    s_add_u32 s80, s80, s81
    s_lshl_b32 s81, s84, 11
    s_add_u32 s80, s80, s81
    s_add_u32 s80, s80, 8388608
    buffer_store_dwordx4 v[176:179], v2, s[68:71], s80 offen sc1
    s_waitcnt lgkmcnt(2)
    v_mfma_f32_32x32x16_bf16 v[144:159], v[216:219], v[160:163], v[144:159]
    s_waitcnt lgkmcnt(0)
    v_mfma_f32_32x32x16_bf16 v[128:143], v[216:219], v[164:167], v[128:143]
    s_lshl_b32 s80, s76, 18
    s_lshl_b32 s81, s85, 17
    s_add_u32 s80, s80, s81
    s_lshl_b32 s81, s77, 12
    s_add_u32 s80, s80, s81
    s_lshl_b32 s81, s84, 11
    s_add_u32 s80, s80, s81
    s_add_u32 s80, s80, 8389632
    buffer_store_dwordx4 v[176:179], v2, s[68:71], s80 offen sc1
    v_mfma_f32_32x32x16_bf16 v[144:159], v[220:223], v[36:39], v[144:159]
    v_mfma_f32_32x32x16_bf16 v[128:143], v[220:223], v[32:35], v[128:143]
    s_mul_i32 s80, s75, 229376
    s_lshl_b32 s81, s78, 12
    s_add_u32 s80, s80, s81
    s_lshl_b32 s81, s84, 11
    s_add_u32 s80, s80, s81
    s_lshl_b32 s81, s85, 10
    s_add_u32 s80, s80, s81
    s_add_u32 s80, s80, 12582912
    s_cmp_ge_u32 s73, 28
    s_cselect_b32 s80, 1073741824, s80
    buffer_store_dwordx4 v[176:179], v2, s[68:71], s80 offen sc1
    v_mfma_f32_32x32x16_bf16 v[144:159], v[224:227], v[44:47], v[144:159]
    v_mfma_f32_32x32x16_bf16 v[128:143], v[224:227], v[40:43], v[128:143]
    s_mul_i32 s80, s75, 229376
    s_lshl_b32 s81, s78, 12
    s_add_u32 s80, s80, s81
    s_lshl_b32 s81, s84, 11
    s_add_u32 s80, s80, s81
    s_lshl_b32 s81, s85, 10
    s_add_u32 s80, s80, s81
    s_add_u32 s80, s80, 12697600
    s_cmp_ge_u32 s73, 28
    s_cselect_b32 s80, 1073741824, s80
    buffer_store_dwordx4 v[176:179], v2, s[68:71], s80 offen sc1
    v_mfma_f32_32x32x16_bf16 v[144:159], v[228:231], v[52:55], v[144:159]
    s_waitcnt vmcnt(10)
    v_max3_u32 v9, v232, v236, v240
    v_max_u32 v9, v9, v244
    v_cmp_eq_u32 vcc, -1, v9
    v_mfma_f32_32x32x16_bf16 v[128:143], v[228:231], v[48:51], v[128:143]
    s_cbranch_vccnz L_redo_64
L_back_65:
    v_mfma_f32_32x32x16_bf16 v[144:159], v[232:235], v[60:63], v[144:159]
    v_mfma_f32_32x32x16_bf16 v[128:143], v[232:235], v[56:59], v[128:143]
    v_mfma_f32_32x32x16_bf16 v[144:159], v[236:239], v[68:71], v[144:159]
    v_mfma_f32_32x32x16_bf16 v[128:143], v[236:239], v[64:67], v[128:143]
    v_mfma_f32_32x32x16_bf16 v[144:159], v[240:243], v[76:79], v[144:159]
    v_mfma_f32_32x32x16_bf16 v[128:143], v[240:243], v[72:75], v[128:143]
    v_mfma_f32_32x32x16_bf16 v[144:159], v[244:247], v[84:87], v[144:159]
    s_waitcnt vmcnt(6)
    v_max3_u32 v9, v120, v124, v184
    v_max_u32 v9, v9, v188
    v_cmp_eq_u32 vcc, -1, v9
    v_mfma_f32_32x32x16_bf16 v[128:143], v[244:247], v[80:83], v[128:143]
    s_cbranch_vccnz L_redo_66
L_back_67:
    v_mfma_f32_32x32x16_bf16 v[144:159], v[120:123], v[92:95], v[144:159]
    v_mfma_f32_32x32x16_bf16 v[144:159], v[124:127], v[100:103], v[144:159]
    v_mfma_f32_32x32x16_bf16 v[144:159], v[184:187], v[108:111], v[144:159]
    v_mfma_f32_32x32x16_bf16 v[144:159], v[188:191], v[116:119], v[144:159]
    v_mfma_f32_32x32x16_bf16 v[128:143], v[120:123], v[88:91], v[128:143]
    v_lshlrev_b32 v176, 16, v20
    v_and_b32 v177, 0xffff0000, v20
    v_lshlrev_b32 v178, 16, v21
    v_and_b32 v179, 0xffff0000, v21
    v_lshlrev_b32 v180, 16, v22
    v_and_b32 v181, 0xffff0000, v22
    v_lshlrev_b32 v182, 16, v23
    v_and_b32 v183, 0xffff0000, v23
    v_mfma_f32_32x32x16_bf16 v[128:143], v[124:127], v[96:99], v[128:143]
    s_nop 1
    ds_write_b128 v252, v[144:147] offset:0
    v_mfma_f32_32x32x16_bf16 v[128:143], v[184:187], v[104:107], v[128:143]
    ds_write_b128 v252, v[148:151] offset:1024
    v_mfma_f32_32x32x16_bf16 v[128:143], v[188:191], v[112:115], v[128:143]
    ds_write_b128 v252, v[152:155] offset:4096
    ds_read_b64_tr_b16 v[160:161], v248 offset:0
    ds_read_b64_tr_b16 v[162:163], v248 offset:1024
    ds_read_b64_tr_b16 v[164:165], v249 offset:0
    ds_read_b64_tr_b16 v[166:167], v249 offset:1024
    ds_read_b64_tr_b16 v[168:169], v248 offset:2048
    ds_read_b64_tr_b16 v[170:171], v248 offset:3072
    s_mul_i32 s100, s76, 229376
    s_mul_i32 s81, s3, 28672
    s_add_u32 s100, s100, s81
    s_add_u32 s100, s100, 10600448
    buffer_load_dwordx4 v[192:195], v6, s[68:71], s100 offen offset:0 sc1
    buffer_load_dwordx4 v[196:199], v6, s[68:71], s100 offen offset:1024 sc1
    ds_write_b128 v252, v[156:159] offset:5120
    ds_write_b128 v252, v[136:139] offset:2048
    ds_write_b128 v252, v[140:143] offset:3072
    buffer_load_dwordx4 v[200:203], v6, s[68:71], s100 offen offset:2048 sc1
    buffer_load_dwordx4 v[204:207], v6, s[68:71], s100 offen offset:3072 sc1
    s_add_u32 s100, s100, 4096
    buffer_load_dwordx4 v[208:211], v6, s[68:71], s100 offen offset:0 sc1
    buffer_load_dwordx4 v[212:215], v6, s[68:71], s100 offen offset:1024 sc1
    s_lshl_b32 s93, s77, 16
    s_lshl_b32 s81, s84, 15
    s_add_u32 s93, s93, s81
    s_lshl_b32 s81, s76, 12
    s_add_u32 s93, s93, s81
    s_lshl_b32 s81, s85, 10
    s_add_u32 s93, s93, s81
    v_pk_add_f32 v[176:177], v[176:177], v[12:13] op_sel:[0,1] op_sel_hi:[1,1]
    v_pk_add_f32 v[178:179], v[178:179], v[12:13] op_sel:[0,1] op_sel_hi:[1,1]
    v_pk_add_f32 v[180:181], v[180:181], v[12:13] op_sel:[0,1] op_sel_hi:[1,1]
    v_pk_add_f32 v[182:183], v[182:183], v[12:13] op_sel:[0,1] op_sel_hi:[1,1]
    v_pk_add_f32 v[176:177], v[176:177], v[128:129]
    v_pk_add_f32 v[178:179], v[178:179], v[130:131]
    v_pk_add_f32 v[180:181], v[180:181], v[132:133]
    v_pk_add_f32 v[182:183], v[182:183], v[134:135]
    s_waitcnt lgkmcnt(0)
    s_barrier
    ds_read_b128 v[136:139], v253 offset:0
    ds_read_b128 v[140:143], v253 offset:1024
    ds_read_b128 v[144:147], v254 offset:0
    ds_read_b128 v[148:151], v254 offset:1024
    ds_read_b128 v[152:155], v0 offset:0
    ds_read_b128 v[156:159], v0 offset:1024
    s_waitcnt lgkmcnt(4)
    v_pk_add_f32 v[176:177], v[176:177], v[136:137]
    v_pk_add_f32 v[178:179], v[178:179], v[138:139]
    v_pk_add_f32 v[180:181], v[180:181], v[140:141]
    v_pk_add_f32 v[182:183], v[182:183], v[142:143]
    s_waitcnt lgkmcnt(0)
    s_barrier
    v_pk_add_f32 v[144:145], v[144:145], v[152:153]
    v_pk_add_f32 v[146:147], v[146:147], v[154:155]
    v_pk_add_f32 v[148:149], v[148:149], v[156:157]
    v_pk_add_f32 v[150:151], v[150:151], v[158:159]
    v_pk_add_f32 v[176:177], v[176:177], v[144:145]
    v_pk_add_f32 v[178:179], v[178:179], v[146:147]
    v_pk_add_f32 v[180:181], v[180:181], v[148:149]
    v_pk_add_f32 v[182:183], v[182:183], v[150:151]
    v_cvt_pk_bf16_f32 v20, v176, v177
    v_cvt_pk_bf16_f32 v21, v178, v179
    v_cvt_pk_bf16_f32 v22, v180, v181
    v_cvt_pk_bf16_f32 v23, v182, v183
    buffer_store_dwordx4 v[20:23], v2, s[68:71], s93 offen sc1
    buffer_load_dwordx4 v[216:219], v6, s[68:71], s100 offen offset:2048 sc1
    buffer_load_dwordx4 v[220:223], v6, s[68:71], s100 offen offset:3072 sc1
    s_add_u32 s100, s100, 4096
    buffer_load_dwordx4 v[224:227], v6, s[68:71], s100 offen offset:0 sc1
    buffer_load_dwordx4 v[228:231], v6, s[68:71], s100 offen offset:1024 sc1
    buffer_load_dwordx4 v[232:235], v6, s[68:71], s100 offen offset:2048 sc1
    buffer_load_dwordx4 v[236:239], v6, s[68:71], s100 offen offset:3072 sc1
    s_add_u32 s100, s100, 4096
    buffer_load_dwordx4 v[240:243], v6, s[68:71], s100 offen offset:0 sc1
    buffer_load_dwordx4 v[244:247], v6, s[68:71], s100 offen offset:1024 sc1
    buffer_load_dwordx4 v[120:123], v6, s[68:71], s100 offen offset:2048 sc1
    buffer_load_dwordx4 v[124:127], v6, s[68:71], s100 offen offset:3072 sc1
    s_add_u32 s100, s100, 4096
    buffer_load_dwordx4 v[184:187], v6, s[68:71], s100 offen offset:0 sc1
    buffer_load_dwordx4 v[188:191], v6, s[68:71], s100 offen offset:1024 sc1
    v_lshlrev_b32 v128, 16, v20
    v_and_b32 v129, 0xffff0000, v20
    v_lshlrev_b32 v130, 16, v21
    v_and_b32 v131, 0xffff0000, v21
    v_lshlrev_b32 v132, 16, v22
    v_and_b32 v133, 0xffff0000, v22
    v_lshlrev_b32 v134, 16, v23
    v_and_b32 v135, 0xffff0000, v23
    v_add_f32 v18, v128, v129
    v_mul_f32 v19, v128, v128
    v_fmac_f32 v19, v129, v129
    v_add_f32 v18, v18, v130
    v_fmac_f32 v19, v130, v130
    v_add_f32 v18, v18, v131
    v_fmac_f32 v19, v131, v131
    v_add_f32 v18, v18, v132
    v_fmac_f32 v19, v132, v132
    v_add_f32 v18, v18, v133
    v_fmac_f32 v19, v133, v133
    v_add_f32 v18, v18, v134
    v_fmac_f32 v19, v134, v134
    v_add_f32 v18, v18, v135
    v_fmac_f32 v19, v135, v135
    s_waitcnt vmcnt(15)
    v_max3_u32 v9, v192, v196, v200
    v_max_u32 v9, v9, v204
    v_cmp_eq_u32 vcc, -1, v9
    s_cbranch_vccnz L_redo_68
L_back_69:
    v_mfma_f32_32x32x16_bf16 v[144:159], v[192:195], v[160:163], 0
    ds_read_b64_tr_b16 v[172:173], v249 offset:2048
    ds_read_b64_tr_b16 v[174:175], v249 offset:3072
    v_mfma_f32_32x32x16_bf16 v[128:143], v[192:195], v[164:167], 0
    ds_read_b64_tr_b16 v[160:161], v248 offset:4096
    ds_read_b64_tr_b16 v[162:163], v248 offset:5120
    buffer_load_dwordx4 v[192:195], v6, s[68:71], s100 offen offset:2048 sc1
    v_mfma_f32_32x32x16_bf16 v[144:159], v[196:199], v[168:171], v[144:159]
    ds_read_b64_tr_b16 v[164:165], v249 offset:4096
    ds_read_b64_tr_b16 v[166:167], v249 offset:5120
    s_waitcnt lgkmcnt(4)
    v_mfma_f32_32x32x16_bf16 v[128:143], v[196:199], v[172:175], v[128:143]
    ds_read_b64_tr_b16 v[168:169], v248 offset:6144
    ds_read_b64_tr_b16 v[170:171], v248 offset:7168
    buffer_load_dwordx4 v[196:199], v6, s[68:71], s100 offen offset:3072 sc1
    s_waitcnt lgkmcnt(4)
    v_mfma_f32_32x32x16_bf16 v[144:159], v[200:203], v[160:163], v[144:159]
    ds_read_b64_tr_b16 v[172:173], v249 offset:6144
    ds_read_b64_tr_b16 v[174:175], v249 offset:7168
    s_waitcnt lgkmcnt(4)
    v_mfma_f32_32x32x16_bf16 v[128:143], v[200:203], v[164:167], v[128:143]
    ds_read_b64_tr_b16 v[160:161], v248 offset:8192
    ds_read_b64_tr_b16 v[162:163], v248 offset:9216
    s_lshl_b32 s94, s90, 10
    s_add_u32 s94, s94, 20447232
    buffer_load_dwordx3 v[10:12], v2, s[68:71], s94 offen sc1
    s_mul_i32 s94, s90, 98304
    s_mul_i32 s81, s3, 24576
    s_add_u32 s94, s94, s81
    s_add_u32 s94, s94, 18874368
    s_lshl_b32 s95, s91, 15
    s_add_u32 s97, s95, 2032
    v_and_b32 v251, 7, v1
    v_lshlrev_b32 v251, 12, v251
    s_add_u32 s100, s100, 4096
    buffer_load_dwordx4 v[200:203], v6, s[68:71], s100 offen offset:0 sc1
    s_waitcnt lgkmcnt(4)
    v_mfma_f32_32x32x16_bf16 v[144:159], v[204:207], v[168:171], v[144:159]
    ds_read_b64_tr_b16 v[164:165], v249 offset:8192
    ds_read_b64_tr_b16 v[166:167], v249 offset:9216
    s_waitcnt vmcnt(14)
    v_max3_u32 v9, v208, v212, v216
    v_max_u32 v9, v9, v220
    v_cmp_eq_u32 vcc, -1, v9
    s_waitcnt lgkmcnt(4)
    v_mfma_f32_32x32x16_bf16 v[128:143], v[204:207], v[172:175], v[128:143]
    ds_read_b64_tr_b16 v[168:169], v248 offset:10240
    ds_read_b64_tr_b16 v[170:171], v248 offset:11264
    s_cbranch_vccnz L_redo_70
L_back_71:
    buffer_load_dwordx4 v[204:207], v6, s[68:71], s100 offen offset:1024 sc1
    s_waitcnt lgkmcnt(4)
    v_mfma_f32_32x32x16_bf16 v[144:159], v[208:211], v[160:163], v[144:159]
    ds_read_b64_tr_b16 v[172:173], v249 offset:10240
    ds_read_b64_tr_b16 v[174:175], v249 offset:11264
    s_waitcnt lgkmcnt(4)
    v_mfma_f32_32x32x16_bf16 v[128:143], v[208:211], v[164:167], v[128:143]
    ds_read_b64_tr_b16 v[160:161], v248 offset:12288
    ds_read_b64_tr_b16 v[162:163], v248 offset:13312
    buffer_load_dwordx4 v[208:211], v6, s[68:71], s100 offen offset:2048 sc1
    s_waitcnt lgkmcnt(4)
    v_mfma_f32_32x32x16_bf16 v[144:159], v[212:215], v[168:171], v[144:159]
    ds_read_b64_tr_b16 v[164:165], v249 offset:12288
    ds_read_b64_tr_b16 v[166:167], v249 offset:13312
    s_waitcnt lgkmcnt(4)
    v_mfma_f32_32x32x16_bf16 v[128:143], v[212:215], v[172:175], v[128:143]
    ds_read_b64_tr_b16 v[168:169], v248 offset:14336
    ds_read_b64_tr_b16 v[170:171], v248 offset:15360
    buffer_load_dwordx4 v[212:215], v6, s[68:71], s100 offen offset:3072 sc1
    s_waitcnt lgkmcnt(4)
    v_mfma_f32_32x32x16_bf16 v[144:159], v[216:219], v[160:163], v[144:159]
    ds_read_b64_tr_b16 v[172:173], v249 offset:14336
    ds_read_b64_tr_b16 v[174:175], v249 offset:15360
    s_waitcnt lgkmcnt(4)
    v_mfma_f32_32x32x16_bf16 v[128:143], v[216:219], v[164:167], v[128:143]
    ds_read_b64_tr_b16 v[160:161], v248 offset:16384
    ds_read_b64_tr_b16 v[162:163], v248 offset:17408
    s_add_u32 s100, s100, 4096
    buffer_load_dwordx4 v[216:219], v6, s[68:71], s100 offen offset:0 sc1
    s_waitcnt lgkmcnt(4)
    v_mfma_f32_32x32x16_bf16 v[144:159], v[220:223], v[168:171], v[144:159]
    ds_read_b64_tr_b16 v[164:165], v249 offset:16384
    ds_read_b64_tr_b16 v[166:167], v249 offset:17408
    s_waitcnt vmcnt(14)
    v_max3_u32 v9, v224, v228, v232
    v_max_u32 v9, v9, v236
    v_cmp_eq_u32 vcc, -1, v9
    s_waitcnt lgkmcnt(4)
    v_mfma_f32_32x32x16_bf16 v[128:143], v[220:223], v[172:175], v[128:143]
    ds_read_b64_tr_b16 v[168:169], v248 offset:18432
    ds_read_b64_tr_b16 v[170:171], v248 offset:19456
    s_cbranch_vccnz L_redo_72
L_back_73:
    buffer_load_dwordx4 v[220:223], v6, s[68:71], s100 offen offset:1024 sc1
    s_waitcnt lgkmcnt(4)
    v_mfma_f32_32x32x16_bf16 v[144:159], v[224:227], v[160:163], v[144:159]
    ds_read_b64_tr_b16 v[172:173], v249 offset:18432
    ds_read_b64_tr_b16 v[174:175], v249 offset:19456
    s_waitcnt lgkmcnt(4)
    v_mfma_f32_32x32x16_bf16 v[128:143], v[224:227], v[164:167], v[128:143]
    ds_read_b64_tr_b16 v[160:161], v248 offset:20480
    ds_read_b64_tr_b16 v[162:163], v248 offset:21504
    s_add_u32 m0, s79, 0
    s_add_u32 s83, s94, 0
    buffer_load_dwordx4 v2, s[68:71], s83 offen offset:1024 sc1 lds
    buffer_load_dwordx4 v[224:227], v6, s[68:71], s100 offen offset:2048 sc1
    s_waitcnt lgkmcnt(4)
    v_mfma_f32_32x32x16_bf16 v[144:159], v[228:231], v[168:171], v[144:159]
    ds_read_b64_tr_b16 v[164:165], v249 offset:20480
    ds_read_b64_tr_b16 v[166:167], v249 offset:21504
    s_waitcnt lgkmcnt(4)
    v_mfma_f32_32x32x16_bf16 v[128:143], v[228:231], v[172:175], v[128:143]
    ds_read_b64_tr_b16 v[168:169], v248 offset:22528
    ds_read_b64_tr_b16 v[170:171], v248 offset:23552
    s_add_u32 m0, s79, 0
    s_add_u32 s83, s94, 0
    buffer_load_dwordx4 v2, s[68:71], s83 offen offset:2048 sc1 lds
    buffer_load_dwordx4 v[228:231], v6, s[68:71], s100 offen offset:3072 sc1
    s_waitcnt lgkmcnt(4)
    v_mfma_f32_32x32x16_bf16 v[144:159], v[232:235], v[160:163], v[144:159]
    ds_read_b64_tr_b16 v[172:173], v249 offset:22528
    ds_read_b64_tr_b16 v[174:175], v249 offset:23552
    s_waitcnt lgkmcnt(4)
    v_mfma_f32_32x32x16_bf16 v[128:143], v[232:235], v[164:167], v[128:143]
    ds_read_b64_tr_b16 v[160:161], v248 offset:24576
    ds_read_b64_tr_b16 v[162:163], v248 offset:25600
    s_add_u32 m0, s79, 0
    s_add_u32 s83, s94, 0
    buffer_load_dwordx4 v2, s[68:71], s83 offen offset:0 sc1 lds
    s_waitcnt lgkmcnt(4)
    v_mfma_f32_32x32x16_bf16 v[144:159], v[236:239], v[168:171], v[144:159]
    ds_read_b64_tr_b16 v[164:165], v249 offset:24576
    ds_read_b64_tr_b16 v[166:167], v249 offset:25600
    s_waitcnt vmcnt(16)
    v_max3_u32 v9, v240, v244, v120
    v_max_u32 v9, v9, v124
    v_cmp_eq_u32 vcc, -1, v9
    s_waitcnt lgkmcnt(4)
    v_mfma_f32_32x32x16_bf16 v[128:143], v[236:239], v[172:175], v[128:143]
    ds_read_b64_tr_b16 v[168:169], v248 offset:26624
    ds_read_b64_tr_b16 v[170:171], v248 offset:27648
    s_cbranch_vccnz L_redo_74
L_back_75:
    s_add_u32 m0, s79, 3072
    s_add_u32 s83, s94, 3072
    buffer_load_dwordx4 v2, s[68:71], s83 offen offset:1024 sc1 lds
    s_waitcnt lgkmcnt(4)
    v_mfma_f32_32x32x16_bf16 v[144:159], v[240:243], v[160:163], v[144:159]
    ds_read_b64_tr_b16 v[172:173], v249 offset:26624
    ds_read_b64_tr_b16 v[174:175], v249 offset:27648
    s_waitcnt lgkmcnt(4)
    v_mfma_f32_32x32x16_bf16 v[128:143], v[240:243], v[164:167], v[128:143]
    ds_read_b64_tr_b16 v[160:161], v248 offset:28672
    ds_read_b64_tr_b16 v[162:163], v248 offset:29696
    s_add_u32 m0, s79, 3072
    s_add_u32 s83, s94, 3072
    buffer_load_dwordx4 v2, s[68:71], s83 offen offset:2048 sc1 lds
    s_waitcnt lgkmcnt(4)
    v_mfma_f32_32x32x16_bf16 v[144:159], v[244:247], v[168:171], v[144:159]
    ds_read_b64_tr_b16 v[164:165], v249 offset:28672
    ds_read_b64_tr_b16 v[166:167], v249 offset:29696
    s_waitcnt lgkmcnt(4)
    v_mfma_f32_32x32x16_bf16 v[128:143], v[244:247], v[172:175], v[128:143]
    ds_read_b64_tr_b16 v[168:169], v248 offset:30720
    ds_read_b64_tr_b16 v[170:171], v248 offset:31744
    s_add_u32 m0, s79, 3072
    s_add_u32 s83, s94, 3072
    buffer_load_dwordx4 v2, s[68:71], s83 offen offset:0 sc1 lds
    s_waitcnt lgkmcnt(4)
    v_mfma_f32_32x32x16_bf16 v[144:159], v[120:123], v[160:163], v[144:159]
    ds_read_b64_tr_b16 v[172:173], v249 offset:30720
    ds_read_b64_tr_b16 v[174:175], v249 offset:31744
    s_waitcnt lgkmcnt(4)
    v_mfma_f32_32x32x16_bf16 v[128:143], v[120:123], v[164:167], v[128:143]
    ds_read_b64_tr_b16 v[160:161], v248 offset:38912
    ds_read_b64_tr_b16 v[162:163], v248 offset:39936
    s_add_u32 m0, s79, 6144
    s_add_u32 s83, s94, 6144
    buffer_load_dwordx4 v2, s[68:71], s83 offen offset:1024 sc1 lds
    s_waitcnt lgkmcnt(4)
    v_mfma_f32_32x32x16_bf16 v[144:159], v[124:127], v[168:171], v[144:159]
    ds_read_b64_tr_b16 v[164:165], v249 offset:38912
    ds_read_b64_tr_b16 v[166:167], v249 offset:39936
    s_waitcnt vmcnt(16)
    v_max3_u32 v9, v184, v188, v192
    v_max_u32 v9, v9, v196
    v_cmp_eq_u32 vcc, -1, v9
    s_waitcnt lgkmcnt(4)
    v_mfma_f32_32x32x16_bf16 v[128:143], v[124:127], v[172:175], v[128:143]
    s_cbranch_vccnz L_redo_76
L_back_77:
    s_add_u32 m0, s79, 6144
    s_add_u32 s83, s94, 6144
    buffer_load_dwordx4 v2, s[68:71], s83 offen offset:2048 sc1 lds
    s_waitcnt lgkmcnt(2)
    v_mfma_f32_32x32x16_bf16 v[144:159], v[184:187], v[160:163], v[144:159]
    s_waitcnt lgkmcnt(0)
    v_mfma_f32_32x32x16_bf16 v[128:143], v[184:187], v[164:167], v[128:143]
    s_add_u32 m0, s79, 6144
    s_add_u32 s83, s94, 6144
    buffer_load_dwordx4 v2, s[68:71], s83 offen offset:0 sc1 lds
    v_mfma_f32_32x32x16_bf16 v[144:159], v[188:191], v[36:39], v[144:159]
    v_mfma_f32_32x32x16_bf16 v[128:143], v[188:191], v[32:35], v[128:143]
    s_add_u32 m0, s79, 9216
    s_add_u32 s83, s94, 9216
    buffer_load_dwordx4 v2, s[68:71], s83 offen offset:1024 sc1 lds
    v_mfma_f32_32x32x16_bf16 v[144:159], v[192:195], v[44:47], v[144:159]
    v_mfma_f32_32x32x16_bf16 v[128:143], v[192:195], v[40:43], v[128:143]
    s_add_u32 m0, s79, 9216
    s_add_u32 s83, s94, 9216
    buffer_load_dwordx4 v2, s[68:71], s83 offen offset:2048 sc1 lds
    s_add_u32 s83, s95, 0
    buffer_load_dwordx4 v[32:35], v2, s[68:71], s83 offen offset:0 sc1
    s_add_u32 s83, s95, 0
    buffer_load_dwordx4 v[36:39], v2, s[68:71], s83 offen offset:1024 sc1
    v_mfma_f32_32x32x16_bf16 v[144:159], v[196:199], v[52:55], v[144:159]
    s_waitcnt vmcnt(17)
    v_max3_u32 v9, v200, v204, v208
    v_max_u32 v9, v9, v212
    v_cmp_eq_u32 vcc, -1, v9
    v_mfma_f32_32x32x16_bf16 v[128:143], v[196:199], v[48:51], v[128:143]
    s_cbranch_vccnz L_redo_78
L_back_79:
    s_add_u32 m0, s79, 9216
    s_add_u32 s83, s94, 9216
    buffer_load_dwordx4 v2, s[68:71], s83 offen offset:0 sc1 lds
    s_add_u32 s83, s95, 4096
    buffer_load_dwordx4 v[40:43], v2, s[68:71], s83 offen offset:0 sc1
    s_add_u32 s83, s95, 4096
    buffer_load_dwordx4 v[44:47], v2, s[68:71], s83 offen offset:1024 sc1
    v_mfma_f32_32x32x16_bf16 v[144:159], v[200:203], v[60:63], v[144:159]
    v_mfma_f32_32x32x16_bf16 v[128:143], v[200:203], v[56:59], v[128:143]
    s_add_u32 m0, s79, 12288
    s_add_u32 s83, s94, 12288
    buffer_load_dwordx4 v2, s[68:71], s83 offen offset:1024 sc1 lds
    s_add_u32 s83, s95, 8192
    buffer_load_dwordx4 v[48:51], v2, s[68:71], s83 offen offset:0 sc1
    s_add_u32 s83, s95, 8192
    buffer_load_dwordx4 v[52:55], v2, s[68:71], s83 offen offset:1024 sc1
    v_mfma_f32_32x32x16_bf16 v[144:159], v[204:207], v[68:71], v[144:159]
    v_mfma_f32_32x32x16_bf16 v[128:143], v[204:207], v[64:67], v[128:143]
    s_add_u32 m0, s79, 12288
    s_add_u32 s83, s94, 12288
    buffer_load_dwordx4 v2, s[68:71], s83 offen offset:2048 sc1 lds
    s_add_u32 s83, s95, 12288
    buffer_load_dwordx4 v[56:59], v2, s[68:71], s83 offen offset:0 sc1
    s_add_u32 s83, s95, 12288
    buffer_load_dwordx4 v[60:63], v2, s[68:71], s83 offen offset:1024 sc1
    v_mfma_f32_32x32x16_bf16 v[144:159], v[208:211], v[76:79], v[144:159]
    v_mfma_f32_32x32x16_bf16 v[128:143], v[208:211], v[72:75], v[128:143]
    s_add_u32 m0, s79, 12288
    s_add_u32 s83, s94, 12288
    buffer_load_dwordx4 v2, s[68:71], s83 offen offset:0 sc1 lds
    v_mfma_f32_32x32x16_bf16 v[144:159], v[212:215], v[84:87], v[144:159]
    s_waitcnt vmcnt(21)
    v_max3_u32 v9, v216, v220, v224
    v_max_u32 v9, v9, v228
    v_cmp_eq_u32 vcc, -1, v9
    v_mfma_f32_32x32x16_bf16 v[128:143], v[212:215], v[80:83], v[128:143]
    s_cbranch_vccnz L_redo_80
L_back_81:
    s_add_u32 m0, s79, 15360
    s_add_u32 s83, s94, 15360
    buffer_load_dwordx4 v2, s[68:71], s83 offen offset:1024 sc1 lds
    v_mfma_f32_32x32x16_bf16 v[144:159], v[216:219], v[92:95], v[144:159]
    v_mfma_f32_32x32x16_bf16 v[144:159], v[220:223], v[100:103], v[144:159]
    v_mfma_f32_32x32x16_bf16 v[144:159], v[224:227], v[108:111], v[144:159]
    v_mfma_f32_32x32x16_bf16 v[144:159], v[228:231], v[116:119], v[144:159]
    v_mfma_f32_32x32x16_bf16 v[128:143], v[216:219], v[88:91], v[128:143]
    v_lshlrev_b32 v176, 16, v24
    v_and_b32 v177, 0xffff0000, v24
    v_lshlrev_b32 v178, 16, v25
    v_and_b32 v179, 0xffff0000, v25
    v_lshlrev_b32 v180, 16, v26
    v_and_b32 v181, 0xffff0000, v26
    v_lshlrev_b32 v182, 16, v27
    v_and_b32 v183, 0xffff0000, v27
    s_add_u32 m0, s79, 15360
    s_add_u32 s83, s94, 15360
    buffer_load_dwordx4 v2, s[68:71], s83 offen offset:2048 sc1 lds
    v_mfma_f32_32x32x16_bf16 v[128:143], v[220:223], v[96:99], v[128:143]
    ds_write_b128 v252, v[144:147] offset:0
    s_add_u32 m0, s79, 15360
    s_add_u32 s83, s94, 15360
    buffer_load_dwordx4 v2, s[68:71], s83 offen offset:0 sc1 lds
    v_mfma_f32_32x32x16_bf16 v[128:143], v[224:227], v[104:107], v[128:143]
    ds_write_b128 v252, v[148:151] offset:1024
    s_add_u32 m0, s79, 18432
    s_add_u32 s83, s94, 18432
    buffer_load_dwordx4 v2, s[68:71], s83 offen offset:1024 sc1 lds
    v_mfma_f32_32x32x16_bf16 v[128:143], v[228:231], v[112:115], v[128:143]
    ds_write_b128 v252, v[152:155] offset:4096
    s_add_u32 m0, s79, 18432
    s_add_u32 s83, s94, 18432
    buffer_load_dwordx4 v2, s[68:71], s83 offen offset:2048 sc1 lds
    ds_write_b128 v252, v[156:159] offset:5120
    s_nop 6
    ds_write_b128 v252, v[136:139] offset:2048
    ds_write_b128 v252, v[140:143] offset:3072
    s_add_u32 m0, s79, 18432
    s_add_u32 s83, s94, 18432
    buffer_load_dwordx4 v2, s[68:71], s83 offen offset:0 sc1 lds
    s_add_u32 m0, s79, 21504
    s_add_u32 s83, s94, 21504
    buffer_load_dwordx4 v2, s[68:71], s83 offen offset:1024 sc1 lds
    s_add_u32 m0, s79, 21504
    s_add_u32 s83, s94, 21504
    buffer_load_dwordx4 v2, s[68:71], s83 offen offset:2048 sc1 lds
    s_add_u32 m0, s79, 21504
    s_add_u32 s83, s94, 21504
    buffer_load_dwordx4 v2, s[68:71], s83 offen offset:0 sc1 lds
    s_lshl_b32 s93, s77, 16
    s_lshl_b32 s81, s84, 15
    s_add_u32 s93, s93, s81
    s_lshl_b32 s81, s76, 12
    s_add_u32 s93, s93, s81
    s_lshl_b32 s81, s85, 10
    s_add_u32 s93, s93, s81
    s_add_u32 s93, s93, 2048
    v_pk_add_f32 v[176:177], v[176:177], v[12:13] op_sel:[0,1] op_sel_hi:[1,1]
    v_pk_add_f32 v[178:179], v[178:179], v[12:13] op_sel:[0,1] op_sel_hi:[1,1]
    v_pk_add_f32 v[180:181], v[180:181], v[12:13] op_sel:[0,1] op_sel_hi:[1,1]
    v_pk_add_f32 v[182:183], v[182:183], v[12:13] op_sel:[0,1] op_sel_hi:[1,1]
    v_pk_add_f32 v[176:177], v[176:177], v[128:129]
    v_pk_add_f32 v[178:179], v[178:179], v[130:131]
    v_pk_add_f32 v[180:181], v[180:181], v[132:133]
    v_pk_add_f32 v[182:183], v[182:183], v[134:135]
    s_waitcnt lgkmcnt(0)
    s_barrier
    ds_read_b128 v[136:139], v253 offset:0
    ds_read_b128 v[140:143], v253 offset:1024
    ds_read_b128 v[144:147], v254 offset:0
    ds_read_b128 v[148:151], v254 offset:1024
    ds_read_b128 v[152:155], v0 offset:0
    ds_read_b128 v[156:159], v0 offset:1024
    s_waitcnt lgkmcnt(4)
    v_pk_add_f32 v[176:177], v[176:177], v[136:137]
    v_pk_add_f32 v[178:179], v[178:179], v[138:139]
    v_pk_add_f32 v[180:181], v[180:181], v[140:141]
    v_pk_add_f32 v[182:183], v[182:183], v[142:143]
    s_waitcnt lgkmcnt(0)
    v_pk_add_f32 v[144:145], v[144:145], v[152:153]
    v_pk_add_f32 v[146:147], v[146:147], v[154:155]
    v_pk_add_f32 v[148:149], v[148:149], v[156:157]
    v_pk_add_f32 v[150:151], v[150:151], v[158:159]
    v_pk_add_f32 v[176:177], v[176:177], v[144:145]
    v_pk_add_f32 v[178:179], v[178:179], v[146:147]
    v_pk_add_f32 v[180:181], v[180:181], v[148:149]
    v_pk_add_f32 v[182:183], v[182:183], v[150:151]
    v_cvt_pk_bf16_f32 v24, v176, v177
    v_cvt_pk_bf16_f32 v25, v178, v179
    v_cvt_pk_bf16_f32 v26, v180, v181
    v_cvt_pk_bf16_f32 v27, v182, v183
    buffer_store_dwordx4 v[24:27], v2, s[68:71], s93 offen sc1
    v_lshlrev_b32 v128, 16, v24
    v_and_b32 v129, 0xffff0000, v24
    v_lshlrev_b32 v130, 16, v25
    v_and_b32 v131, 0xffff0000, v25
    v_lshlrev_b32 v132, 16, v26
    v_and_b32 v133, 0xffff0000, v26
    v_lshlrev_b32 v134, 16, v27
    v_and_b32 v135, 0xffff0000, v27
    v_add_f32 v18, v18, v128
    v_fmac_f32 v19, v128, v128
    v_add_f32 v18, v18, v129
    v_fmac_f32 v19, v129, v129
    v_add_f32 v18, v18, v130
    v_fmac_f32 v19, v130, v130
    v_add_f32 v18, v18, v131
    v_fmac_f32 v19, v131, v131
    v_add_f32 v18, v18, v132
    v_fmac_f32 v19, v132, v132
    v_add_f32 v18, v18, v133
    v_fmac_f32 v19, v133, v133
    v_add_f32 v18, v18, v134
    v_fmac_f32 v19, v134, v134
    v_add_f32 v18, v18, v135
    v_fmac_f32 v19, v135, v135
    v_mov_b32 v128, v18
    s_nop 1
    v_permlane32_swap_b32 v18, v128
    v_add_f32 v18, v18, v128
    v_mov_b32 v129, v19
    s_nop 1
    v_permlane32_swap_b32 v19, v129
    v_add_f32 v19, v19, v129
    v_and_b32 v19, 0x7fffffff, v19
    s_lshl_b32 s80, s77, 13
    s_lshl_b32 s81, s84, 12
    s_add_u32 s80, s80, s81
    s_lshl_b32 s81, s76, 9
    s_add_u32 s80, s80, s81
    s_lshl_b32 s81, s85, 8
    s_add_u32 s80, s80, s81
    s_add_u32 s80, s80, 16252928
    v_and_b32 v7, 31, v1
    v_lshlrev_b32 v7, 3, v7
    s_mov_b64 exec, s[86:87]
    buffer_store_dwordx2 v[18:19], v7, s[68:71], s80 offen sc1
    s_mov_b64 exec, -1
    s_add_u32 s83, s95, 16384
    buffer_load_dwordx4 v[64:67], v2, s[68:71], s83 offen offset:0 sc1
    s_add_u32 s83, s95, 16384
    buffer_load_dwordx4 v[68:71], v2, s[68:71], s83 offen offset:1024 sc1
    s_add_u32 s83, s95, 20480
    buffer_load_dwordx4 v[72:75], v2, s[68:71], s83 offen offset:0 sc1
    s_add_u32 s83, s95, 20480
    buffer_load_dwordx4 v[76:79], v2, s[68:71], s83 offen offset:1024 sc1
    s_add_u32 s83, s95, 24576
    buffer_load_dwordx4 v[80:83], v2, s[68:71], s83 offen offset:0 sc1
    s_add_u32 s83, s95, 24576
    buffer_load_dwordx4 v[84:87], v2, s[68:71], s83 offen offset:1024 sc1
    s_add_u32 s83, s95, 28672
    buffer_load_dwordx4 v[88:91], v2, s[68:71], s83 offen offset:0 sc1
    s_add_u32 s83, s95, 28672
    buffer_load_dwordx4 v[92:95], v2, s[68:71], s83 offen offset:1024 sc1
    s_add_u32 s97, s97, 2048
    v_mov_b32 v7, v251
    v_mov_b32 v232, 0x3f803f80
    v_mov_b32 v233, 0x3f803f80
    v_mov_b32 v234, 0x3f803f80
    v_mov_b32 v235, 0x3f803f80
    v_mov_b32 v244, v3
    v_add_u32 v245, 81920, v3
    v_and_b32 v8, 31, v1
    v_lshlrev_b32 v8, 3, v8
    v_lshl_add_u32 v8, v4, 11, v8
    s_lshl_b32 s92, s91, 12
    s_add_u32 s92, s92, 16252928
    s_waitcnt vmcnt(10)
    s_barrier
    ds_read_b64_tr_b16 v[208:209], v244 offset:1024
    ds_read_b64_tr_b16 v[210:211], v244 offset:1536
    ds_read_b64_tr_b16 v[212:213], v244 offset:2048
    ds_read_b64_tr_b16 v[214:215], v244 offset:2560
    ds_read_b64_tr_b16 v[216:217], v244 offset:0
    ds_read_b64_tr_b16 v[218:219], v244 offset:512
    ds_read_b64_tr_b16 v[220:221], v244 offset:4096
    ds_read_b64_tr_b16 v[222:223], v244 offset:4608
    ds_read_b64_tr_b16 v[224:225], v244 offset:5120
    ds_read_b64_tr_b16 v[226:227], v244 offset:5632
    v_max3_u32 v254, v32, v36, v40
    v_max_u32 v254, v254, v44
    v_cmp_eq_u32 vcc, -1, v254
    s_cbranch_vccnz L_redo_82
L_back_83:
    s_waitcnt lgkmcnt(8)
    v_mfma_f32_32x32x16_bf16 v[160:175], v[32:35], v[208:211], 0
    ds_read_b64_tr_b16 v[228:229], v244 offset:3072
    ds_read_b64_tr_b16 v[230:231], v244 offset:3584
    s_waitcnt lgkmcnt(8)
    v_mfma_f32_32x32x16_bf16 v[176:191], v[32:35], v[212:215], 0
    ds_read_b64_tr_b16 v[208:209], v244 offset:13312
    ds_read_b64_tr_b16 v[210:211], v244 offset:13824
    s_waitcnt lgkmcnt(8)
    v_mfma_f32_32x32x16_bf16 v[192:207], v[216:219], v[32:35], 0
    ds_read_b64_tr_b16 v[212:213], v244 offset:14336
    ds_read_b64_tr_b16 v[214:215], v244 offset:14848
    s_waitcnt lgkmcnt(8)
    v_mfma_f32_32x32x16_bf16 v[160:175], v[36:39], v[220:223], v[160:175]
    ds_read_b64_tr_b16 v[216:217], v244 offset:12288
    ds_read_b64_tr_b16 v[218:219], v244 offset:12800
    s_waitcnt lgkmcnt(8)
    v_mfma_f32_32x32x16_bf16 v[176:191], v[36:39], v[224:227], v[176:191]
    ds_read_b64_tr_b16 v[220:221], v244 offset:16384
    ds_read_b64_tr_b16 v[222:223], v244 offset:16896
    s_waitcnt lgkmcnt(8)
    v_mfma_f32_32x32x16_bf16 v[192:207], v[228:231], v[36:39], v[192:207]
    ds_read_b64_tr_b16 v[224:225], v244 offset:17408
    ds_read_b64_tr_b16 v[226:227], v244 offset:17920
    s_waitcnt lgkmcnt(8)
    v_mfma_f32_32x32x16_bf16 v[160:175], v[40:43], v[208:211], v[160:175]
    ds_read_b64_tr_b16 v[228:229], v244 offset:15360
    ds_read_b64_tr_b16 v[230:231], v244 offset:15872
    s_waitcnt lgkmcnt(8)
    v_mfma_f32_32x32x16_bf16 v[176:191], v[40:43], v[212:215], v[176:191]
    ds_read_b64_tr_b16 v[208:209], v244 offset:41984
    ds_read_b64_tr_b16 v[210:211], v244 offset:42496
    s_waitcnt lgkmcnt(8)
    v_mfma_f32_32x32x16_bf16 v[192:207], v[216:219], v[40:43], v[192:207]
    ds_read_b64_tr_b16 v[212:213], v244 offset:43008
    ds_read_b64_tr_b16 v[214:215], v244 offset:43520
    v_max3_u32 v254, v48, v52, v56
    s_waitcnt lgkmcnt(8)
    v_mfma_f32_32x32x16_bf16 v[160:175], v[44:47], v[220:223], v[160:175]
    ds_read_b64_tr_b16 v[216:217], v244 offset:40960
    ds_read_b64_tr_b16 v[218:219], v244 offset:41472
    v_max_u32 v254, v254, v60
    s_waitcnt lgkmcnt(8)
    v_mfma_f32_32x32x16_bf16 v[176:191], v[44:47], v[224:227], v[176:191]
    ds_read_b64_tr_b16 v[220:221], v244 offset:45056
    ds_read_b64_tr_b16 v[222:223], v244 offset:45568
    v_cmp_eq_u32 vcc, -1, v254
    s_waitcnt lgkmcnt(8)
    v_mfma_f32_32x32x16_bf16 v[192:207], v[228:231], v[44:47], v[192:207]
    ds_read_b64_tr_b16 v[224:225], v244 offset:46080
    ds_read_b64_tr_b16 v[226:227], v244 offset:46592
    s_cbranch_vccnz L_redo_84
L_back_85:
    buffer_load_dword v31, v7, s[68:71], s97 offen sc1
    s_waitcnt lgkmcnt(8)
    v_mfma_f32_32x32x16_bf16 v[160:175], v[48:51], v[208:211], v[160:175]
    ds_read_b64_tr_b16 v[228:229], v244 offset:44032
    ds_read_b64_tr_b16 v[230:231], v244 offset:44544
    s_waitcnt lgkmcnt(8)
    v_mfma_f32_32x32x16_bf16 v[176:191], v[48:51], v[212:215], v[176:191]
    ds_read_b64_tr_b16 v[208:209], v244 offset:54272
    ds_read_b64_tr_b16 v[210:211], v244 offset:54784
    s_waitcnt lgkmcnt(8)
    v_mfma_f32_32x32x16_bf16 v[192:207], v[216:219], v[48:51], v[192:207]
    ds_read_b64_tr_b16 v[212:213], v244 offset:55296
    ds_read_b64_tr_b16 v[214:215], v244 offset:55808
    s_waitcnt lgkmcnt(8)
    v_mfma_f32_32x32x16_bf16 v[160:175], v[52:55], v[220:223], v[160:175]
    ds_read_b64_tr_b16 v[216:217], v244 offset:53248
    ds_read_b64_tr_b16 v[218:219], v244 offset:53760
    s_waitcnt lgkmcnt(8)
    v_mfma_f32_32x32x16_bf16 v[176:191], v[52:55], v[224:227], v[176:191]
    ds_read_b64_tr_b16 v[220:221], v244 offset:57344
    ds_read_b64_tr_b16 v[222:223], v244 offset:57856
    s_waitcnt lgkmcnt(8)
    v_mfma_f32_32x32x16_bf16 v[192:207], v[228:231], v[52:55], v[192:207]
    ds_read_b64_tr_b16 v[224:225], v244 offset:58368
    ds_read_b64_tr_b16 v[226:227], v244 offset:58880
    s_waitcnt lgkmcnt(8)
    v_mfma_f32_32x32x16_bf16 v[160:175], v[56:59], v[208:211], v[160:175]
    ds_read_b64_tr_b16 v[228:229], v244 offset:56320
    ds_read_b64_tr_b16 v[230:231], v244 offset:56832
    s_waitcnt lgkmcnt(8)
    v_mfma_f32_32x32x16_bf16 v[176:191], v[56:59], v[212:215], v[176:191]
    ds_read_b64_tr_b16 v[208:209], v245 offset:1024
    ds_read_b64_tr_b16 v[210:211], v245 offset:1536
    s_waitcnt lgkmcnt(8)
    v_mfma_f32_32x32x16_bf16 v[192:207], v[216:219], v[56:59], v[192:207]
    ds_read_b64_tr_b16 v[212:213], v245 offset:2048
    ds_read_b64_tr_b16 v[214:215], v245 offset:2560
    s_waitcnt vmcnt(5)
    v_max3_u32 v254, v64, v68, v72
    s_waitcnt lgkmcnt(8)
    v_mfma_f32_32x32x16_bf16 v[160:175], v[60:63], v[220:223], v[160:175]
    ds_read_b64_tr_b16 v[216:217], v245 offset:0
    ds_read_b64_tr_b16 v[218:219], v245 offset:512
    v_max_u32 v254, v254, v76
    s_waitcnt lgkmcnt(8)
    v_mfma_f32_32x32x16_bf16 v[176:191], v[60:63], v[224:227], v[176:191]
    ds_read_b64_tr_b16 v[220:221], v245 offset:4096
    ds_read_b64_tr_b16 v[222:223], v245 offset:4608
    v_cmp_eq_u32 vcc, -1, v254
    s_waitcnt lgkmcnt(8)
    v_mfma_f32_32x32x16_bf16 v[192:207], v[228:231], v[60:63], v[192:207]
    ds_read_b64_tr_b16 v[224:225], v245 offset:5120
    ds_read_b64_tr_b16 v[226:227], v245 offset:5632
    s_cbranch_vccnz L_redo_86
L_back_87:
    s_waitcnt lgkmcnt(8)
    v_mfma_f32_32x32x16_bf16 v[160:175], v[64:67], v[208:211], v[160:175]
    ds_read_b64_tr_b16 v[228:229], v245 offset:3072
    ds_read_b64_tr_b16 v[230:231], v245 offset:3584
    s_waitcnt lgkmcnt(8)
    v_mfma_f32_32x32x16_bf16 v[176:191], v[64:67], v[212:215], v[176:191]
    ds_read_b64_tr_b16 v[208:209], v245 offset:13312
    ds_read_b64_tr_b16 v[210:211], v245 offset:13824
    s_waitcnt lgkmcnt(8)
    v_mfma_f32_32x32x16_bf16 v[192:207], v[216:219], v[64:67], v[192:207]
    ds_read_b64_tr_b16 v[212:213], v245 offset:14336
    ds_read_b64_tr_b16 v[214:215], v245 offset:14848
    s_waitcnt lgkmcnt(8)
    v_mfma_f32_32x32x16_bf16 v[160:175], v[68:71], v[220:223], v[160:175]
    ds_read_b64_tr_b16 v[216:217], v245 offset:12288
    ds_read_b64_tr_b16 v[218:219], v245 offset:12800
    s_waitcnt lgkmcnt(8)
    v_mfma_f32_32x32x16_bf16 v[176:191], v[68:71], v[224:227], v[176:191]
    ds_read_b64_tr_b16 v[220:221], v245 offset:16384
    ds_read_b64_tr_b16 v[222:223], v245 offset:16896
    s_waitcnt lgkmcnt(8)
    v_mfma_f32_32x32x16_bf16 v[192:207], v[228:231], v[68:71], v[192:207]
    ds_read_b64_tr_b16 v[224:225], v245 offset:17408
    ds_read_b64_tr_b16 v[226:227], v245 offset:17920
    s_waitcnt vmcnt(0)
    v_cmp_eq_u32 vcc, -1, v31
    s_nop 7
    s_cbranch_vccz L_rdy_88
    s_mov_b32 s96, 0
L_spin_89:
    s_mov_b64 exec, vcc
    buffer_load_dword v31, v7, s[68:71], s97 offen sc1
    s_add_u32 s96, s96, 1
    s_waitcnt vmcnt(0)
    v_cmp_eq_u32 vcc, -1, v31
    s_nop 1
    s_cbranch_vccz L_out_90
    s_cmp_lt_u32 s96, 50000
    s_cbranch_scc1 L_spin_89
L_out_90:
    s_mov_b64 exec, -1
L_rdy_88:
    s_waitcnt lgkmcnt(8)
    v_mfma_f32_32x32x16_bf16 v[160:175], v[72:75], v[208:211], v[160:175]
    ds_read_b64_tr_b16 v[228:229], v245 offset:15360
    ds_read_b64_tr_b16 v[230:231], v245 offset:15872
    buffer_load_dwordx2 v[246:247], v8, s[68:71], s92 offen offset:0 sc1
    s_waitcnt lgkmcnt(8)
    v_mfma_f32_32x32x16_bf16 v[176:191], v[72:75], v[212:215], v[176:191]
    ds_read_b64_tr_b16 v[208:209], v245 offset:41984
    ds_read_b64_tr_b16 v[210:211], v245 offset:42496
    buffer_load_dwordx2 v[248:249], v8, s[68:71], s92 offen offset:256 sc1
    s_waitcnt lgkmcnt(8)
    v_mfma_f32_32x32x16_bf16 v[192:207], v[216:219], v[72:75], v[192:207]
    ds_read_b64_tr_b16 v[212:213], v245 offset:43008
    ds_read_b64_tr_b16 v[214:215], v245 offset:43520
    v_max3_u32 v254, v80, v84, v88
    buffer_load_dwordx2 v[250:251], v8, s[68:71], s92 offen offset:512 sc1
    s_waitcnt lgkmcnt(8)
    v_mfma_f32_32x32x16_bf16 v[160:175], v[76:79], v[220:223], v[160:175]
    ds_read_b64_tr_b16 v[216:217], v245 offset:40960
    ds_read_b64_tr_b16 v[218:219], v245 offset:41472
    v_max_u32 v254, v254, v92
    buffer_load_dwordx2 v[252:253], v8, s[68:71], s92 offen offset:768 sc1
    s_waitcnt lgkmcnt(8)
    v_mfma_f32_32x32x16_bf16 v[176:191], v[76:79], v[224:227], v[176:191]
    ds_read_b64_tr_b16 v[220:221], v245 offset:45056
    ds_read_b64_tr_b16 v[222:223], v245 offset:45568
    v_cmp_eq_u32 vcc, -1, v254
    buffer_load_dwordx2 v[236:237], v8, s[68:71], s92 offen offset:1024 sc1
    s_waitcnt lgkmcnt(8)
    v_mfma_f32_32x32x16_bf16 v[192:207], v[228:231], v[76:79], v[192:207]
    ds_read_b64_tr_b16 v[224:225], v245 offset:46080
    ds_read_b64_tr_b16 v[226:227], v245 offset:46592
    s_cbranch_vccnz L_redo_91
L_back_92:
    buffer_load_dwordx2 v[238:239], v8, s[68:71], s92 offen offset:1280 sc1
    s_waitcnt lgkmcnt(8)
    v_mfma_f32_32x32x16_bf16 v[160:175], v[80:83], v[208:211], v[160:175]
    ds_read_b64_tr_b16 v[228:229], v245 offset:44032
    ds_read_b64_tr_b16 v[230:231], v245 offset:44544
    buffer_load_dwordx2 v[240:241], v8, s[68:71], s92 offen offset:1536 sc1
    s_waitcnt lgkmcnt(8)
    v_mfma_f32_32x32x16_bf16 v[176:191], v[80:83], v[212:215], v[176:191]
    ds_read_b64_tr_b16 v[208:209], v245 offset:54272
    ds_read_b64_tr_b16 v[210:211], v245 offset:54784
    buffer_load_dwordx2 v[242:243], v8, s[68:71], s92 offen offset:1792 sc1
    s_waitcnt lgkmcnt(8)
    v_mfma_f32_32x32x16_bf16 v[192:207], v[216:219], v[80:83], v[192:207]
    ds_read_b64_tr_b16 v[212:213], v245 offset:55296
    ds_read_b64_tr_b16 v[214:215], v245 offset:55808
    s_add_u32 s83, s95, 0
    buffer_load_dwordx4 v[96:99], v2, s[68:71], s83 offen offset:2048 sc1
    s_waitcnt lgkmcnt(8)
    v_mfma_f32_32x32x16_bf16 v[160:175], v[84:87], v[220:223], v[160:175]
    ds_read_b64_tr_b16 v[216:217], v245 offset:53248
    ds_read_b64_tr_b16 v[218:219], v245 offset:53760
    s_add_u32 s83, s95, 0
    buffer_load_dwordx4 v[100:103], v2, s[68:71], s83 offen offset:3072 sc1
    s_waitcnt lgkmcnt(8)
    v_mfma_f32_32x32x16_bf16 v[176:191], v[84:87], v[224:227], v[176:191]
    ds_read_b64_tr_b16 v[220:221], v245 offset:57344
    ds_read_b64_tr_b16 v[222:223], v245 offset:57856
    s_add_u32 s83, s95, 4096
    buffer_load_dwordx4 v[104:107], v2, s[68:71], s83 offen offset:2048 sc1
    s_waitcnt lgkmcnt(8)
    v_mfma_f32_32x32x16_bf16 v[192:207], v[228:231], v[84:87], v[192:207]
    ds_read_b64_tr_b16 v[224:225], v245 offset:58368
    ds_read_b64_tr_b16 v[226:227], v245 offset:58880
    s_add_u32 s83, s95, 4096
    buffer_load_dwordx4 v[108:111], v2, s[68:71], s83 offen offset:3072 sc1
    s_waitcnt lgkmcnt(8)
    v_mfma_f32_32x32x16_bf16 v[160:175], v[88:91], v[208:211], v[160:175]
    ds_read_b64_tr_b16 v[228:229], v245 offset:56320
    ds_read_b64_tr_b16 v[230:231], v245 offset:56832
    s_add_u32 s83, s95, 8192
    buffer_load_dwordx4 v[112:115], v2, s[68:71], s83 offen offset:2048 sc1
    s_waitcnt lgkmcnt(8)
    v_mfma_f32_32x32x16_bf16 v[176:191], v[88:91], v[212:215], v[176:191]
    s_add_u32 s83, s95, 8192
    buffer_load_dwordx4 v[116:119], v2, s[68:71], s83 offen offset:3072 sc1
    s_waitcnt lgkmcnt(6)
    v_mfma_f32_32x32x16_bf16 v[192:207], v[216:219], v[88:91], v[192:207]
    s_waitcnt lgkmcnt(4)
    v_mfma_f32_32x32x16_bf16 v[160:175], v[92:95], v[220:223], v[160:175]
    s_waitcnt lgkmcnt(2)
    v_mfma_f32_32x32x16_bf16 v[176:191], v[92:95], v[224:227], v[176:191]
    s_waitcnt lgkmcnt(0)
    v_mfma_f32_32x32x16_bf16 v[192:207], v[228:231], v[92:95], v[192:207]
    s_add_u32 s83, s95, 12288
    buffer_load_dwordx4 v[120:123], v2, s[68:71], s83 offen offset:2048 sc1
    s_add_u32 s83, s95, 12288
    buffer_load_dwordx4 v[124:127], v2, s[68:71], s83 offen offset:3072 sc1
    s_add_u32 s83, s95, 16384
    buffer_load_dwordx4 v[128:131], v2, s[68:71], s83 offen offset:2048 sc1
    s_add_u32 s83, s95, 16384
    buffer_load_dwordx4 v[132:135], v2, s[68:71], s83 offen offset:3072 sc1
    s_add_u32 s83, s95, 20480
    buffer_load_dwordx4 v[136:139], v2, s[68:71], s83 offen offset:2048 sc1
    s_add_u32 s83, s95, 20480
    buffer_load_dwordx4 v[140:143], v2, s[68:71], s83 offen offset:3072 sc1
    s_add_u32 s83, s95, 24576
    buffer_load_dwordx4 v[144:147], v2, s[68:71], s83 offen offset:2048 sc1
    s_add_u32 s83, s95, 24576
    buffer_load_dwordx4 v[148:151], v2, s[68:71], s83 offen offset:3072 sc1
    s_add_u32 s83, s95, 28672
    buffer_load_dwordx4 v[152:155], v2, s[68:71], s83 offen offset:2048 sc1
    s_add_u32 s83, s95, 28672
    buffer_load_dwordx4 v[156:159], v2, s[68:71], s83 offen offset:3072 sc1
    s_waitcnt vmcnt(16)
    v_max3_u32 v254, v247, v249, v251
    v_max3_u32 v254, v254, v253, v237
    v_max3_u32 v254, v254, v239, v241
    v_max_u32 v254, v254, v243
    v_cmp_eq_u32 vcc, -1, v254
    s_nop 1
    s_cbranch_vccnz L_redo_93
L_back_94:
    v_add_f32 v246, v246, v248
    v_add_f32 v247, v247, v249
    v_add_f32 v250, v250, v252
    v_add_f32 v251, v251, v253
    v_add_f32 v236, v236, v238
    v_add_f32 v237, v237, v239
    v_add_f32 v240, v240, v242
    v_add_f32 v241, v241, v243
    v_add_f32 v246, v246, v250
    v_add_f32 v247, v247, v251
    v_add_f32 v236, v236, v240
    v_add_f32 v237, v237, v241
    v_add_f32 v246, v246, v236
    v_add_f32 v247, v247, v237
    v_mov_b32 v8, v246
    v_mov_b32 v9, v247
    s_nop 0
    v_permlane32_swap_b32 v246, v8
    v_permlane32_swap_b32 v247, v9
    v_add_f32 v76, v246, v8
    v_add_f32 v77, v247, v9
    v_mul_f32 v240, 0xbb000000, v76
    v_mul_f32 v242, 0x3b000000, v77
    v_fma_f32 v242, -v240, v240, v242
    v_max_f32 v242, 0, v242
    v_add_f32 v242, 0x3727c5ac, v242
    v_rsq_f32 v242, v242
    v_and_b32 v246, 31, v1
    v_lshlrev_b32 v246, 2, v246
    v_add_u32 v246, s79, v246
    v_mul_f32 v243, 0x3fb8aa3b, v242
    ds_write_b32 v246, v243 offset:33920
    v_cvt_pk_bf16_f32 v8, v240, v240
    v_and_b32 v9, 0xffff0000, v8
    v_sub_f32 v9, v240, v9
    v_cvt_pk_bf16_f32 v9, v240, v9
    v_and_b32 v8, 0xffff, v8
    v_cndmask_b32 v236, 0, v9, s[86:87]
    v_cndmask_b32 v237, 0, v8, s[86:87]
    v_mov_b32 v238, 0
    v_mov_b32 v239, 0
    v_lshlrev_b32 v8, 4, v4
    v_add_u32 v8, s79, v8
    s_waitcnt lgkmcnt(0)
    ds_read_b128 v[48:51], v8 offset:33920
    ds_read_b128 v[52:55], v8 offset:33952
    ds_read_b128 v[56:59], v8 offset:33984
    ds_read_b128 v[60:63], v8 offset:34016
    v_mov_b32 v246, 0x358637bd
    v_mov_b32 v247, 0x3f317218
    v_lshlrev_b32 v248, 3, v1
    v_add_u32 v249, s79, v248
    v_lshlrev_b32 v250, 2, v1
    ds_read_b64_tr_b16 v[208:209], v244 offset:7168
    ds_read_b64_tr_b16 v[210:211], v244 offset:7680
    ds_read_b64_tr_b16 v[212:213], v244 offset:8192
    ds_read_b64_tr_b16 v[214:215], v244 offset:8704
    ds_read_b64_tr_b16 v[216:217], v244 offset:10240
    ds_read_b64_tr_b16 v[218:219], v244 offset:10752
    ds_read_b64_tr_b16 v[220:221], v244 offset:11264
    ds_read_b64_tr_b16 v[222:223], v244 offset:11776
    ds_read_b64_tr_b16 v[224:225], v244 offset:19456
    ds_read_b64_tr_b16 v[226:227], v244 offset:19968
    s_waitcnt vmcnt(12)
    v_max3_u32 v254, v96, v100, v104
    v_max_u32 v254, v254, v108
    v_cmp_eq_u32 vcc, -1, v254
    s_cbranch_vccnz L_redo_95
L_back_96:
    s_waitcnt lgkmcnt(8)
    v_mfma_f32_32x32x16_bf16 v[160:175], v[96:99], v[208:211], v[160:175]
    ds_read_b64_tr_b16 v[228:229], v244 offset:20480
    ds_read_b64_tr_b16 v[230:231], v244 offset:20992
    v_add_u32 v251, s79, v250
    s_lshl_b32 s80, s3, 9
    s_add_u32 s80, s80, 34816
    v_add_u32 v252, s80, v248
    v_add_u32 v248, 81920, v252
    v_add_u32 v253, 34048, v250
    s_waitcnt lgkmcnt(8)
    v_mfma_f32_32x32x16_bf16 v[176:191], v[96:99], v[212:215], v[176:191]
    ds_read_b64_tr_b16 v[208:209], v244 offset:22528
    ds_read_b64_tr_b16 v[210:211], v244 offset:23040
    v_add_u32 v9, 81920, v253
    s_mul_i32 s93, s90, 2304
    s_add_u32 s93, s93, 14745600
    s_waitcnt lgkmcnt(8)
    v_mfma_f32_32x32x16_bf16 v[160:175], v[100:103], v[216:219], v[160:175]
    ds_read_b64_tr_b16 v[212:213], v244 offset:23552
    ds_read_b64_tr_b16 v[214:215], v244 offset:24064
    s_lshl_b32 s92, s3, 9
    s_add_u32 s92, s92, s93
    s_add_u32 s93, s93, 2048
    s_cmp_eq_u32 s3, 0
    s_cselect_b32 s93, s93, 1073741824
    v_cvt_pk_bf16_f32 v64, v10, v10
    s_waitcnt lgkmcnt(8)
    v_mfma_f32_32x32x16_bf16 v[176:191], v[100:103], v[220:223], v[176:191]
    ds_read_b64_tr_b16 v[216:217], v244 offset:48128
    ds_read_b64_tr_b16 v[218:219], v244 offset:48640
    v_and_b32 v65, 0xffff0000, v64
    v_sub_f32 v65, v10, v65
    s_waitcnt lgkmcnt(8)
    v_mfma_f32_32x32x16_bf16 v[160:175], v[104:107], v[224:227], v[160:175]
    ds_read_b64_tr_b16 v[220:221], v244 offset:49152
    ds_read_b64_tr_b16 v[222:223], v244 offset:49664
    s_waitcnt vmcnt(8)
    v_max3_u32 v254, v112, v116, v120
    v_cvt_pk_bf16_f32 v65, v65, 0
    v_cvt_pk_bf16_f32 v66, v11, v11
    v_and_b32 v67, 0xffff0000, v66
    v_sub_f32 v67, v11, v67
    s_waitcnt lgkmcnt(8)
    v_mfma_f32_32x32x16_bf16 v[176:191], v[104:107], v[228:231], v[176:191]
    ds_read_b64_tr_b16 v[224:225], v244 offset:51200
    ds_read_b64_tr_b16 v[226:227], v244 offset:51712
    v_max_u32 v254, v254, v124
    v_cvt_pk_bf16_f32 v67, v67, 0
    v_cvt_pk_bf16_f32 v68, v12, v12
    s_waitcnt lgkmcnt(8)
    v_mfma_f32_32x32x16_bf16 v[160:175], v[108:111], v[208:211], v[160:175]
    ds_read_b64_tr_b16 v[228:229], v244 offset:52224
    ds_read_b64_tr_b16 v[230:231], v244 offset:52736
    v_cmp_eq_u32 vcc, -1, v254
    v_and_b32 v69, 0xffff0000, v68
    v_sub_f32 v69, v12, v69
    v_cvt_pk_bf16_f32 v69, v69, 0
    v_mov_b32 v70, 0
    s_waitcnt lgkmcnt(8)
    v_mfma_f32_32x32x16_bf16 v[176:191], v[108:111], v[212:215], v[176:191]
    ds_read_b64_tr_b16 v[208:209], v244 offset:60416
    ds_read_b64_tr_b16 v[210:211], v244 offset:60928
    s_cbranch_vccnz L_redo_97
L_back_98:
    v_mov_b32 v71, 0
    s_waitcnt lgkmcnt(8)
    v_mfma_f32_32x32x16_bf16 v[160:175], v[112:115], v[216:219], v[160:175]
    ds_read_b64_tr_b16 v[212:213], v244 offset:61440
    ds_read_b64_tr_b16 v[214:215], v244 offset:61952
    s_waitcnt lgkmcnt(8)
    v_mfma_f32_32x32x16_bf16 v[176:191], v[112:115], v[220:223], v[176:191]
    ds_read_b64_tr_b16 v[216:217], v244 offset:63488
    ds_read_b64_tr_b16 v[218:219], v244 offset:64000
    s_waitcnt lgkmcnt(8)
    v_mfma_f32_32x32x16_bf16 v[160:175], v[116:119], v[224:227], v[160:175]
    ds_read_b64_tr_b16 v[220:221], v244 offset:64512
    ds_read_b64_tr_b16 v[222:223], v244 offset:65024
    s_waitcnt lgkmcnt(8)
    v_mfma_f32_32x32x16_bf16 v[176:191], v[116:119], v[228:231], v[176:191]
    ds_read_b64_tr_b16 v[224:225], v245 offset:7168
    ds_read_b64_tr_b16 v[226:227], v245 offset:7680
    s_waitcnt lgkmcnt(8)
    v_mfma_f32_32x32x16_bf16 v[160:175], v[120:123], v[208:211], v[160:175]
    ds_read_b64_tr_b16 v[228:229], v245 offset:8192
    ds_read_b64_tr_b16 v[230:231], v245 offset:8704
    s_waitcnt vmcnt(4)
    v_max3_u32 v254, v128, v132, v136
    s_waitcnt lgkmcnt(8)
    v_mfma_f32_32x32x16_bf16 v[176:191], v[120:123], v[212:215], v[176:191]
    ds_read_b64_tr_b16 v[208:209], v245 offset:10240
    ds_read_b64_tr_b16 v[210:211], v245 offset:10752
    v_max_u32 v254, v254, v140
    s_waitcnt lgkmcnt(8)
    v_mfma_f32_32x32x16_bf16 v[160:175], v[124:127], v[216:219], v[160:175]
    ds_read_b64_tr_b16 v[212:213], v245 offset:11264
    ds_read_b64_tr_b16 v[214:215], v245 offset:11776
    v_cmp_eq_u32 vcc, -1, v254
    s_waitcnt lgkmcnt(8)
    v_mfma_f32_32x32x16_bf16 v[176:191], v[124:127], v[220:223], v[176:191]
    ds_read_b64_tr_b16 v[216:217], v245 offset:19456
    ds_read_b64_tr_b16 v[218:219], v245 offset:19968
    s_cbranch_vccnz L_redo_99
L_back_100:
    s_waitcnt lgkmcnt(8)
    v_mfma_f32_32x32x16_bf16 v[160:175], v[128:131], v[224:227], v[160:175]
    ds_read_b64_tr_b16 v[220:221], v245 offset:20480
    ds_read_b64_tr_b16 v[222:223], v245 offset:20992
    s_waitcnt lgkmcnt(8)
    v_mfma_f32_32x32x16_bf16 v[176:191], v[128:131], v[228:231], v[176:191]
    ds_read_b64_tr_b16 v[224:225], v245 offset:22528
    ds_read_b64_tr_b16 v[226:227], v245 offset:23040
    s_waitcnt lgkmcnt(8)
    v_mfma_f32_32x32x16_bf16 v[160:175], v[132:135], v[208:211], v[160:175]
    ds_read_b64_tr_b16 v[228:229], v245 offset:23552
    ds_read_b64_tr_b16 v[230:231], v245 offset:24064
    s_waitcnt lgkmcnt(8)
    v_mfma_f32_32x32x16_bf16 v[176:191], v[132:135], v[212:215], v[176:191]
    ds_read_b64_tr_b16 v[208:209], v245 offset:48128
    ds_read_b64_tr_b16 v[210:211], v245 offset:48640
    s_waitcnt lgkmcnt(8)
    v_mfma_f32_32x32x16_bf16 v[160:175], v[136:139], v[216:219], v[160:175]
    ds_read_b64_tr_b16 v[212:213], v245 offset:49152
    ds_read_b64_tr_b16 v[214:215], v245 offset:49664
    s_waitcnt vmcnt(0)
    v_max3_u32 v254, v144, v148, v152
    s_waitcnt lgkmcnt(8)
    v_mfma_f32_32x32x16_bf16 v[176:191], v[136:139], v[220:223], v[176:191]
    ds_read_b64_tr_b16 v[216:217], v245 offset:51200
    ds_read_b64_tr_b16 v[218:219], v245 offset:51712
    v_max_u32 v254, v254, v156
    s_waitcnt lgkmcnt(8)
    v_mfma_f32_32x32x16_bf16 v[160:175], v[140:143], v[224:227], v[160:175]
    ds_read_b64_tr_b16 v[220:221], v245 offset:52224
    ds_read_b64_tr_b16 v[222:223], v245 offset:52736
    v_cmp_eq_u32 vcc, -1, v254
    s_waitcnt lgkmcnt(8)
    v_mfma_f32_32x32x16_bf16 v[176:191], v[140:143], v[228:231], v[176:191]
    ds_read_b64_tr_b16 v[224:225], v245 offset:60416
    ds_read_b64_tr_b16 v[226:227], v245 offset:60928
    s_cbranch_vccnz L_redo_101
L_back_102:
    s_waitcnt lgkmcnt(8)
    v_mfma_f32_32x32x16_bf16 v[160:175], v[144:147], v[208:211], v[160:175]
    ds_read_b64_tr_b16 v[228:229], v245 offset:61440
    ds_read_b64_tr_b16 v[230:231], v245 offset:61952
    s_waitcnt lgkmcnt(8)
    v_mfma_f32_32x32x16_bf16 v[176:191], v[144:147], v[212:215], v[176:191]
    ds_read_b64_tr_b16 v[208:209], v245 offset:63488
    ds_read_b64_tr_b16 v[210:211], v245 offset:64000
    s_waitcnt lgkmcnt(8)
    v_mfma_f32_32x32x16_bf16 v[160:175], v[148:151], v[216:219], v[160:175]
    ds_read_b64_tr_b16 v[212:213], v245 offset:64512
    ds_read_b64_tr_b16 v[214:215], v245 offset:65024
    s_waitcnt lgkmcnt(8)
    v_mfma_f32_32x32x16_bf16 v[176:191], v[148:151], v[220:223], v[176:191]
    s_waitcnt lgkmcnt(6)
    v_mfma_f32_32x32x16_bf16 v[160:175], v[152:155], v[224:227], v[160:175]
    s_waitcnt lgkmcnt(4)
    v_mfma_f32_32x32x16_bf16 v[176:191], v[152:155], v[228:231], v[176:191]
    s_add_u32 m0, s79, 36864
    s_add_u32 s83, s99, 1114112
    buffer_load_dwordx4 v29, s[52:55], s83 offen lds
    s_waitcnt lgkmcnt(2)
    v_mfma_f32_32x32x16_bf16 v[160:175], v[156:159], v[208:211], v[160:175]
    s_waitcnt lgkmcnt(0)
    v_mfma_f32_32x32x16_bf16 v[176:191], v[156:159], v[212:215], v[176:191]
    s_add_u32 m0, s79, 37888
    s_add_u32 s83, s99, 1146880
    buffer_load_dwordx4 v29, s[52:55], s83 offen lds
    v_mfma_f32_32x32x16_bf16 v[160:175], v[236:239], v[66:69], v[160:175]
    v_mfma_f32_32x32x16_bf16 v[176:191], v[236:239], v[68:71], v[176:191]
    v_mfma_f32_32x32x16_bf16 v[192:207], v[64:67], v[236:239], v[192:207]
    s_waitcnt lgkmcnt(0)
    s_nop 8
    v_pk_mul_f32 v[160:161], v[160:161], v[48:49]
    v_pk_mul_f32 v[162:163], v[162:163], v[50:51]
    v_pk_mul_f32 v[164:165], v[164:165], v[52:53]
    v_pk_mul_f32 v[166:167], v[166:167], v[54:55]
    v_pk_mul_f32 v[168:169], v[168:169], v[56:57]
    v_pk_mul_f32 v[170:171], v[170:171], v[58:59]
    v_pk_mul_f32 v[172:173], v[172:173], v[60:61]
    v_pk_mul_f32 v[174:175], v[174:175], v[62:63]
    v_exp_f32_e64 v32, v160 clamp
    v_pk_mul_f32 v[176:177], v[176:177], v[48:49]
    v_max_f32 v160, 0, v160
    v_exp_f32_e64 v33, v161 clamp
    v_max_f32 v161, 0, v161
    v_exp_f32_e64 v34, v162 clamp
    v_pk_mul_f32 v[178:179], v[178:179], v[50:51]
    v_max_f32 v162, 0, v162
    v_exp_f32_e64 v35, v163 clamp
    v_max_f32 v163, 0, v163
    v_exp_f32_e64 v36, v164 clamp
    v_pk_mul_f32 v[180:181], v[180:181], v[52:53]
    v_max_f32 v164, 0, v164
    v_exp_f32_e64 v37, v165 clamp
    v_max_f32 v165, 0, v165
    v_exp_f32_e64 v38, v166 clamp
    v_pk_mul_f32 v[182:183], v[182:183], v[54:55]
    v_max_f32 v166, 0, v166
    v_exp_f32_e64 v39, v167 clamp
    v_max_f32 v167, 0, v167
    v_exp_f32_e64 v40, v168 clamp
    v_pk_mul_f32 v[184:185], v[184:185], v[56:57]
    v_max_f32 v168, 0, v168
    v_exp_f32_e64 v41, v169 clamp
    v_max_f32 v169, 0, v169
    v_exp_f32_e64 v42, v170 clamp
    v_pk_mul_f32 v[186:187], v[186:187], v[58:59]
    v_max_f32 v170, 0, v170
    v_exp_f32_e64 v43, v171 clamp
    v_max_f32 v171, 0, v171
    v_exp_f32_e64 v44, v172 clamp
    v_pk_mul_f32 v[188:189], v[188:189], v[60:61]
    v_max_f32 v172, 0, v172
    v_exp_f32_e64 v45, v173 clamp
    v_max_f32 v173, 0, v173
    v_exp_f32_e64 v46, v174 clamp
    v_pk_mul_f32 v[190:191], v[190:191], v[62:63]
    v_max_f32 v174, 0, v174
    v_exp_f32_e64 v47, v175 clamp
    v_max_f32 v175, 0, v175
    v_pk_add_f32 v[32:33], v[32:33], v[246:247] op_sel:[0,0] op_sel_hi:[1,0]
    v_pk_add_f32 v[34:35], v[34:35], v[246:247] op_sel:[0,0] op_sel_hi:[1,0]
    v_pk_add_f32 v[36:37], v[36:37], v[246:247] op_sel:[0,0] op_sel_hi:[1,0]
    v_pk_add_f32 v[38:39], v[38:39], v[246:247] op_sel:[0,0] op_sel_hi:[1,0]
    v_pk_add_f32 v[40:41], v[40:41], v[246:247] op_sel:[0,0] op_sel_hi:[1,0]
    v_pk_add_f32 v[42:43], v[42:43], v[246:247] op_sel:[0,0] op_sel_hi:[1,0]
    v_pk_add_f32 v[44:45], v[44:45], v[246:247] op_sel:[0,0] op_sel_hi:[1,0]
    v_pk_add_f32 v[46:47], v[46:47], v[246:247] op_sel:[0,0] op_sel_hi:[1,0]
    v_cvt_pk_bf16_f32 v88, v176, v177
    v_cvt_pk_bf16_f32 v89, v178, v179
    v_cvt_pk_bf16_f32 v90, v180, v181
    v_cvt_pk_bf16_f32 v91, v182, v183
    v_cvt_pk_bf16_f32 v92, v184, v185
    v_cvt_pk_bf16_f32 v93, v186, v187
    v_cvt_pk_bf16_f32 v94, v188, v189
    v_cvt_pk_bf16_f32 v95, v190, v191
    v_pk_fma_f32 v[160:161], v[160:161], v[246:247], v[32:33] op_sel:[0,1,0] op_sel_hi:[1,1,1]
    v_pk_fma_f32 v[162:163], v[162:163], v[246:247], v[34:35] op_sel:[0,1,0] op_sel_hi:[1,1,1]
    v_pk_fma_f32 v[164:165], v[164:165], v[246:247], v[36:37] op_sel:[0,1,0] op_sel_hi:[1,1,1]
    v_pk_fma_f32 v[166:167], v[166:167], v[246:247], v[38:39] op_sel:[0,1,0] op_sel_hi:[1,1,1]
    v_pk_fma_f32 v[168:169], v[168:169], v[246:247], v[40:41] op_sel:[0,1,0] op_sel_hi:[1,1,1]
    v_pk_fma_f32 v[170:171], v[170:171], v[246:247], v[42:43] op_sel:[0,1,0] op_sel_hi:[1,1,1]
    v_pk_fma_f32 v[172:173], v[172:173], v[246:247], v[44:45] op_sel:[0,1,0] op_sel_hi:[1,1,1]
    v_pk_fma_f32 v[174:175], v[174:175], v[246:247], v[46:47] op_sel:[0,1,0] op_sel_hi:[1,1,1]
    v_cvt_pk_bf16_f32 v80, v160, v161
    v_cvt_pk_bf16_f32 v81, v162, v163
    v_cvt_pk_bf16_f32 v82, v164, v165
    v_cvt_pk_bf16_f32 v83, v166, v167
    v_cvt_pk_bf16_f32 v84, v168, v169
    v_cvt_pk_bf16_f32 v85, v170, v171
    v_cvt_pk_bf16_f32 v86, v172, v173
    v_cvt_pk_bf16_f32 v87, v174, v175
    v_mfma_f32_32x32x16_bf16 v[160:175], v[80:83], v[88:91], 0
    s_nop 0
    v_mfma_f32_32x32x16_bf16 v[160:175], v[84:87], v[92:95], v[160:175]
    v_mfma_f32_32x32x16_bf16 v[176:191], v[232:235], v[80:83], 0
    v_mfma_f32_32x32x16_bf16 v[176:191], v[232:235], v[84:87], v[176:191]
    ds_read_b64_tr_b16 v[208:209], v244 offset:6144
    ds_read_b64_tr_b16 v[210:211], v244 offset:6656
    ds_read_b64_tr_b16 v[212:213], v244 offset:9216
    ds_read_b64_tr_b16 v[214:215], v244 offset:9728
    ds_read_b64_tr_b16 v[216:217], v244 offset:18432
    ds_read_b64_tr_b16 v[218:219], v244 offset:18944
    ds_read_b64_tr_b16 v[220:221], v244 offset:21504
    ds_read_b64_tr_b16 v[222:223], v244 offset:22016
    ds_read_b64_tr_b16 v[224:225], v244 offset:47104
    ds_read_b64_tr_b16 v[226:227], v244 offset:47616
    s_waitcnt lgkmcnt(8)
    v_mfma_f32_32x32x16_bf16 v[192:207], v[208:211], v[96:99], v[192:207]
    ds_read_b64_tr_b16 v[228:229], v244 offset:50176
    ds_read_b64_tr_b16 v[230:231], v244 offset:50688
    s_waitcnt lgkmcnt(8)
    v_mfma_f32_32x32x16_bf16 v[192:207], v[212:215], v[100:103], v[192:207]
    ds_read_b64_tr_b16 v[208:209], v244 offset:59392
    ds_read_b64_tr_b16 v[210:211], v244 offset:59904
    v_cndmask_b32 v48, v160, v168, s[88:89]
    v_cndmask_b32 v49, v161, v169, s[88:89]
    ds_write_b64 v249, v[48:49] offset:34816
    v_cndmask_b32 v50, v162, v170, s[88:89]
    v_cndmask_b32 v51, v163, v171, s[88:89]
    ds_write_b64 v249, v[50:51] offset:35328
    v_cndmask_b32 v52, v164, v172, s[88:89]
    v_cndmask_b32 v53, v165, v173, s[88:89]
    ds_write_b64 v249, v[52:53] offset:35840
    v_cndmask_b32 v54, v166, v174, s[88:89]
    v_cndmask_b32 v55, v167, v175, s[88:89]
    ds_write_b64 v249, v[54:55] offset:36352
    ds_write_b32 v251, v176 offset:34048
    s_waitcnt lgkmcnt(13)
    v_mfma_f32_32x32x16_bf16 v[192:207], v[216:219], v[104:107], v[192:207]
    ds_read_b64_tr_b16 v[212:213], v244 offset:62464
    ds_read_b64_tr_b16 v[214:215], v244 offset:62976
    s_waitcnt lgkmcnt(2)
    s_barrier
    ds_read_b64 v[160:161], v252 offset:0
    ds_read_b64 v[162:163], v252 offset:40960
    ds_read_b64 v[164:165], v248 offset:0
    ds_read_b64 v[166:167], v248 offset:40960
    ds_read_b32 v168, v253 offset:0
    ds_read_b32 v169, v253 offset:40960
    ds_read_b32 v170, v9 offset:0
    ds_read_b32 v171, v9 offset:40960
    v_mfma_f32_32x32x16_bf16 v[192:207], v[220:223], v[108:111], v[192:207]
    ds_read_b64_tr_b16 v[216:217], v245 offset:6144
    ds_read_b64_tr_b16 v[218:219], v245 offset:6656
    v_mfma_f32_32x32x16_bf16 v[192:207], v[224:227], v[112:115], v[192:207]
    ds_read_b64_tr_b16 v[220:221], v245 offset:9216
    ds_read_b64_tr_b16 v[222:223], v245 offset:9728
    s_waitcnt lgkmcnt(4)
    v_add_f32 v160, v160, v162
    v_add_f32 v164, v164, v166
    v_add_f32 v168, v168, v170
    v_add_f32 v161, v161, v163
    v_add_f32 v165, v165, v167
    v_add_f32 v169, v169, v171
    v_add_f32 v160, v160, v164
    v_add_f32 v161, v161, v165
    v_add_f32 v168, v168, v169
    v_mul_f32 v160, v160, v247
    v_mul_f32 v161, v161, v247
    buffer_atomic_add_f32 v160, v250, s[68:71], s92 offen
    buffer_atomic_add_f32 v161, v250, s[68:71], s92 offen offset:256
    s_mov_b64 exec, s[86:87]
    buffer_atomic_add_f32 v168, v250, s[68:71], s93 offen
    s_mov_b64 exec, -1
    v_mfma_f32_32x32x16_bf16 v[192:207], v[228:231], v[116:119], v[192:207]
    ds_read_b64_tr_b16 v[224:225], v245 offset:18432
    ds_read_b64_tr_b16 v[226:227], v245 offset:18944
    v_mfma_f32_32x32x16_bf16 v[192:207], v[208:211], v[120:123], v[192:207]
    ds_read_b64_tr_b16 v[228:229], v245 offset:21504
    ds_read_b64_tr_b16 v[230:231], v245 offset:22016
    v_mfma_f32_32x32x16_bf16 v[192:207], v[212:215], v[124:127], v[192:207]
    ds_read_b64_tr_b16 v[208:209], v245 offset:47104
    ds_read_b64_tr_b16 v[210:211], v245 offset:47616
    s_waitcnt lgkmcnt(8)
    v_mfma_f32_32x32x16_bf16 v[192:207], v[216:219], v[128:131], v[192:207]
    ds_read_b64_tr_b16 v[212:213], v245 offset:50176
    ds_read_b64_tr_b16 v[214:215], v245 offset:50688
    s_waitcnt lgkmcnt(8)
    v_mfma_f32_32x32x16_bf16 v[192:207], v[220:223], v[132:135], v[192:207]
    ds_read_b64_tr_b16 v[216:217], v245 offset:59392
    ds_read_b64_tr_b16 v[218:219], v245 offset:59904
    s_waitcnt lgkmcnt(8)
    v_mfma_f32_32x32x16_bf16 v[192:207], v[224:227], v[136:139], v[192:207]
    ds_read_b64_tr_b16 v[220:221], v245 offset:62464
    ds_read_b64_tr_b16 v[222:223], v245 offset:62976
    s_waitcnt lgkmcnt(8)
    v_mfma_f32_32x32x16_bf16 v[192:207], v[228:231], v[140:143], v[192:207]
    s_waitcnt lgkmcnt(6)
    v_mfma_f32_32x32x16_bf16 v[192:207], v[208:211], v[144:147], v[192:207]
    s_waitcnt lgkmcnt(4)
    v_mfma_f32_32x32x16_bf16 v[192:207], v[212:215], v[148:151], v[192:207]
    s_waitcnt lgkmcnt(2)
    v_mfma_f32_32x32x16_bf16 v[192:207], v[216:219], v[152:155], v[192:207]
    s_waitcnt lgkmcnt(0)
    v_mfma_f32_32x32x16_bf16 v[192:207], v[220:223], v[156:159], v[192:207]
    s_lshl_b32 s92, s91, 15
    s_lshl_b32 s81, s90, 11
    s_add_u32 s92, s92, s81
    s_add_u32 s92, s92, 4194304
    s_lshr_b32 s82, s91, 2
    s_lshl_b32 s93, s90, 11
    s_lshl_b32 s81, s82, 7
    s_add_u32 s93, s93, s81
    s_add_u32 s93, s93, 16809984
    s_nop 2
    v_pk_mul_f32 v[96:97], v[192:193], v[242:243] op_sel:[0,1] op_sel_hi:[1,1]
    v_pk_mul_f32 v[98:99], v[194:195], v[242:243] op_sel:[0,1] op_sel_hi:[1,1]
    v_pk_mul_f32 v[100:101], v[196:197], v[242:243] op_sel:[0,1] op_sel_hi:[1,1]
    v_pk_mul_f32 v[102:103], v[198:199], v[242:243] op_sel:[0,1] op_sel_hi:[1,1]
    v_pk_mul_f32 v[104:105], v[200:201], v[242:243] op_sel:[0,1] op_sel_hi:[1,1]
    v_pk_mul_f32 v[106:107], v[202:203], v[242:243] op_sel:[0,1] op_sel_hi:[1,1]
    v_pk_mul_f32 v[108:109], v[204:205], v[242:243] op_sel:[0,1] op_sel_hi:[1,1]
    v_pk_mul_f32 v[110:111], v[206:207], v[242:243] op_sel:[0,1] op_sel_hi:[1,1]
    v_exp_f32_e64 v96, v96 clamp
    v_max_f32 v192, 0, v192
    v_exp_f32_e64 v97, v97 clamp
    v_max_f32 v193, 0, v193
    v_exp_f32_e64 v98, v98 clamp
    v_max_f32 v194, 0, v194
    v_exp_f32_e64 v99, v99 clamp
    v_max_f32 v195, 0, v195
    v_exp_f32_e64 v100, v100 clamp
    v_max_f32 v196, 0, v196
    v_exp_f32_e64 v101, v101 clamp
    v_max_f32 v197, 0, v197
    v_exp_f32_e64 v102, v102 clamp
    v_max_f32 v198, 0, v198
    v_exp_f32_e64 v103, v103 clamp
    v_max_f32 v199, 0, v199
    v_exp_f32_e64 v104, v104 clamp
    v_max_f32 v200, 0, v200
    v_exp_f32_e64 v105, v105 clamp
    v_max_f32 v201, 0, v201
    v_exp_f32_e64 v106, v106 clamp
    v_max_f32 v202, 0, v202
    v_exp_f32_e64 v107, v107 clamp
    v_max_f32 v203, 0, v203
    v_exp_f32_e64 v108, v108 clamp
    v_max_f32 v204, 0, v204
    v_exp_f32_e64 v109, v109 clamp
    v_max_f32 v205, 0, v205
    v_exp_f32_e64 v110, v110 clamp
    v_max_f32 v206, 0, v206
    v_exp_f32_e64 v111, v111 clamp
    v_max_f32 v207, 0, v207
    v_mov_b32 v9, 1
    s_cmp_eq_u32 s3, 0
    s_cselect_b32 s93, s93, 1073741824
    s_waitcnt vmcnt(0)
    s_barrier
    s_mov_b64 exec, 1
    buffer_store_dword v9, off, s[68:71], s93 sc1
    s_mov_b64 exec, -1
    v_pk_add_f32 v[96:97], v[96:97], v[246:247] op_sel:[0,0] op_sel_hi:[1,0]
    v_pk_add_f32 v[98:99], v[98:99], v[246:247] op_sel:[0,0] op_sel_hi:[1,0]
    v_pk_add_f32 v[100:101], v[100:101], v[246:247] op_sel:[0,0] op_sel_hi:[1,0]
    v_pk_add_f32 v[102:103], v[102:103], v[246:247] op_sel:[0,0] op_sel_hi:[1,0]
    v_pk_add_f32 v[104:105], v[104:105], v[246:247] op_sel:[0,0] op_sel_hi:[1,0]
    v_pk_add_f32 v[106:107], v[106:107], v[246:247] op_sel:[0,0] op_sel_hi:[1,0]
    v_pk_add_f32 v[108:109], v[108:109], v[246:247] op_sel:[0,0] op_sel_hi:[1,0]
    v_pk_add_f32 v[110:111], v[110:111], v[246:247] op_sel:[0,0] op_sel_hi:[1,0]
    v_pk_fma_f32 v[192:193], v[192:193], v[242:243], v[96:97] op_sel:[0,0,0] op_sel_hi:[1,0,1]
    v_pk_fma_f32 v[194:195], v[194:195], v[242:243], v[98:99] op_sel:[0,0,0] op_sel_hi:[1,0,1]
    v_pk_fma_f32 v[196:197], v[196:197], v[242:243], v[100:101] op_sel:[0,0,0] op_sel_hi:[1,0,1]
    v_pk_fma_f32 v[198:199], v[198:199], v[242:243], v[102:103] op_sel:[0,0,0] op_sel_hi:[1,0,1]
    v_pk_fma_f32 v[200:201], v[200:201], v[242:243], v[104:105] op_sel:[0,0,0] op_sel_hi:[1,0,1]
    v_pk_fma_f32 v[202:203], v[202:203], v[242:243], v[106:107] op_sel:[0,0,0] op_sel_hi:[1,0,1]
    v_pk_fma_f32 v[204:205], v[204:205], v[242:243], v[108:109] op_sel:[0,0,0] op_sel_hi:[1,0,1]
    v_pk_fma_f32 v[206:207], v[206:207], v[242:243], v[110:111] op_sel:[0,0,0] op_sel_hi:[1,0,1]
    v_cvt_pk_bf16_f32 v176, v192, v193
    v_cvt_pk_bf16_f32 v177, v194, v195
    v_cvt_pk_bf16_f32 v178, v196, v197
    v_cvt_pk_bf16_f32 v179, v198, v199
    v_cvt_pk_bf16_f32 v180, v200, v201
    v_cvt_pk_bf16_f32 v181, v202, v203
    v_cvt_pk_bf16_f32 v182, v204, v205
    v_cvt_pk_bf16_f32 v183, v206, v207
    buffer_store_dwordx4 v[176:179], v2, s[68:71], s92 offen sc1
    buffer_store_dwordx4 v[180:183], v2, s[68:71], s92 offen offset:1024 sc1
    s_add_u32 m0, s79, 0
    s_add_u32 s83, s101, 0
    buffer_load_dwordx4 v30, s[40:43], s83 offen lds
    s_add_u32 m0, s79, 1024
    s_add_u32 s83, s101, 8192
    buffer_load_dwordx4 v30, s[40:43], s83 offen lds
    s_add_u32 m0, s79, 2048
    s_add_u32 s83, s101, 16384
    buffer_load_dwordx4 v30, s[40:43], s83 offen lds
    s_add_u32 m0, s79, 3072
    s_add_u32 s83, s101, 24576
    buffer_load_dwordx4 v30, s[40:43], s83 offen lds
    s_add_u32 m0, s79, 4096
    s_add_u32 s83, s101, 32768
    buffer_load_dwordx4 v30, s[40:43], s83 offen lds
    s_add_u32 m0, s79, 5120
    s_add_u32 s83, s101, 40960
    buffer_load_dwordx4 v30, s[40:43], s83 offen lds
    s_add_u32 m0, s79, 6144
    s_add_u32 s83, s101, 49152
    buffer_load_dwordx4 v30, s[40:43], s83 offen lds
    s_add_u32 m0, s79, 7168
    s_add_u32 s83, s101, 57344
    buffer_load_dwordx4 v30, s[40:43], s83 offen lds
    s_xor_b32 s80, s84, 0
    s_lshl_b32 s92, s77, 16
    s_lshl_b32 s81, s80, 15
    s_add_u32 s92, s92, s81
    s_lshl_b32 s81, s3, 13
    s_add_u32 s92, s92, s81
    s_add_u32 s92, s92, 4194304
    s_xor_b32 s80, s84, 1
    s_lshl_b32 s93, s77, 16
    s_lshl_b32 s81, s80, 15
    s_add_u32 s93, s93, s81
    s_lshl_b32 s81, s3, 13
    s_add_u32 s93, s93, s81
    s_add_u32 s93, s93, 4194304
    v_lshlrev_b32 v250, 2, v1
    v_bfe_u32 v251, v1, 4, 1
    v_xor_b32 v251, 1, v251
    v_lshlrev_b32 v251, 6, v251
    v_lshl_add_u32 v251, v4, 4, v251
    v_add_u32 v248, s79, v5
    s_mul_i32 s94, s3, 9216
    s_add_u32 s94, s94, 14745600
    v_and_b32 v7, 63, v1
    v_lshlrev_b32 v7, 7, v7
    s_lshl_b32 s97, s3, 13
    s_add_u32 s97, s97, 16809984
    buffer_load_dword v8, v7, s[68:71], s97 offen sc1
    s_waitcnt vmcnt(0)
    v_cmp_gt_u32 vcc, 1, v8
    s_nop 1
    s_cbranch_vccz L_rdy_103
    s_mov_b32 s96, 0
L_spin_104:
    s_mov_b64 exec, vcc
    buffer_load_dword v8, v7, s[68:71], s97 offen sc1
    s_add_u32 s96, s96, 1
    s_waitcnt vmcnt(0)
    v_cmp_gt_u32 vcc, 1, v8
    s_nop 1
    s_cbranch_vccz L_out_105
    s_cmp_lt_u32 s96, 50000
    s_cbranch_scc1 L_spin_104
L_out_105:
    s_mov_b64 exec, -1
L_rdy_103:
    buffer_load_dword v128, v250, s[68:71], s94 offen offset:0 sc1
    buffer_load_dword v129, v250, s[68:71], s94 offen offset:256 sc1
    buffer_load_dword v130, v250, s[68:71], s94 offen offset:512 sc1
    buffer_load_dword v131, v250, s[68:71], s94 offen offset:768 sc1
    buffer_load_dword v132, v250, s[68:71], s94 offen offset:1024 sc1
    buffer_load_dword v133, v250, s[68:71], s94 offen offset:1280 sc1
    buffer_load_dword v134, v250, s[68:71], s94 offen offset:1536 sc1
    buffer_load_dword v135, v250, s[68:71], s94 offen offset:1792 sc1
    buffer_load_dwordx4 v[160:163], v251, s[68:71], s94 offen offset:2048 sc1
    buffer_load_dwordx4 v[164:167], v251, s[68:71], s94 offen offset:2080 sc1
    s_add_u32 s94, s94, 2304
    buffer_load_dword v136, v250, s[68:71], s94 offen offset:0 sc1
    buffer_load_dword v137, v250, s[68:71], s94 offen offset:256 sc1
    buffer_load_dword v138, v250, s[68:71], s94 offen offset:512 sc1
    buffer_load_dword v139, v250, s[68:71], s94 offen offset:768 sc1
    buffer_load_dword v140, v250, s[68:71], s94 offen offset:1024 sc1
    buffer_load_dword v141, v250, s[68:71], s94 offen offset:1280 sc1
    buffer_load_dword v142, v250, s[68:71], s94 offen offset:1536 sc1
    buffer_load_dword v143, v250, s[68:71], s94 offen offset:1792 sc1
    buffer_load_dwordx4 v[168:171], v251, s[68:71], s94 offen offset:2048 sc1
    buffer_load_dwordx4 v[172:175], v251, s[68:71], s94 offen offset:2080 sc1
    s_add_u32 s94, s94, 2304
    buffer_load_dword v144, v250, s[68:71], s94 offen offset:0 sc1
    buffer_load_dword v145, v250, s[68:71], s94 offen offset:256 sc1
    buffer_load_dword v146, v250, s[68:71], s94 offen offset:512 sc1
    buffer_load_dword v147, v250, s[68:71], s94 offen offset:768 sc1
    buffer_load_dword v148, v250, s[68:71], s94 offen offset:1024 sc1
    buffer_load_dword v149, v250, s[68:71], s94 offen offset:1280 sc1
    buffer_load_dword v150, v250, s[68:71], s94 offen offset:1536 sc1
    buffer_load_dword v151, v250, s[68:71], s94 offen offset:1792 sc1
    buffer_load_dwordx4 v[176:179], v251, s[68:71], s94 offen offset:2048 sc1
    buffer_load_dwordx4 v[180:183], v251, s[68:71], s94 offen offset:2080 sc1
    s_add_u32 s94, s94, 2304
    buffer_load_dword v152, v250, s[68:71], s94 offen offset:0 sc1
    buffer_load_dword v153, v250, s[68:71], s94 offen offset:256 sc1
    buffer_load_dword v154, v250, s[68:71], s94 offen offset:512 sc1
    buffer_load_dword v155, v250, s[68:71], s94 offen offset:768 sc1
    buffer_load_dword v156, v250, s[68:71], s94 offen offset:1024 sc1
    buffer_load_dword v157, v250, s[68:71], s94 offen offset:1280 sc1
    buffer_load_dword v158, v250, s[68:71], s94 offen offset:1536 sc1
    buffer_load_dword v159, v250, s[68:71], s94 offen offset:1792 sc1
    buffer_load_dwordx4 v[184:187], v251, s[68:71], s94 offen offset:2048 sc1
    buffer_load_dwordx4 v[188:191], v251, s[68:71], s94 offen offset:2080 sc1
    buffer_load_dwordx4 v[64:67], v2, s[68:71], s93 offen offset:0 sc1
    buffer_load_dwordx4 v[32:35], v2, s[68:71], s92 offen offset:0 sc1
    buffer_load_dwordx4 v[68:71], v2, s[68:71], s93 offen offset:1024 sc1
    buffer_load_dwordx4 v[36:39], v2, s[68:71], s92 offen offset:1024 sc1
    buffer_load_dwordx4 v[72:75], v2, s[68:71], s93 offen offset:2048 sc1
    buffer_load_dwordx4 v[40:43], v2, s[68:71], s92 offen offset:2048 sc1
    buffer_load_dwordx4 v[76:79], v2, s[68:71], s93 offen offset:3072 sc1
    buffer_load_dwordx4 v[44:47], v2, s[68:71], s92 offen offset:3072 sc1
    s_add_u32 s93, s93, 4096
    buffer_load_dwordx4 v[80:83], v2, s[68:71], s93 offen offset:0 sc1
    s_add_u32 s92, s92, 4096
    buffer_load_dwordx4 v[48:51], v2, s[68:71], s92 offen offset:0 sc1
    buffer_load_dwordx4 v[84:87], v2, s[68:71], s93 offen offset:1024 sc1
    buffer_load_dwordx4 v[52:55], v2, s[68:71], s92 offen offset:1024 sc1
    buffer_load_dwordx4 v[88:91], v2, s[68:71], s93 offen offset:2048 sc1
    buffer_load_dwordx4 v[56:59], v2, s[68:71], s92 offen offset:2048 sc1
    buffer_load_dwordx4 v[92:95], v2, s[68:71], s93 offen offset:3072 sc1
    buffer_load_dwordx4 v[60:63], v2, s[68:71], s92 offen offset:3072 sc1
    s_add_u32 s80, s79, 0
    v_add_u32 v252, s80, v2
    s_xor_b32 s80, s3, 1
    s_mul_i32 s80, s80, 40960
    s_add_u32 s80, s80, 0
    v_add_u32 v253, s80, v2
    s_xor_b32 s80, s3, 2
    s_mul_i32 s80, s80, 40960
    s_add_u32 s80, s80, 4096
    v_add_u32 v254, s80, v2
    s_xor_b32 s80, s3, 3
    s_mul_i32 s80, s80, 40960
    s_add_u32 s80, s80, 8192
    v_add_u32 v0, s80, v2
    s_waitcnt vmcnt(46)
    v_cvt_pk_bf16_f32 v128, v128, v129
    v_cvt_pk_bf16_f32 v160, v160, v161
    v_cvt_pk_bf16_f32 v129, v130, v131
    v_cvt_pk_bf16_f32 v161, v162, v163
    v_cvt_pk_bf16_f32 v130, v132, v133
    v_cvt_pk_bf16_f32 v162, v164, v165
    v_cvt_pk_bf16_f32 v131, v134, v135
    v_cvt_pk_bf16_f32 v163, v166, v167
    v_cndmask_b32 v96, v128, v160, s[88:89]
    v_cndmask_b32 v100, v160, v128, s[88:89]
    v_cndmask_b32 v97, v129, v161, s[88:89]
    v_cndmask_b32 v101, v161, v129, s[88:89]
    v_cndmask_b32 v98, v130, v162, s[88:89]
    v_cndmask_b32 v102, v162, v130, s[88:89]
    v_cndmask_b32 v99, v131, v163, s[88:89]
    v_cndmask_b32 v103, v163, v131, s[88:89]
    s_waitcnt vmcnt(36)
    v_cvt_pk_bf16_f32 v136, v136, v137
    v_cvt_pk_bf16_f32 v168, v168, v169
    v_cvt_pk_bf16_f32 v137, v138, v139
    v_cvt_pk_bf16_f32 v169, v170, v171
    v_cvt_pk_bf16_f32 v138, v140, v141
    v_cvt_pk_bf16_f32 v170, v172, v173
    v_cvt_pk_bf16_f32 v139, v142, v143
    v_cvt_pk_bf16_f32 v171, v174, v175
    v_cndmask_b32 v104, v136, v168, s[88:89]
    v_cndmask_b32 v108, v168, v136, s[88:89]
    v_cndmask_b32 v105, v137, v169, s[88:89]
    v_cndmask_b32 v109, v169, v137, s[88:89]
    v_cndmask_b32 v106, v138, v170, s[88:89]
    v_cndmask_b32 v110, v170, v138, s[88:89]
    v_cndmask_b32 v107, v139, v171, s[88:89]
    v_cndmask_b32 v111, v171, v139, s[88:89]
    s_waitcnt vmcnt(26)
    v_cvt_pk_bf16_f32 v144, v144, v145
    v_cvt_pk_bf16_f32 v176, v176, v177
    v_cvt_pk_bf16_f32 v145, v146, v147
    v_cvt_pk_bf16_f32 v177, v178, v179
    v_cvt_pk_bf16_f32 v146, v148, v149
    v_cvt_pk_bf16_f32 v178, v180, v181
    v_cvt_pk_bf16_f32 v147, v150, v151
    v_cvt_pk_bf16_f32 v179, v182, v183
    v_cndmask_b32 v112, v144, v176, s[88:89]
    v_cndmask_b32 v116, v176, v144, s[88:89]
    v_cndmask_b32 v113, v145, v177, s[88:89]
    v_cndmask_b32 v117, v177, v145, s[88:89]
    v_cndmask_b32 v114, v146, v178, s[88:89]
    v_cndmask_b32 v118, v178, v146, s[88:89]
    v_cndmask_b32 v115, v147, v179, s[88:89]
    v_cndmask_b32 v119, v179, v147, s[88:89]
    s_waitcnt vmcnt(16)
    v_cvt_pk_bf16_f32 v152, v152, v153
    v_cvt_pk_bf16_f32 v184, v184, v185
    v_cvt_pk_bf16_f32 v153, v154, v155
    v_cvt_pk_bf16_f32 v185, v186, v187
    v_cvt_pk_bf16_f32 v154, v156, v157
    v_cvt_pk_bf16_f32 v186, v188, v189
    v_cvt_pk_bf16_f32 v155, v158, v159
    v_cvt_pk_bf16_f32 v187, v190, v191
    v_cndmask_b32 v120, v152, v184, s[88:89]
    v_cndmask_b32 v124, v184, v152, s[88:89]
    v_cndmask_b32 v121, v153, v185, s[88:89]
    v_cndmask_b32 v125, v185, v153, s[88:89]
    v_cndmask_b32 v122, v154, v186, s[88:89]
    v_cndmask_b32 v126, v186, v154, s[88:89]
    v_cndmask_b32 v123, v155, v187, s[88:89]
    v_cndmask_b32 v127, v187, v155, s[88:89]
    ds_read_b64_tr_b16 v[232:233], v248 offset:0
    ds_read_b64_tr_b16 v[234:235], v248 offset:1024
    ds_read_b64_tr_b16 v[236:237], v248 offset:512
    ds_read_b64_tr_b16 v[238:239], v248 offset:1536
    s_waitcnt vmcnt(12)
    v_max3_u32 v9, v32, v64, v36
    v_max_u32 v9, v9, v68
    v_cmp_eq_u32 vcc, -1, v9
    s_nop 1
    s_cbranch_vccnz L_redo_106
L_back_107:
    v_mfma_f32_32x32x16_bf16 v[192:207], v[96:99], v[64:67], 0
    v_mfma_f32_32x32x16_bf16 v[208:223], v[96:99], v[32:35], 0
    s_nop 10
    v_add_f32 v200, 0x358637bd, v200
    v_rcp_f32 v200, v200
    s_nop 0
    v_mul_f32 v192, v192, v200
    v_mul_f32 v193, v193, v200
    v_mul_f32 v194, v194, v200
    v_mul_f32 v195, v195, v200
    v_mul_f32 v196, v196, v200
    v_mul_f32 v197, v197, v200
    v_mul_f32 v198, v198, v200
    v_mul_f32 v199, v199, v200
    v_cvt_pk_bf16_f32 v224, v192, v193
    v_cvt_pk_bf16_f32 v225, v194, v195
    v_cvt_pk_bf16_f32 v226, v196, v197
    v_cvt_pk_bf16_f32 v227, v198, v199
    ds_read_b64_tr_b16 v[240:241], v248 offset:2048
    ds_read_b64_tr_b16 v[242:243], v248 offset:3072
    ds_read_b64_tr_b16 v[244:245], v248 offset:2560
    ds_read_b64_tr_b16 v[246:247], v248 offset:3584
    v_mfma_f32_32x32x16_bf16 v[192:207], v[100:103], v[68:71], 0
    v_add_f32 v216, 0x358637bd, v216
    v_rcp_f32 v216, v216
    s_waitcnt lgkmcnt(4)
    v_mfma_f32_32x32x16_bf16 v[160:175], v[232:235], v[224:227], 0
    v_mul_f32 v208, v208, v216
    v_mul_f32 v209, v209, v216
    v_mul_f32 v210, v210, v216
    v_mul_f32 v211, v211, v216
    v_mul_f32 v212, v212, v216
    v_mul_f32 v213, v213, v216
    v_mfma_f32_32x32x16_bf16 v[176:191], v[236:239], v[224:227], 0
    v_mul_f32 v214, v214, v216
    v_mul_f32 v215, v215, v216
    v_cvt_pk_bf16_f32 v228, v208, v209
    v_cvt_pk_bf16_f32 v229, v210, v211
    v_cvt_pk_bf16_f32 v230, v212, v213
    v_cvt_pk_bf16_f32 v231, v214, v215
    s_add_u32 m0, s79, 8192
    s_add_u32 s83, s101, 65536
    buffer_load_dwordx4 v30, s[40:43], s83 offen lds
    s_add_u32 m0, s79, 9216
    s_add_u32 s83, s101, 73728
    buffer_load_dwordx4 v30, s[40:43], s83 offen lds
    v_mfma_f32_32x32x16_bf16 v[208:223], v[100:103], v[36:39], 0
    v_add_f32 v192, 0x358637bd, v192
    v_rcp_f32 v192, v192
    v_mfma_f32_32x32x16_bf16 v[128:143], v[232:235], v[228:231], 0
    v_mul_f32 v200, v200, v192
    v_mul_f32 v201, v201, v192
    v_mul_f32 v202, v202, v192
    v_mul_f32 v203, v203, v192
    v_mul_f32 v204, v204, v192
    v_mul_f32 v205, v205, v192
    v_mfma_f32_32x32x16_bf16 v[144:159], v[236:239], v[228:231], 0
    v_mul_f32 v206, v206, v192
    v_mul_f32 v207, v207, v192
    v_cvt_pk_bf16_f32 v224, v200, v201
    v_cvt_pk_bf16_f32 v225, v202, v203
    v_cvt_pk_bf16_f32 v226, v204, v205
    v_cvt_pk_bf16_f32 v227, v206, v207
    ds_read_b64_tr_b16 v[232:233], v248 offset:4096
    ds_read_b64_tr_b16 v[234:235], v248 offset:5120
    ds_read_b64_tr_b16 v[236:237], v248 offset:4608
    ds_read_b64_tr_b16 v[238:239], v248 offset:5632
    s_add_u32 m0, s79, 10240
    s_add_u32 s83, s101, 81920
    buffer_load_dwordx4 v30, s[40:43], s83 offen lds
    s_add_u32 m0, s79, 11264
    s_add_u32 s83, s101, 90112
    buffer_load_dwordx4 v30, s[40:43], s83 offen lds
    s_waitcnt vmcnt(12)
    v_max3_u32 v9, v40, v72, v44
    v_max_u32 v9, v9, v76
    v_cmp_eq_u32 vcc, -1, v9
    s_nop 1
    s_cbranch_vccnz L_redo_108
L_back_109:
    v_mfma_f32_32x32x16_bf16 v[192:207], v[104:107], v[72:75], 0
    v_add_f32 v208, 0x358637bd, v208
    v_rcp_f32 v208, v208
    s_waitcnt lgkmcnt(4)
    v_mfma_f32_32x32x16_bf16 v[160:175], v[240:243], v[224:227], v[160:175]
    v_mul_f32 v216, v216, v208
    v_mul_f32 v217, v217, v208
    v_mul_f32 v218, v218, v208
    v_mul_f32 v219, v219, v208
    v_mul_f32 v220, v220, v208
    v_mul_f32 v221, v221, v208
    v_mfma_f32_32x32x16_bf16 v[176:191], v[244:247], v[224:227], v[176:191]
    v_mul_f32 v222, v222, v208
    v_mul_f32 v223, v223, v208
    v_cvt_pk_bf16_f32 v228, v216, v217
    v_cvt_pk_bf16_f32 v229, v218, v219
    v_cvt_pk_bf16_f32 v230, v220, v221
    v_cvt_pk_bf16_f32 v231, v222, v223
    s_add_u32 m0, s79, 12288
    s_add_u32 s83, s101, 98304
    buffer_load_dwordx4 v30, s[40:43], s83 offen lds
    s_add_u32 m0, s79, 13312
    s_add_u32 s83, s101, 106496
    buffer_load_dwordx4 v30, s[40:43], s83 offen lds
    v_mfma_f32_32x32x16_bf16 v[208:223], v[104:107], v[40:43], 0
    v_add_f32 v200, 0x358637bd, v200
    v_rcp_f32 v200, v200
    v_mfma_f32_32x32x16_bf16 v[128:143], v[240:243], v[228:231], v[128:143]
    v_mul_f32 v192, v192, v200
    v_mul_f32 v193, v193, v200
    v_mul_f32 v194, v194, v200
    v_mul_f32 v195, v195, v200
    v_mul_f32 v196, v196, v200
    v_mul_f32 v197, v197, v200
    v_mfma_f32_32x32x16_bf16 v[144:159], v[244:247], v[228:231], v[144:159]
    v_mul_f32 v198, v198, v200
    v_mul_f32 v199, v199, v200
    v_cvt_pk_bf16_f32 v224, v192, v193
    v_cvt_pk_bf16_f32 v225, v194, v195
    v_cvt_pk_bf16_f32 v226, v196, v197
    v_cvt_pk_bf16_f32 v227, v198, v199
    ds_read_b64_tr_b16 v[240:241], v248 offset:6144
    ds_read_b64_tr_b16 v[242:243], v248 offset:7168
    ds_read_b64_tr_b16 v[244:245], v248 offset:6656
    ds_read_b64_tr_b16 v[246:247], v248 offset:7680
    s_add_u32 m0, s79, 14336
    s_add_u32 s83, s101, 114688
    buffer_load_dwordx4 v30, s[40:43], s83 offen lds
    s_add_u32 m0, s79, 15360
    s_add_u32 s83, s101, 122880
    buffer_load_dwordx4 v30, s[40:43], s83 offen lds
    v_mfma_f32_32x32x16_bf16 v[192:207], v[108:111], v[76:79], 0
    v_add_f32 v216, 0x358637bd, v216
    v_rcp_f32 v216, v216
    s_waitcnt lgkmcnt(4)
    v_mfma_f32_32x32x16_bf16 v[160:175], v[232:235], v[224:227], v[160:175]
    v_mul_f32 v208, v208, v216
    v_mul_f32 v209, v209, v216
    v_mul_f32 v210, v210, v216
    v_mul_f32 v211, v211, v216
    v_mul_f32 v212, v212, v216
    v_mul_f32 v213, v213, v216
    v_mfma_f32_32x32x16_bf16 v[176:191], v[236:239], v[224:227], v[176:191]
    v_mul_f32 v214, v214, v216
    v_mul_f32 v215, v215, v216
    v_cvt_pk_bf16_f32 v228, v208, v209
    v_cvt_pk_bf16_f32 v229, v210, v211
    v_cvt_pk_bf16_f32 v230, v212, v213
    v_cvt_pk_bf16_f32 v231, v214, v215
    s_add_u32 m0, s79, 16384
    s_add_u32 s83, s99, 1179648
    buffer_load_dwordx4 v29, s[52:55], s83 offen lds
    v_mfma_f32_32x32x16_bf16 v[208:223], v[108:111], v[44:47], 0
    v_add_f32 v192, 0x358637bd, v192
    v_rcp_f32 v192, v192
    v_mfma_f32_32x32x16_bf16 v[128:143], v[232:235], v[228:231], v[128:143]
    v_mul_f32 v200, v200, v192
    v_mul_f32 v201, v201, v192
    v_mul_f32 v202, v202, v192
    v_mul_f32 v203, v203, v192
    v_mul_f32 v204, v204, v192
    v_mul_f32 v205, v205, v192
    v_mfma_f32_32x32x16_bf16 v[144:159], v[236:239], v[228:231], v[144:159]
    v_mul_f32 v206, v206, v192
    v_mul_f32 v207, v207, v192
    v_cvt_pk_bf16_f32 v224, v200, v201
    v_cvt_pk_bf16_f32 v225, v202, v203
    v_cvt_pk_bf16_f32 v226, v204, v205
    v_cvt_pk_bf16_f32 v227, v206, v207
    s_waitcnt vmcnt(7)
    ds_read_b64_tr_b16 v[32:33], v248 offset:8192
    ds_read_b64_tr_b16 v[34:35], v248 offset:9216
    ds_read_b64_tr_b16 v[64:65], v248 offset:8704
    ds_read_b64_tr_b16 v[66:67], v248 offset:9728
    s_add_u32 m0, s79, 17408
    s_add_u32 s83, s99, 1212416
    buffer_load_dwordx4 v29, s[52:55], s83 offen lds
    v_max3_u32 v9, v48, v80, v52
    v_max_u32 v9, v9, v84
    v_cmp_eq_u32 vcc, -1, v9
    s_nop 1
    s_cbranch_vccnz L_redo_110
L_back_111:
    v_mfma_f32_32x32x16_bf16 v[192:207], v[112:115], v[80:83], 0
    v_add_f32 v208, 0x358637bd, v208
    v_rcp_f32 v208, v208
    s_waitcnt lgkmcnt(4)
    v_mfma_f32_32x32x16_bf16 v[160:175], v[240:243], v[224:227], v[160:175]
    v_mul_f32 v216, v216, v208
    v_mul_f32 v217, v217, v208
    v_mul_f32 v218, v218, v208
    v_mul_f32 v219, v219, v208
    v_mul_f32 v220, v220, v208
    v_mul_f32 v221, v221, v208
    v_mfma_f32_32x32x16_bf16 v[176:191], v[244:247], v[224:227], v[176:191]
    v_mul_f32 v222, v222, v208
    v_mul_f32 v223, v223, v208
    v_cvt_pk_bf16_f32 v228, v216, v217
    v_cvt_pk_bf16_f32 v229, v218, v219
    v_cvt_pk_bf16_f32 v230, v220, v221
    v_cvt_pk_bf16_f32 v231, v222, v223
    s_waitcnt vmcnt(6)
    ds_read_b64_tr_b16 v[36:37], v248 offset:10240
    ds_read_b64_tr_b16 v[38:39], v248 offset:11264
    ds_read_b64_tr_b16 v[68:69], v248 offset:10752
    ds_read_b64_tr_b16 v[70:71], v248 offset:11776
    s_add_u32 m0, s79, 18432
    s_add_u32 s83, s99, 1245184
    buffer_load_dwordx4 v29, s[52:55], s83 offen lds
    v_mfma_f32_32x32x16_bf16 v[208:223], v[116:119], v[84:87], 0
    v_add_f32 v200, 0x358637bd, v200
    v_rcp_f32 v200, v200
    v_mfma_f32_32x32x16_bf16 v[128:143], v[240:243], v[228:231], v[128:143]
    v_mul_f32 v192, v192, v200
    v_mul_f32 v193, v193, v200
    v_mul_f32 v194, v194, v200
    v_mul_f32 v195, v195, v200
    v_mul_f32 v196, v196, v200
    v_mul_f32 v197, v197, v200
    v_mfma_f32_32x32x16_bf16 v[144:159], v[244:247], v[228:231], v[144:159]
    v_mul_f32 v198, v198, v200
    v_mul_f32 v199, v199, v200
    v_cvt_pk_bf16_f32 v224, v192, v193
    v_cvt_pk_bf16_f32 v225, v194, v195
    v_cvt_pk_bf16_f32 v226, v196, v197
    v_cvt_pk_bf16_f32 v227, v198, v199
    s_waitcnt vmcnt(5)
    ds_read_b64_tr_b16 v[40:41], v248 offset:12288
    ds_read_b64_tr_b16 v[42:43], v248 offset:13312
    ds_read_b64_tr_b16 v[72:73], v248 offset:12800
    ds_read_b64_tr_b16 v[74:75], v248 offset:13824
    s_add_u32 m0, s79, 19456
    s_add_u32 s83, s99, 1277952
    buffer_load_dwordx4 v29, s[52:55], s83 offen lds
    v_max3_u32 v9, v56, v88, v60
    v_max_u32 v9, v9, v92
    v_cmp_eq_u32 vcc, -1, v9
    s_nop 1
    s_cbranch_vccnz L_redo_112
L_back_113:
    v_mfma_f32_32x32x16_bf16 v[192:207], v[120:123], v[88:91], 0
    v_add_f32 v208, 0x358637bd, v208
    v_rcp_f32 v208, v208
    s_waitcnt lgkmcnt(8)
    v_mfma_f32_32x32x16_bf16 v[160:175], v[32:35], v[224:227], v[160:175]
    v_mul_f32 v216, v216, v208
    v_mul_f32 v217, v217, v208
    v_mul_f32 v218, v218, v208
    v_mul_f32 v219, v219, v208
    v_mul_f32 v220, v220, v208
    v_mul_f32 v221, v221, v208
    v_mfma_f32_32x32x16_bf16 v[176:191], v[64:67], v[224:227], v[176:191]
    v_mul_f32 v222, v222, v208
    v_mul_f32 v223, v223, v208
    v_cvt_pk_bf16_f32 v228, v216, v217
    v_cvt_pk_bf16_f32 v229, v218, v219
    v_cvt_pk_bf16_f32 v230, v220, v221
    v_cvt_pk_bf16_f32 v231, v222, v223
    s_waitcnt vmcnt(4)
    ds_read_b64_tr_b16 v[44:45], v248 offset:14336
    ds_read_b64_tr_b16 v[46:47], v248 offset:15360
    ds_read_b64_tr_b16 v[76:77], v248 offset:14848
    ds_read_b64_tr_b16 v[78:79], v248 offset:15872
    v_mfma_f32_32x32x16_bf16 v[208:223], v[124:127], v[92:95], 0
    v_add_f32 v200, 0x358637bd, v200
    v_rcp_f32 v200, v200
    s_waitcnt lgkmcnt(8)
    v_mfma_f32_32x32x16_bf16 v[160:175], v[36:39], v[228:231], v[160:175]
    v_mul_f32 v192, v192, v200
    v_mul_f32 v193, v193, v200
    v_mul_f32 v194, v194, v200
    v_mul_f32 v195, v195, v200
    v_mul_f32 v196, v196, v200
    v_mul_f32 v197, v197, v200
    v_mfma_f32_32x32x16_bf16 v[176:191], v[68:71], v[228:231], v[176:191]
    v_mul_f32 v198, v198, v200
    v_mul_f32 v199, v199, v200
    v_cvt_pk_bf16_f32 v224, v192, v193
    v_cvt_pk_bf16_f32 v225, v194, v195
    v_cvt_pk_bf16_f32 v226, v196, v197
    v_cvt_pk_bf16_f32 v227, v198, v199
    v_mfma_f32_32x32x16_bf16 v[192:207], v[112:115], v[48:51], 0
    v_add_f32 v208, 0x358637bd, v208
    v_rcp_f32 v208, v208
    s_waitcnt lgkmcnt(4)
    v_mfma_f32_32x32x16_bf16 v[160:175], v[40:43], v[224:227], v[160:175]
    v_mul_f32 v216, v216, v208
    v_mul_f32 v217, v217, v208
    v_mul_f32 v218, v218, v208
    v_mul_f32 v219, v219, v208
    v_mul_f32 v220, v220, v208
    v_mul_f32 v221, v221, v208
    v_mfma_f32_32x32x16_bf16 v[176:191], v[72:75], v[224:227], v[176:191]
    v_mul_f32 v222, v222, v208
    v_mul_f32 v223, v223, v208
    v_cvt_pk_bf16_f32 v228, v216, v217
    v_cvt_pk_bf16_f32 v229, v218, v219
    v_cvt_pk_bf16_f32 v230, v220, v221
    v_cvt_pk_bf16_f32 v231, v222, v223
    v_mfma_f32_32x32x16_bf16 v[208:223], v[116:119], v[52:55], 0
    v_add_f32 v200, 0x358637bd, v200
    v_rcp_f32 v200, v200
    s_waitcnt lgkmcnt(0)
    v_mfma_f32_32x32x16_bf16 v[160:175], v[44:47], v[228:231], v[160:175]
    v_mul_f32 v192, v192, v200
    v_mul_f32 v193, v193, v200
    v_mul_f32 v194, v194, v200
    v_mul_f32 v195, v195, v200
    v_mul_f32 v196, v196, v200
    v_mul_f32 v197, v197, v200
    v_mfma_f32_32x32x16_bf16 v[176:191], v[76:79], v[228:231], v[176:191]
    v_mul_f32 v198, v198, v200
    v_mul_f32 v199, v199, v200
    v_cvt_pk_bf16_f32 v224, v192, v193
    v_cvt_pk_bf16_f32 v225, v194, v195
    v_cvt_pk_bf16_f32 v226, v196, v197
    v_cvt_pk_bf16_f32 v227, v198, v199
    v_mfma_f32_32x32x16_bf16 v[192:207], v[120:123], v[56:59], 0
    v_add_f32 v208, 0x358637bd, v208
    v_rcp_f32 v208, v208
    v_mfma_f32_32x32x16_bf16 v[128:143], v[32:35], v[224:227], v[128:143]
    v_mul_f32 v216, v216, v208
    v_mul_f32 v217, v217, v208
    v_mul_f32 v218, v218, v208
    v_mul_f32 v219, v219, v208
    v_mul_f32 v220, v220, v208
    v_mul_f32 v221, v221, v208
    v_mfma_f32_32x32x16_bf16 v[144:159], v[64:67], v[224:227], v[144:159]
    v_mul_f32 v222, v222, v208
    ds_write_b128 v252, v[160:163] offset:0
    v_mul_f32 v223, v223, v208
    v_cvt_pk_bf16_f32 v228, v216, v217
    ds_write_b128 v252, v[164:167] offset:1024
    v_cvt_pk_bf16_f32 v229, v218, v219
    v_cvt_pk_bf16_f32 v230, v220, v221
    ds_write_b128 v252, v[176:179] offset:2048
    v_cvt_pk_bf16_f32 v231, v222, v223
    v_mfma_f32_32x32x16_bf16 v[208:223], v[124:127], v[60:63], 0
    v_add_f32 v200, 0x358637bd, v200
    v_rcp_f32 v200, v200
    v_mfma_f32_32x32x16_bf16 v[128:143], v[36:39], v[228:231], v[128:143]
    v_mul_f32 v192, v192, v200
    v_mul_f32 v193, v193, v200
    v_mul_f32 v194, v194, v200
    v_mul_f32 v195, v195, v200
    v_mul_f32 v196, v196, v200
    v_mul_f32 v197, v197, v200
    v_mfma_f32_32x32x16_bf16 v[144:159], v[68:71], v[228:231], v[144:159]
    v_mul_f32 v198, v198, v200
    ds_write_b128 v252, v[180:183] offset:3072
    v_mul_f32 v199, v199, v200
    v_cvt_pk_bf16_f32 v224, v192, v193
    ds_write_b128 v252, v[168:171] offset:8192
    v_cvt_pk_bf16_f32 v225, v194, v195
    v_cvt_pk_bf16_f32 v226, v196, v197
    ds_write_b128 v252, v[172:175] offset:9216
    v_cvt_pk_bf16_f32 v227, v198, v199
    v_add_f32 v208, 0x358637bd, v208
    v_rcp_f32 v208, v208
    v_mfma_f32_32x32x16_bf16 v[128:143], v[40:43], v[224:227], v[128:143]
    v_mul_f32 v216, v216, v208
    v_mul_f32 v217, v217, v208
    v_mul_f32 v218, v218, v208
    v_mul_f32 v219, v219, v208
    v_mul_f32 v220, v220, v208
    v_mul_f32 v221, v221, v208
    v_mfma_f32_32x32x16_bf16 v[144:159], v[72:75], v[224:227], v[144:159]
    v_mul_f32 v222, v222, v208
    ds_write_b128 v252, v[184:187] offset:10240
    v_mul_f32 v223, v223, v208
    v_cvt_pk_bf16_f32 v228, v216, v217
    ds_write_b128 v252, v[188:191] offset:11264
    v_cvt_pk_bf16_f32 v229, v218, v219
    v_cvt_pk_bf16_f32 v230, v220, v221
    v_cvt_pk_bf16_f32 v231, v222, v223
    s_nop 1
    v_mfma_f32_32x32x16_bf16 v[128:143], v[44:47], v[228:231], v[128:143]
    v_mfma_f32_32x32x16_bf16 v[144:159], v[76:79], v[228:231], v[144:159]
    v_lshlrev_b32 v32, 16, v20
    v_and_b32 v33, 0xffff0000, v20
    v_lshlrev_b32 v34, 16, v21
    v_and_b32 v35, 0xffff0000, v21
    v_lshlrev_b32 v36, 16, v22
    v_and_b32 v37, 0xffff0000, v22
    v_lshlrev_b32 v38, 16, v23
    v_and_b32 v39, 0xffff0000, v23
    v_lshlrev_b32 v40, 16, v24
    v_and_b32 v41, 0xffff0000, v24
    v_lshlrev_b32 v42, 16, v25
    v_and_b32 v43, 0xffff0000, v25
    v_lshlrev_b32 v44, 16, v26
    v_and_b32 v45, 0xffff0000, v26
    v_lshlrev_b32 v46, 16, v27
    v_and_b32 v47, 0xffff0000, v27
    ds_write_b128 v252, v[136:139] offset:4096
    v_and_b32 v250, 31, v1
    v_lshlrev_b32 v251, 3, v250
    s_lshl_b32 s92, s77, 13
    s_lshl_b32 s81, s84, 12
    s_add_u32 s92, s92, s81
    s_add_u32 s92, s92, 15990784
    s_lshl_b32 s93, s76, 9
    s_lshl_b32 s81, s85, 8
    s_add_u32 s93, s93, s81
    s_add_u32 s93, s93, s92
    v_mov_b32 v243, 0x3f803f80
    ds_write_b128 v252, v[140:143] offset:5120
    v_mov_b32 v244, 0
    v_mov_b32 v245, 0
    v_mov_b32 v246, 0
    v_mov_b32 v247, 0
    v_pk_add_f32 v[32:33], v[32:33], v[128:129]
    ds_write_b128 v252, v[152:155] offset:6144
    v_pk_add_f32 v[34:35], v[34:35], v[130:131]
    v_pk_add_f32 v[36:37], v[36:37], v[132:133]
    v_pk_add_f32 v[38:39], v[38:39], v[134:135]
    v_pk_add_f32 v[40:41], v[40:41], v[144:145]
    v_pk_add_f32 v[42:43], v[42:43], v[146:147]
    ds_write_b128 v252, v[156:159] offset:7168
    v_pk_add_f32 v[44:45], v[44:45], v[148:149]
    v_pk_add_f32 v[46:47], v[46:47], v[150:151]
    s_waitcnt lgkmcnt(0)
    s_barrier
    ds_read_b128 v[192:195], v253 offset:0
    ds_read_b128 v[196:199], v253 offset:1024
    ds_read_b128 v[200:203], v253 offset:2048
    ds_read_b128 v[204:207], v253 offset:3072
    ds_read_b128 v[208:211], v254 offset:0
    ds_read_b128 v[212:215], v254 offset:1024
    ds_read_b128 v[216:219], v254 offset:2048
    ds_read_b128 v[220:223], v254 offset:3072
    ds_read_b128 v[224:227], v0 offset:0
    ds_read_b128 v[228:231], v0 offset:1024
    ds_read_b128 v[232:235], v0 offset:2048
    ds_read_b128 v[236:239], v0 offset:3072
    s_add_u32 m0, s79, 20480
    s_add_u32 s83, s99, 1310720
    buffer_load_dwordx4 v29, s[52:55], s83 offen lds
    s_add_u32 m0, s79, 21504
    s_add_u32 s83, s99, 1343488
    buffer_load_dwordx4 v29, s[52:55], s83 offen lds
    s_add_u32 m0, s79, 22528
    s_add_u32 s83, s99, 1376256
    buffer_load_dwordx4 v29, s[52:55], s83 offen lds
    s_add_u32 m0, s79, 23552
    s_add_u32 s83, s99, 1409024
    buffer_load_dwordx4 v29, s[52:55], s83 offen lds
    s_add_u32 m0, s79, 32768
    s_add_u32 s83, s99, 1441792
    buffer_load_dwordx4 v29, s[52:55], s83 offen lds
    s_add_u32 m0, s79, 33792
    s_add_u32 s83, s99, 1474560
    buffer_load_dwordx4 v29, s[52:55], s83 offen lds
    s_add_u32 m0, s79, 34816
    s_add_u32 s83, s99, 1507328
    buffer_load_dwordx4 v29, s[52:55], s83 offen lds
    s_add_u32 m0, s79, 35840
    s_add_u32 s83, s99, 1540096
    buffer_load_dwordx4 v29, s[52:55], s83 offen lds
    s_waitcnt lgkmcnt(8)
    v_pk_add_f32 v[192:193], v[192:193], v[32:33]
    v_pk_add_f32 v[194:195], v[194:195], v[34:35]
    v_pk_add_f32 v[196:197], v[196:197], v[36:37]
    v_pk_add_f32 v[198:199], v[198:199], v[38:39]
    v_pk_add_f32 v[200:201], v[200:201], v[40:41]
    v_pk_add_f32 v[202:203], v[202:203], v[42:43]
    v_pk_add_f32 v[204:205], v[204:205], v[44:45]
    v_pk_add_f32 v[206:207], v[206:207], v[46:47]
    s_waitcnt lgkmcnt(4)
    v_pk_add_f32 v[192:193], v[192:193], v[208:209]
    v_pk_add_f32 v[194:195], v[194:195], v[210:211]
    v_pk_add_f32 v[196:197], v[196:197], v[212:213]
    v_pk_add_f32 v[198:199], v[198:199], v[214:215]
    v_pk_add_f32 v[200:201], v[200:201], v[216:217]
    v_pk_add_f32 v[202:203], v[202:203], v[218:219]
    v_pk_add_f32 v[204:205], v[204:205], v[220:221]
    v_pk_add_f32 v[206:207], v[206:207], v[222:223]
    s_waitcnt lgkmcnt(0)
    v_pk_add_f32 v[192:193], v[192:193], v[224:225]
    v_pk_add_f32 v[194:195], v[194:195], v[226:227]
    v_pk_add_f32 v[196:197], v[196:197], v[228:229]
    v_pk_add_f32 v[198:199], v[198:199], v[230:231]
    v_pk_add_f32 v[200:201], v[200:201], v[232:233]
    v_pk_add_f32 v[202:203], v[202:203], v[234:235]
    v_pk_add_f32 v[204:205], v[204:205], v[236:237]
    v_pk_add_f32 v[206:207], v[206:207], v[238:239]
    v_cvt_pk_bf16_f32 v20, v192, v193
    v_cvt_pk_bf16_f32 v21, v194, v195
    v_cvt_pk_bf16_f32 v22, v196, v197
    v_cvt_pk_bf16_f32 v23, v198, v199
    v_cvt_pk_bf16_f32 v24, v200, v201
    v_cvt_pk_bf16_f32 v25, v202, v203
    v_cvt_pk_bf16_f32 v26, v204, v205
    v_cvt_pk_bf16_f32 v27, v206, v207
    v_dot2c_f32_bf16 v244, v20, v243
    v_dot2c_f32_bf16 v245, v20, v20
    v_dot2c_f32_bf16 v246, v21, v243
    v_dot2c_f32_bf16 v247, v21, v21
    v_dot2c_f32_bf16 v244, v22, v243
    v_dot2c_f32_bf16 v245, v22, v22
    v_dot2c_f32_bf16 v246, v23, v243
    v_dot2c_f32_bf16 v247, v23, v23
    v_dot2c_f32_bf16 v244, v24, v243
    v_dot2c_f32_bf16 v245, v24, v24
    v_dot2c_f32_bf16 v246, v25, v243
    v_dot2c_f32_bf16 v247, v25, v25
    v_dot2c_f32_bf16 v244, v26, v243
    v_dot2c_f32_bf16 v245, v26, v26
    v_dot2c_f32_bf16 v246, v27, v243
    v_dot2c_f32_bf16 v247, v27, v27
    s_nop 2
    v_pk_add_f32 v[208:209], v[244:245], v[246:247]
    v_mov_b32 v210, v208
    v_mov_b32 v211, v209
    s_nop 0
    v_permlane32_swap_b32 v208, v210
    v_permlane32_swap_b32 v209, v211
    v_pk_add_f32 v[208:209], v[208:209], v[210:211]
    v_and_b32 v209, 0x7fffffff, v209
    s_mov_b64 exec, s[86:87]
    s_cmp_eq_u32 s30, 1
    s_cselect_b32 s82, s93, 1073741824
    s_cselect_b32 s83, 1073741824, s93
    buffer_store_dwordx2 v[208:209], v251, s[68:71], s82 offen
    buffer_store_dwordx2 v[208:209], v251, s[68:71], s83 offen sc1
    s_mov_b64 exec, -1
    v_lshlrev_b32 v192, 16, v20
    v_and_b32 v193, 0xffff0000, v20
    v_lshlrev_b32 v194, 16, v21
    v_and_b32 v195, 0xffff0000, v21
    v_lshlrev_b32 v196, 16, v22
    v_and_b32 v197, 0xffff0000, v22
    v_lshlrev_b32 v198, 16, v23
    v_and_b32 v199, 0xffff0000, v23
    v_lshlrev_b32 v200, 16, v24
    v_and_b32 v201, 0xffff0000, v24
    v_lshlrev_b32 v202, 16, v25
    v_and_b32 v203, 0xffff0000, v25
    v_lshlrev_b32 v204, 16, v26
    v_and_b32 v205, 0xffff0000, v26
    v_lshlrev_b32 v206, 16, v27
    v_and_b32 v207, 0xffff0000, v27
    v_lshl_add_u32 v249, v4, 11, v251
    v_bfe_u32 v240, v1, 1, 3
    v_xor_b32 v240, v240, v4
    s_lshl_b32 s80, s85, 2
    v_xor_b32 v240, s80, v240
    v_lshlrev_b32 v240, 3, v240
    v_lshl_add_u32 v240, v250, 6, v240
    s_mul_i32 s80, s84, 40960
    s_add_u32 s80, s80, 12288
    v_add_u32 v240, s80, v240
    v_xor_b32 v241, 16, v240
    v_add_u32 v245, 81920, v240
    v_add_u32 v246, 81920, v241
    v_bfe_u32 v242, v1, 3, 1
    v_lshl_add_u32 v242, v4, 1, v242
    v_lshlrev_b32 v242, 3, v242
    v_xor_b32 v242, v242, v3
    s_add_u32 s80, s79, 12288
    v_add_u32 v242, s80, v242
    v_xor_b32 v248, 32, v242
    s_lshl_b32 s94, s76, 18
    s_lshl_b32 s81, s85, 17
    s_add_u32 s94, s94, s81
    s_lshl_b32 s81, s77, 12
    s_add_u32 s94, s94, s81
    s_lshl_b32 s81, s84, 11
    s_add_u32 s94, s94, s81
    s_add_u32 s94, s94, 8388608
    v_mov_b32 v244, 0x3b000054
    s_lshl_b32 s80, s84, 9
    s_add_u32 s80, s80, s79
    v_add_u32 v7, s80, v3
    s_xor_b32 s80, s80, 512
    v_add_u32 v8, s80, v3
    ds_read_b64_tr_b16 v[32:33], v7 offset:36864
    ds_read_b64_tr_b16 v[34:35], v7 offset:37888
    ds_read_b64_tr_b16 v[36:37], v8 offset:36864
    ds_read_b64_tr_b16 v[38:39], v8 offset:37888
    s_waitcnt vmcnt(12)
    ds_read_b64_tr_b16 v[40:41], v7 offset:16384
    ds_read_b64_tr_b16 v[42:43], v7 offset:17408
    ds_read_b64_tr_b16 v[44:45], v8 offset:16384
    ds_read_b64_tr_b16 v[46:47], v8 offset:17408
    s_waitcnt vmcnt(10)
    ds_read_b64_tr_b16 v[48:49], v7 offset:18432
    ds_read_b64_tr_b16 v[50:51], v7 offset:19456
    ds_read_b64_tr_b16 v[52:53], v8 offset:18432
    ds_read_b64_tr_b16 v[54:55], v8 offset:19456
    s_waitcnt lgkmcnt(0)
    s_mov_b32 s96, 0
L_xp_114:
    buffer_load_dwordx2 v[212:213], v249, s[68:71], s92 offen offset:0 sc1
    buffer_load_dwordx2 v[214:215], v249, s[68:71], s92 offen offset:256 sc1
    buffer_load_dwordx2 v[216:217], v249, s[68:71], s92 offen offset:512 sc1
    buffer_load_dwordx2 v[218:219], v249, s[68:71], s92 offen offset:768 sc1
    buffer_load_dwordx2 v[220:221], v249, s[68:71], s92 offen offset:1024 sc1
    buffer_load_dwordx2 v[222:223], v249, s[68:71], s92 offen offset:1280 sc1
    buffer_load_dwordx2 v[224:225], v249, s[68:71], s92 offen offset:1536 sc1
    buffer_load_dwordx2 v[226:227], v249, s[68:71], s92 offen offset:1792 sc1
    s_waitcnt vmcnt(0)
    v_max_u32 v7, v213, v215
    v_max3_u32 v7, v7, v217, v219
    v_max3_u32 v7, v7, v221, v223
    v_max3_u32 v7, v7, v225, v227
    v_cmp_eq_u32 vcc, -1, v7
    s_add_u32 s96, s96, 1
    s_nop 0
    s_cbranch_vccz L_xd_115
    s_cmp_lt_u32 s96, 50000
    s_cbranch_scc1 L_xp_114
L_xd_115:
    v_pk_add_f32 v[212:213], v[212:213], v[220:221]
    v_pk_add_f32 v[214:215], v[214:215], v[222:223]
    v_pk_add_f32 v[216:217], v[216:217], v[224:225]
    v_pk_add_f32 v[218:219], v[218:219], v[226:227]
    v_pk_add_f32 v[212:213], v[212:213], v[216:217]
    v_pk_add_f32 v[214:215], v[214:215], v[218:219]
    v_pk_add_f32 v[212:213], v[212:213], v[214:215]
    v_mov_b32 v214, v212
    v_mov_b32 v215, v213
    s_nop 0
    v_permlane32_swap_b32 v212, v214
    v_permlane32_swap_b32 v213, v215
    v_pk_add_f32 v[212:213], v[212:213], v[214:215]
    v_mul_f32 v212, 0xbb000000, v212
    v_mul_f32 v213, v244, v213
    v_mul_f32 v214, 0x3f800054, v212
    v_fma_f32 v213, -v212, v214, v213
    v_max_f32 v213, 0, v213
    v_add_f32 v213, 0x2edbe6ff, v213
    v_rsq_f32 v213, v213
    s_nop 0
    v_mul_f32 v212, v212, v213
    v_pk_fma_f32 v[192:193], v[192:193], v[212:213], v[212:213] op_sel:[0,1,0] op_sel_hi:[1,1,0]
    v_pk_fma_f32 v[194:195], v[194:195], v[212:213], v[212:213] op_sel:[0,1,0] op_sel_hi:[1,1,0]
    v_pk_fma_f32 v[196:197], v[196:197], v[212:213], v[212:213] op_sel:[0,1,0] op_sel_hi:[1,1,0]
    v_pk_fma_f32 v[198:199], v[198:199], v[212:213], v[212:213] op_sel:[0,1,0] op_sel_hi:[1,1,0]
    v_pk_fma_f32 v[200:201], v[200:201], v[212:213], v[212:213] op_sel:[0,1,0] op_sel_hi:[1,1,0]
    v_pk_fma_f32 v[202:203], v[202:203], v[212:213], v[212:213] op_sel:[0,1,0] op_sel_hi:[1,1,0]
    v_pk_fma_f32 v[204:205], v[204:205], v[212:213], v[212:213] op_sel:[0,1,0] op_sel_hi:[1,1,0]
    v_pk_fma_f32 v[206:207], v[206:207], v[212:213], v[212:213] op_sel:[0,1,0] op_sel_hi:[1,1,0]
    v_cvt_pk_bf16_f32 v192, v192, v193
    v_cvt_pk_bf16_f32 v193, v194, v195
    v_cvt_pk_bf16_f32 v194, v196, v197
    v_cvt_pk_bf16_f32 v195, v198, v199
    ds_write_b64 v240, v[192:193]
    ds_write_b64 v241, v[194:195]
    v_cvt_pk_bf16_f32 v196, v200, v201
    v_cvt_pk_bf16_f32 v197, v202, v203
    v_cvt_pk_bf16_f32 v198, v204, v205
    v_cvt_pk_bf16_f32 v199, v206, v207
    ds_write_b64 v245, v[196:197]
    ds_write_b64 v246, v[198:199]
    s_add_u32 m0, s79, 18432
    s_add_u32 s83, s99, 1638400
    buffer_load_dwordx4 v29, s[52:55], s83 offen lds
    s_add_u32 m0, s79, 19456
    s_add_u32 s83, s99, 1671168
    buffer_load_dwordx4 v29, s[52:55], s83 offen lds
    s_add_u32 m0, s79, 36864
    s_add_u32 s83, s99, 1703936
    buffer_load_dwordx4 v29, s[52:55], s83 offen lds
    s_add_u32 m0, s79, 37888
    s_add_u32 s83, s99, 1736704
    buffer_load_dwordx4 v29, s[52:55], s83 offen lds
    s_waitcnt lgkmcnt(0)
    s_barrier
    ds_read_b64_tr_b16 v[208:209], v242 offset:0
    ds_read_b64_tr_b16 v[210:211], v248 offset:512
    ds_read_b64_tr_b16 v[212:213], v242 offset:1024
    ds_read_b64_tr_b16 v[214:215], v248 offset:1536
    s_add_u32 m0, s79, 14336
    s_add_u32 s83, s99, 1769472
    buffer_load_dwordx4 v29, s[52:55], s83 offen lds
    s_add_u32 m0, s79, 15360
    s_add_u32 s83, s99, 1802240
    buffer_load_dwordx4 v29, s[52:55], s83 offen lds
    s_waitcnt lgkmcnt(2)
    buffer_store_dwordx4 v[208:211], v2, s[68:71], s94 offen sc1
    s_waitcnt lgkmcnt(0)
    buffer_store_dwordx4 v[212:215], v2, s[68:71], s94 offen offset:1024 sc1
    s_add_u32 m0, s79, 16384
    s_add_u32 s83, s99, 1572864
    buffer_load_dwordx4 v29, s[52:55], s83 offen lds
    s_add_u32 m0, s79, 17408
    s_add_u32 s83, s99, 1605632
    buffer_load_dwordx4 v29, s[52:55], s83 offen lds
    s_add_u32 m0, s79, 0
    s_add_u32 s83, s99, 0
    buffer_load_dwordx4 v29, s[52:55], s83 offen lds
    s_add_u32 m0, s79, 1024
    s_add_u32 s83, s99, 32768
    buffer_load_dwordx4 v29, s[52:55], s83 offen lds
    s_add_u32 m0, s79, 2048
    s_add_u32 s83, s99, 65536
    buffer_load_dwordx4 v29, s[52:55], s83 offen lds
    s_add_u32 m0, s79, 3072
    s_add_u32 s83, s99, 98304
    buffer_load_dwordx4 v29, s[52:55], s83 offen lds
    s_add_u32 m0, s79, 4096
    s_add_u32 s83, s99, 131072
    buffer_load_dwordx4 v29, s[52:55], s83 offen lds
    s_add_u32 m0, s79, 5120
    s_add_u32 s83, s99, 163840
    buffer_load_dwordx4 v29, s[52:55], s83 offen lds
    s_add_u32 m0, s79, 6144
    s_add_u32 s83, s99, 196608
    buffer_load_dwordx4 v29, s[52:55], s83 offen lds
    s_add_u32 m0, s79, 7168
    s_add_u32 s83, s99, 229376
    buffer_load_dwordx4 v29, s[52:55], s83 offen lds
    s_add_u32 m0, s79, 8192
    s_add_u32 s83, s99, 262144
    buffer_load_dwordx4 v29, s[52:55], s83 offen lds
    s_add_u32 m0, s79, 9216
    s_add_u32 s83, s99, 294912
    buffer_load_dwordx4 v29, s[52:55], s83 offen lds
    s_add_u32 m0, s79, 10240
    s_add_u32 s83, s99, 327680
    buffer_load_dwordx4 v29, s[52:55], s83 offen lds
    s_add_u32 m0, s79, 11264
    s_add_u32 s83, s99, 360448
    buffer_load_dwordx4 v29, s[52:55], s83 offen lds
    s_add_u32 m0, s79, 12288
    s_add_u32 s83, s99, 393216
    buffer_load_dwordx4 v29, s[52:55], s83 offen lds
    s_add_u32 m0, s79, 13312
    s_add_u32 s83, s99, 425984
    buffer_load_dwordx4 v29, s[52:55], s83 offen lds
    s_lshl_b32 s80, s84, 9
    s_add_u32 s80, s80, s79
    v_add_u32 v7, s80, v3
    s_xor_b32 s80, s80, 512
    v_add_u32 v8, s80, v3
    ds_read_b64_tr_b16 v[56:57], v7 offset:20480
    ds_read_b64_tr_b16 v[58:59], v7 offset:21504
    ds_read_b64_tr_b16 v[60:61], v8 offset:20480
    ds_read_b64_tr_b16 v[62:63], v8 offset:21504
    ds_read_b64_tr_b16 v[64:65], v7 offset:22528
    ds_read_b64_tr_b16 v[66:67], v7 offset:23552
    ds_read_b64_tr_b16 v[68:69], v8 offset:22528
    ds_read_b64_tr_b16 v[70:71], v8 offset:23552
    ds_read_b64_tr_b16 v[72:73], v7 offset:32768
    ds_read_b64_tr_b16 v[74:75], v7 offset:33792
    ds_read_b64_tr_b16 v[76:77], v8 offset:32768
    ds_read_b64_tr_b16 v[78:79], v8 offset:33792
    ds_read_b64_tr_b16 v[80:81], v7 offset:34816
    ds_read_b64_tr_b16 v[82:83], v7 offset:35840
    ds_read_b64_tr_b16 v[84:85], v8 offset:34816
    ds_read_b64_tr_b16 v[86:87], v8 offset:35840
    s_waitcnt vmcnt(14)
    ds_read_b64_tr_b16 v[88:89], v7 offset:16384
    ds_read_b64_tr_b16 v[90:91], v7 offset:17408
    ds_read_b64_tr_b16 v[92:93], v8 offset:16384
    ds_read_b64_tr_b16 v[94:95], v8 offset:17408
    ds_read_b64_tr_b16 v[96:97], v7 offset:18432
    ds_read_b64_tr_b16 v[98:99], v7 offset:19456
    ds_read_b64_tr_b16 v[100:101], v8 offset:18432
    ds_read_b64_tr_b16 v[102:103], v8 offset:19456
    ds_read_b64_tr_b16 v[104:105], v7 offset:36864
    ds_read_b64_tr_b16 v[106:107], v7 offset:37888
    ds_read_b64_tr_b16 v[108:109], v8 offset:36864
    ds_read_b64_tr_b16 v[110:111], v8 offset:37888
    ds_read_b64_tr_b16 v[112:113], v7 offset:14336
    ds_read_b64_tr_b16 v[114:115], v7 offset:15360
    ds_read_b64_tr_b16 v[116:117], v8 offset:14336
    ds_read_b64_tr_b16 v[118:119], v8 offset:15360
    s_waitcnt lgkmcnt(0)
    s_add_u32 s80, s79, 32768
    v_add_u32 v252, s80, v2
    s_xor_b32 s80, s3, 1
    s_mul_i32 s80, s80, 40960
    s_add_u32 s80, s80, 32768
    v_add_u32 v253, s80, v2
    s_xor_b32 s80, s3, 2
    s_mul_i32 s80, s80, 40960
    s_add_u32 s80, s80, 34816
    v_add_u32 v254, s80, v2
    s_xor_b32 s80, s3, 3
    s_mul_i32 s80, s80, 40960
    s_add_u32 s80, s80, 36864
    v_add_u32 v0, s80, v2
    s_cmp_ge_u32 s73, 28
    s_nop 0
    s_cbranch_scc1 L_nop3_116
    v_and_b32 v251, 7, v1
    v_lshlrev_b32 v251, 12, v251
    s_lshl_b32 s97, s75, 18
    s_lshl_b32 s81, s3, 15
    s_add_u32 s97, s97, s81
    s_add_u32 s97, s97, 8523760
    v_mov_b32 v160, 0xbdd2d3e8
    v_mov_b32 v161, 0xc0135761
    v_mov_b32 v162, 1.0
    v_mov_b32 v31, 0xc0135761
    s_lshl_b32 s100, s75, 18
    s_lshl_b32 s81, s3, 15
    s_add_u32 s100, s100, s81
    s_add_u32 s100, s100, 8388608
    buffer_load_dwordx4 v[184:187], v2, s[68:71], s100 offen offset:0 sc1
    buffer_load_dwordx4 v[188:191], v2, s[68:71], s100 offen offset:1024 sc1
    buffer_load_dwordx4 v[192:195], v2, s[68:71], s100 offen offset:2048 sc1
    buffer_load_dwordx4 v[196:199], v2, s[68:71], s100 offen offset:3072 sc1
    s_add_u32 s100, s100, 4096
    buffer_load_dwordx4 v[200:203], v2, s[68:71], s100 offen offset:0 sc1
    buffer_load_dwordx4 v[204:207], v2, s[68:71], s100 offen offset:1024 sc1
    buffer_load_dwordx4 v[208:211], v2, s[68:71], s100 offen offset:2048 sc1
    buffer_load_dwordx4 v[212:215], v2, s[68:71], s100 offen offset:3072 sc1
    s_add_u32 s100, s100, 4096
    buffer_load_dwordx4 v[216:219], v2, s[68:71], s100 offen offset:0 sc1
    buffer_load_dwordx4 v[220:223], v2, s[68:71], s100 offen offset:1024 sc1
    buffer_load_dwordx4 v[224:227], v2, s[68:71], s100 offen offset:2048 sc1
    buffer_load_dwordx4 v[228:231], v2, s[68:71], s100 offen offset:3072 sc1
    s_add_u32 s100, s100, 4096
    buffer_load_dwordx4 v[232:235], v2, s[68:71], s100 offen offset:0 sc1
    buffer_load_dwordx4 v[236:239], v2, s[68:71], s100 offen offset:1024 sc1
    buffer_load_dwordx4 v[240:243], v2, s[68:71], s100 offen offset:2048 sc1
    buffer_load_dwordx4 v[244:247], v2, s[68:71], s100 offen offset:3072 sc1
    s_add_u32 s100, s100, 4096
    buffer_load_dwordx4 v[120:123], v2, s[68:71], s100 offen offset:0 sc1
    buffer_load_dwordx4 v[124:127], v2, s[68:71], s100 offen offset:1024 sc1
    v_and_b32 v251, 7, v1
    v_min_u32 v251, 6, v251
    v_lshlrev_b32 v251, 12, v251
    s_mul_i32 s97, s76, 229376
    s_mul_i32 s81, s3, 28672
    s_add_u32 s97, s97, s81
    s_add_u32 s97, s97, 12586992
    s_waitcnt vmcnt(14)
    v_max3_u32 v9, v184, v188, v192
    v_max_u32 v9, v9, v196
    v_cmp_eq_u32 vcc, -1, v9
    s_cbranch_vccnz L_redo_118
L_back_119:
    v_mfma_f32_32x32x16_bf16 v[144:159], a[4:7], v[184:187], 0
    v_mfma_f32_32x32x16_bf16 v[128:143], a[0:3], v[184:187], 0
    buffer_load_dwordx4 v[184:187], v2, s[68:71], s100 offen offset:2048 sc1
    v_mfma_f32_32x32x16_bf16 v[144:159], a[12:15], v[188:191], v[144:159]
    v_mfma_f32_32x32x16_bf16 v[128:143], a[8:11], v[188:191], v[128:143]
    buffer_load_dwordx4 v[188:191], v2, s[68:71], s100 offen offset:3072 sc1
    v_mfma_f32_32x32x16_bf16 v[144:159], a[20:23], v[192:195], v[144:159]
    v_mfma_f32_32x32x16_bf16 v[128:143], a[16:19], v[192:195], v[128:143]
    s_add_u32 s100, s100, 4096
    buffer_load_dwordx4 v[192:195], v2, s[68:71], s100 offen offset:0 sc1
    v_mfma_f32_32x32x16_bf16 v[144:159], a[28:31], v[196:199], v[144:159]
    s_waitcnt vmcnt(13)
    v_max3_u32 v9, v200, v204, v208
    v_max_u32 v9, v9, v212
    v_cmp_eq_u32 vcc, -1, v9
    v_mfma_f32_32x32x16_bf16 v[128:143], a[24:27], v[196:199], v[128:143]
    s_cbranch_vccnz L_redo_120
L_back_121:
    buffer_load_dwordx4 v[196:199], v2, s[68:71], s100 offen offset:1024 sc1
    v_mfma_f32_32x32x16_bf16 v[144:159], a[36:39], v[200:203], v[144:159]
    v_mfma_f32_32x32x16_bf16 v[128:143], a[32:35], v[200:203], v[128:143]
    buffer_load_dwordx4 v[200:203], v2, s[68:71], s100 offen offset:2048 sc1
    v_mfma_f32_32x32x16_bf16 v[144:159], a[44:47], v[204:207], v[144:159]
    v_mfma_f32_32x32x16_bf16 v[128:143], a[40:43], v[204:207], v[128:143]
    buffer_load_dwordx4 v[204:207], v2, s[68:71], s100 offen offset:3072 sc1
    v_mfma_f32_32x32x16_bf16 v[144:159], a[52:55], v[208:211], v[144:159]
    v_mfma_f32_32x32x16_bf16 v[128:143], a[48:51], v[208:211], v[128:143]
    s_add_u32 s100, s100, 4096
    buffer_load_dwordx4 v[208:211], v2, s[68:71], s100 offen offset:0 sc1
    v_mfma_f32_32x32x16_bf16 v[144:159], a[60:63], v[212:215], v[144:159]
    s_waitcnt vmcnt(13)
    v_max3_u32 v9, v216, v220, v224
    v_max_u32 v9, v9, v228
    v_cmp_eq_u32 vcc, -1, v9
    v_mfma_f32_32x32x16_bf16 v[128:143], a[56:59], v[212:215], v[128:143]
    s_cbranch_vccnz L_redo_122
L_back_123:
    buffer_load_dwordx4 v[212:215], v2, s[68:71], s100 offen offset:1024 sc1
    v_mfma_f32_32x32x16_bf16 v[144:159], a[68:71], v[216:219], v[144:159]
    v_mfma_f32_32x32x16_bf16 v[128:143], a[64:67], v[216:219], v[128:143]
    buffer_load_dwordx4 v[216:219], v2, s[68:71], s100 offen offset:2048 sc1
    v_mfma_f32_32x32x16_bf16 v[144:159], a[76:79], v[220:223], v[144:159]
    v_mfma_f32_32x32x16_bf16 v[128:143], a[72:75], v[220:223], v[128:143]
    buffer_load_dwordx4 v[220:223], v2, s[68:71], s100 offen offset:3072 sc1
    v_mfma_f32_32x32x16_bf16 v[144:159], a[84:87], v[224:227], v[144:159]
    v_mfma_f32_32x32x16_bf16 v[128:143], a[80:83], v[224:227], v[128:143]
    s_add_u32 s100, s100, 4096
    buffer_load_dwordx4 v[224:227], v2, s[68:71], s100 offen offset:0 sc1
    v_mfma_f32_32x32x16_bf16 v[144:159], a[92:95], v[228:231], v[144:159]
    s_waitcnt vmcnt(13)
    v_max3_u32 v9, v232, v236, v240
    v_max_u32 v9, v9, v244
    v_cmp_eq_u32 vcc, -1, v9
    v_mfma_f32_32x32x16_bf16 v[128:143], a[88:91], v[228:231], v[128:143]
    s_cbranch_vccnz L_redo_124
L_back_125:
    buffer_load_dwordx4 v[228:231], v2, s[68:71], s100 offen offset:1024 sc1
    v_mfma_f32_32x32x16_bf16 v[144:159], a[100:103], v[232:235], v[144:159]
    v_mfma_f32_32x32x16_bf16 v[128:143], a[96:99], v[232:235], v[128:143]
    buffer_load_dwordx4 v[232:235], v2, s[68:71], s100 offen offset:2048 sc1
    v_mfma_f32_32x32x16_bf16 v[144:159], a[108:111], v[236:239], v[144:159]
    v_mfma_f32_32x32x16_bf16 v[128:143], a[104:107], v[236:239], v[128:143]
    buffer_load_dwordx4 v[236:239], v2, s[68:71], s100 offen offset:3072 sc1
    v_mfma_f32_32x32x16_bf16 v[144:159], a[116:119], v[240:243], v[144:159]
    v_mfma_f32_32x32x16_bf16 v[128:143], a[112:115], v[240:243], v[128:143]
    s_lshl_b32 s100, s75, 18
    s_lshl_b32 s81, s3, 15
    s_add_u32 s100, s100, s81
    s_add_u32 s100, s100, 8519680
    buffer_load_dwordx4 v[240:243], v2, s[68:71], s100 offen offset:0 sc1
    v_mfma_f32_32x32x16_bf16 v[144:159], a[124:127], v[244:247], v[144:159]
    s_waitcnt vmcnt(13)
    v_max3_u32 v9, v120, v124, v184
    v_max_u32 v9, v9, v188
    v_cmp_eq_u32 vcc, -1, v9
    v_mfma_f32_32x32x16_bf16 v[128:143], a[120:123], v[244:247], v[128:143]
    s_cbranch_vccnz L_redo_126
L_back_127:
    buffer_load_dwordx4 v[244:247], v2, s[68:71], s100 offen offset:1024 sc1
    v_mfma_f32_32x32x16_bf16 v[144:159], a[132:135], v[120:123], v[144:159]
    v_mfma_f32_32x32x16_bf16 v[128:143], a[128:131], v[120:123], v[128:143]
    buffer_load_dwordx4 v[120:123], v2, s[68:71], s100 offen offset:2048 sc1
    v_mfma_f32_32x32x16_bf16 v[144:159], a[140:143], v[124:127], v[144:159]
    v_mfma_f32_32x32x16_bf16 v[128:143], a[136:139], v[124:127], v[128:143]
    buffer_load_dwordx4 v[124:127], v2, s[68:71], s100 offen offset:3072 sc1
    v_mfma_f32_32x32x16_bf16 v[144:159], a[148:151], v[184:187], v[144:159]
    v_mfma_f32_32x32x16_bf16 v[128:143], a[144:147], v[184:187], v[128:143]
    s_add_u32 s100, s100, 4096
    buffer_load_dwordx4 v[184:187], v2, s[68:71], s100 offen offset:0 sc1
    v_mfma_f32_32x32x16_bf16 v[144:159], a[156:159], v[188:191], v[144:159]
    s_waitcnt vmcnt(13)
    v_max3_u32 v9, v192, v196, v200
    v_max_u32 v9, v9, v204
    v_cmp_eq_u32 vcc, -1, v9
    v_mfma_f32_32x32x16_bf16 v[128:143], a[152:155], v[188:191], v[128:143]
    s_cbranch_vccnz L_redo_128
L_back_129:
    buffer_load_dwordx4 v[188:191], v2, s[68:71], s100 offen offset:1024 sc1
    v_mfma_f32_32x32x16_bf16 v[144:159], a[164:167], v[192:195], v[144:159]
    v_mfma_f32_32x32x16_bf16 v[128:143], a[160:163], v[192:195], v[128:143]
    buffer_load_dwordx4 v[192:195], v2, s[68:71], s100 offen offset:2048 sc1
    v_mfma_f32_32x32x16_bf16 v[144:159], a[172:175], v[196:199], v[144:159]
    v_mfma_f32_32x32x16_bf16 v[128:143], a[168:171], v[196:199], v[128:143]
    buffer_load_dwordx4 v[196:199], v2, s[68:71], s100 offen offset:3072 sc1
    v_mfma_f32_32x32x16_bf16 v[144:159], a[180:183], v[200:203], v[144:159]
    v_mfma_f32_32x32x16_bf16 v[128:143], a[176:179], v[200:203], v[128:143]
    s_add_u32 s100, s100, 4096
    buffer_load_dwordx4 v[200:203], v2, s[68:71], s100 offen offset:0 sc1
    v_mfma_f32_32x32x16_bf16 v[144:159], a[188:191], v[204:207], v[144:159]
    s_waitcnt vmcnt(13)
    v_max3_u32 v9, v208, v212, v216
    v_max_u32 v9, v9, v220
    v_cmp_eq_u32 vcc, -1, v9
    v_mfma_f32_32x32x16_bf16 v[128:143], a[184:187], v[204:207], v[128:143]
    s_cbranch_vccnz L_redo_130
L_back_131:
    buffer_load_dwordx4 v[204:207], v2, s[68:71], s100 offen offset:1024 sc1
    v_mfma_f32_32x32x16_bf16 v[144:159], a[196:199], v[208:211], v[144:159]
    v_mfma_f32_32x32x16_bf16 v[128:143], a[192:195], v[208:211], v[128:143]
    buffer_load_dwordx4 v[208:211], v2, s[68:71], s100 offen offset:2048 sc1
    v_mfma_f32_32x32x16_bf16 v[144:159], a[204:207], v[212:215], v[144:159]
    v_mfma_f32_32x32x16_bf16 v[128:143], a[200:203], v[212:215], v[128:143]
    buffer_load_dwordx4 v[212:215], v2, s[68:71], s100 offen offset:3072 sc1
    v_mfma_f32_32x32x16_bf16 v[144:159], a[212:215], v[216:219], v[144:159]
    v_mfma_f32_32x32x16_bf16 v[128:143], a[208:211], v[216:219], v[128:143]
    s_add_u32 s100, s100, 4096
    buffer_load_dwordx4 v[216:219], v2, s[68:71], s100 offen offset:0 sc1
    v_mfma_f32_32x32x16_bf16 v[144:159], a[220:223], v[220:223], v[144:159]
    s_waitcnt vmcnt(13)
    v_max3_u32 v9, v224, v228, v232
    v_max_u32 v9, v9, v236
    v_cmp_eq_u32 vcc, -1, v9
    v_mfma_f32_32x32x16_bf16 v[128:143], a[216:219], v[220:223], v[128:143]
    s_cbranch_vccnz L_redo_132
L_back_133:
    buffer_load_dwordx4 v[220:223], v2, s[68:71], s100 offen offset:1024 sc1
    v_mfma_f32_32x32x16_bf16 v[144:159], a[228:231], v[224:227], v[144:159]
    v_mfma_f32_32x32x16_bf16 v[144:159], a[236:239], v[228:231], v[144:159]
    v_mfma_f32_32x32x16_bf16 v[144:159], a[244:247], v[232:235], v[144:159]
    v_mfma_f32_32x32x16_bf16 v[144:159], a[252:255], v[236:239], v[144:159]
    v_mfma_f32_32x32x16_bf16 v[128:143], a[224:227], v[224:227], v[128:143]
    v_lshlrev_b32 v176, 16, v14
    v_and_b32 v177, 0xffff0000, v14
    v_lshlrev_b32 v178, 16, v15
    v_and_b32 v179, 0xffff0000, v15
    v_lshlrev_b32 v180, 16, v16
    v_and_b32 v181, 0xffff0000, v16
    v_lshlrev_b32 v182, 16, v17
    v_and_b32 v183, 0xffff0000, v17
    buffer_load_dwordx4 v[224:227], v2, s[68:71], s100 offen offset:2048 sc1
    v_mfma_f32_32x32x16_bf16 v[128:143], a[232:235], v[228:231], v[128:143]
    s_nop 0
    ds_write_b128 v252, v[144:147] offset:0
    buffer_load_dwordx4 v[228:231], v2, s[68:71], s100 offen offset:3072 sc1
    v_mfma_f32_32x32x16_bf16 v[128:143], a[240:243], v[232:235], v[128:143]
    ds_write_b128 v252, v[148:151] offset:1024
    s_add_u32 s100, s100, 4096
    buffer_load_dwordx4 v[232:235], v2, s[68:71], s100 offen offset:0 sc1
    v_mfma_f32_32x32x16_bf16 v[128:143], a[248:251], v[236:239], v[128:143]
    ds_write_b128 v252, v[152:155] offset:4096
    buffer_load_dwordx4 v[236:239], v2, s[68:71], s100 offen offset:1024 sc1
    ds_write_b128 v252, v[156:159] offset:5120
    s_nop 8
    ds_write_b128 v252, v[136:139] offset:2048
    ds_write_b128 v252, v[140:143] offset:3072
    s_mul_i32 s93, s75, 229376
    s_lshl_b32 s81, s78, 12
    s_add_u32 s93, s93, s81
    s_lshl_b32 s81, s84, 11
    s_add_u32 s93, s93, s81
    s_lshl_b32 s81, s85, 10
    s_add_u32 s93, s93, s81
    s_add_u32 s93, s93, 12582912
    v_pk_add_f32 v[176:177], v[176:177], v[128:129]
    v_pk_add_f32 v[178:179], v[178:179], v[130:131]
    v_pk_add_f32 v[180:181], v[180:181], v[132:133]
    v_pk_add_f32 v[182:183], v[182:183], v[134:135]
    s_waitcnt lgkmcnt(0)
    s_barrier
    ds_read_b128 v[136:139], v253 offset:0
    ds_read_b128 v[140:143], v253 offset:1024
    ds_read_b128 v[144:147], v254 offset:0
    ds_read_b128 v[148:151], v254 offset:1024
    ds_read_b128 v[152:155], v0 offset:0
    ds_read_b128 v[156:159], v0 offset:1024
    s_waitcnt lgkmcnt(4)
    v_pk_add_f32 v[176:177], v[176:177], v[136:137]
    v_pk_add_f32 v[178:179], v[178:179], v[138:139]
    v_pk_add_f32 v[180:181], v[180:181], v[140:141]
    v_pk_add_f32 v[182:183], v[182:183], v[142:143]
    s_waitcnt lgkmcnt(0)
    s_barrier
    v_pk_add_f32 v[144:145], v[144:145], v[152:153]
    v_pk_add_f32 v[146:147], v[146:147], v[154:155]
    v_pk_add_f32 v[148:149], v[148:149], v[156:157]
    v_pk_add_f32 v[150:151], v[150:151], v[158:159]
    v_pk_add_f32 v[176:177], v[176:177], v[144:145]
    v_pk_add_f32 v[178:179], v[178:179], v[146:147]
    v_pk_add_f32 v[180:181], v[180:181], v[148:149]
    v_pk_add_f32 v[182:183], v[182:183], v[150:151]
    v_pk_mul_f32 v[128:129], v[176:177], v[176:177]
    v_pk_mul_f32 v[130:131], v[178:179], v[178:179]
    v_pk_mul_f32 v[132:133], v[180:181], v[180:181]
    v_pk_mul_f32 v[134:135], v[182:183], v[182:183]
    v_pk_fma_f32 v[128:129], v[128:129], v[160:161], v[160:161] op_sel:[0,0,1] op_sel_hi:[1,0,1]
    v_pk_fma_f32 v[130:131], v[130:131], v[160:161], v[160:161] op_sel:[0,0,1] op_sel_hi:[1,0,1]
    v_pk_fma_f32 v[132:133], v[132:133], v[160:161], v[160:161] op_sel:[0,0,1] op_sel_hi:[1,0,1]
    v_pk_fma_f32 v[134:135], v[134:135], v[160:161], v[160:161] op_sel:[0,0,1] op_sel_hi:[1,0,1]
    v_pk_mul_f32 v[128:129], v[128:129], v[176:177]
    v_pk_mul_f32 v[130:131], v[130:131], v[178:179]
    v_pk_mul_f32 v[132:133], v[132:133], v[180:181]
    v_pk_mul_f32 v[134:135], v[134:135], v[182:183]
    v_exp_f32 v128, v128
    v_exp_f32 v129, v129
    v_exp_f32 v130, v130
    v_exp_f32 v131, v131
    v_exp_f32 v132, v132
    v_exp_f32 v133, v133
    v_exp_f32 v134, v134
    v_exp_f32 v135, v135
    v_pk_add_f32 v[128:129], v[128:129], v[162:163] op_sel:[0,0] op_sel_hi:[1,0]
    v_pk_add_f32 v[130:131], v[130:131], v[162:163] op_sel:[0,0] op_sel_hi:[1,0]
    v_pk_add_f32 v[132:133], v[132:133], v[162:163] op_sel:[0,0] op_sel_hi:[1,0]
    v_pk_add_f32 v[134:135], v[134:135], v[162:163] op_sel:[0,0] op_sel_hi:[1,0]
    v_rcp_f32 v128, v128
    v_rcp_f32 v129, v129
    v_rcp_f32 v130, v130
    v_rcp_f32 v131, v131
    v_rcp_f32 v132, v132
    v_rcp_f32 v133, v133
    v_rcp_f32 v134, v134
    v_rcp_f32 v135, v135
    v_pk_mul_f32 v[176:177], v[176:177], v[128:129]
    v_pk_mul_f32 v[178:179], v[178:179], v[130:131]
    v_pk_mul_f32 v[180:181], v[180:181], v[132:133]
    v_pk_mul_f32 v[182:183], v[182:183], v[134:135]
    v_cvt_pk_bf16_f32 v176, v176, v177
    v_cvt_pk_bf16_f32 v177, v178, v179
    v_cvt_pk_bf16_f32 v178, v180, v181
    v_cvt_pk_bf16_f32 v179, v182, v183
    buffer_store_dwordx4 v[176:179], v2, s[68:71], s93 offen sc1
    s_waitcnt vmcnt(15)
    v_max3_u32 v9, v240, v244, v120
    v_max_u32 v9, v9, v124
    v_cmp_eq_u32 vcc, -1, v9
    s_cbranch_vccnz L_redo_134
L_back_135:
    v_mfma_f32_32x32x16_bf16 v[144:159], a[4:7], v[240:243], 0
    v_mfma_f32_32x32x16_bf16 v[128:143], a[0:3], v[240:243], 0
    buffer_load_dwordx4 v[240:243], v2, s[68:71], s100 offen offset:2048 sc1
    v_mfma_f32_32x32x16_bf16 v[144:159], a[12:15], v[244:247], v[144:159]
    v_mfma_f32_32x32x16_bf16 v[128:143], a[8:11], v[244:247], v[128:143]
    buffer_load_dwordx4 v[244:247], v2, s[68:71], s100 offen offset:3072 sc1
    v_mfma_f32_32x32x16_bf16 v[144:159], a[20:23], v[120:123], v[144:159]
    v_mfma_f32_32x32x16_bf16 v[128:143], a[16:19], v[120:123], v[128:143]
    s_add_u32 s100, s100, 4096
    buffer_load_dwordx4 v[120:123], v2, s[68:71], s100 offen offset:0 sc1
    v_mfma_f32_32x32x16_bf16 v[144:159], a[28:31], v[124:127], v[144:159]
    s_waitcnt vmcnt(14)
    v_max3_u32 v9, v184, v188, v192
    v_max_u32 v9, v9, v196
    v_cmp_eq_u32 vcc, -1, v9
    v_mfma_f32_32x32x16_bf16 v[128:143], a[24:27], v[124:127], v[128:143]
    s_cbranch_vccnz L_redo_136
L_back_137:
    buffer_load_dwordx4 v[124:127], v2, s[68:71], s100 offen offset:1024 sc1
    v_mfma_f32_32x32x16_bf16 v[144:159], a[36:39], v[184:187], v[144:159]
    v_mfma_f32_32x32x16_bf16 v[128:143], a[32:35], v[184:187], v[128:143]
    buffer_load_dwordx4 v[184:187], v2, s[68:71], s100 offen offset:2048 sc1
    v_mfma_f32_32x32x16_bf16 v[144:159], a[44:47], v[188:191], v[144:159]
    v_mfma_f32_32x32x16_bf16 v[128:143], a[40:43], v[188:191], v[128:143]
    buffer_load_dwordx4 v[188:191], v2, s[68:71], s100 offen offset:3072 sc1
    v_mfma_f32_32x32x16_bf16 v[144:159], a[52:55], v[192:195], v[144:159]
    v_mfma_f32_32x32x16_bf16 v[128:143], a[48:51], v[192:195], v[128:143]
    s_add_u32 s100, s100, 4096
    buffer_load_dwordx4 v[192:195], v2, s[68:71], s100 offen offset:0 sc1
    v_mfma_f32_32x32x16_bf16 v[144:159], a[60:63], v[196:199], v[144:159]
    s_waitcnt vmcnt(14)
    v_max3_u32 v9, v200, v204, v208
    v_max_u32 v9, v9, v212
    v_cmp_eq_u32 vcc, -1, v9
    v_mfma_f32_32x32x16_bf16 v[128:143], a[56:59], v[196:199], v[128:143]
    s_cbranch_vccnz L_redo_138
L_back_139:
    buffer_load_dwordx4 v[196:199], v2, s[68:71], s100 offen offset:1024 sc1
    v_mfma_f32_32x32x16_bf16 v[144:159], a[68:71], v[200:203], v[144:159]
    v_mfma_f32_32x32x16_bf16 v[128:143], a[64:67], v[200:203], v[128:143]
    buffer_load_dwordx4 v[200:203], v2, s[68:71], s100 offen offset:2048 sc1
    v_mfma_f32_32x32x16_bf16 v[144:159], a[76:79], v[204:207], v[144:159]
    v_mfma_f32_32x32x16_bf16 v[128:143], a[72:75], v[204:207], v[128:143]
    buffer_load_dwordx4 v[204:207], v2, s[68:71], s100 offen offset:3072 sc1
    v_mfma_f32_32x32x16_bf16 v[144:159], a[84:87], v[208:211], v[144:159]
    v_mfma_f32_32x32x16_bf16 v[128:143], a[80:83], v[208:211], v[128:143]
    s_add_u32 s100, s100, 4096
    buffer_load_dwordx4 v[208:211], v2, s[68:71], s100 offen offset:0 sc1
    v_mfma_f32_32x32x16_bf16 v[144:159], a[92:95], v[212:215], v[144:159]
    s_waitcnt vmcnt(14)
    v_max3_u32 v9, v216, v220, v224
    v_max_u32 v9, v9, v228
    v_cmp_eq_u32 vcc, -1, v9
    v_mfma_f32_32x32x16_bf16 v[128:143], a[88:91], v[212:215], v[128:143]
    s_cbranch_vccnz L_redo_140
L_back_141:
    buffer_load_dwordx4 v[212:215], v2, s[68:71], s100 offen offset:1024 sc1
    v_mfma_f32_32x32x16_bf16 v[144:159], a[100:103], v[216:219], v[144:159]
    v_mfma_f32_32x32x16_bf16 v[128:143], a[96:99], v[216:219], v[128:143]
    buffer_load_dwordx4 v[216:219], v2, s[68:71], s100 offen offset:2048 sc1
    s_add_u32 m0, s79, 14336
    s_add_u32 s83, s99, 458752
    buffer_load_dwordx4 v29, s[52:55], s83 offen lds
    v_mfma_f32_32x32x16_bf16 v[144:159], a[108:111], v[220:223], v[144:159]
    v_mfma_f32_32x32x16_bf16 v[128:143], a[104:107], v[220:223], v[128:143]
    buffer_load_dwordx4 v[220:223], v2, s[68:71], s100 offen offset:3072 sc1
    s_add_u32 m0, s79, 15360
    s_add_u32 s83, s99, 491520
    buffer_load_dwordx4 v29, s[52:55], s83 offen lds
    v_mfma_f32_32x32x16_bf16 v[144:159], a[116:119], v[224:227], v[144:159]
    v_mfma_f32_32x32x16_bf16 v[128:143], a[112:115], v[224:227], v[128:143]
    s_add_u32 m0, s79, 16384
    s_add_u32 s83, s99, 524288
    buffer_load_dwordx4 v29, s[52:55], s83 offen lds
    v_mfma_f32_32x32x16_bf16 v[144:159], a[124:127], v[228:231], v[144:159]
    s_waitcnt vmcnt(15)
    v_max3_u32 v9, v232, v236, v240
    v_max_u32 v9, v9, v244
    v_cmp_eq_u32 vcc, -1, v9
    v_mfma_f32_32x32x16_bf16 v[128:143], a[120:123], v[228:231], v[128:143]
    s_cbranch_vccnz L_redo_142
L_back_143:
    s_add_u32 m0, s79, 17408
    s_add_u32 s83, s99, 557056
    buffer_load_dwordx4 v29, s[52:55], s83 offen lds
    v_mfma_f32_32x32x16_bf16 v[144:159], a[132:135], v[232:235], v[144:159]
    v_mfma_f32_32x32x16_bf16 v[128:143], a[128:131], v[232:235], v[128:143]
    s_add_u32 m0, s79, 18432
    s_add_u32 s83, s99, 589824
    buffer_load_dwordx4 v29, s[52:55], s83 offen lds
    v_mfma_f32_32x32x16_bf16 v[144:159], a[140:143], v[236:239], v[144:159]
    v_mfma_f32_32x32x16_bf16 v[128:143], a[136:139], v[236:239], v[128:143]
    s_add_u32 m0, s79, 19456
    s_add_u32 s83, s99, 622592
    buffer_load_dwordx4 v29, s[52:55], s83 offen lds
    v_mfma_f32_32x32x16_bf16 v[144:159], a[148:151], v[240:243], v[144:159]
    v_mfma_f32_32x32x16_bf16 v[128:143], a[144:147], v[240:243], v[128:143]
    s_add_u32 m0, s79, 20480
    s_add_u32 s83, s99, 655360
    buffer_load_dwordx4 v29, s[52:55], s83 offen lds
    v_mfma_f32_32x32x16_bf16 v[144:159], a[156:159], v[244:247], v[144:159]
    s_waitcnt vmcnt(15)
    v_max3_u32 v9, v120, v124, v184
    v_max_u32 v9, v9, v188
    v_cmp_eq_u32 vcc, -1, v9
    v_mfma_f32_32x32x16_bf16 v[128:143], a[152:155], v[244:247], v[128:143]
    s_cbranch_vccnz L_redo_144
L_back_145:
    s_add_u32 m0, s79, 21504
    s_add_u32 s83, s99, 688128
    buffer_load_dwordx4 v29, s[52:55], s83 offen lds
    v_mfma_f32_32x32x16_bf16 v[144:159], a[164:167], v[120:123], v[144:159]
    v_mfma_f32_32x32x16_bf16 v[128:143], a[160:163], v[120:123], v[128:143]
    s_add_u32 m0, s79, 22528
    s_add_u32 s83, s99, 720896
    buffer_load_dwordx4 v29, s[52:55], s83 offen lds
    v_mfma_f32_32x32x16_bf16 v[144:159], a[172:175], v[124:127], v[144:159]
    v_mfma_f32_32x32x16_bf16 v[128:143], a[168:171], v[124:127], v[128:143]
    s_add_u32 m0, s79, 23552
    s_add_u32 s83, s99, 753664
    buffer_load_dwordx4 v29, s[52:55], s83 offen lds
    v_mfma_f32_32x32x16_bf16 v[144:159], a[180:183], v[184:187], v[144:159]
    v_mfma_f32_32x32x16_bf16 v[128:143], a[176:179], v[184:187], v[128:143]
    v_mfma_f32_32x32x16_bf16 v[144:159], a[188:191], v[188:191], v[144:159]
    s_waitcnt vmcnt(14)
    v_max3_u32 v9, v192, v196, v200
    v_max_u32 v9, v9, v204
    v_cmp_eq_u32 vcc, -1, v9
    v_mfma_f32_32x32x16_bf16 v[128:143], a[184:187], v[188:191], v[128:143]
    s_cbranch_vccnz L_redo_146
L_back_147:
    v_mfma_f32_32x32x16_bf16 v[144:159], a[196:199], v[192:195], v[144:159]
    v_mfma_f32_32x32x16_bf16 v[128:143], a[192:195], v[192:195], v[128:143]
    v_mfma_f32_32x32x16_bf16 v[144:159], a[204:207], v[196:199], v[144:159]
    v_mfma_f32_32x32x16_bf16 v[128:143], a[200:203], v[196:199], v[128:143]
    s_mul_i32 s100, s76, 229376
    s_mul_i32 s81, s3, 28672
    s_add_u32 s100, s100, s81
    s_add_u32 s100, s100, 12582912
    buffer_load_dwordx4 v[224:227], v6, s[68:71], s100 offen offset:0 sc1
    buffer_load_dwordx4 v[228:231], v6, s[68:71], s100 offen offset:1024 sc1
    v_mfma_f32_32x32x16_bf16 v[144:159], a[212:215], v[200:203], v[144:159]
    v_mfma_f32_32x32x16_bf16 v[128:143], a[208:211], v[200:203], v[128:143]
    buffer_load_dwordx4 v[232:235], v6, s[68:71], s100 offen offset:2048 sc1
    buffer_load_dwordx4 v[236:239], v6, s[68:71], s100 offen offset:3072 sc1
    v_mfma_f32_32x32x16_bf16 v[144:159], a[220:223], v[204:207], v[144:159]
    s_waitcnt vmcnt(13)
    v_max3_u32 v9, v208, v212, v216
    v_max_u32 v9, v9, v220
    v_cmp_eq_u32 vcc, -1, v9
    v_mfma_f32_32x32x16_bf16 v[128:143], a[216:219], v[204:207], v[128:143]
    s_cbranch_vccnz L_redo_148
L_back_149:
    s_add_u32 s100, s100, 4096
    buffer_load_dwordx4 v[240:243], v6, s[68:71], s100 offen offset:0 sc1
    buffer_load_dwordx4 v[244:247], v6, s[68:71], s100 offen offset:1024 sc1
    v_mfma_f32_32x32x16_bf16 v[144:159], a[228:231], v[208:211], v[144:159]
    v_mfma_f32_32x32x16_bf16 v[144:159], a[236:239], v[212:215], v[144:159]
    v_mfma_f32_32x32x16_bf16 v[144:159], a[244:247], v[216:219], v[144:159]
    v_mfma_f32_32x32x16_bf16 v[144:159], a[252:255], v[220:223], v[144:159]
    v_mfma_f32_32x32x16_bf16 v[128:143], a[224:227], v[208:211], v[128:143]
    v_lshlrev_b32 v176, 16, v14
    v_and_b32 v177, 0xffff0000, v14
    v_lshlrev_b32 v178, 16, v15
    v_and_b32 v179, 0xffff0000, v15
    v_lshlrev_b32 v180, 16, v16
    v_and_b32 v181, 0xffff0000, v16
    v_lshlrev_b32 v182, 16, v17
    v_and_b32 v183, 0xffff0000, v17
    buffer_load_dwordx4 v[120:123], v6, s[68:71], s100 offen offset:2048 sc1
    buffer_load_dwordx4 v[124:127], v6, s[68:71], s100 offen offset:3072 sc1
    v_mfma_f32_32x32x16_bf16 v[128:143], a[232:235], v[212:215], v[128:143]
    ds_write_b128 v252, v[144:147] offset:0
    s_add_u32 s100, s100, 4096
    buffer_load_dwordx4 v[184:187], v6, s[68:71], s100 offen offset:0 sc1
    buffer_load_dwordx4 v[188:191], v6, s[68:71], s100 offen offset:1024 sc1
    v_mfma_f32_32x32x16_bf16 v[128:143], a[240:243], v[216:219], v[128:143]
    ds_write_b128 v252, v[148:151] offset:1024
    buffer_load_dwordx4 v[192:195], v6, s[68:71], s100 offen offset:2048 sc1
    buffer_load_dwordx4 v[196:199], v6, s[68:71], s100 offen offset:3072 sc1
    v_mfma_f32_32x32x16_bf16 v[128:143], a[248:251], v[220:223], v[128:143]
    ds_write_b128 v252, v[152:155] offset:4096
    s_add_u32 s100, s100, 4096
    buffer_load_dwordx4 v[200:203], v6, s[68:71], s100 offen offset:0 sc1
    buffer_load_dwordx4 v[204:207], v6, s[68:71], s100 offen offset:1024 sc1
    ds_write_b128 v252, v[156:159] offset:5120
    s_nop 6
    ds_write_b128 v252, v[136:139] offset:2048
    ds_write_b128 v252, v[140:143] offset:3072
    buffer_load_dwordx4 v[208:211], v6, s[68:71], s100 offen offset:2048 sc1
    buffer_load_dwordx4 v[212:215], v6, s[68:71], s100 offen offset:3072 sc1
    s_add_u32 s100, s100, 4096
    buffer_load_dwordx4 v[216:219], v6, s[68:71], s100 offen offset:0 sc1
    buffer_load_dwordx4 v[220:223], v6, s[68:71], s100 offen offset:1024 sc1
    s_mul_i32 s93, s75, 229376
    s_lshl_b32 s81, s78, 12
    s_add_u32 s93, s93, s81
    s_lshl_b32 s81, s84, 11
    s_add_u32 s93, s93, s81
    s_lshl_b32 s81, s85, 10
    s_add_u32 s93, s93, s81
    s_add_u32 s93, s93, 12697600
    v_pk_add_f32 v[176:177], v[176:177], v[128:129]
    v_pk_add_f32 v[178:179], v[178:179], v[130:131]
    v_pk_add_f32 v[180:181], v[180:181], v[132:133]
    v_pk_add_f32 v[182:183], v[182:183], v[134:135]
    s_waitcnt lgkmcnt(0)
    s_barrier
    ds_read_b128 v[136:139], v253 offset:0
    ds_read_b128 v[140:143], v253 offset:1024
    ds_read_b128 v[144:147], v254 offset:0
    ds_read_b128 v[148:151], v254 offset:1024
    ds_read_b128 v[152:155], v0 offset:0
    ds_read_b128 v[156:159], v0 offset:1024
    s_waitcnt lgkmcnt(4)
    v_pk_add_f32 v[176:177], v[176:177], v[136:137]
    v_pk_add_f32 v[178:179], v[178:179], v[138:139]
    v_pk_add_f32 v[180:181], v[180:181], v[140:141]
    v_pk_add_f32 v[182:183], v[182:183], v[142:143]
    s_waitcnt lgkmcnt(0)
    s_barrier
    v_pk_add_f32 v[144:145], v[144:145], v[152:153]
    v_pk_add_f32 v[146:147], v[146:147], v[154:155]
    v_pk_add_f32 v[148:149], v[148:149], v[156:157]
    v_pk_add_f32 v[150:151], v[150:151], v[158:159]
    v_pk_add_f32 v[176:177], v[176:177], v[144:145]
    v_pk_add_f32 v[178:179], v[178:179], v[146:147]
    v_pk_add_f32 v[180:181], v[180:181], v[148:149]
    v_pk_add_f32 v[182:183], v[182:183], v[150:151]
    v_pk_mul_f32 v[128:129], v[176:177], v[176:177]
    v_pk_mul_f32 v[130:131], v[178:179], v[178:179]
    v_pk_mul_f32 v[132:133], v[180:181], v[180:181]
    v_pk_mul_f32 v[134:135], v[182:183], v[182:183]
    v_pk_fma_f32 v[128:129], v[128:129], v[160:161], v[160:161] op_sel:[0,0,1] op_sel_hi:[1,0,1]
    v_pk_fma_f32 v[130:131], v[130:131], v[160:161], v[160:161] op_sel:[0,0,1] op_sel_hi:[1,0,1]
    v_pk_fma_f32 v[132:133], v[132:133], v[160:161], v[160:161] op_sel:[0,0,1] op_sel_hi:[1,0,1]
    v_pk_fma_f32 v[134:135], v[134:135], v[160:161], v[160:161] op_sel:[0,0,1] op_sel_hi:[1,0,1]
    v_pk_mul_f32 v[128:129], v[128:129], v[176:177]
    v_pk_mul_f32 v[130:131], v[130:131], v[178:179]
    v_pk_mul_f32 v[132:133], v[132:133], v[180:181]
    v_pk_mul_f32 v[134:135], v[134:135], v[182:183]
    v_exp_f32 v128, v128
    v_exp_f32 v129, v129
    v_exp_f32 v130, v130
    v_exp_f32 v131, v131
    v_exp_f32 v132, v132
    v_exp_f32 v133, v133
    v_exp_f32 v134, v134
    v_exp_f32 v135, v135
    v_pk_add_f32 v[128:129], v[128:129], v[162:163] op_sel:[0,0] op_sel_hi:[1,0]
    v_pk_add_f32 v[130:131], v[130:131], v[162:163] op_sel:[0,0] op_sel_hi:[1,0]
    v_pk_add_f32 v[132:133], v[132:133], v[162:163] op_sel:[0,0] op_sel_hi:[1,0]
    v_pk_add_f32 v[134:135], v[134:135], v[162:163] op_sel:[0,0] op_sel_hi:[1,0]
    v_rcp_f32 v128, v128
    v_rcp_f32 v129, v129
    v_rcp_f32 v130, v130
    v_rcp_f32 v131, v131
    v_rcp_f32 v132, v132
    v_rcp_f32 v133, v133
    v_rcp_f32 v134, v134
    v_rcp_f32 v135, v135
    v_pk_mul_f32 v[176:177], v[176:177], v[128:129]
    v_pk_mul_f32 v[178:179], v[178:179], v[130:131]
    v_pk_mul_f32 v[180:181], v[180:181], v[132:133]
    v_pk_mul_f32 v[182:183], v[182:183], v[134:135]
    v_cvt_pk_bf16_f32 v176, v176, v177
    v_cvt_pk_bf16_f32 v177, v178, v179
    v_cvt_pk_bf16_f32 v178, v180, v181
    v_cvt_pk_bf16_f32 v179, v182, v183
    buffer_store_dwordx4 v[176:179], v2, s[68:71], s93 offen sc1
    s_nop 1
    s_branch L_p4_117
L_nop3_116:
    s_add_u32 m0, s79, 14336
    s_add_u32 s83, s99, 458752
    buffer_load_dwordx4 v29, s[52:55], s83 offen lds
    s_add_u32 m0, s79, 15360
    s_add_u32 s83, s99, 491520
    buffer_load_dwordx4 v29, s[52:55], s83 offen lds
    s_add_u32 m0, s79, 16384
    s_add_u32 s83, s99, 524288
    buffer_load_dwordx4 v29, s[52:55], s83 offen lds
    s_add_u32 m0, s79, 17408
    s_add_u32 s83, s99, 557056
    buffer_load_dwordx4 v29, s[52:55], s83 offen lds
    s_add_u32 m0, s79, 18432
    s_add_u32 s83, s99, 589824
    buffer_load_dwordx4 v29, s[52:55], s83 offen lds
    s_add_u32 m0, s79, 19456
    s_add_u32 s83, s99, 622592
    buffer_load_dwordx4 v29, s[52:55], s83 offen lds
    s_add_u32 m0, s79, 20480
    s_add_u32 s83, s99, 655360
    buffer_load_dwordx4 v29, s[52:55], s83 offen lds
    s_add_u32 m0, s79, 21504
    s_add_u32 s83, s99, 688128
    buffer_load_dwordx4 v29, s[52:55], s83 offen lds
    s_add_u32 m0, s79, 22528
    s_add_u32 s83, s99, 720896
    buffer_load_dwordx4 v29, s[52:55], s83 offen lds
    s_add_u32 m0, s79, 23552
    s_add_u32 s83, s99, 753664
    buffer_load_dwordx4 v29, s[52:55], s83 offen lds
    v_and_b32 v251, 7, v1
    v_min_u32 v251, 6, v251
    v_lshlrev_b32 v251, 12, v251
    s_mul_i32 s97, s76, 229376
    s_mul_i32 s81, s3, 28672
    s_add_u32 s97, s97, s81
    s_add_u32 s97, s97, 12586992
    buffer_load_dword v250, v251, s[68:71], s97 offen sc1
    s_waitcnt vmcnt(0)
    v_cmp_eq_u32 vcc, -1, v250
    s_nop 1
    s_cbranch_vccz L_rdy_150
    s_mov_b32 s96, 0
L_spin_151:
    s_mov_b64 exec, vcc
    buffer_load_dword v250, v251, s[68:71], s97 offen sc1
    s_add_u32 s96, s96, 1
    s_waitcnt vmcnt(0)
    v_cmp_eq_u32 vcc, -1, v250
    s_nop 1
    s_cbranch_vccz L_out_152
    s_cmp_lt_u32 s96, 50000
    s_cbranch_scc1 L_spin_151
L_out_152:
    s_mov_b64 exec, -1
L_rdy_150:
    s_waitcnt vmcnt(0)
    s_mul_i32 s100, s76, 229376
    s_mul_i32 s81, s3, 28672
    s_add_u32 s100, s100, s81
    s_add_u32 s100, s100, 12582912
    buffer_load_dwordx4 v[224:227], v6, s[68:71], s100 offen offset:0 sc1
    buffer_load_dwordx4 v[228:231], v6, s[68:71], s100 offen offset:1024 sc1
    buffer_load_dwordx4 v[232:235], v6, s[68:71], s100 offen offset:2048 sc1
    buffer_load_dwordx4 v[236:239], v6, s[68:71], s100 offen offset:3072 sc1
    s_add_u32 s100, s100, 4096
    buffer_load_dwordx4 v[240:243], v6, s[68:71], s100 offen offset:0 sc1
    buffer_load_dwordx4 v[244:247], v6, s[68:71], s100 offen offset:1024 sc1
    buffer_load_dwordx4 v[120:123], v6, s[68:71], s100 offen offset:2048 sc1
    buffer_load_dwordx4 v[124:127], v6, s[68:71], s100 offen offset:3072 sc1
    s_add_u32 s100, s100, 4096
    buffer_load_dwordx4 v[184:187], v6, s[68:71], s100 offen offset:0 sc1
    buffer_load_dwordx4 v[188:191], v6, s[68:71], s100 offen offset:1024 sc1
    buffer_load_dwordx4 v[192:195], v6, s[68:71], s100 offen offset:2048 sc1
    buffer_load_dwordx4 v[196:199], v6, s[68:71], s100 offen offset:3072 sc1
    s_add_u32 s100, s100, 4096
    buffer_load_dwordx4 v[200:203], v6, s[68:71], s100 offen offset:0 sc1
    buffer_load_dwordx4 v[204:207], v6, s[68:71], s100 offen offset:1024 sc1
    buffer_load_dwordx4 v[208:211], v6, s[68:71], s100 offen offset:2048 sc1
    buffer_load_dwordx4 v[212:215], v6, s[68:71], s100 offen offset:3072 sc1
    s_add_u32 s100, s100, 4096
    buffer_load_dwordx4 v[216:219], v6, s[68:71], s100 offen offset:0 sc1
    buffer_load_dwordx4 v[220:223], v6, s[68:71], s100 offen offset:1024 sc1
    s_waitcnt vmcnt(0)
L_p4_117:
    s_lshl_b32 s80, s84, 9
    s_add_u32 s80, s80, s79
    v_add_u32 v249, s80, v3
    s_xor_b32 s80, s80, 512
    v_add_u32 v248, s80, v3
    s_add_u32 s97, s97, 114688
    ds_read_b64_tr_b16 v[160:161], v248 offset:0
    ds_read_b64_tr_b16 v[162:163], v248 offset:1024
    ds_read_b64_tr_b16 v[164:165], v249 offset:0
    ds_read_b64_tr_b16 v[166:167], v249 offset:1024
    ds_read_b64_tr_b16 v[168:169], v248 offset:2048
    ds_read_b64_tr_b16 v[170:171], v248 offset:3072
    s_waitcnt vmcnt(15)
    v_max3_u32 v9, v224, v228, v232
    v_max_u32 v9, v9, v236
    v_cmp_eq_u32 vcc, -1, v9
    s_cbranch_vccnz L_redo_153
L_back_154:
    s_waitcnt lgkmcnt(4)
    v_mfma_f32_32x32x16_bf16 v[144:159], v[224:227], v[160:163], 0
    ds_read_b64_tr_b16 v[172:173], v249 offset:2048
    ds_read_b64_tr_b16 v[174:175], v249 offset:3072
    s_waitcnt lgkmcnt(4)
    v_mfma_f32_32x32x16_bf16 v[128:143], v[224:227], v[164:167], 0
    ds_read_b64_tr_b16 v[160:161], v248 offset:4096
    ds_read_b64_tr_b16 v[162:163], v248 offset:5120
    buffer_load_dwordx4 v[224:227], v6, s[68:71], s100 offen offset:2048 sc1
    s_waitcnt lgkmcnt(4)
    v_mfma_f32_32x32x16_bf16 v[144:159], v[228:231], v[168:171], v[144:159]
    ds_read_b64_tr_b16 v[164:165], v249 offset:4096
    ds_read_b64_tr_b16 v[166:167], v249 offset:5120
    s_waitcnt lgkmcnt(4)
    v_mfma_f32_32x32x16_bf16 v[128:143], v[228:231], v[172:175], v[128:143]
    ds_read_b64_tr_b16 v[168:169], v248 offset:6144
    ds_read_b64_tr_b16 v[170:171], v248 offset:7168
    buffer_load_dwordx4 v[228:231], v6, s[68:71], s100 offen offset:3072 sc1
    s_waitcnt lgkmcnt(4)
    v_mfma_f32_32x32x16_bf16 v[144:159], v[232:235], v[160:163], v[144:159]
    ds_read_b64_tr_b16 v[172:173], v249 offset:6144
    ds_read_b64_tr_b16 v[174:175], v249 offset:7168
    s_waitcnt lgkmcnt(4)
    v_mfma_f32_32x32x16_bf16 v[128:143], v[232:235], v[164:167], v[128:143]
    ds_read_b64_tr_b16 v[160:161], v248 offset:8192
    ds_read_b64_tr_b16 v[162:163], v248 offset:9216
    s_add_u32 s100, s100, 4096
    buffer_load_dwordx4 v[232:235], v6, s[68:71], s100 offen offset:0 sc1
    s_waitcnt lgkmcnt(4)
    v_mfma_f32_32x32x16_bf16 v[144:159], v[236:239], v[168:171], v[144:159]
    ds_read_b64_tr_b16 v[164:165], v249 offset:8192
    ds_read_b64_tr_b16 v[166:167], v249 offset:9216
    s_waitcnt vmcnt(14)
    v_max3_u32 v9, v240, v244, v120
    v_max_u32 v9, v9, v124
    v_cmp_eq_u32 vcc, -1, v9
    s_waitcnt lgkmcnt(4)
    v_mfma_f32_32x32x16_bf16 v[128:143], v[236:239], v[172:175], v[128:143]
    ds_read_b64_tr_b16 v[168:169], v248 offset:10240
    ds_read_b64_tr_b16 v[170:171], v248 offset:11264
    s_cbranch_vccnz L_redo_155
L_back_156:
    buffer_load_dwordx4 v[236:239], v6, s[68:71], s100 offen offset:1024 sc1
    s_waitcnt lgkmcnt(4)
    v_mfma_f32_32x32x16_bf16 v[144:159], v[240:243], v[160:163], v[144:159]
    ds_read_b64_tr_b16 v[172:173], v249 offset:10240
    ds_read_b64_tr_b16 v[174:175], v249 offset:11264
    s_waitcnt lgkmcnt(4)
    v_mfma_f32_32x32x16_bf16 v[128:143], v[240:243], v[164:167], v[128:143]
    ds_read_b64_tr_b16 v[160:161], v248 offset:12288
    ds_read_b64_tr_b16 v[162:163], v248 offset:13312
    buffer_load_dwordx4 v[240:243], v6, s[68:71], s100 offen offset:2048 sc1
    s_waitcnt lgkmcnt(4)
    v_mfma_f32_32x32x16_bf16 v[144:159], v[244:247], v[168:171], v[144:159]
    ds_read_b64_tr_b16 v[164:165], v249 offset:12288
    ds_read_b64_tr_b16 v[166:167], v249 offset:13312
    s_waitcnt lgkmcnt(4)
    v_mfma_f32_32x32x16_bf16 v[128:143], v[244:247], v[172:175], v[128:143]
    ds_read_b64_tr_b16 v[168:169], v248 offset:14336
    ds_read_b64_tr_b16 v[170:171], v248 offset:15360
    buffer_load_dwordx4 v[244:247], v6, s[68:71], s100 offen offset:3072 sc1
    s_waitcnt lgkmcnt(4)
    v_mfma_f32_32x32x16_bf16 v[144:159], v[120:123], v[160:163], v[144:159]
    ds_read_b64_tr_b16 v[172:173], v249 offset:14336
    ds_read_b64_tr_b16 v[174:175], v249 offset:15360
    s_waitcnt lgkmcnt(4)
    v_mfma_f32_32x32x16_bf16 v[128:143], v[120:123], v[164:167], v[128:143]
    ds_read_b64_tr_b16 v[160:161], v248 offset:16384
    ds_read_b64_tr_b16 v[162:163], v248 offset:17408
    s_add_u32 s100, s100, 4096
    buffer_load_dwordx4 v[120:123], v6, s[68:71], s100 offen offset:0 sc1
    s_waitcnt lgkmcnt(4)
    v_mfma_f32_32x32x16_bf16 v[144:159], v[124:127], v[168:171], v[144:159]
    ds_read_b64_tr_b16 v[164:165], v249 offset:16384
    ds_read_b64_tr_b16 v[166:167], v249 offset:17408
    s_waitcnt vmcnt(14)
    v_max3_u32 v9, v184, v188, v192
    v_max_u32 v9, v9, v196
    v_cmp_eq_u32 vcc, -1, v9
    s_waitcnt lgkmcnt(4)
    v_mfma_f32_32x32x16_bf16 v[128:143], v[124:127], v[172:175], v[128:143]
    ds_read_b64_tr_b16 v[168:169], v248 offset:18432
    ds_read_b64_tr_b16 v[170:171], v248 offset:19456
    s_cbranch_vccnz L_redo_157
L_back_158:
    buffer_load_dwordx4 v[124:127], v6, s[68:71], s100 offen offset:1024 sc1
    s_waitcnt lgkmcnt(4)
    v_mfma_f32_32x32x16_bf16 v[144:159], v[184:187], v[160:163], v[144:159]
    ds_read_b64_tr_b16 v[172:173], v249 offset:18432
    ds_read_b64_tr_b16 v[174:175], v249 offset:19456
    s_waitcnt lgkmcnt(4)
    v_mfma_f32_32x32x16_bf16 v[128:143], v[184:187], v[164:167], v[128:143]
    ds_read_b64_tr_b16 v[160:161], v248 offset:20480
    ds_read_b64_tr_b16 v[162:163], v248 offset:21504
    buffer_load_dwordx4 v[184:187], v6, s[68:71], s100 offen offset:2048 sc1
    s_waitcnt lgkmcnt(4)
    v_mfma_f32_32x32x16_bf16 v[144:159], v[188:191], v[168:171], v[144:159]
    ds_read_b64_tr_b16 v[164:165], v249 offset:20480
    ds_read_b64_tr_b16 v[166:167], v249 offset:21504
    s_waitcnt lgkmcnt(4)
    v_mfma_f32_32x32x16_bf16 v[128:143], v[188:191], v[172:175], v[128:143]
    ds_read_b64_tr_b16 v[168:169], v248 offset:22528
    ds_read_b64_tr_b16 v[170:171], v248 offset:23552
    buffer_load_dwordx4 v[188:191], v6, s[68:71], s100 offen offset:3072 sc1
    s_waitcnt lgkmcnt(4)
    v_mfma_f32_32x32x16_bf16 v[144:159], v[192:195], v[160:163], v[144:159]
    ds_read_b64_tr_b16 v[172:173], v249 offset:22528
    ds_read_b64_tr_b16 v[174:175], v249 offset:23552
    s_waitcnt lgkmcnt(4)
    v_mfma_f32_32x32x16_bf16 v[128:143], v[192:195], v[164:167], v[128:143]
    ds_read_b64_tr_b16 v[160:161], v248 offset:24576
    ds_read_b64_tr_b16 v[162:163], v248 offset:25600
    s_waitcnt lgkmcnt(4)
    v_mfma_f32_32x32x16_bf16 v[144:159], v[196:199], v[168:171], v[144:159]
    ds_read_b64_tr_b16 v[164:165], v249 offset:24576
    ds_read_b64_tr_b16 v[166:167], v249 offset:25600
    s_waitcnt vmcnt(13)
    v_max3_u32 v9, v200, v204, v208
    v_max_u32 v9, v9, v212
    v_cmp_eq_u32 vcc, -1, v9
    s_waitcnt lgkmcnt(4)
    v_mfma_f32_32x32x16_bf16 v[128:143], v[196:199], v[172:175], v[128:143]
    ds_read_b64_tr_b16 v[168:169], v248 offset:26624
    ds_read_b64_tr_b16 v[170:171], v248 offset:27648
    s_cbranch_vccnz L_redo_159
L_back_160:
    s_waitcnt lgkmcnt(4)
    v_mfma_f32_32x32x16_bf16 v[144:159], v[200:203], v[160:163], v[144:159]
    ds_read_b64_tr_b16 v[172:173], v249 offset:26624
    ds_read_b64_tr_b16 v[174:175], v249 offset:27648
    s_waitcnt lgkmcnt(4)
    v_mfma_f32_32x32x16_bf16 v[128:143], v[200:203], v[164:167], v[128:143]
    ds_read_b64_tr_b16 v[160:161], v248 offset:28672
    ds_read_b64_tr_b16 v[162:163], v248 offset:29696
    s_waitcnt lgkmcnt(4)
    v_mfma_f32_32x32x16_bf16 v[144:159], v[204:207], v[168:171], v[144:159]
    ds_read_b64_tr_b16 v[164:165], v249 offset:28672
    ds_read_b64_tr_b16 v[166:167], v249 offset:29696
    s_waitcnt lgkmcnt(4)
    v_mfma_f32_32x32x16_bf16 v[128:143], v[204:207], v[172:175], v[128:143]
    ds_read_b64_tr_b16 v[168:169], v248 offset:30720
    ds_read_b64_tr_b16 v[170:171], v248 offset:31744
    s_waitcnt lgkmcnt(4)
    v_mfma_f32_32x32x16_bf16 v[144:159], v[208:211], v[160:163], v[144:159]
    ds_read_b64_tr_b16 v[172:173], v249 offset:30720
    ds_read_b64_tr_b16 v[174:175], v249 offset:31744
    s_waitcnt lgkmcnt(4)
    v_mfma_f32_32x32x16_bf16 v[128:143], v[208:211], v[164:167], v[128:143]
    ds_read_b64_tr_b16 v[160:161], v248 offset:38912
    ds_read_b64_tr_b16 v[162:163], v248 offset:39936
    s_waitcnt lgkmcnt(4)
    v_mfma_f32_32x32x16_bf16 v[144:159], v[212:215], v[168:171], v[144:159]
    ds_read_b64_tr_b16 v[164:165], v249 offset:38912
    ds_read_b64_tr_b16 v[166:167], v249 offset:39936
    s_waitcnt vmcnt(8)
    v_max3_u32 v9, v216, v220, v224
    v_max_u32 v9, v9, v228
    v_cmp_eq_u32 vcc, -1, v9
    s_waitcnt lgkmcnt(4)
    v_mfma_f32_32x32x16_bf16 v[128:143], v[212:215], v[172:175], v[128:143]
    s_cbranch_vccnz L_redo_161
L_back_162:
    s_waitcnt lgkmcnt(2)
    v_mfma_f32_32x32x16_bf16 v[144:159], v[216:219], v[160:163], v[144:159]
    s_waitcnt lgkmcnt(0)
    v_mfma_f32_32x32x16_bf16 v[128:143], v[216:219], v[164:167], v[128:143]
    v_mfma_f32_32x32x16_bf16 v[144:159], v[220:223], v[36:39], v[144:159]
    v_mfma_f32_32x32x16_bf16 v[128:143], v[220:223], v[32:35], v[128:143]
    v_mfma_f32_32x32x16_bf16 v[144:159], v[224:227], v[44:47], v[144:159]
    v_mfma_f32_32x32x16_bf16 v[128:143], v[224:227], v[40:43], v[128:143]
    v_mfma_f32_32x32x16_bf16 v[144:159], v[228:231], v[52:55], v[144:159]
    s_waitcnt vmcnt(4)
    v_max3_u32 v9, v232, v236, v240
    v_max_u32 v9, v9, v244
    v_cmp_eq_u32 vcc, -1, v9
    v_mfma_f32_32x32x16_bf16 v[128:143], v[228:231], v[48:51], v[128:143]
    s_cbranch_vccnz L_redo_163
L_back_164:
    v_mfma_f32_32x32x16_bf16 v[144:159], v[232:235], v[60:63], v[144:159]
    v_mfma_f32_32x32x16_bf16 v[128:143], v[232:235], v[56:59], v[128:143]
    v_mfma_f32_32x32x16_bf16 v[144:159], v[236:239], v[68:71], v[144:159]
    v_mfma_f32_32x32x16_bf16 v[128:143], v[236:239], v[64:67], v[128:143]
    v_mfma_f32_32x32x16_bf16 v[144:159], v[240:243], v[76:79], v[144:159]
    v_mfma_f32_32x32x16_bf16 v[128:143], v[240:243], v[72:75], v[128:143]
    v_mfma_f32_32x32x16_bf16 v[144:159], v[244:247], v[84:87], v[144:159]
    s_waitcnt vmcnt(0)
    v_max3_u32 v9, v120, v124, v184
    v_max_u32 v9, v9, v188
    v_cmp_eq_u32 vcc, -1, v9
    v_mfma_f32_32x32x16_bf16 v[128:143], v[244:247], v[80:83], v[128:143]
    s_cbranch_vccnz L_redo_165
L_back_166:
    v_mfma_f32_32x32x16_bf16 v[144:159], v[120:123], v[92:95], v[144:159]
    v_mfma_f32_32x32x16_bf16 v[144:159], v[124:127], v[100:103], v[144:159]
    v_mfma_f32_32x32x16_bf16 v[144:159], v[184:187], v[108:111], v[144:159]
    v_mfma_f32_32x32x16_bf16 v[144:159], v[188:191], v[116:119], v[144:159]
    v_mfma_f32_32x32x16_bf16 v[128:143], v[120:123], v[88:91], v[128:143]
    v_lshlrev_b32 v176, 16, v20
    v_and_b32 v177, 0xffff0000, v20
    v_lshlrev_b32 v178, 16, v21
    v_and_b32 v179, 0xffff0000, v21
    v_lshlrev_b32 v180, 16, v22
    v_and_b32 v181, 0xffff0000, v22
    v_lshlrev_b32 v182, 16, v23
    v_and_b32 v183, 0xffff0000, v23
    s_mul_i32 s100, s76, 229376
    s_mul_i32 s81, s3, 28672
    s_add_u32 s100, s100, s81
    s_add_u32 s100, s100, 12697600
    buffer_load_dwordx4 v[192:195], v6, s[68:71], s100 offen offset:0 sc1
    buffer_load_dwordx4 v[196:199], v6, s[68:71], s100 offen offset:1024 sc1
    v_mfma_f32_32x32x16_bf16 v[128:143], v[124:127], v[96:99], v[128:143]
    ds_write_b128 v252, v[144:147] offset:0
    buffer_load_dwordx4 v[200:203], v6, s[68:71], s100 offen offset:2048 sc1
    buffer_load_dwordx4 v[204:207], v6, s[68:71], s100 offen offset:3072 sc1
    v_mfma_f32_32x32x16_bf16 v[128:143], v[184:187], v[104:107], v[128:143]
    ds_write_b128 v252, v[148:151] offset:1024
    s_add_u32 s100, s100, 4096
    buffer_load_dwordx4 v[208:211], v6, s[68:71], s100 offen offset:0 sc1
    buffer_load_dwordx4 v[212:215], v6, s[68:71], s100 offen offset:1024 sc1
    v_mfma_f32_32x32x16_bf16 v[128:143], v[188:191], v[112:115], v[128:143]
    ds_write_b128 v252, v[152:155] offset:4096
    ds_read_b64_tr_b16 v[160:161], v248 offset:0
    ds_read_b64_tr_b16 v[162:163], v248 offset:1024
    ds_read_b64_tr_b16 v[164:165], v249 offset:0
    ds_read_b64_tr_b16 v[166:167], v249 offset:1024
    ds_read_b64_tr_b16 v[168:169], v248 offset:2048
    ds_read_b64_tr_b16 v[170:171], v248 offset:3072
    buffer_load_dwordx4 v[216:219], v6, s[68:71], s100 offen offset:2048 sc1
    buffer_load_dwordx4 v[220:223], v6, s[68:71], s100 offen offset:3072 sc1
    ds_write_b128 v252, v[156:159] offset:5120
    s_nop 1
    ds_write_b128 v252, v[136:139] offset:2048
    ds_write_b128 v252, v[140:143] offset:3072
    s_add_u32 s100, s100, 4096
    buffer_load_dwordx4 v[224:227], v6, s[68:71], s100 offen offset:0 sc1
    buffer_load_dwordx4 v[228:231], v6, s[68:71], s100 offen offset:1024 sc1
    buffer_load_dwordx4 v[232:235], v6, s[68:71], s100 offen offset:2048 sc1
    buffer_load_dwordx4 v[236:239], v6, s[68:71], s100 offen offset:3072 sc1
    v_and_b32 v7, 31, v1
    v_lshlrev_b32 v7, 10, v7
    v_lshl_add_u32 v7, v4, 4, v7
    s_lshl_b32 s93, s77, 16
    s_lshl_b32 s81, s84, 15
    s_add_u32 s93, s93, s81
    s_lshl_b32 s81, s76, 7
    s_add_u32 s93, s93, s81
    s_lshl_b32 s81, s85, 5
    s_add_u32 s93, s93, s81
    v_pk_add_f32 v[176:177], v[176:177], v[12:13] op_sel:[0,1] op_sel_hi:[1,1]
    v_pk_add_f32 v[178:179], v[178:179], v[12:13] op_sel:[0,1] op_sel_hi:[1,1]
    v_pk_add_f32 v[180:181], v[180:181], v[12:13] op_sel:[0,1] op_sel_hi:[1,1]
    v_pk_add_f32 v[182:183], v[182:183], v[12:13] op_sel:[0,1] op_sel_hi:[1,1]
    v_pk_add_f32 v[176:177], v[176:177], v[128:129]
    v_pk_add_f32 v[178:179], v[178:179], v[130:131]
    v_pk_add_f32 v[180:181], v[180:181], v[132:133]
    v_pk_add_f32 v[182:183], v[182:183], v[134:135]
    s_waitcnt lgkmcnt(0)
    s_barrier
    ds_read_b128 v[136:139], v253 offset:0
    ds_read_b128 v[140:143], v253 offset:1024
    ds_read_b128 v[144:147], v254 offset:0
    ds_read_b128 v[148:151], v254 offset:1024
    ds_read_b128 v[152:155], v0 offset:0
    ds_read_b128 v[156:159], v0 offset:1024
    s_waitcnt lgkmcnt(4)
    v_pk_add_f32 v[176:177], v[176:177], v[136:137]
    v_pk_add_f32 v[178:179], v[178:179], v[138:139]
    v_pk_add_f32 v[180:181], v[180:181], v[140:141]
    v_pk_add_f32 v[182:183], v[182:183], v[142:143]
    s_waitcnt lgkmcnt(0)
    s_barrier
    v_pk_add_f32 v[144:145], v[144:145], v[152:153]
    v_pk_add_f32 v[146:147], v[146:147], v[154:155]
    v_pk_add_f32 v[148:149], v[148:149], v[156:157]
    v_pk_add_f32 v[150:151], v[150:151], v[158:159]
    v_pk_add_f32 v[176:177], v[176:177], v[144:145]
    v_pk_add_f32 v[178:179], v[178:179], v[146:147]
    v_pk_add_f32 v[180:181], v[180:181], v[148:149]
    v_pk_add_f32 v[182:183], v[182:183], v[150:151]
    v_cvt_pk_bf16_f32 v176, v176, v177
    v_cvt_pk_bf16_f32 v177, v178, v179
    v_cvt_pk_bf16_f32 v178, v180, v181
    v_cvt_pk_bf16_f32 v179, v182, v183
    s_nop 0
    v_permlane32_swap_b32 v176, v178
    v_permlane32_swap_b32 v177, v179
    buffer_store_dwordx4 v[176:179], v7, s[60:63], s93 offen
    s_add_u32 s100, s100, 4096
    buffer_load_dwordx4 v[240:243], v6, s[68:71], s100 offen offset:0 sc1
    buffer_load_dwordx4 v[244:247], v6, s[68:71], s100 offen offset:1024 sc1
    buffer_load_dwordx4 v[120:123], v6, s[68:71], s100 offen offset:2048 sc1
    buffer_load_dwordx4 v[124:127], v6, s[68:71], s100 offen offset:3072 sc1
    s_add_u32 s100, s100, 4096
    buffer_load_dwordx4 v[184:187], v6, s[68:71], s100 offen offset:0 sc1
    buffer_load_dwordx4 v[188:191], v6, s[68:71], s100 offen offset:1024 sc1
    s_waitcnt vmcnt(15)
    v_max3_u32 v9, v192, v196, v200
    v_max_u32 v9, v9, v204
    v_cmp_eq_u32 vcc, -1, v9
    s_cbranch_vccnz L_redo_167
L_back_168:
    v_mfma_f32_32x32x16_bf16 v[144:159], v[192:195], v[160:163], 0
    ds_read_b64_tr_b16 v[172:173], v249 offset:2048
    ds_read_b64_tr_b16 v[174:175], v249 offset:3072
    v_mfma_f32_32x32x16_bf16 v[128:143], v[192:195], v[164:167], 0
    ds_read_b64_tr_b16 v[160:161], v248 offset:4096
    ds_read_b64_tr_b16 v[162:163], v248 offset:5120
    buffer_load_dwordx4 v[192:195], v6, s[68:71], s100 offen offset:2048 sc1
    v_mfma_f32_32x32x16_bf16 v[144:159], v[196:199], v[168:171], v[144:159]
    ds_read_b64_tr_b16 v[164:165], v249 offset:4096
    ds_read_b64_tr_b16 v[166:167], v249 offset:5120
    s_waitcnt lgkmcnt(4)
    v_mfma_f32_32x32x16_bf16 v[128:143], v[196:199], v[172:175], v[128:143]
    ds_read_b64_tr_b16 v[168:169], v248 offset:6144
    ds_read_b64_tr_b16 v[170:171], v248 offset:7168
    buffer_load_dwordx4 v[196:199], v6, s[68:71], s100 offen offset:3072 sc1
    s_waitcnt lgkmcnt(4)
    v_mfma_f32_32x32x16_bf16 v[144:159], v[200:203], v[160:163], v[144:159]
    ds_read_b64_tr_b16 v[172:173], v249 offset:6144
    ds_read_b64_tr_b16 v[174:175], v249 offset:7168
    s_waitcnt lgkmcnt(4)
    v_mfma_f32_32x32x16_bf16 v[128:143], v[200:203], v[164:167], v[128:143]
    ds_read_b64_tr_b16 v[160:161], v248 offset:8192
    ds_read_b64_tr_b16 v[162:163], v248 offset:9216
    s_add_u32 s100, s100, 4096
    buffer_load_dwordx4 v[200:203], v6, s[68:71], s100 offen offset:0 sc1
    s_waitcnt lgkmcnt(4)
    v_mfma_f32_32x32x16_bf16 v[144:159], v[204:207], v[168:171], v[144:159]
    ds_read_b64_tr_b16 v[164:165], v249 offset:8192
    ds_read_b64_tr_b16 v[166:167], v249 offset:9216
    s_waitcnt vmcnt(14)
    v_max3_u32 v9, v208, v212, v216
    v_max_u32 v9, v9, v220
    v_cmp_eq_u32 vcc, -1, v9
    s_waitcnt lgkmcnt(4)
    v_mfma_f32_32x32x16_bf16 v[128:143], v[204:207], v[172:175], v[128:143]
    ds_read_b64_tr_b16 v[168:169], v248 offset:10240
    ds_read_b64_tr_b16 v[170:171], v248 offset:11264
    s_cbranch_vccnz L_redo_169
L_back_170:
    buffer_load_dwordx4 v[204:207], v6, s[68:71], s100 offen offset:1024 sc1
    s_waitcnt lgkmcnt(4)
    v_mfma_f32_32x32x16_bf16 v[144:159], v[208:211], v[160:163], v[144:159]
    ds_read_b64_tr_b16 v[172:173], v249 offset:10240
    ds_read_b64_tr_b16 v[174:175], v249 offset:11264
    s_waitcnt lgkmcnt(4)
    v_mfma_f32_32x32x16_bf16 v[128:143], v[208:211], v[164:167], v[128:143]
    ds_read_b64_tr_b16 v[160:161], v248 offset:12288
    ds_read_b64_tr_b16 v[162:163], v248 offset:13312
    buffer_load_dwordx4 v[208:211], v6, s[68:71], s100 offen offset:2048 sc1
    s_waitcnt lgkmcnt(4)
    v_mfma_f32_32x32x16_bf16 v[144:159], v[212:215], v[168:171], v[144:159]
    ds_read_b64_tr_b16 v[164:165], v249 offset:12288
    ds_read_b64_tr_b16 v[166:167], v249 offset:13312
    s_waitcnt lgkmcnt(4)
    v_mfma_f32_32x32x16_bf16 v[128:143], v[212:215], v[172:175], v[128:143]
    ds_read_b64_tr_b16 v[168:169], v248 offset:14336
    ds_read_b64_tr_b16 v[170:171], v248 offset:15360
    buffer_load_dwordx4 v[212:215], v6, s[68:71], s100 offen offset:3072 sc1
    s_waitcnt lgkmcnt(4)
    v_mfma_f32_32x32x16_bf16 v[144:159], v[216:219], v[160:163], v[144:159]
    ds_read_b64_tr_b16 v[172:173], v249 offset:14336
    ds_read_b64_tr_b16 v[174:175], v249 offset:15360
    s_waitcnt lgkmcnt(4)
    v_mfma_f32_32x32x16_bf16 v[128:143], v[216:219], v[164:167], v[128:143]
    ds_read_b64_tr_b16 v[160:161], v248 offset:16384
    ds_read_b64_tr_b16 v[162:163], v248 offset:17408
    s_add_u32 s100, s100, 4096
    buffer_load_dwordx4 v[216:219], v6, s[68:71], s100 offen offset:0 sc1
    s_waitcnt lgkmcnt(4)
    v_mfma_f32_32x32x16_bf16 v[144:159], v[220:223], v[168:171], v[144:159]
    ds_read_b64_tr_b16 v[164:165], v249 offset:16384
    ds_read_b64_tr_b16 v[166:167], v249 offset:17408
    s_waitcnt vmcnt(14)
    v_max3_u32 v9, v224, v228, v232
    v_max_u32 v9, v9, v236
    v_cmp_eq_u32 vcc, -1, v9
    s_waitcnt lgkmcnt(4)
    v_mfma_f32_32x32x16_bf16 v[128:143], v[220:223], v[172:175], v[128:143]
    ds_read_b64_tr_b16 v[168:169], v248 offset:18432
    ds_read_b64_tr_b16 v[170:171], v248 offset:19456
    s_cbranch_vccnz L_redo_171
L_back_172:
    buffer_load_dwordx4 v[220:223], v6, s[68:71], s100 offen offset:1024 sc1
    s_waitcnt lgkmcnt(4)
    v_mfma_f32_32x32x16_bf16 v[144:159], v[224:227], v[160:163], v[144:159]
    ds_read_b64_tr_b16 v[172:173], v249 offset:18432
    ds_read_b64_tr_b16 v[174:175], v249 offset:19456
    s_waitcnt lgkmcnt(4)
    v_mfma_f32_32x32x16_bf16 v[128:143], v[224:227], v[164:167], v[128:143]
    ds_read_b64_tr_b16 v[160:161], v248 offset:20480
    ds_read_b64_tr_b16 v[162:163], v248 offset:21504
    buffer_load_dwordx4 v[224:227], v6, s[68:71], s100 offen offset:2048 sc1
    s_waitcnt lgkmcnt(4)
    v_mfma_f32_32x32x16_bf16 v[144:159], v[228:231], v[168:171], v[144:159]
    ds_read_b64_tr_b16 v[164:165], v249 offset:20480
    ds_read_b64_tr_b16 v[166:167], v249 offset:21504
    s_waitcnt lgkmcnt(4)
    v_mfma_f32_32x32x16_bf16 v[128:143], v[228:231], v[172:175], v[128:143]
    ds_read_b64_tr_b16 v[168:169], v248 offset:22528
    ds_read_b64_tr_b16 v[170:171], v248 offset:23552
    buffer_load_dwordx4 v[228:231], v6, s[68:71], s100 offen offset:3072 sc1
    s_waitcnt lgkmcnt(4)
    v_mfma_f32_32x32x16_bf16 v[144:159], v[232:235], v[160:163], v[144:159]
    ds_read_b64_tr_b16 v[172:173], v249 offset:22528
    ds_read_b64_tr_b16 v[174:175], v249 offset:23552
    s_waitcnt lgkmcnt(4)
    v_mfma_f32_32x32x16_bf16 v[128:143], v[232:235], v[164:167], v[128:143]
    ds_read_b64_tr_b16 v[160:161], v248 offset:24576
    ds_read_b64_tr_b16 v[162:163], v248 offset:25600
    s_waitcnt lgkmcnt(4)
    v_mfma_f32_32x32x16_bf16 v[144:159], v[236:239], v[168:171], v[144:159]
    ds_read_b64_tr_b16 v[164:165], v249 offset:24576
    ds_read_b64_tr_b16 v[166:167], v249 offset:25600
    s_waitcnt vmcnt(12)
    v_max3_u32 v9, v240, v244, v120
    v_max_u32 v9, v9, v124
    v_cmp_eq_u32 vcc, -1, v9
    s_waitcnt lgkmcnt(4)
    v_mfma_f32_32x32x16_bf16 v[128:143], v[236:239], v[172:175], v[128:143]
    ds_read_b64_tr_b16 v[168:169], v248 offset:26624
    ds_read_b64_tr_b16 v[170:171], v248 offset:27648
    s_cbranch_vccnz L_redo_173
L_back_174:
    s_waitcnt lgkmcnt(4)
    v_mfma_f32_32x32x16_bf16 v[144:159], v[240:243], v[160:163], v[144:159]
    ds_read_b64_tr_b16 v[172:173], v249 offset:26624
    ds_read_b64_tr_b16 v[174:175], v249 offset:27648
    s_waitcnt lgkmcnt(4)
    v_mfma_f32_32x32x16_bf16 v[128:143], v[240:243], v[164:167], v[128:143]
    ds_read_b64_tr_b16 v[160:161], v248 offset:28672
    ds_read_b64_tr_b16 v[162:163], v248 offset:29696
    s_waitcnt lgkmcnt(4)
    v_mfma_f32_32x32x16_bf16 v[144:159], v[244:247], v[168:171], v[144:159]
    ds_read_b64_tr_b16 v[164:165], v249 offset:28672
    ds_read_b64_tr_b16 v[166:167], v249 offset:29696
    s_waitcnt lgkmcnt(4)
    v_mfma_f32_32x32x16_bf16 v[128:143], v[244:247], v[172:175], v[128:143]
    ds_read_b64_tr_b16 v[168:169], v248 offset:30720
    ds_read_b64_tr_b16 v[170:171], v248 offset:31744
    s_waitcnt lgkmcnt(4)
    v_mfma_f32_32x32x16_bf16 v[144:159], v[120:123], v[160:163], v[144:159]
    ds_read_b64_tr_b16 v[172:173], v249 offset:30720
    ds_read_b64_tr_b16 v[174:175], v249 offset:31744
    s_waitcnt lgkmcnt(4)
    v_mfma_f32_32x32x16_bf16 v[128:143], v[120:123], v[164:167], v[128:143]
    ds_read_b64_tr_b16 v[160:161], v248 offset:38912
    ds_read_b64_tr_b16 v[162:163], v248 offset:39936
    s_waitcnt lgkmcnt(4)
    v_mfma_f32_32x32x16_bf16 v[144:159], v[124:127], v[168:171], v[144:159]
    ds_read_b64_tr_b16 v[164:165], v249 offset:38912
    ds_read_b64_tr_b16 v[166:167], v249 offset:39936
    s_waitcnt vmcnt(8)
    v_max3_u32 v9, v184, v188, v192
    v_max_u32 v9, v9, v196
    v_cmp_eq_u32 vcc, -1, v9
    s_waitcnt lgkmcnt(4)
    v_mfma_f32_32x32x16_bf16 v[128:143], v[124:127], v[172:175], v[128:143]
    s_cbranch_vccnz L_redo_175
L_back_176:
    s_waitcnt lgkmcnt(2)
    v_mfma_f32_32x32x16_bf16 v[144:159], v[184:187], v[160:163], v[144:159]
    s_waitcnt lgkmcnt(0)
    v_mfma_f32_32x32x16_bf16 v[128:143], v[184:187], v[164:167], v[128:143]
    v_mfma_f32_32x32x16_bf16 v[144:159], v[188:191], v[36:39], v[144:159]
    v_mfma_f32_32x32x16_bf16 v[128:143], v[188:191], v[32:35], v[128:143]
    v_mfma_f32_32x32x16_bf16 v[144:159], v[192:195], v[44:47], v[144:159]
    v_mfma_f32_32x32x16_bf16 v[128:143], v[192:195], v[40:43], v[128:143]
    v_mfma_f32_32x32x16_bf16 v[144:159], v[196:199], v[52:55], v[144:159]
    s_waitcnt vmcnt(4)
    v_max3_u32 v9, v200, v204, v208
    v_max_u32 v9, v9, v212
    v_cmp_eq_u32 vcc, -1, v9
    v_mfma_f32_32x32x16_bf16 v[128:143], v[196:199], v[48:51], v[128:143]
    s_cbranch_vccnz L_redo_177
L_back_178:
    v_mfma_f32_32x32x16_bf16 v[144:159], v[200:203], v[60:63], v[144:159]
    v_mfma_f32_32x32x16_bf16 v[128:143], v[200:203], v[56:59], v[128:143]
    v_mfma_f32_32x32x16_bf16 v[144:159], v[204:207], v[68:71], v[144:159]
    v_mfma_f32_32x32x16_bf16 v[128:143], v[204:207], v[64:67], v[128:143]
    v_mfma_f32_32x32x16_bf16 v[144:159], v[208:211], v[76:79], v[144:159]
    v_mfma_f32_32x32x16_bf16 v[128:143], v[208:211], v[72:75], v[128:143]
    v_mfma_f32_32x32x16_bf16 v[144:159], v[212:215], v[84:87], v[144:159]
    s_waitcnt vmcnt(0)
    v_max3_u32 v9, v216, v220, v224
    v_max_u32 v9, v9, v228
    v_cmp_eq_u32 vcc, -1, v9
    v_mfma_f32_32x32x16_bf16 v[128:143], v[212:215], v[80:83], v[128:143]
    s_cbranch_vccnz L_redo_179
L_back_180:
    v_mfma_f32_32x32x16_bf16 v[144:159], v[216:219], v[92:95], v[144:159]
    v_mfma_f32_32x32x16_bf16 v[144:159], v[220:223], v[100:103], v[144:159]
    v_mfma_f32_32x32x16_bf16 v[144:159], v[224:227], v[108:111], v[144:159]
    v_mfma_f32_32x32x16_bf16 v[144:159], v[228:231], v[116:119], v[144:159]
    v_mfma_f32_32x32x16_bf16 v[128:143], v[216:219], v[88:91], v[128:143]
    v_lshlrev_b32 v176, 16, v24
    v_and_b32 v177, 0xffff0000, v24
    v_lshlrev_b32 v178, 16, v25
    v_and_b32 v179, 0xffff0000, v25
    v_lshlrev_b32 v180, 16, v26
    v_and_b32 v181, 0xffff0000, v26
    v_lshlrev_b32 v182, 16, v27
    v_and_b32 v183, 0xffff0000, v27
    v_mfma_f32_32x32x16_bf16 v[128:143], v[220:223], v[96:99], v[128:143]
    s_nop 1
    ds_write_b128 v252, v[144:147] offset:0
    v_mfma_f32_32x32x16_bf16 v[128:143], v[224:227], v[104:107], v[128:143]
    ds_write_b128 v252, v[148:151] offset:1024
    v_mfma_f32_32x32x16_bf16 v[128:143], v[228:231], v[112:115], v[128:143]
    ds_write_b128 v252, v[152:155] offset:4096
    ds_write_b128 v252, v[156:159] offset:5120
    s_nop 9
    ds_write_b128 v252, v[136:139] offset:2048
    ds_write_b128 v252, v[140:143] offset:3072
    v_and_b32 v7, 31, v1
    v_lshlrev_b32 v7, 10, v7
    v_lshl_add_u32 v7, v4, 4, v7
    s_lshl_b32 s93, s77, 16
    s_lshl_b32 s81, s84, 15
    s_add_u32 s93, s93, s81
    s_lshl_b32 s81, s76, 7
    s_add_u32 s93, s93, s81
    s_lshl_b32 s81, s85, 5
    s_add_u32 s93, s93, s81
    s_add_u32 s93, s93, 64
    v_pk_add_f32 v[176:177], v[176:177], v[12:13] op_sel:[0,1] op_sel_hi:[1,1]
    v_pk_add_f32 v[178:179], v[178:179], v[12:13] op_sel:[0,1] op_sel_hi:[1,1]
    v_pk_add_f32 v[180:181], v[180:181], v[12:13] op_sel:[0,1] op_sel_hi:[1,1]
    v_pk_add_f32 v[182:183], v[182:183], v[12:13] op_sel:[0,1] op_sel_hi:[1,1]
    v_pk_add_f32 v[176:177], v[176:177], v[128:129]
    v_pk_add_f32 v[178:179], v[178:179], v[130:131]
    v_pk_add_f32 v[180:181], v[180:181], v[132:133]
    v_pk_add_f32 v[182:183], v[182:183], v[134:135]
    s_waitcnt lgkmcnt(0)
    s_barrier
    ds_read_b128 v[136:139], v253 offset:0
    ds_read_b128 v[140:143], v253 offset:1024
    ds_read_b128 v[144:147], v254 offset:0
    ds_read_b128 v[148:151], v254 offset:1024
    ds_read_b128 v[152:155], v0 offset:0
    ds_read_b128 v[156:159], v0 offset:1024
    s_waitcnt lgkmcnt(4)
    v_pk_add_f32 v[176:177], v[176:177], v[136:137]
    v_pk_add_f32 v[178:179], v[178:179], v[138:139]
    v_pk_add_f32 v[180:181], v[180:181], v[140:141]
    v_pk_add_f32 v[182:183], v[182:183], v[142:143]
    s_waitcnt lgkmcnt(0)
    v_pk_add_f32 v[144:145], v[144:145], v[152:153]
    v_pk_add_f32 v[146:147], v[146:147], v[154:155]
    v_pk_add_f32 v[148:149], v[148:149], v[156:157]
    v_pk_add_f32 v[150:151], v[150:151], v[158:159]
    v_pk_add_f32 v[176:177], v[176:177], v[144:145]
    v_pk_add_f32 v[178:179], v[178:179], v[146:147]
    v_pk_add_f32 v[180:181], v[180:181], v[148:149]
    v_pk_add_f32 v[182:183], v[182:183], v[150:151]
    v_cvt_pk_bf16_f32 v176, v176, v177
    v_cvt_pk_bf16_f32 v177, v178, v179
    v_cvt_pk_bf16_f32 v178, v180, v181
    v_cvt_pk_bf16_f32 v179, v182, v183
    s_nop 0
    v_permlane32_swap_b32 v176, v178
    v_permlane32_swap_b32 v177, v179
    buffer_store_dwordx4 v[176:179], v7, s[60:63], s93 offen
    s_waitcnt vmcnt(0)
    s_nop 0
L_end:
    s_endpgm
L_redo_7:
    s_nop 15
    s_mov_b32 s96, 0
L_redo_7_l:
    s_xor_b32 s80, s84, 0
    s_lshl_b32 s82, s77, 16
    s_lshl_b32 s81, s80, 15
    s_add_u32 s82, s82, s81
    s_lshl_b32 s81, s3, 13
    s_add_u32 s82, s82, s81
    s_add_u32 s82, s82, 2097152
    buffer_load_dwordx4 v[32:35], v2, s[68:71], s82 offen offset:0 sc1
    buffer_load_dwordx4 v[36:39], v2, s[68:71], s82 offen offset:1024 sc1
    s_xor_b32 s80, s84, 1
    s_lshl_b32 s82, s77, 16
    s_lshl_b32 s81, s80, 15
    s_add_u32 s82, s82, s81
    s_lshl_b32 s81, s3, 13
    s_add_u32 s82, s82, s81
    s_add_u32 s82, s82, 2097152
    buffer_load_dwordx4 v[64:67], v2, s[68:71], s82 offen offset:0 sc1
    buffer_load_dwordx4 v[68:71], v2, s[68:71], s82 offen offset:1024 sc1
    s_add_u32 s96, s96, 1
    s_waitcnt vmcnt(0)
    v_max3_u32 v9, v32, v64, v36
    v_max_u32 v9, v9, v68
    v_cmp_eq_u32 vcc, -1, v9
    s_nop 1
    s_cbranch_vccz L_redo_7_x
    s_cmp_lt_u32 s96, 50000
    s_cbranch_scc1 L_redo_7_l
L_redo_7_x:
    s_nop 3
    s_branch L_back_8

L_redo_9:
    s_nop 15
    s_mov_b32 s96, 0
L_redo_9_l:
    s_xor_b32 s80, s84, 0
    s_lshl_b32 s82, s77, 16
    s_lshl_b32 s81, s80, 15
    s_add_u32 s82, s82, s81
    s_lshl_b32 s81, s3, 13
    s_add_u32 s82, s82, s81
    s_add_u32 s82, s82, 2099200
    buffer_load_dwordx4 v[40:43], v2, s[68:71], s82 offen offset:0 sc1
    buffer_load_dwordx4 v[44:47], v2, s[68:71], s82 offen offset:1024 sc1
    s_xor_b32 s80, s84, 1
    s_lshl_b32 s82, s77, 16
    s_lshl_b32 s81, s80, 15
    s_add_u32 s82, s82, s81
    s_lshl_b32 s81, s3, 13
    s_add_u32 s82, s82, s81
    s_add_u32 s82, s82, 2099200
    buffer_load_dwordx4 v[72:75], v2, s[68:71], s82 offen offset:0 sc1
    buffer_load_dwordx4 v[76:79], v2, s[68:71], s82 offen offset:1024 sc1
    s_add_u32 s96, s96, 1
    s_waitcnt vmcnt(0)
    v_max3_u32 v9, v40, v72, v44
    v_max_u32 v9, v9, v76
    v_cmp_eq_u32 vcc, -1, v9
    s_nop 1
    s_cbranch_vccz L_redo_9_x
    s_cmp_lt_u32 s96, 50000
    s_cbranch_scc1 L_redo_9_l
L_redo_9_x:
    s_nop 3
    s_branch L_back_10

L_redo_11:
    s_nop 15
    s_mov_b32 s96, 0
L_redo_11_l:
    s_xor_b32 s80, s84, 0
    s_lshl_b32 s82, s77, 16
    s_lshl_b32 s81, s80, 15
    s_add_u32 s82, s82, s81
    s_lshl_b32 s81, s3, 13
    s_add_u32 s82, s82, s81
    s_add_u32 s82, s82, 2101248
    buffer_load_dwordx4 v[48:51], v2, s[68:71], s82 offen offset:0 sc1
    buffer_load_dwordx4 v[52:55], v2, s[68:71], s82 offen offset:1024 sc1
    s_xor_b32 s80, s84, 1
    s_lshl_b32 s82, s77, 16
    s_lshl_b32 s81, s80, 15
    s_add_u32 s82, s82, s81
    s_lshl_b32 s81, s3, 13
    s_add_u32 s82, s82, s81
    s_add_u32 s82, s82, 2101248
    buffer_load_dwordx4 v[80:83], v2, s[68:71], s82 offen offset:0 sc1
    buffer_load_dwordx4 v[84:87], v2, s[68:71], s82 offen offset:1024 sc1
    s_add_u32 s96, s96, 1
    s_waitcnt vmcnt(0)
    v_max3_u32 v9, v48, v80, v52
    v_max_u32 v9, v9, v84
    v_cmp_eq_u32 vcc, -1, v9
    s_nop 1
    s_cbranch_vccz L_redo_11_x
    s_cmp_lt_u32 s96, 50000
    s_cbranch_scc1 L_redo_11_l
L_redo_11_x:
    s_nop 3
    s_branch L_back_12

L_redo_13:
    s_nop 15
    s_mov_b32 s96, 0
L_redo_13_l:
    s_xor_b32 s80, s84, 0
    s_lshl_b32 s82, s77, 16
    s_lshl_b32 s81, s80, 15
    s_add_u32 s82, s82, s81
    s_lshl_b32 s81, s3, 13
    s_add_u32 s82, s82, s81
    s_add_u32 s82, s82, 2103296
    buffer_load_dwordx4 v[56:59], v2, s[68:71], s82 offen offset:0 sc1
    buffer_load_dwordx4 v[60:63], v2, s[68:71], s82 offen offset:1024 sc1
    s_xor_b32 s80, s84, 1
    s_lshl_b32 s82, s77, 16
    s_lshl_b32 s81, s80, 15
    s_add_u32 s82, s82, s81
    s_lshl_b32 s81, s3, 13
    s_add_u32 s82, s82, s81
    s_add_u32 s82, s82, 2103296
    buffer_load_dwordx4 v[88:91], v2, s[68:71], s82 offen offset:0 sc1
    buffer_load_dwordx4 v[92:95], v2, s[68:71], s82 offen offset:1024 sc1
    s_add_u32 s96, s96, 1
    s_waitcnt vmcnt(0)
    v_max3_u32 v9, v56, v88, v60
    v_max_u32 v9, v9, v92
    v_cmp_eq_u32 vcc, -1, v9
    s_nop 1
    s_cbranch_vccz L_redo_13_x
    s_cmp_lt_u32 s96, 50000
    s_cbranch_scc1 L_redo_13_l
L_redo_13_x:
    s_nop 3
    s_branch L_back_14

L_redo_19:
    s_nop 15
    s_mov_b32 s96, 0
L_redo_19_l:
    s_lshl_b32 s80, s75, 18
    s_lshl_b32 s81, s3, 15
    s_add_u32 s80, s80, s81
    s_add_u32 s80, s80, 6291456
    buffer_load_dwordx4 v[184:187], v2, s[68:71], s80 offen offset:0 sc1
    buffer_load_dwordx4 v[188:191], v2, s[68:71], s80 offen offset:1024 sc1
    buffer_load_dwordx4 v[192:195], v2, s[68:71], s80 offen offset:2048 sc1
    buffer_load_dwordx4 v[196:199], v2, s[68:71], s80 offen offset:3072 sc1
    s_lshl_b32 s80, s75, 18
    s_lshl_b32 s81, s3, 15
    s_add_u32 s80, s80, s81
    s_add_u32 s80, s80, 6295552
    buffer_load_dwordx4 v[200:203], v2, s[68:71], s80 offen offset:0 sc1
    buffer_load_dwordx4 v[204:207], v2, s[68:71], s80 offen offset:1024 sc1
    buffer_load_dwordx4 v[208:211], v2, s[68:71], s80 offen offset:2048 sc1
    buffer_load_dwordx4 v[212:215], v2, s[68:71], s80 offen offset:3072 sc1
    s_lshl_b32 s80, s75, 18
    s_lshl_b32 s81, s3, 15
    s_add_u32 s80, s80, s81
    s_add_u32 s80, s80, 6299648
    buffer_load_dwordx4 v[216:219], v2, s[68:71], s80 offen offset:0 sc1
    buffer_load_dwordx4 v[220:223], v2, s[68:71], s80 offen offset:1024 sc1
    buffer_load_dwordx4 v[224:227], v2, s[68:71], s80 offen offset:2048 sc1
    buffer_load_dwordx4 v[228:231], v2, s[68:71], s80 offen offset:3072 sc1
    s_lshl_b32 s80, s75, 18
    s_lshl_b32 s81, s3, 15
    s_add_u32 s80, s80, s81
    s_add_u32 s80, s80, 6303744
    buffer_load_dwordx4 v[232:235], v2, s[68:71], s80 offen offset:0 sc1
    buffer_load_dwordx4 v[236:239], v2, s[68:71], s80 offen offset:1024 sc1
    buffer_load_dwordx4 v[240:243], v2, s[68:71], s80 offen offset:2048 sc1
    buffer_load_dwordx4 v[244:247], v2, s[68:71], s80 offen offset:3072 sc1
    s_lshl_b32 s80, s75, 18
    s_lshl_b32 s81, s3, 15
    s_add_u32 s80, s80, s81
    s_add_u32 s80, s80, 6307840
    buffer_load_dwordx4 v[120:123], v2, s[68:71], s80 offen offset:0 sc1
    buffer_load_dwordx4 v[124:127], v2, s[68:71], s80 offen offset:1024 sc1
    s_add_u32 s96, s96, 1
    s_waitcnt vmcnt(0)
    v_max3_u32 v9, v184, v188, v192
    v_max_u32 v9, v9, v196
    v_cmp_eq_u32 vcc, -1, v9
    s_nop 1
    s_cbranch_vccz L_redo_19_x
    s_cmp_lt_u32 s96, 50000
    s_cbranch_scc1 L_redo_19_l
L_redo_19_x:
    s_nop 3
    s_branch L_back_20

L_redo_21:
    s_nop 15
    s_mov_b32 s96, 0
L_redo_21_l:
    s_lshl_b32 s80, s75, 18
    s_lshl_b32 s81, s3, 15
    s_add_u32 s80, s80, s81
    s_add_u32 s80, s80, 6295552
    buffer_load_dwordx4 v[200:203], v2, s[68:71], s80 offen offset:0 sc1
    buffer_load_dwordx4 v[204:207], v2, s[68:71], s80 offen offset:1024 sc1
    buffer_load_dwordx4 v[208:211], v2, s[68:71], s80 offen offset:2048 sc1
    buffer_load_dwordx4 v[212:215], v2, s[68:71], s80 offen offset:3072 sc1
    s_lshl_b32 s80, s75, 18
    s_lshl_b32 s81, s3, 15
    s_add_u32 s80, s80, s81
    s_add_u32 s80, s80, 6299648
    buffer_load_dwordx4 v[216:219], v2, s[68:71], s80 offen offset:0 sc1
    buffer_load_dwordx4 v[220:223], v2, s[68:71], s80 offen offset:1024 sc1
    buffer_load_dwordx4 v[224:227], v2, s[68:71], s80 offen offset:2048 sc1
    buffer_load_dwordx4 v[228:231], v2, s[68:71], s80 offen offset:3072 sc1
    s_lshl_b32 s80, s75, 18
    s_lshl_b32 s81, s3, 15
    s_add_u32 s80, s80, s81
    s_add_u32 s80, s80, 6303744
    buffer_load_dwordx4 v[232:235], v2, s[68:71], s80 offen offset:0 sc1
    buffer_load_dwordx4 v[236:239], v2, s[68:71], s80 offen offset:1024 sc1
    buffer_load_dwordx4 v[240:243], v2, s[68:71], s80 offen offset:2048 sc1
    buffer_load_dwordx4 v[244:247], v2, s[68:71], s80 offen offset:3072 sc1
    s_lshl_b32 s80, s75, 18
    s_lshl_b32 s81, s3, 15
    s_add_u32 s80, s80, s81
    s_add_u32 s80, s80, 6307840
    buffer_load_dwordx4 v[120:123], v2, s[68:71], s80 offen offset:0 sc1
    buffer_load_dwordx4 v[124:127], v2, s[68:71], s80 offen offset:1024 sc1
    buffer_load_dwordx4 v[184:187], v2, s[68:71], s80 offen offset:2048 sc1
    buffer_load_dwordx4 v[188:191], v2, s[68:71], s80 offen offset:3072 sc1
    s_lshl_b32 s80, s75, 18
    s_lshl_b32 s81, s3, 15
    s_add_u32 s80, s80, s81
    s_add_u32 s80, s80, 6311936
    buffer_load_dwordx4 v[192:195], v2, s[68:71], s80 offen offset:0 sc1
    s_add_u32 s96, s96, 1
    s_waitcnt vmcnt(0)
    v_max3_u32 v9, v200, v204, v208
    v_max_u32 v9, v9, v212
    v_cmp_eq_u32 vcc, -1, v9
    s_nop 1
    s_cbranch_vccz L_redo_21_x
    s_cmp_lt_u32 s96, 50000
    s_cbranch_scc1 L_redo_21_l
L_redo_21_x:
    s_nop 3
    s_branch L_back_22

L_redo_23:
    s_nop 15
    s_mov_b32 s96, 0
L_redo_23_l:
    s_lshl_b32 s80, s75, 18
    s_lshl_b32 s81, s3, 15
    s_add_u32 s80, s80, s81
    s_add_u32 s80, s80, 6299648
    buffer_load_dwordx4 v[216:219], v2, s[68:71], s80 offen offset:0 sc1
    buffer_load_dwordx4 v[220:223], v2, s[68:71], s80 offen offset:1024 sc1
    buffer_load_dwordx4 v[224:227], v2, s[68:71], s80 offen offset:2048 sc1
    buffer_load_dwordx4 v[228:231], v2, s[68:71], s80 offen offset:3072 sc1
    s_lshl_b32 s80, s75, 18
    s_lshl_b32 s81, s3, 15
    s_add_u32 s80, s80, s81
    s_add_u32 s80, s80, 6303744
    buffer_load_dwordx4 v[232:235], v2, s[68:71], s80 offen offset:0 sc1
    buffer_load_dwordx4 v[236:239], v2, s[68:71], s80 offen offset:1024 sc1
    buffer_load_dwordx4 v[240:243], v2, s[68:71], s80 offen offset:2048 sc1
    buffer_load_dwordx4 v[244:247], v2, s[68:71], s80 offen offset:3072 sc1
    s_lshl_b32 s80, s75, 18
    s_lshl_b32 s81, s3, 15
    s_add_u32 s80, s80, s81
    s_add_u32 s80, s80, 6307840
    buffer_load_dwordx4 v[120:123], v2, s[68:71], s80 offen offset:0 sc1
    buffer_load_dwordx4 v[124:127], v2, s[68:71], s80 offen offset:1024 sc1
    buffer_load_dwordx4 v[184:187], v2, s[68:71], s80 offen offset:2048 sc1
    buffer_load_dwordx4 v[188:191], v2, s[68:71], s80 offen offset:3072 sc1
    s_lshl_b32 s80, s75, 18
    s_lshl_b32 s81, s3, 15
    s_add_u32 s80, s80, s81
    s_add_u32 s80, s80, 6311936
    buffer_load_dwordx4 v[192:195], v2, s[68:71], s80 offen offset:0 sc1
    buffer_load_dwordx4 v[196:199], v2, s[68:71], s80 offen offset:1024 sc1
    buffer_load_dwordx4 v[200:203], v2, s[68:71], s80 offen offset:2048 sc1
    buffer_load_dwordx4 v[204:207], v2, s[68:71], s80 offen offset:3072 sc1
    s_lshl_b32 s80, s75, 18
    s_lshl_b32 s81, s3, 15
    s_add_u32 s80, s80, s81
    s_add_u32 s80, s80, 6316032
    buffer_load_dwordx4 v[208:211], v2, s[68:71], s80 offen offset:0 sc1
    s_add_u32 s96, s96, 1
    s_waitcnt vmcnt(0)
    v_max3_u32 v9, v216, v220, v224
    v_max_u32 v9, v9, v228
    v_cmp_eq_u32 vcc, -1, v9
    s_nop 1
    s_cbranch_vccz L_redo_23_x
    s_cmp_lt_u32 s96, 50000
    s_cbranch_scc1 L_redo_23_l
L_redo_23_x:
    s_nop 3
    s_branch L_back_24

L_redo_25:
    s_nop 15
    s_mov_b32 s96, 0
L_redo_25_l:
    s_lshl_b32 s80, s75, 18
    s_lshl_b32 s81, s3, 15
    s_add_u32 s80, s80, s81
    s_add_u32 s80, s80, 6303744
    buffer_load_dwordx4 v[232:235], v2, s[68:71], s80 offen offset:0 sc1
    buffer_load_dwordx4 v[236:239], v2, s[68:71], s80 offen offset:1024 sc1
    buffer_load_dwordx4 v[240:243], v2, s[68:71], s80 offen offset:2048 sc1
    buffer_load_dwordx4 v[244:247], v2, s[68:71], s80 offen offset:3072 sc1
    s_lshl_b32 s80, s75, 18
    s_lshl_b32 s81, s3, 15
    s_add_u32 s80, s80, s81
    s_add_u32 s80, s80, 6307840
    buffer_load_dwordx4 v[120:123], v2, s[68:71], s80 offen offset:0 sc1
    buffer_load_dwordx4 v[124:127], v2, s[68:71], s80 offen offset:1024 sc1
    buffer_load_dwordx4 v[184:187], v2, s[68:71], s80 offen offset:2048 sc1
    buffer_load_dwordx4 v[188:191], v2, s[68:71], s80 offen offset:3072 sc1
    s_lshl_b32 s80, s75, 18
    s_lshl_b32 s81, s3, 15
    s_add_u32 s80, s80, s81
    s_add_u32 s80, s80, 6311936
    buffer_load_dwordx4 v[192:195], v2, s[68:71], s80 offen offset:0 sc1
    buffer_load_dwordx4 v[196:199], v2, s[68:71], s80 offen offset:1024 sc1
    buffer_load_dwordx4 v[200:203], v2, s[68:71], s80 offen offset:2048 sc1
    buffer_load_dwordx4 v[204:207], v2, s[68:71], s80 offen offset:3072 sc1
    s_lshl_b32 s80, s75, 18
    s_lshl_b32 s81, s3, 15
    s_add_u32 s80, s80, s81
    s_add_u32 s80, s80, 6316032
    buffer_load_dwordx4 v[208:211], v2, s[68:71], s80 offen offset:0 sc1
    buffer_load_dwordx4 v[212:215], v2, s[68:71], s80 offen offset:1024 sc1
    buffer_load_dwordx4 v[216:219], v2, s[68:71], s80 offen offset:2048 sc1
    buffer_load_dwordx4 v[220:223], v2, s[68:71], s80 offen offset:3072 sc1
    s_lshl_b32 s80, s75, 18
    s_lshl_b32 s81, s3, 15
    s_add_u32 s80, s80, s81
    s_add_u32 s80, s80, 6320128
    buffer_load_dwordx4 v[224:227], v2, s[68:71], s80 offen offset:0 sc1
    s_add_u32 s96, s96, 1
    s_waitcnt vmcnt(0)
    v_max3_u32 v9, v232, v236, v240
    v_max_u32 v9, v9, v244
    v_cmp_eq_u32 vcc, -1, v9
    s_nop 1
    s_cbranch_vccz L_redo_25_x
    s_cmp_lt_u32 s96, 50000
    s_cbranch_scc1 L_redo_25_l
L_redo_25_x:
    s_nop 3
    s_branch L_back_26

L_redo_27:
    s_nop 15
    s_mov_b32 s96, 0
L_redo_27_l:
    s_lshl_b32 s80, s75, 18
    s_lshl_b32 s81, s3, 15
    s_add_u32 s80, s80, s81
    s_add_u32 s80, s80, 6307840
    buffer_load_dwordx4 v[120:123], v2, s[68:71], s80 offen offset:0 sc1
    buffer_load_dwordx4 v[124:127], v2, s[68:71], s80 offen offset:1024 sc1
    buffer_load_dwordx4 v[184:187], v2, s[68:71], s80 offen offset:2048 sc1
    buffer_load_dwordx4 v[188:191], v2, s[68:71], s80 offen offset:3072 sc1
    s_lshl_b32 s80, s75, 18
    s_lshl_b32 s81, s3, 15
    s_add_u32 s80, s80, s81
    s_add_u32 s80, s80, 6311936
    buffer_load_dwordx4 v[192:195], v2, s[68:71], s80 offen offset:0 sc1
    buffer_load_dwordx4 v[196:199], v2, s[68:71], s80 offen offset:1024 sc1
    buffer_load_dwordx4 v[200:203], v2, s[68:71], s80 offen offset:2048 sc1
    buffer_load_dwordx4 v[204:207], v2, s[68:71], s80 offen offset:3072 sc1
    s_lshl_b32 s80, s75, 18
    s_lshl_b32 s81, s3, 15
    s_add_u32 s80, s80, s81
    s_add_u32 s80, s80, 6316032
    buffer_load_dwordx4 v[208:211], v2, s[68:71], s80 offen offset:0 sc1
    buffer_load_dwordx4 v[212:215], v2, s[68:71], s80 offen offset:1024 sc1
    buffer_load_dwordx4 v[216:219], v2, s[68:71], s80 offen offset:2048 sc1
    buffer_load_dwordx4 v[220:223], v2, s[68:71], s80 offen offset:3072 sc1
    s_lshl_b32 s80, s75, 18
    s_lshl_b32 s81, s3, 15
    s_add_u32 s80, s80, s81
    s_add_u32 s80, s80, 6320128
    buffer_load_dwordx4 v[224:227], v2, s[68:71], s80 offen offset:0 sc1
    buffer_load_dwordx4 v[228:231], v2, s[68:71], s80 offen offset:1024 sc1
    buffer_load_dwordx4 v[232:235], v2, s[68:71], s80 offen offset:2048 sc1
    buffer_load_dwordx4 v[236:239], v2, s[68:71], s80 offen offset:3072 sc1
    s_lshl_b32 s80, s75, 18
    s_lshl_b32 s81, s3, 15
    s_add_u32 s80, s80, s81
    s_add_u32 s80, s80, 6422528
    buffer_load_dwordx4 v[240:243], v2, s[68:71], s80 offen offset:0 sc1
    s_add_u32 s96, s96, 1
    s_waitcnt vmcnt(0)
    v_max3_u32 v9, v120, v124, v184
    v_max_u32 v9, v9, v188
    v_cmp_eq_u32 vcc, -1, v9
    s_nop 1
    s_cbranch_vccz L_redo_27_x
    s_cmp_lt_u32 s96, 50000
    s_cbranch_scc1 L_redo_27_l
L_redo_27_x:
    s_nop 3
    s_branch L_back_28

L_redo_29:
    s_nop 15
    s_mov_b32 s96, 0
L_redo_29_l:
    s_lshl_b32 s80, s75, 18
    s_lshl_b32 s81, s3, 15
    s_add_u32 s80, s80, s81
    s_add_u32 s80, s80, 6311936
    buffer_load_dwordx4 v[192:195], v2, s[68:71], s80 offen offset:0 sc1
    buffer_load_dwordx4 v[196:199], v2, s[68:71], s80 offen offset:1024 sc1
    buffer_load_dwordx4 v[200:203], v2, s[68:71], s80 offen offset:2048 sc1
    buffer_load_dwordx4 v[204:207], v2, s[68:71], s80 offen offset:3072 sc1
    s_lshl_b32 s80, s75, 18
    s_lshl_b32 s81, s3, 15
    s_add_u32 s80, s80, s81
    s_add_u32 s80, s80, 6316032
    buffer_load_dwordx4 v[208:211], v2, s[68:71], s80 offen offset:0 sc1
    buffer_load_dwordx4 v[212:215], v2, s[68:71], s80 offen offset:1024 sc1
    buffer_load_dwordx4 v[216:219], v2, s[68:71], s80 offen offset:2048 sc1
    buffer_load_dwordx4 v[220:223], v2, s[68:71], s80 offen offset:3072 sc1
    s_lshl_b32 s80, s75, 18
    s_lshl_b32 s81, s3, 15
    s_add_u32 s80, s80, s81
    s_add_u32 s80, s80, 6320128
    buffer_load_dwordx4 v[224:227], v2, s[68:71], s80 offen offset:0 sc1
    buffer_load_dwordx4 v[228:231], v2, s[68:71], s80 offen offset:1024 sc1
    buffer_load_dwordx4 v[232:235], v2, s[68:71], s80 offen offset:2048 sc1
    buffer_load_dwordx4 v[236:239], v2, s[68:71], s80 offen offset:3072 sc1
    s_lshl_b32 s80, s75, 18
    s_lshl_b32 s81, s3, 15
    s_add_u32 s80, s80, s81
    s_add_u32 s80, s80, 6422528
    buffer_load_dwordx4 v[240:243], v2, s[68:71], s80 offen offset:0 sc1
    buffer_load_dwordx4 v[244:247], v2, s[68:71], s80 offen offset:1024 sc1
    buffer_load_dwordx4 v[120:123], v2, s[68:71], s80 offen offset:2048 sc1
    buffer_load_dwordx4 v[124:127], v2, s[68:71], s80 offen offset:3072 sc1
    s_lshl_b32 s80, s75, 18
    s_lshl_b32 s81, s3, 15
    s_add_u32 s80, s80, s81
    s_add_u32 s80, s80, 6426624
    buffer_load_dwordx4 v[184:187], v2, s[68:71], s80 offen offset:0 sc1
    s_add_u32 s96, s96, 1
    s_waitcnt vmcnt(0)
    v_max3_u32 v9, v192, v196, v200
    v_max_u32 v9, v9, v204
    v_cmp_eq_u32 vcc, -1, v9
    s_nop 1
    s_cbranch_vccz L_redo_29_x
    s_cmp_lt_u32 s96, 50000
    s_cbranch_scc1 L_redo_29_l
L_redo_29_x:
    s_nop 3
    s_branch L_back_30

L_redo_31:
    s_nop 15
    s_mov_b32 s96, 0
L_redo_31_l:
    s_lshl_b32 s80, s75, 18
    s_lshl_b32 s81, s3, 15
    s_add_u32 s80, s80, s81
    s_add_u32 s80, s80, 6316032
    buffer_load_dwordx4 v[208:211], v2, s[68:71], s80 offen offset:0 sc1
    buffer_load_dwordx4 v[212:215], v2, s[68:71], s80 offen offset:1024 sc1
    buffer_load_dwordx4 v[216:219], v2, s[68:71], s80 offen offset:2048 sc1
    buffer_load_dwordx4 v[220:223], v2, s[68:71], s80 offen offset:3072 sc1
    s_lshl_b32 s80, s75, 18
    s_lshl_b32 s81, s3, 15
    s_add_u32 s80, s80, s81
    s_add_u32 s80, s80, 6320128
    buffer_load_dwordx4 v[224:227], v2, s[68:71], s80 offen offset:0 sc1
    buffer_load_dwordx4 v[228:231], v2, s[68:71], s80 offen offset:1024 sc1
    buffer_load_dwordx4 v[232:235], v2, s[68:71], s80 offen offset:2048 sc1
    buffer_load_dwordx4 v[236:239], v2, s[68:71], s80 offen offset:3072 sc1
    s_lshl_b32 s80, s75, 18
    s_lshl_b32 s81, s3, 15
    s_add_u32 s80, s80, s81
    s_add_u32 s80, s80, 6422528
    buffer_load_dwordx4 v[240:243], v2, s[68:71], s80 offen offset:0 sc1
    buffer_load_dwordx4 v[244:247], v2, s[68:71], s80 offen offset:1024 sc1
    buffer_load_dwordx4 v[120:123], v2, s[68:71], s80 offen offset:2048 sc1
    buffer_load_dwordx4 v[124:127], v2, s[68:71], s80 offen offset:3072 sc1
    s_lshl_b32 s80, s75, 18
    s_lshl_b32 s81, s3, 15
    s_add_u32 s80, s80, s81
    s_add_u32 s80, s80, 6426624
    buffer_load_dwordx4 v[184:187], v2, s[68:71], s80 offen offset:0 sc1
    buffer_load_dwordx4 v[188:191], v2, s[68:71], s80 offen offset:1024 sc1
    buffer_load_dwordx4 v[192:195], v2, s[68:71], s80 offen offset:2048 sc1
    buffer_load_dwordx4 v[196:199], v2, s[68:71], s80 offen offset:3072 sc1
    s_lshl_b32 s80, s75, 18
    s_lshl_b32 s81, s3, 15
    s_add_u32 s80, s80, s81
    s_add_u32 s80, s80, 6430720
    buffer_load_dwordx4 v[200:203], v2, s[68:71], s80 offen offset:0 sc1
    s_add_u32 s96, s96, 1
    s_waitcnt vmcnt(0)
    v_max3_u32 v9, v208, v212, v216
    v_max_u32 v9, v9, v220
    v_cmp_eq_u32 vcc, -1, v9
    s_nop 1
    s_cbranch_vccz L_redo_31_x
    s_cmp_lt_u32 s96, 50000
    s_cbranch_scc1 L_redo_31_l
L_redo_31_x:
    s_nop 3
    s_branch L_back_32

L_redo_33:
    s_nop 15
    s_mov_b32 s96, 0
L_redo_33_l:
    s_lshl_b32 s80, s75, 18
    s_lshl_b32 s81, s3, 15
    s_add_u32 s80, s80, s81
    s_add_u32 s80, s80, 6320128
    buffer_load_dwordx4 v[224:227], v2, s[68:71], s80 offen offset:0 sc1
    buffer_load_dwordx4 v[228:231], v2, s[68:71], s80 offen offset:1024 sc1
    buffer_load_dwordx4 v[232:235], v2, s[68:71], s80 offen offset:2048 sc1
    buffer_load_dwordx4 v[236:239], v2, s[68:71], s80 offen offset:3072 sc1
    s_lshl_b32 s80, s75, 18
    s_lshl_b32 s81, s3, 15
    s_add_u32 s80, s80, s81
    s_add_u32 s80, s80, 6422528
    buffer_load_dwordx4 v[240:243], v2, s[68:71], s80 offen offset:0 sc1
    buffer_load_dwordx4 v[244:247], v2, s[68:71], s80 offen offset:1024 sc1
    buffer_load_dwordx4 v[120:123], v2, s[68:71], s80 offen offset:2048 sc1
    buffer_load_dwordx4 v[124:127], v2, s[68:71], s80 offen offset:3072 sc1
    s_lshl_b32 s80, s75, 18
    s_lshl_b32 s81, s3, 15
    s_add_u32 s80, s80, s81
    s_add_u32 s80, s80, 6426624
    buffer_load_dwordx4 v[184:187], v2, s[68:71], s80 offen offset:0 sc1
    buffer_load_dwordx4 v[188:191], v2, s[68:71], s80 offen offset:1024 sc1
    buffer_load_dwordx4 v[192:195], v2, s[68:71], s80 offen offset:2048 sc1
    buffer_load_dwordx4 v[196:199], v2, s[68:71], s80 offen offset:3072 sc1
    s_lshl_b32 s80, s75, 18
    s_lshl_b32 s81, s3, 15
    s_add_u32 s80, s80, s81
    s_add_u32 s80, s80, 6430720
    buffer_load_dwordx4 v[200:203], v2, s[68:71], s80 offen offset:0 sc1
    buffer_load_dwordx4 v[204:207], v2, s[68:71], s80 offen offset:1024 sc1
    buffer_load_dwordx4 v[208:211], v2, s[68:71], s80 offen offset:2048 sc1
    buffer_load_dwordx4 v[212:215], v2, s[68:71], s80 offen offset:3072 sc1
    s_lshl_b32 s80, s75, 18
    s_lshl_b32 s81, s3, 15
    s_add_u32 s80, s80, s81
    s_add_u32 s80, s80, 6434816
    buffer_load_dwordx4 v[216:219], v2, s[68:71], s80 offen offset:0 sc1
    s_add_u32 s96, s96, 1
    s_waitcnt vmcnt(0)
    v_max3_u32 v9, v224, v228, v232
    v_max_u32 v9, v9, v236
    v_cmp_eq_u32 vcc, -1, v9
    s_nop 1
    s_cbranch_vccz L_redo_33_x
    s_cmp_lt_u32 s96, 50000
    s_cbranch_scc1 L_redo_33_l
L_redo_33_x:
    s_nop 3
    s_branch L_back_34

L_redo_35:
    s_nop 15
    s_mov_b32 s96, 0
L_redo_35_l:
    s_lshl_b32 s80, s75, 18
    s_lshl_b32 s81, s3, 15
    s_add_u32 s80, s80, s81
    s_add_u32 s80, s80, 6422528
    buffer_load_dwordx4 v[240:243], v2, s[68:71], s80 offen offset:0 sc1
    buffer_load_dwordx4 v[244:247], v2, s[68:71], s80 offen offset:1024 sc1
    buffer_load_dwordx4 v[120:123], v2, s[68:71], s80 offen offset:2048 sc1
    buffer_load_dwordx4 v[124:127], v2, s[68:71], s80 offen offset:3072 sc1
    s_lshl_b32 s80, s75, 18
    s_lshl_b32 s81, s3, 15
    s_add_u32 s80, s80, s81
    s_add_u32 s80, s80, 6426624
    buffer_load_dwordx4 v[184:187], v2, s[68:71], s80 offen offset:0 sc1
    buffer_load_dwordx4 v[188:191], v2, s[68:71], s80 offen offset:1024 sc1
    buffer_load_dwordx4 v[192:195], v2, s[68:71], s80 offen offset:2048 sc1
    buffer_load_dwordx4 v[196:199], v2, s[68:71], s80 offen offset:3072 sc1
    s_lshl_b32 s80, s75, 18
    s_lshl_b32 s81, s3, 15
    s_add_u32 s80, s80, s81
    s_add_u32 s80, s80, 6430720
    buffer_load_dwordx4 v[200:203], v2, s[68:71], s80 offen offset:0 sc1
    buffer_load_dwordx4 v[204:207], v2, s[68:71], s80 offen offset:1024 sc1
    buffer_load_dwordx4 v[208:211], v2, s[68:71], s80 offen offset:2048 sc1
    buffer_load_dwordx4 v[212:215], v2, s[68:71], s80 offen offset:3072 sc1
    s_lshl_b32 s80, s75, 18
    s_lshl_b32 s81, s3, 15
    s_add_u32 s80, s80, s81
    s_add_u32 s80, s80, 6434816
    buffer_load_dwordx4 v[216:219], v2, s[68:71], s80 offen offset:0 sc1
    buffer_load_dwordx4 v[220:223], v2, s[68:71], s80 offen offset:1024 sc1
    buffer_load_dwordx4 v[224:227], v2, s[68:71], s80 offen offset:2048 sc1
    buffer_load_dwordx4 v[228:231], v2, s[68:71], s80 offen offset:3072 sc1
    s_lshl_b32 s80, s75, 18
    s_lshl_b32 s81, s3, 15
    s_add_u32 s80, s80, s81
    s_add_u32 s80, s80, 6438912
    buffer_load_dwordx4 v[232:235], v2, s[68:71], s80 offen offset:0 sc1
    buffer_load_dwordx4 v[236:239], v2, s[68:71], s80 offen offset:1024 sc1
    s_add_u32 s96, s96, 1
    s_waitcnt vmcnt(0)
    v_max3_u32 v9, v240, v244, v120
    v_max_u32 v9, v9, v124
    v_cmp_eq_u32 vcc, -1, v9
    s_nop 1
    s_cbranch_vccz L_redo_35_x
    s_cmp_lt_u32 s96, 50000
    s_cbranch_scc1 L_redo_35_l
L_redo_35_x:
    s_nop 3
    s_branch L_back_36

L_redo_37:
    s_nop 15
    s_mov_b32 s96, 0
L_redo_37_l:
    s_lshl_b32 s80, s75, 18
    s_lshl_b32 s81, s3, 15
    s_add_u32 s80, s80, s81
    s_add_u32 s80, s80, 6426624
    buffer_load_dwordx4 v[184:187], v2, s[68:71], s80 offen offset:0 sc1
    buffer_load_dwordx4 v[188:191], v2, s[68:71], s80 offen offset:1024 sc1
    buffer_load_dwordx4 v[192:195], v2, s[68:71], s80 offen offset:2048 sc1
    buffer_load_dwordx4 v[196:199], v2, s[68:71], s80 offen offset:3072 sc1
    s_lshl_b32 s80, s75, 18
    s_lshl_b32 s81, s3, 15
    s_add_u32 s80, s80, s81
    s_add_u32 s80, s80, 6430720
    buffer_load_dwordx4 v[200:203], v2, s[68:71], s80 offen offset:0 sc1
    buffer_load_dwordx4 v[204:207], v2, s[68:71], s80 offen offset:1024 sc1
    buffer_load_dwordx4 v[208:211], v2, s[68:71], s80 offen offset:2048 sc1
    buffer_load_dwordx4 v[212:215], v2, s[68:71], s80 offen offset:3072 sc1
    s_lshl_b32 s80, s75, 18
    s_lshl_b32 s81, s3, 15
    s_add_u32 s80, s80, s81
    s_add_u32 s80, s80, 6434816
    buffer_load_dwordx4 v[216:219], v2, s[68:71], s80 offen offset:0 sc1
    buffer_load_dwordx4 v[220:223], v2, s[68:71], s80 offen offset:1024 sc1
    buffer_load_dwordx4 v[224:227], v2, s[68:71], s80 offen offset:2048 sc1
    buffer_load_dwordx4 v[228:231], v2, s[68:71], s80 offen offset:3072 sc1
    s_lshl_b32 s80, s75, 18
    s_lshl_b32 s81, s3, 15
    s_add_u32 s80, s80, s81
    s_add_u32 s80, s80, 6438912
    buffer_load_dwordx4 v[232:235], v2, s[68:71], s80 offen offset:0 sc1
    buffer_load_dwordx4 v[236:239], v2, s[68:71], s80 offen offset:1024 sc1
    buffer_load_dwordx4 v[240:243], v2, s[68:71], s80 offen offset:2048 sc1
    buffer_load_dwordx4 v[244:247], v2, s[68:71], s80 offen offset:3072 sc1
    s_lshl_b32 s80, s75, 18
    s_lshl_b32 s81, s3, 15
    s_add_u32 s80, s80, s81
    s_add_u32 s80, s80, 6443008
    buffer_load_dwordx4 v[120:123], v2, s[68:71], s80 offen offset:0 sc1
    s_add_u32 s96, s96, 1
    s_waitcnt vmcnt(0)
    v_max3_u32 v9, v184, v188, v192
    v_max_u32 v9, v9, v196
    v_cmp_eq_u32 vcc, -1, v9
    s_nop 1
    s_cbranch_vccz L_redo_37_x
    s_cmp_lt_u32 s96, 50000
    s_cbranch_scc1 L_redo_37_l
L_redo_37_x:
    s_nop 3
    s_branch L_back_38

L_redo_39:
    s_nop 15
    s_mov_b32 s96, 0
L_redo_39_l:
    s_lshl_b32 s80, s75, 18
    s_lshl_b32 s81, s3, 15
    s_add_u32 s80, s80, s81
    s_add_u32 s80, s80, 6430720
    buffer_load_dwordx4 v[200:203], v2, s[68:71], s80 offen offset:0 sc1
    buffer_load_dwordx4 v[204:207], v2, s[68:71], s80 offen offset:1024 sc1
    buffer_load_dwordx4 v[208:211], v2, s[68:71], s80 offen offset:2048 sc1
    buffer_load_dwordx4 v[212:215], v2, s[68:71], s80 offen offset:3072 sc1
    s_lshl_b32 s80, s75, 18
    s_lshl_b32 s81, s3, 15
    s_add_u32 s80, s80, s81
    s_add_u32 s80, s80, 6434816
    buffer_load_dwordx4 v[216:219], v2, s[68:71], s80 offen offset:0 sc1
    buffer_load_dwordx4 v[220:223], v2, s[68:71], s80 offen offset:1024 sc1
    buffer_load_dwordx4 v[224:227], v2, s[68:71], s80 offen offset:2048 sc1
    buffer_load_dwordx4 v[228:231], v2, s[68:71], s80 offen offset:3072 sc1
    s_lshl_b32 s80, s75, 18
    s_lshl_b32 s81, s3, 15
    s_add_u32 s80, s80, s81
    s_add_u32 s80, s80, 6438912
    buffer_load_dwordx4 v[232:235], v2, s[68:71], s80 offen offset:0 sc1
    buffer_load_dwordx4 v[236:239], v2, s[68:71], s80 offen offset:1024 sc1
    buffer_load_dwordx4 v[240:243], v2, s[68:71], s80 offen offset:2048 sc1
    buffer_load_dwordx4 v[244:247], v2, s[68:71], s80 offen offset:3072 sc1
    s_lshl_b32 s80, s75, 18
    s_lshl_b32 s81, s3, 15
    s_add_u32 s80, s80, s81
    s_add_u32 s80, s80, 6443008
    buffer_load_dwordx4 v[120:123], v2, s[68:71], s80 offen offset:0 sc1
    buffer_load_dwordx4 v[124:127], v2, s[68:71], s80 offen offset:1024 sc1
    buffer_load_dwordx4 v[184:187], v2, s[68:71], s80 offen offset:2048 sc1
    buffer_load_dwordx4 v[188:191], v2, s[68:71], s80 offen offset:3072 sc1
    s_lshl_b32 s80, s75, 18
    s_lshl_b32 s81, s3, 15
    s_add_u32 s80, s80, s81
    s_add_u32 s80, s80, 6447104
    buffer_load_dwordx4 v[192:195], v2, s[68:71], s80 offen offset:0 sc1
    s_add_u32 s96, s96, 1
    s_waitcnt vmcnt(0)
    v_max3_u32 v9, v200, v204, v208
    v_max_u32 v9, v9, v212
    v_cmp_eq_u32 vcc, -1, v9
    s_nop 1
    s_cbranch_vccz L_redo_39_x
    s_cmp_lt_u32 s96, 50000
    s_cbranch_scc1 L_redo_39_l
L_redo_39_x:
    s_nop 3
    s_branch L_back_40

L_redo_41:
    s_nop 15
    s_mov_b32 s96, 0
L_redo_41_l:
    s_lshl_b32 s80, s75, 18
    s_lshl_b32 s81, s3, 15
    s_add_u32 s80, s80, s81
    s_add_u32 s80, s80, 6434816
    buffer_load_dwordx4 v[216:219], v2, s[68:71], s80 offen offset:0 sc1
    buffer_load_dwordx4 v[220:223], v2, s[68:71], s80 offen offset:1024 sc1
    buffer_load_dwordx4 v[224:227], v2, s[68:71], s80 offen offset:2048 sc1
    buffer_load_dwordx4 v[228:231], v2, s[68:71], s80 offen offset:3072 sc1
    s_lshl_b32 s80, s75, 18
    s_lshl_b32 s81, s3, 15
    s_add_u32 s80, s80, s81
    s_add_u32 s80, s80, 6438912
    buffer_load_dwordx4 v[232:235], v2, s[68:71], s80 offen offset:0 sc1
    buffer_load_dwordx4 v[236:239], v2, s[68:71], s80 offen offset:1024 sc1
    buffer_load_dwordx4 v[240:243], v2, s[68:71], s80 offen offset:2048 sc1
    buffer_load_dwordx4 v[244:247], v2, s[68:71], s80 offen offset:3072 sc1
    s_lshl_b32 s80, s75, 18
    s_lshl_b32 s81, s3, 15
    s_add_u32 s80, s80, s81
    s_add_u32 s80, s80, 6443008
    buffer_load_dwordx4 v[120:123], v2, s[68:71], s80 offen offset:0 sc1
    buffer_load_dwordx4 v[124:127], v2, s[68:71], s80 offen offset:1024 sc1
    buffer_load_dwordx4 v[184:187], v2, s[68:71], s80 offen offset:2048 sc1
    buffer_load_dwordx4 v[188:191], v2, s[68:71], s80 offen offset:3072 sc1
    s_lshl_b32 s80, s75, 18
    s_lshl_b32 s81, s3, 15
    s_add_u32 s80, s80, s81
    s_add_u32 s80, s80, 6447104
    buffer_load_dwordx4 v[192:195], v2, s[68:71], s80 offen offset:0 sc1
    buffer_load_dwordx4 v[196:199], v2, s[68:71], s80 offen offset:1024 sc1
    buffer_load_dwordx4 v[200:203], v2, s[68:71], s80 offen offset:2048 sc1
    buffer_load_dwordx4 v[204:207], v2, s[68:71], s80 offen offset:3072 sc1
    s_lshl_b32 s80, s75, 18
    s_lshl_b32 s81, s3, 15
    s_add_u32 s80, s80, s81
    s_add_u32 s80, s80, 6451200
    buffer_load_dwordx4 v[208:211], v2, s[68:71], s80 offen offset:0 sc1
    s_add_u32 s96, s96, 1
    s_waitcnt vmcnt(0)
    v_max3_u32 v9, v216, v220, v224
    v_max_u32 v9, v9, v228
    v_cmp_eq_u32 vcc, -1, v9
    s_nop 1
    s_cbranch_vccz L_redo_41_x
    s_cmp_lt_u32 s96, 50000
    s_cbranch_scc1 L_redo_41_l
L_redo_41_x:
    s_nop 3
    s_branch L_back_42

L_redo_43:
    s_nop 15
    s_mov_b32 s96, 0
L_redo_43_l:
    s_lshl_b32 s80, s75, 18
    s_lshl_b32 s81, s3, 15
    s_add_u32 s80, s80, s81
    s_add_u32 s80, s80, 6438912
    buffer_load_dwordx4 v[232:235], v2, s[68:71], s80 offen offset:0 sc1
    buffer_load_dwordx4 v[236:239], v2, s[68:71], s80 offen offset:1024 sc1
    buffer_load_dwordx4 v[240:243], v2, s[68:71], s80 offen offset:2048 sc1
    buffer_load_dwordx4 v[244:247], v2, s[68:71], s80 offen offset:3072 sc1
    s_lshl_b32 s80, s75, 18
    s_lshl_b32 s81, s3, 15
    s_add_u32 s80, s80, s81
    s_add_u32 s80, s80, 6443008
    buffer_load_dwordx4 v[120:123], v2, s[68:71], s80 offen offset:0 sc1
    buffer_load_dwordx4 v[124:127], v2, s[68:71], s80 offen offset:1024 sc1
    buffer_load_dwordx4 v[184:187], v2, s[68:71], s80 offen offset:2048 sc1
    buffer_load_dwordx4 v[188:191], v2, s[68:71], s80 offen offset:3072 sc1
    s_lshl_b32 s80, s75, 18
    s_lshl_b32 s81, s3, 15
    s_add_u32 s80, s80, s81
    s_add_u32 s80, s80, 6447104
    buffer_load_dwordx4 v[192:195], v2, s[68:71], s80 offen offset:0 sc1
    buffer_load_dwordx4 v[196:199], v2, s[68:71], s80 offen offset:1024 sc1
    buffer_load_dwordx4 v[200:203], v2, s[68:71], s80 offen offset:2048 sc1
    buffer_load_dwordx4 v[204:207], v2, s[68:71], s80 offen offset:3072 sc1
    s_lshl_b32 s80, s75, 18
    s_lshl_b32 s81, s3, 15
    s_add_u32 s80, s80, s81
    s_add_u32 s80, s80, 6451200
    buffer_load_dwordx4 v[208:211], v2, s[68:71], s80 offen offset:0 sc1
    buffer_load_dwordx4 v[212:215], v2, s[68:71], s80 offen offset:1024 sc1
    buffer_load_dwordx4 v[216:219], v2, s[68:71], s80 offen offset:2048 sc1
    buffer_load_dwordx4 v[220:223], v2, s[68:71], s80 offen offset:3072 sc1
    s_add_u32 s96, s96, 1
    s_waitcnt vmcnt(0)
    v_max3_u32 v9, v232, v236, v240
    v_max_u32 v9, v9, v244
    v_cmp_eq_u32 vcc, -1, v9
    s_nop 1
    s_cbranch_vccz L_redo_43_x
    s_cmp_lt_u32 s96, 50000
    s_cbranch_scc1 L_redo_43_l
L_redo_43_x:
    s_nop 3
    s_branch L_back_44

L_redo_45:
    s_nop 15
    s_mov_b32 s96, 0
L_redo_45_l:
    s_lshl_b32 s80, s75, 18
    s_lshl_b32 s81, s3, 15
    s_add_u32 s80, s80, s81
    s_add_u32 s80, s80, 6443008
    buffer_load_dwordx4 v[120:123], v2, s[68:71], s80 offen offset:0 sc1
    buffer_load_dwordx4 v[124:127], v2, s[68:71], s80 offen offset:1024 sc1
    buffer_load_dwordx4 v[184:187], v2, s[68:71], s80 offen offset:2048 sc1
    buffer_load_dwordx4 v[188:191], v2, s[68:71], s80 offen offset:3072 sc1
    s_lshl_b32 s80, s75, 18
    s_lshl_b32 s81, s3, 15
    s_add_u32 s80, s80, s81
    s_add_u32 s80, s80, 6447104
    buffer_load_dwordx4 v[192:195], v2, s[68:71], s80 offen offset:0 sc1
    buffer_load_dwordx4 v[196:199], v2, s[68:71], s80 offen offset:1024 sc1
    buffer_load_dwordx4 v[200:203], v2, s[68:71], s80 offen offset:2048 sc1
    buffer_load_dwordx4 v[204:207], v2, s[68:71], s80 offen offset:3072 sc1
    s_lshl_b32 s80, s75, 18
    s_lshl_b32 s81, s3, 15
    s_add_u32 s80, s80, s81
    s_add_u32 s80, s80, 6451200
    buffer_load_dwordx4 v[208:211], v2, s[68:71], s80 offen offset:0 sc1
    buffer_load_dwordx4 v[212:215], v2, s[68:71], s80 offen offset:1024 sc1
    buffer_load_dwordx4 v[216:219], v2, s[68:71], s80 offen offset:2048 sc1
    buffer_load_dwordx4 v[220:223], v2, s[68:71], s80 offen offset:3072 sc1
    s_add_u32 s96, s96, 1
    s_waitcnt vmcnt(0)
    v_max3_u32 v9, v120, v124, v184
    v_max_u32 v9, v9, v188
    v_cmp_eq_u32 vcc, -1, v9
    s_nop 1
    s_cbranch_vccz L_redo_45_x
    s_cmp_lt_u32 s96, 50000
    s_cbranch_scc1 L_redo_45_l
L_redo_45_x:
    s_nop 3
    s_branch L_back_46

L_redo_47:
    s_nop 15
    s_mov_b32 s96, 0
L_redo_47_l:
    s_lshl_b32 s80, s75, 18
    s_lshl_b32 s81, s3, 15
    s_add_u32 s80, s80, s81
    s_add_u32 s80, s80, 6447104
    buffer_load_dwordx4 v[192:195], v2, s[68:71], s80 offen offset:0 sc1
    buffer_load_dwordx4 v[196:199], v2, s[68:71], s80 offen offset:1024 sc1
    buffer_load_dwordx4 v[200:203], v2, s[68:71], s80 offen offset:2048 sc1
    buffer_load_dwordx4 v[204:207], v2, s[68:71], s80 offen offset:3072 sc1
    s_lshl_b32 s80, s75, 18
    s_lshl_b32 s81, s3, 15
    s_add_u32 s80, s80, s81
    s_add_u32 s80, s80, 6451200
    buffer_load_dwordx4 v[208:211], v2, s[68:71], s80 offen offset:0 sc1
    buffer_load_dwordx4 v[212:215], v2, s[68:71], s80 offen offset:1024 sc1
    buffer_load_dwordx4 v[216:219], v2, s[68:71], s80 offen offset:2048 sc1
    buffer_load_dwordx4 v[220:223], v2, s[68:71], s80 offen offset:3072 sc1
    s_add_u32 s96, s96, 1
    s_waitcnt vmcnt(0)
    v_max3_u32 v9, v192, v196, v200
    v_max_u32 v9, v9, v204
    v_cmp_eq_u32 vcc, -1, v9
    s_nop 1
    s_cbranch_vccz L_redo_47_x
    s_cmp_lt_u32 s96, 50000
    s_cbranch_scc1 L_redo_47_l
L_redo_47_x:
    s_nop 3
    s_branch L_back_48

L_redo_49:
    s_nop 15
    s_mov_b32 s96, 0
L_redo_49_l:
    s_lshl_b32 s80, s75, 18
    s_lshl_b32 s81, s3, 15
    s_add_u32 s80, s80, s81
    s_add_u32 s80, s80, 6451200
    buffer_load_dwordx4 v[208:211], v2, s[68:71], s80 offen offset:0 sc1
    buffer_load_dwordx4 v[212:215], v2, s[68:71], s80 offen offset:1024 sc1
    buffer_load_dwordx4 v[216:219], v2, s[68:71], s80 offen offset:2048 sc1
    buffer_load_dwordx4 v[220:223], v2, s[68:71], s80 offen offset:3072 sc1
    s_add_u32 s96, s96, 1
    s_waitcnt vmcnt(0)
    v_max3_u32 v9, v208, v212, v216
    v_max_u32 v9, v9, v220
    v_cmp_eq_u32 vcc, -1, v9
    s_nop 1
    s_cbranch_vccz L_redo_49_x
    s_cmp_lt_u32 s96, 50000
    s_cbranch_scc1 L_redo_49_l
L_redo_49_x:
    s_nop 3
    s_branch L_back_50

L_redo_54:
    s_nop 15
    s_mov_b32 s96, 0
L_redo_54_l:
    s_mul_i32 s80, s76, 229376
    s_mul_i32 s81, s3, 28672
    s_add_u32 s80, s80, s81
    s_add_u32 s80, s80, 10485760
    buffer_load_dwordx4 v[224:227], v6, s[68:71], s80 offen offset:0 sc1
    buffer_load_dwordx4 v[228:231], v6, s[68:71], s80 offen offset:1024 sc1
    buffer_load_dwordx4 v[232:235], v6, s[68:71], s80 offen offset:2048 sc1
    buffer_load_dwordx4 v[236:239], v6, s[68:71], s80 offen offset:3072 sc1
    s_mul_i32 s80, s76, 229376
    s_mul_i32 s81, s3, 28672
    s_add_u32 s80, s80, s81
    s_add_u32 s80, s80, 10489856
    buffer_load_dwordx4 v[240:243], v6, s[68:71], s80 offen offset:0 sc1
    buffer_load_dwordx4 v[244:247], v6, s[68:71], s80 offen offset:1024 sc1
    buffer_load_dwordx4 v[120:123], v6, s[68:71], s80 offen offset:2048 sc1
    buffer_load_dwordx4 v[124:127], v6, s[68:71], s80 offen offset:3072 sc1
    s_mul_i32 s80, s76, 229376
    s_mul_i32 s81, s3, 28672
    s_add_u32 s80, s80, s81
    s_add_u32 s80, s80, 10493952
    buffer_load_dwordx4 v[184:187], v6, s[68:71], s80 offen offset:0 sc1
    buffer_load_dwordx4 v[188:191], v6, s[68:71], s80 offen offset:1024 sc1
    buffer_load_dwordx4 v[192:195], v6, s[68:71], s80 offen offset:2048 sc1
    buffer_load_dwordx4 v[196:199], v6, s[68:71], s80 offen offset:3072 sc1
    s_mul_i32 s80, s76, 229376
    s_mul_i32 s81, s3, 28672
    s_add_u32 s80, s80, s81
    s_add_u32 s80, s80, 10498048
    buffer_load_dwordx4 v[200:203], v6, s[68:71], s80 offen offset:0 sc1
    buffer_load_dwordx4 v[204:207], v6, s[68:71], s80 offen offset:1024 sc1
    buffer_load_dwordx4 v[208:211], v6, s[68:71], s80 offen offset:2048 sc1
    buffer_load_dwordx4 v[212:215], v6, s[68:71], s80 offen offset:3072 sc1
    s_mul_i32 s80, s76, 229376
    s_mul_i32 s81, s3, 28672
    s_add_u32 s80, s80, s81
    s_add_u32 s80, s80, 10502144
    buffer_load_dwordx4 v[216:219], v6, s[68:71], s80 offen offset:0 sc1
    buffer_load_dwordx4 v[220:223], v6, s[68:71], s80 offen offset:1024 sc1
    s_add_u32 s96, s96, 1
    s_waitcnt vmcnt(0)
    v_max3_u32 v9, v224, v228, v232
    v_max_u32 v9, v9, v236
    v_cmp_eq_u32 vcc, -1, v9
    s_nop 1
    s_cbranch_vccz L_redo_54_x
    s_cmp_lt_u32 s96, 50000
    s_cbranch_scc1 L_redo_54_l
L_redo_54_x:
    s_nop 3
    s_branch L_back_55

L_redo_56:
    s_nop 15
    s_mov_b32 s96, 0
L_redo_56_l:
    s_mul_i32 s80, s76, 229376
    s_mul_i32 s81, s3, 28672
    s_add_u32 s80, s80, s81
    s_add_u32 s80, s80, 10489856
    buffer_load_dwordx4 v[240:243], v6, s[68:71], s80 offen offset:0 sc1
    buffer_load_dwordx4 v[244:247], v6, s[68:71], s80 offen offset:1024 sc1
    buffer_load_dwordx4 v[120:123], v6, s[68:71], s80 offen offset:2048 sc1
    buffer_load_dwordx4 v[124:127], v6, s[68:71], s80 offen offset:3072 sc1
    s_mul_i32 s80, s76, 229376
    s_mul_i32 s81, s3, 28672
    s_add_u32 s80, s80, s81
    s_add_u32 s80, s80, 10493952
    buffer_load_dwordx4 v[184:187], v6, s[68:71], s80 offen offset:0 sc1
    buffer_load_dwordx4 v[188:191], v6, s[68:71], s80 offen offset:1024 sc1
    buffer_load_dwordx4 v[192:195], v6, s[68:71], s80 offen offset:2048 sc1
    buffer_load_dwordx4 v[196:199], v6, s[68:71], s80 offen offset:3072 sc1
    s_mul_i32 s80, s76, 229376
    s_mul_i32 s81, s3, 28672
    s_add_u32 s80, s80, s81
    s_add_u32 s80, s80, 10498048
    buffer_load_dwordx4 v[200:203], v6, s[68:71], s80 offen offset:0 sc1
    buffer_load_dwordx4 v[204:207], v6, s[68:71], s80 offen offset:1024 sc1
    buffer_load_dwordx4 v[208:211], v6, s[68:71], s80 offen offset:2048 sc1
    buffer_load_dwordx4 v[212:215], v6, s[68:71], s80 offen offset:3072 sc1
    s_mul_i32 s80, s76, 229376
    s_mul_i32 s81, s3, 28672
    s_add_u32 s80, s80, s81
    s_add_u32 s80, s80, 10502144
    buffer_load_dwordx4 v[216:219], v6, s[68:71], s80 offen offset:0 sc1
    buffer_load_dwordx4 v[220:223], v6, s[68:71], s80 offen offset:1024 sc1
    buffer_load_dwordx4 v[224:227], v6, s[68:71], s80 offen offset:2048 sc1
    buffer_load_dwordx4 v[228:231], v6, s[68:71], s80 offen offset:3072 sc1
    s_mul_i32 s80, s76, 229376
    s_mul_i32 s81, s3, 28672
    s_add_u32 s80, s80, s81
    s_add_u32 s80, s80, 10506240
    buffer_load_dwordx4 v[232:235], v6, s[68:71], s80 offen offset:0 sc1
    s_add_u32 s96, s96, 1
    s_waitcnt vmcnt(0)
    v_max3_u32 v9, v240, v244, v120
    v_max_u32 v9, v9, v124
    v_cmp_eq_u32 vcc, -1, v9
    s_nop 1
    s_cbranch_vccz L_redo_56_x
    s_cmp_lt_u32 s96, 50000
    s_cbranch_scc1 L_redo_56_l
L_redo_56_x:
    s_nop 3
    s_branch L_back_57

L_redo_58:
    s_nop 15
    s_mov_b32 s96, 0
L_redo_58_l:
    s_mul_i32 s80, s76, 229376
    s_mul_i32 s81, s3, 28672
    s_add_u32 s80, s80, s81
    s_add_u32 s80, s80, 10493952
    buffer_load_dwordx4 v[184:187], v6, s[68:71], s80 offen offset:0 sc1
    buffer_load_dwordx4 v[188:191], v6, s[68:71], s80 offen offset:1024 sc1
    buffer_load_dwordx4 v[192:195], v6, s[68:71], s80 offen offset:2048 sc1
    buffer_load_dwordx4 v[196:199], v6, s[68:71], s80 offen offset:3072 sc1
    s_mul_i32 s80, s76, 229376
    s_mul_i32 s81, s3, 28672
    s_add_u32 s80, s80, s81
    s_add_u32 s80, s80, 10498048
    buffer_load_dwordx4 v[200:203], v6, s[68:71], s80 offen offset:0 sc1
    buffer_load_dwordx4 v[204:207], v6, s[68:71], s80 offen offset:1024 sc1
    buffer_load_dwordx4 v[208:211], v6, s[68:71], s80 offen offset:2048 sc1
    buffer_load_dwordx4 v[212:215], v6, s[68:71], s80 offen offset:3072 sc1
    s_mul_i32 s80, s76, 229376
    s_mul_i32 s81, s3, 28672
    s_add_u32 s80, s80, s81
    s_add_u32 s80, s80, 10502144
    buffer_load_dwordx4 v[216:219], v6, s[68:71], s80 offen offset:0 sc1
    buffer_load_dwordx4 v[220:223], v6, s[68:71], s80 offen offset:1024 sc1
    buffer_load_dwordx4 v[224:227], v6, s[68:71], s80 offen offset:2048 sc1
    buffer_load_dwordx4 v[228:231], v6, s[68:71], s80 offen offset:3072 sc1
    s_mul_i32 s80, s76, 229376
    s_mul_i32 s81, s3, 28672
    s_add_u32 s80, s80, s81
    s_add_u32 s80, s80, 10506240
    buffer_load_dwordx4 v[232:235], v6, s[68:71], s80 offen offset:0 sc1
    buffer_load_dwordx4 v[236:239], v6, s[68:71], s80 offen offset:1024 sc1
    buffer_load_dwordx4 v[240:243], v6, s[68:71], s80 offen offset:2048 sc1
    buffer_load_dwordx4 v[244:247], v6, s[68:71], s80 offen offset:3072 sc1
    s_mul_i32 s80, s76, 229376
    s_mul_i32 s81, s3, 28672
    s_add_u32 s80, s80, s81
    s_add_u32 s80, s80, 10510336
    buffer_load_dwordx4 v[120:123], v6, s[68:71], s80 offen offset:0 sc1
    s_add_u32 s96, s96, 1
    s_waitcnt vmcnt(0)
    v_max3_u32 v9, v184, v188, v192
    v_max_u32 v9, v9, v196
    v_cmp_eq_u32 vcc, -1, v9
    s_nop 1
    s_cbranch_vccz L_redo_58_x
    s_cmp_lt_u32 s96, 50000
    s_cbranch_scc1 L_redo_58_l
L_redo_58_x:
    s_nop 3
    s_branch L_back_59

L_redo_60:
    s_nop 15
    s_mov_b32 s96, 0
L_redo_60_l:
    s_mul_i32 s80, s76, 229376
    s_mul_i32 s81, s3, 28672
    s_add_u32 s80, s80, s81
    s_add_u32 s80, s80, 10498048
    buffer_load_dwordx4 v[200:203], v6, s[68:71], s80 offen offset:0 sc1
    buffer_load_dwordx4 v[204:207], v6, s[68:71], s80 offen offset:1024 sc1
    buffer_load_dwordx4 v[208:211], v6, s[68:71], s80 offen offset:2048 sc1
    buffer_load_dwordx4 v[212:215], v6, s[68:71], s80 offen offset:3072 sc1
    s_mul_i32 s80, s76, 229376
    s_mul_i32 s81, s3, 28672
    s_add_u32 s80, s80, s81
    s_add_u32 s80, s80, 10502144
    buffer_load_dwordx4 v[216:219], v6, s[68:71], s80 offen offset:0 sc1
    buffer_load_dwordx4 v[220:223], v6, s[68:71], s80 offen offset:1024 sc1
    buffer_load_dwordx4 v[224:227], v6, s[68:71], s80 offen offset:2048 sc1
    buffer_load_dwordx4 v[228:231], v6, s[68:71], s80 offen offset:3072 sc1
    s_mul_i32 s80, s76, 229376
    s_mul_i32 s81, s3, 28672
    s_add_u32 s80, s80, s81
    s_add_u32 s80, s80, 10506240
    buffer_load_dwordx4 v[232:235], v6, s[68:71], s80 offen offset:0 sc1
    buffer_load_dwordx4 v[236:239], v6, s[68:71], s80 offen offset:1024 sc1
    buffer_load_dwordx4 v[240:243], v6, s[68:71], s80 offen offset:2048 sc1
    buffer_load_dwordx4 v[244:247], v6, s[68:71], s80 offen offset:3072 sc1
    s_mul_i32 s80, s76, 229376
    s_mul_i32 s81, s3, 28672
    s_add_u32 s80, s80, s81
    s_add_u32 s80, s80, 10510336
    buffer_load_dwordx4 v[120:123], v6, s[68:71], s80 offen offset:0 sc1
    buffer_load_dwordx4 v[124:127], v6, s[68:71], s80 offen offset:1024 sc1
    buffer_load_dwordx4 v[184:187], v6, s[68:71], s80 offen offset:2048 sc1
    buffer_load_dwordx4 v[188:191], v6, s[68:71], s80 offen offset:3072 sc1
    s_add_u32 s96, s96, 1
    s_waitcnt vmcnt(0)
    v_max3_u32 v9, v200, v204, v208
    v_max_u32 v9, v9, v212
    v_cmp_eq_u32 vcc, -1, v9
    s_nop 1
    s_cbranch_vccz L_redo_60_x
    s_cmp_lt_u32 s96, 50000
    s_cbranch_scc1 L_redo_60_l
L_redo_60_x:
    s_nop 3
    s_branch L_back_61

L_redo_62:
    s_nop 15
    s_mov_b32 s96, 0
L_redo_62_l:
    s_mul_i32 s80, s76, 229376
    s_mul_i32 s81, s3, 28672
    s_add_u32 s80, s80, s81
    s_add_u32 s80, s80, 10502144
    buffer_load_dwordx4 v[216:219], v6, s[68:71], s80 offen offset:0 sc1
    buffer_load_dwordx4 v[220:223], v6, s[68:71], s80 offen offset:1024 sc1
    buffer_load_dwordx4 v[224:227], v6, s[68:71], s80 offen offset:2048 sc1
    buffer_load_dwordx4 v[228:231], v6, s[68:71], s80 offen offset:3072 sc1
    s_mul_i32 s80, s76, 229376
    s_mul_i32 s81, s3, 28672
    s_add_u32 s80, s80, s81
    s_add_u32 s80, s80, 10506240
    buffer_load_dwordx4 v[232:235], v6, s[68:71], s80 offen offset:0 sc1
    buffer_load_dwordx4 v[236:239], v6, s[68:71], s80 offen offset:1024 sc1
    buffer_load_dwordx4 v[240:243], v6, s[68:71], s80 offen offset:2048 sc1
    buffer_load_dwordx4 v[244:247], v6, s[68:71], s80 offen offset:3072 sc1
    s_mul_i32 s80, s76, 229376
    s_mul_i32 s81, s3, 28672
    s_add_u32 s80, s80, s81
    s_add_u32 s80, s80, 10510336
    buffer_load_dwordx4 v[120:123], v6, s[68:71], s80 offen offset:0 sc1
    buffer_load_dwordx4 v[124:127], v6, s[68:71], s80 offen offset:1024 sc1
    buffer_load_dwordx4 v[184:187], v6, s[68:71], s80 offen offset:2048 sc1
    buffer_load_dwordx4 v[188:191], v6, s[68:71], s80 offen offset:3072 sc1
    s_add_u32 s96, s96, 1
    s_waitcnt vmcnt(0)
    v_max3_u32 v9, v216, v220, v224
    v_max_u32 v9, v9, v228
    v_cmp_eq_u32 vcc, -1, v9
    s_nop 1
    s_cbranch_vccz L_redo_62_x
    s_cmp_lt_u32 s96, 50000
    s_cbranch_scc1 L_redo_62_l
L_redo_62_x:
    s_nop 3
    s_branch L_back_63

L_redo_64:
    s_nop 15
    s_mov_b32 s96, 0
L_redo_64_l:
    s_mul_i32 s80, s76, 229376
    s_mul_i32 s81, s3, 28672
    s_add_u32 s80, s80, s81
    s_add_u32 s80, s80, 10506240
    buffer_load_dwordx4 v[232:235], v6, s[68:71], s80 offen offset:0 sc1
    buffer_load_dwordx4 v[236:239], v6, s[68:71], s80 offen offset:1024 sc1
    buffer_load_dwordx4 v[240:243], v6, s[68:71], s80 offen offset:2048 sc1
    buffer_load_dwordx4 v[244:247], v6, s[68:71], s80 offen offset:3072 sc1
    s_mul_i32 s80, s76, 229376
    s_mul_i32 s81, s3, 28672
    s_add_u32 s80, s80, s81
    s_add_u32 s80, s80, 10510336
    buffer_load_dwordx4 v[120:123], v6, s[68:71], s80 offen offset:0 sc1
    buffer_load_dwordx4 v[124:127], v6, s[68:71], s80 offen offset:1024 sc1
    buffer_load_dwordx4 v[184:187], v6, s[68:71], s80 offen offset:2048 sc1
    buffer_load_dwordx4 v[188:191], v6, s[68:71], s80 offen offset:3072 sc1
    s_add_u32 s96, s96, 1
    s_waitcnt vmcnt(0)
    v_max3_u32 v9, v232, v236, v240
    v_max_u32 v9, v9, v244
    v_cmp_eq_u32 vcc, -1, v9
    s_nop 1
    s_cbranch_vccz L_redo_64_x
    s_cmp_lt_u32 s96, 50000
    s_cbranch_scc1 L_redo_64_l
L_redo_64_x:
    s_nop 3
    s_branch L_back_65

L_redo_66:
    s_nop 15
    s_mov_b32 s96, 0
L_redo_66_l:
    s_mul_i32 s80, s76, 229376
    s_mul_i32 s81, s3, 28672
    s_add_u32 s80, s80, s81
    s_add_u32 s80, s80, 10510336
    buffer_load_dwordx4 v[120:123], v6, s[68:71], s80 offen offset:0 sc1
    buffer_load_dwordx4 v[124:127], v6, s[68:71], s80 offen offset:1024 sc1
    buffer_load_dwordx4 v[184:187], v6, s[68:71], s80 offen offset:2048 sc1
    buffer_load_dwordx4 v[188:191], v6, s[68:71], s80 offen offset:3072 sc1
    s_add_u32 s96, s96, 1
    s_waitcnt vmcnt(0)
    v_max3_u32 v9, v120, v124, v184
    v_max_u32 v9, v9, v188
    v_cmp_eq_u32 vcc, -1, v9
    s_nop 1
    s_cbranch_vccz L_redo_66_x
    s_cmp_lt_u32 s96, 50000
    s_cbranch_scc1 L_redo_66_l
L_redo_66_x:
    s_nop 3
    s_branch L_back_67

L_redo_68:
    s_nop 15
    s_mov_b32 s96, 0
L_redo_68_l:
    s_mul_i32 s80, s76, 229376
    s_mul_i32 s81, s3, 28672
    s_add_u32 s80, s80, s81
    s_add_u32 s80, s80, 10600448
    buffer_load_dwordx4 v[192:195], v6, s[68:71], s80 offen offset:0 sc1
    buffer_load_dwordx4 v[196:199], v6, s[68:71], s80 offen offset:1024 sc1
    buffer_load_dwordx4 v[200:203], v6, s[68:71], s80 offen offset:2048 sc1
    buffer_load_dwordx4 v[204:207], v6, s[68:71], s80 offen offset:3072 sc1
    s_mul_i32 s80, s76, 229376
    s_mul_i32 s81, s3, 28672
    s_add_u32 s80, s80, s81
    s_add_u32 s80, s80, 10604544
    buffer_load_dwordx4 v[208:211], v6, s[68:71], s80 offen offset:0 sc1
    buffer_load_dwordx4 v[212:215], v6, s[68:71], s80 offen offset:1024 sc1
    buffer_load_dwordx4 v[216:219], v6, s[68:71], s80 offen offset:2048 sc1
    buffer_load_dwordx4 v[220:223], v6, s[68:71], s80 offen offset:3072 sc1
    s_mul_i32 s80, s76, 229376
    s_mul_i32 s81, s3, 28672
    s_add_u32 s80, s80, s81
    s_add_u32 s80, s80, 10608640
    buffer_load_dwordx4 v[224:227], v6, s[68:71], s80 offen offset:0 sc1
    buffer_load_dwordx4 v[228:231], v6, s[68:71], s80 offen offset:1024 sc1
    buffer_load_dwordx4 v[232:235], v6, s[68:71], s80 offen offset:2048 sc1
    buffer_load_dwordx4 v[236:239], v6, s[68:71], s80 offen offset:3072 sc1
    s_mul_i32 s80, s76, 229376
    s_mul_i32 s81, s3, 28672
    s_add_u32 s80, s80, s81
    s_add_u32 s80, s80, 10612736
    buffer_load_dwordx4 v[240:243], v6, s[68:71], s80 offen offset:0 sc1
    buffer_load_dwordx4 v[244:247], v6, s[68:71], s80 offen offset:1024 sc1
    buffer_load_dwordx4 v[120:123], v6, s[68:71], s80 offen offset:2048 sc1
    buffer_load_dwordx4 v[124:127], v6, s[68:71], s80 offen offset:3072 sc1
    s_mul_i32 s80, s76, 229376
    s_mul_i32 s81, s3, 28672
    s_add_u32 s80, s80, s81
    s_add_u32 s80, s80, 10616832
    buffer_load_dwordx4 v[184:187], v6, s[68:71], s80 offen offset:0 sc1
    buffer_load_dwordx4 v[188:191], v6, s[68:71], s80 offen offset:1024 sc1
    s_add_u32 s96, s96, 1
    s_waitcnt vmcnt(0)
    v_max3_u32 v9, v192, v196, v200
    v_max_u32 v9, v9, v204
    v_cmp_eq_u32 vcc, -1, v9
    s_nop 1
    s_cbranch_vccz L_redo_68_x
    s_cmp_lt_u32 s96, 50000
    s_cbranch_scc1 L_redo_68_l
L_redo_68_x:
    s_nop 3
    s_branch L_back_69

L_redo_70:
    s_nop 15
    s_mov_b32 s96, 0
L_redo_70_l:
    s_mul_i32 s80, s76, 229376
    s_mul_i32 s81, s3, 28672
    s_add_u32 s80, s80, s81
    s_add_u32 s80, s80, 10604544
    buffer_load_dwordx4 v[208:211], v6, s[68:71], s80 offen offset:0 sc1
    buffer_load_dwordx4 v[212:215], v6, s[68:71], s80 offen offset:1024 sc1
    buffer_load_dwordx4 v[216:219], v6, s[68:71], s80 offen offset:2048 sc1
    buffer_load_dwordx4 v[220:223], v6, s[68:71], s80 offen offset:3072 sc1
    s_mul_i32 s80, s76, 229376
    s_mul_i32 s81, s3, 28672
    s_add_u32 s80, s80, s81
    s_add_u32 s80, s80, 10608640
    buffer_load_dwordx4 v[224:227], v6, s[68:71], s80 offen offset:0 sc1
    buffer_load_dwordx4 v[228:231], v6, s[68:71], s80 offen offset:1024 sc1
    buffer_load_dwordx4 v[232:235], v6, s[68:71], s80 offen offset:2048 sc1
    buffer_load_dwordx4 v[236:239], v6, s[68:71], s80 offen offset:3072 sc1
    s_mul_i32 s80, s76, 229376
    s_mul_i32 s81, s3, 28672
    s_add_u32 s80, s80, s81
    s_add_u32 s80, s80, 10612736
    buffer_load_dwordx4 v[240:243], v6, s[68:71], s80 offen offset:0 sc1
    buffer_load_dwordx4 v[244:247], v6, s[68:71], s80 offen offset:1024 sc1
    buffer_load_dwordx4 v[120:123], v6, s[68:71], s80 offen offset:2048 sc1
    buffer_load_dwordx4 v[124:127], v6, s[68:71], s80 offen offset:3072 sc1
    s_mul_i32 s80, s76, 229376
    s_mul_i32 s81, s3, 28672
    s_add_u32 s80, s80, s81
    s_add_u32 s80, s80, 10616832
    buffer_load_dwordx4 v[184:187], v6, s[68:71], s80 offen offset:0 sc1
    buffer_load_dwordx4 v[188:191], v6, s[68:71], s80 offen offset:1024 sc1
    buffer_load_dwordx4 v[192:195], v6, s[68:71], s80 offen offset:2048 sc1
    buffer_load_dwordx4 v[196:199], v6, s[68:71], s80 offen offset:3072 sc1
    s_mul_i32 s80, s76, 229376
    s_mul_i32 s81, s3, 28672
    s_add_u32 s80, s80, s81
    s_add_u32 s80, s80, 10620928
    buffer_load_dwordx4 v[200:203], v6, s[68:71], s80 offen offset:0 sc1
    s_add_u32 s96, s96, 1
    s_waitcnt vmcnt(0)
    v_max3_u32 v9, v208, v212, v216
    v_max_u32 v9, v9, v220
    v_cmp_eq_u32 vcc, -1, v9
    s_nop 1
    s_cbranch_vccz L_redo_70_x
    s_cmp_lt_u32 s96, 50000
    s_cbranch_scc1 L_redo_70_l
L_redo_70_x:
    s_nop 3
    s_branch L_back_71

L_redo_72:
    s_nop 15
    s_mov_b32 s96, 0
L_redo_72_l:
    s_mul_i32 s80, s76, 229376
    s_mul_i32 s81, s3, 28672
    s_add_u32 s80, s80, s81
    s_add_u32 s80, s80, 10608640
    buffer_load_dwordx4 v[224:227], v6, s[68:71], s80 offen offset:0 sc1
    buffer_load_dwordx4 v[228:231], v6, s[68:71], s80 offen offset:1024 sc1
    buffer_load_dwordx4 v[232:235], v6, s[68:71], s80 offen offset:2048 sc1
    buffer_load_dwordx4 v[236:239], v6, s[68:71], s80 offen offset:3072 sc1
    s_mul_i32 s80, s76, 229376
    s_mul_i32 s81, s3, 28672
    s_add_u32 s80, s80, s81
    s_add_u32 s80, s80, 10612736
    buffer_load_dwordx4 v[240:243], v6, s[68:71], s80 offen offset:0 sc1
    buffer_load_dwordx4 v[244:247], v6, s[68:71], s80 offen offset:1024 sc1
    buffer_load_dwordx4 v[120:123], v6, s[68:71], s80 offen offset:2048 sc1
    buffer_load_dwordx4 v[124:127], v6, s[68:71], s80 offen offset:3072 sc1
    s_mul_i32 s80, s76, 229376
    s_mul_i32 s81, s3, 28672
    s_add_u32 s80, s80, s81
    s_add_u32 s80, s80, 10616832
    buffer_load_dwordx4 v[184:187], v6, s[68:71], s80 offen offset:0 sc1
    buffer_load_dwordx4 v[188:191], v6, s[68:71], s80 offen offset:1024 sc1
    buffer_load_dwordx4 v[192:195], v6, s[68:71], s80 offen offset:2048 sc1
    buffer_load_dwordx4 v[196:199], v6, s[68:71], s80 offen offset:3072 sc1
    s_mul_i32 s80, s76, 229376
    s_mul_i32 s81, s3, 28672
    s_add_u32 s80, s80, s81
    s_add_u32 s80, s80, 10620928
    buffer_load_dwordx4 v[200:203], v6, s[68:71], s80 offen offset:0 sc1
    buffer_load_dwordx4 v[204:207], v6, s[68:71], s80 offen offset:1024 sc1
    buffer_load_dwordx4 v[208:211], v6, s[68:71], s80 offen offset:2048 sc1
    buffer_load_dwordx4 v[212:215], v6, s[68:71], s80 offen offset:3072 sc1
    s_mul_i32 s80, s76, 229376
    s_mul_i32 s81, s3, 28672
    s_add_u32 s80, s80, s81
    s_add_u32 s80, s80, 10625024
    buffer_load_dwordx4 v[216:219], v6, s[68:71], s80 offen offset:0 sc1
    s_add_u32 s96, s96, 1
    s_waitcnt vmcnt(0)
    v_max3_u32 v9, v224, v228, v232
    v_max_u32 v9, v9, v236
    v_cmp_eq_u32 vcc, -1, v9
    s_nop 1
    s_cbranch_vccz L_redo_72_x
    s_cmp_lt_u32 s96, 50000
    s_cbranch_scc1 L_redo_72_l
L_redo_72_x:
    s_nop 3
    s_branch L_back_73

L_redo_74:
    s_nop 15
    s_mov_b32 s96, 0
L_redo_74_l:
    s_mul_i32 s80, s76, 229376
    s_mul_i32 s81, s3, 28672
    s_add_u32 s80, s80, s81
    s_add_u32 s80, s80, 10612736
    buffer_load_dwordx4 v[240:243], v6, s[68:71], s80 offen offset:0 sc1
    buffer_load_dwordx4 v[244:247], v6, s[68:71], s80 offen offset:1024 sc1
    buffer_load_dwordx4 v[120:123], v6, s[68:71], s80 offen offset:2048 sc1
    buffer_load_dwordx4 v[124:127], v6, s[68:71], s80 offen offset:3072 sc1
    s_mul_i32 s80, s76, 229376
    s_mul_i32 s81, s3, 28672
    s_add_u32 s80, s80, s81
    s_add_u32 s80, s80, 10616832
    buffer_load_dwordx4 v[184:187], v6, s[68:71], s80 offen offset:0 sc1
    buffer_load_dwordx4 v[188:191], v6, s[68:71], s80 offen offset:1024 sc1
    buffer_load_dwordx4 v[192:195], v6, s[68:71], s80 offen offset:2048 sc1
    buffer_load_dwordx4 v[196:199], v6, s[68:71], s80 offen offset:3072 sc1
    s_mul_i32 s80, s76, 229376
    s_mul_i32 s81, s3, 28672
    s_add_u32 s80, s80, s81
    s_add_u32 s80, s80, 10620928
    buffer_load_dwordx4 v[200:203], v6, s[68:71], s80 offen offset:0 sc1
    buffer_load_dwordx4 v[204:207], v6, s[68:71], s80 offen offset:1024 sc1
    buffer_load_dwordx4 v[208:211], v6, s[68:71], s80 offen offset:2048 sc1
    buffer_load_dwordx4 v[212:215], v6, s[68:71], s80 offen offset:3072 sc1
    s_mul_i32 s80, s76, 229376
    s_mul_i32 s81, s3, 28672
    s_add_u32 s80, s80, s81
    s_add_u32 s80, s80, 10625024
    buffer_load_dwordx4 v[216:219], v6, s[68:71], s80 offen offset:0 sc1
    buffer_load_dwordx4 v[220:223], v6, s[68:71], s80 offen offset:1024 sc1
    buffer_load_dwordx4 v[224:227], v6, s[68:71], s80 offen offset:2048 sc1
    buffer_load_dwordx4 v[228:231], v6, s[68:71], s80 offen offset:3072 sc1
    s_add_u32 s96, s96, 1
    s_waitcnt vmcnt(0)
    v_max3_u32 v9, v240, v244, v120
    v_max_u32 v9, v9, v124
    v_cmp_eq_u32 vcc, -1, v9
    s_nop 1
    s_cbranch_vccz L_redo_74_x
    s_cmp_lt_u32 s96, 50000
    s_cbranch_scc1 L_redo_74_l
L_redo_74_x:
    s_nop 3
    s_branch L_back_75

L_redo_76:
    s_nop 15
    s_mov_b32 s96, 0
L_redo_76_l:
    s_mul_i32 s80, s76, 229376
    s_mul_i32 s81, s3, 28672
    s_add_u32 s80, s80, s81
    s_add_u32 s80, s80, 10616832
    buffer_load_dwordx4 v[184:187], v6, s[68:71], s80 offen offset:0 sc1
    buffer_load_dwordx4 v[188:191], v6, s[68:71], s80 offen offset:1024 sc1
    buffer_load_dwordx4 v[192:195], v6, s[68:71], s80 offen offset:2048 sc1
    buffer_load_dwordx4 v[196:199], v6, s[68:71], s80 offen offset:3072 sc1
    s_mul_i32 s80, s76, 229376
    s_mul_i32 s81, s3, 28672
    s_add_u32 s80, s80, s81
    s_add_u32 s80, s80, 10620928
    buffer_load_dwordx4 v[200:203], v6, s[68:71], s80 offen offset:0 sc1
    buffer_load_dwordx4 v[204:207], v6, s[68:71], s80 offen offset:1024 sc1
    buffer_load_dwordx4 v[208:211], v6, s[68:71], s80 offen offset:2048 sc1
    buffer_load_dwordx4 v[212:215], v6, s[68:71], s80 offen offset:3072 sc1
    s_mul_i32 s80, s76, 229376
    s_mul_i32 s81, s3, 28672
    s_add_u32 s80, s80, s81
    s_add_u32 s80, s80, 10625024
    buffer_load_dwordx4 v[216:219], v6, s[68:71], s80 offen offset:0 sc1
    buffer_load_dwordx4 v[220:223], v6, s[68:71], s80 offen offset:1024 sc1
    buffer_load_dwordx4 v[224:227], v6, s[68:71], s80 offen offset:2048 sc1
    buffer_load_dwordx4 v[228:231], v6, s[68:71], s80 offen offset:3072 sc1
    s_add_u32 s96, s96, 1
    s_waitcnt vmcnt(0)
    v_max3_u32 v9, v184, v188, v192
    v_max_u32 v9, v9, v196
    v_cmp_eq_u32 vcc, -1, v9
    s_nop 1
    s_cbranch_vccz L_redo_76_x
    s_cmp_lt_u32 s96, 50000
    s_cbranch_scc1 L_redo_76_l
L_redo_76_x:
    s_nop 3
    s_branch L_back_77

L_redo_78:
    s_nop 15
    s_mov_b32 s96, 0
L_redo_78_l:
    s_mul_i32 s80, s76, 229376
    s_mul_i32 s81, s3, 28672
    s_add_u32 s80, s80, s81
    s_add_u32 s80, s80, 10620928
    buffer_load_dwordx4 v[200:203], v6, s[68:71], s80 offen offset:0 sc1
    buffer_load_dwordx4 v[204:207], v6, s[68:71], s80 offen offset:1024 sc1
    buffer_load_dwordx4 v[208:211], v6, s[68:71], s80 offen offset:2048 sc1
    buffer_load_dwordx4 v[212:215], v6, s[68:71], s80 offen offset:3072 sc1
    s_mul_i32 s80, s76, 229376
    s_mul_i32 s81, s3, 28672
    s_add_u32 s80, s80, s81
    s_add_u32 s80, s80, 10625024
    buffer_load_dwordx4 v[216:219], v6, s[68:71], s80 offen offset:0 sc1
    buffer_load_dwordx4 v[220:223], v6, s[68:71], s80 offen offset:1024 sc1
    buffer_load_dwordx4 v[224:227], v6, s[68:71], s80 offen offset:2048 sc1
    buffer_load_dwordx4 v[228:231], v6, s[68:71], s80 offen offset:3072 sc1
    s_add_u32 s96, s96, 1
    s_waitcnt vmcnt(0)
    v_max3_u32 v9, v200, v204, v208
    v_max_u32 v9, v9, v212
    v_cmp_eq_u32 vcc, -1, v9
    s_nop 1
    s_cbranch_vccz L_redo_78_x
    s_cmp_lt_u32 s96, 50000
    s_cbranch_scc1 L_redo_78_l
L_redo_78_x:
    s_nop 3
    s_branch L_back_79

L_redo_80:
    s_nop 15
    s_mov_b32 s96, 0
L_redo_80_l:
    s_mul_i32 s80, s76, 229376
    s_mul_i32 s81, s3, 28672
    s_add_u32 s80, s80, s81
    s_add_u32 s80, s80, 10625024
    buffer_load_dwordx4 v[216:219], v6, s[68:71], s80 offen offset:0 sc1
    buffer_load_dwordx4 v[220:223], v6, s[68:71], s80 offen offset:1024 sc1
    buffer_load_dwordx4 v[224:227], v6, s[68:71], s80 offen offset:2048 sc1
    buffer_load_dwordx4 v[228:231], v6, s[68:71], s80 offen offset:3072 sc1
    s_add_u32 s96, s96, 1
    s_waitcnt vmcnt(0)
    v_max3_u32 v9, v216, v220, v224
    v_max_u32 v9, v9, v228
    v_cmp_eq_u32 vcc, -1, v9
    s_nop 1
    s_cbranch_vccz L_redo_80_x
    s_cmp_lt_u32 s96, 50000
    s_cbranch_scc1 L_redo_80_l
L_redo_80_x:
    s_nop 3
    s_branch L_back_81

L_redo_82:
    s_nop 15
    s_mov_b32 s96, 0
L_redo_82_l:
    s_add_u32 s83, s95, 0
    buffer_load_dwordx4 v[32:35], v2, s[68:71], s83 offen offset:0 sc1
    s_add_u32 s83, s95, 0
    buffer_load_dwordx4 v[36:39], v2, s[68:71], s83 offen offset:1024 sc1
    s_add_u32 s83, s95, 4096
    buffer_load_dwordx4 v[40:43], v2, s[68:71], s83 offen offset:0 sc1
    s_add_u32 s83, s95, 4096
    buffer_load_dwordx4 v[44:47], v2, s[68:71], s83 offen offset:1024 sc1
    s_add_u32 s83, s95, 8192
    buffer_load_dwordx4 v[48:51], v2, s[68:71], s83 offen offset:0 sc1
    s_add_u32 s83, s95, 8192
    buffer_load_dwordx4 v[52:55], v2, s[68:71], s83 offen offset:1024 sc1
    s_add_u32 s83, s95, 12288
    buffer_load_dwordx4 v[56:59], v2, s[68:71], s83 offen offset:0 sc1
    s_add_u32 s83, s95, 12288
    buffer_load_dwordx4 v[60:63], v2, s[68:71], s83 offen offset:1024 sc1
    s_add_u32 s83, s95, 16384
    buffer_load_dwordx4 v[64:67], v2, s[68:71], s83 offen offset:0 sc1
    s_add_u32 s83, s95, 16384
    buffer_load_dwordx4 v[68:71], v2, s[68:71], s83 offen offset:1024 sc1
    s_add_u32 s83, s95, 20480
    buffer_load_dwordx4 v[72:75], v2, s[68:71], s83 offen offset:0 sc1
    s_add_u32 s83, s95, 20480
    buffer_load_dwordx4 v[76:79], v2, s[68:71], s83 offen offset:1024 sc1
    s_add_u32 s83, s95, 24576
    buffer_load_dwordx4 v[80:83], v2, s[68:71], s83 offen offset:0 sc1
    s_add_u32 s83, s95, 24576
    buffer_load_dwordx4 v[84:87], v2, s[68:71], s83 offen offset:1024 sc1
    s_add_u32 s83, s95, 28672
    buffer_load_dwordx4 v[88:91], v2, s[68:71], s83 offen offset:0 sc1
    s_add_u32 s83, s95, 28672
    buffer_load_dwordx4 v[92:95], v2, s[68:71], s83 offen offset:1024 sc1
    s_add_u32 s96, s96, 1
    s_waitcnt vmcnt(0)
    v_max3_u32 v254, v32, v36, v40
    v_max_u32 v254, v254, v44
    v_cmp_eq_u32 vcc, -1, v254
    s_nop 1
    s_cbranch_vccz L_redo_82_x
    s_cmp_lt_u32 s96, 50000
    s_cbranch_scc1 L_redo_82_l
L_redo_82_x:
    s_nop 3
    s_branch L_back_83

L_redo_84:
    s_nop 15
    s_mov_b32 s96, 0
L_redo_84_l:
    s_add_u32 s83, s95, 8192
    buffer_load_dwordx4 v[48:51], v2, s[68:71], s83 offen offset:0 sc1
    s_add_u32 s83, s95, 8192
    buffer_load_dwordx4 v[52:55], v2, s[68:71], s83 offen offset:1024 sc1
    s_add_u32 s83, s95, 12288
    buffer_load_dwordx4 v[56:59], v2, s[68:71], s83 offen offset:0 sc1
    s_add_u32 s83, s95, 12288
    buffer_load_dwordx4 v[60:63], v2, s[68:71], s83 offen offset:1024 sc1
    s_add_u32 s83, s95, 16384
    buffer_load_dwordx4 v[64:67], v2, s[68:71], s83 offen offset:0 sc1
    s_add_u32 s83, s95, 16384
    buffer_load_dwordx4 v[68:71], v2, s[68:71], s83 offen offset:1024 sc1
    s_add_u32 s83, s95, 20480
    buffer_load_dwordx4 v[72:75], v2, s[68:71], s83 offen offset:0 sc1
    s_add_u32 s83, s95, 20480
    buffer_load_dwordx4 v[76:79], v2, s[68:71], s83 offen offset:1024 sc1
    s_add_u32 s83, s95, 24576
    buffer_load_dwordx4 v[80:83], v2, s[68:71], s83 offen offset:0 sc1
    s_add_u32 s83, s95, 24576
    buffer_load_dwordx4 v[84:87], v2, s[68:71], s83 offen offset:1024 sc1
    s_add_u32 s83, s95, 28672
    buffer_load_dwordx4 v[88:91], v2, s[68:71], s83 offen offset:0 sc1
    s_add_u32 s83, s95, 28672
    buffer_load_dwordx4 v[92:95], v2, s[68:71], s83 offen offset:1024 sc1
    s_add_u32 s96, s96, 1
    s_waitcnt vmcnt(0)
    v_max3_u32 v254, v48, v52, v56
    v_max_u32 v254, v254, v60
    v_cmp_eq_u32 vcc, -1, v254
    s_nop 1
    s_cbranch_vccz L_redo_84_x
    s_cmp_lt_u32 s96, 50000
    s_cbranch_scc1 L_redo_84_l
L_redo_84_x:
    s_nop 3
    s_branch L_back_85

L_redo_86:
    s_nop 15
    s_mov_b32 s96, 0
L_redo_86_l:
    s_add_u32 s83, s95, 16384
    buffer_load_dwordx4 v[64:67], v2, s[68:71], s83 offen offset:0 sc1
    s_add_u32 s83, s95, 16384
    buffer_load_dwordx4 v[68:71], v2, s[68:71], s83 offen offset:1024 sc1
    s_add_u32 s83, s95, 20480
    buffer_load_dwordx4 v[72:75], v2, s[68:71], s83 offen offset:0 sc1
    s_add_u32 s83, s95, 20480
    buffer_load_dwordx4 v[76:79], v2, s[68:71], s83 offen offset:1024 sc1
    s_add_u32 s83, s95, 24576
    buffer_load_dwordx4 v[80:83], v2, s[68:71], s83 offen offset:0 sc1
    s_add_u32 s83, s95, 24576
    buffer_load_dwordx4 v[84:87], v2, s[68:71], s83 offen offset:1024 sc1
    s_add_u32 s83, s95, 28672
    buffer_load_dwordx4 v[88:91], v2, s[68:71], s83 offen offset:0 sc1
    s_add_u32 s83, s95, 28672
    buffer_load_dwordx4 v[92:95], v2, s[68:71], s83 offen offset:1024 sc1
    s_add_u32 s96, s96, 1
    s_waitcnt vmcnt(0)
    v_max3_u32 v254, v64, v68, v72
    v_max_u32 v254, v254, v76
    v_cmp_eq_u32 vcc, -1, v254
    s_nop 1
    s_cbranch_vccz L_redo_86_x
    s_cmp_lt_u32 s96, 50000
    s_cbranch_scc1 L_redo_86_l
L_redo_86_x:
    s_nop 3
    s_branch L_back_87

L_redo_91:
    s_nop 15
    s_mov_b32 s96, 0
L_redo_91_l:
    s_add_u32 s83, s95, 24576
    buffer_load_dwordx4 v[80:83], v2, s[68:71], s83 offen offset:0 sc1
    s_add_u32 s83, s95, 24576
    buffer_load_dwordx4 v[84:87], v2, s[68:71], s83 offen offset:1024 sc1
    s_add_u32 s83, s95, 28672
    buffer_load_dwordx4 v[88:91], v2, s[68:71], s83 offen offset:0 sc1
    s_add_u32 s83, s95, 28672
    buffer_load_dwordx4 v[92:95], v2, s[68:71], s83 offen offset:1024 sc1
    s_add_u32 s96, s96, 1
    s_waitcnt vmcnt(0)
    v_max3_u32 v254, v80, v84, v88
    v_max_u32 v254, v254, v92
    v_cmp_eq_u32 vcc, -1, v254
    s_nop 1
    s_cbranch_vccz L_redo_91_x
    s_cmp_lt_u32 s96, 50000
    s_cbranch_scc1 L_redo_91_l
L_redo_91_x:
    s_nop 3
    s_branch L_back_92

L_redo_93:
    s_nop 15
    s_mov_b32 s96, 0
L_redo_93_l:
    buffer_load_dwordx2 v[246:247], v8, s[68:71], s92 offen offset:0 sc1
    buffer_load_dwordx2 v[248:249], v8, s[68:71], s92 offen offset:256 sc1
    buffer_load_dwordx2 v[250:251], v8, s[68:71], s92 offen offset:512 sc1
    buffer_load_dwordx2 v[252:253], v8, s[68:71], s92 offen offset:768 sc1
    buffer_load_dwordx2 v[236:237], v8, s[68:71], s92 offen offset:1024 sc1
    buffer_load_dwordx2 v[238:239], v8, s[68:71], s92 offen offset:1280 sc1
    buffer_load_dwordx2 v[240:241], v8, s[68:71], s92 offen offset:1536 sc1
    buffer_load_dwordx2 v[242:243], v8, s[68:71], s92 offen offset:1792 sc1
    s_add_u32 s96, s96, 1
    s_waitcnt vmcnt(0)
    v_max3_u32 v254, v247, v249, v251
    v_max3_u32 v254, v254, v253, v237
    v_max3_u32 v254, v254, v239, v241
    v_max_u32 v254, v254, v243
    v_cmp_eq_u32 vcc, -1, v254
    s_nop 1
    s_cbranch_vccz L_redo_93_x
    s_cmp_lt_u32 s96, 50000
    s_cbranch_scc1 L_redo_93_l
L_redo_93_x:
    s_nop 3
    s_branch L_back_94

L_redo_95:
    s_nop 15
    s_mov_b32 s96, 0
L_redo_95_l:
    s_add_u32 s83, s95, 0
    buffer_load_dwordx4 v[96:99], v2, s[68:71], s83 offen offset:2048 sc1
    s_add_u32 s83, s95, 0
    buffer_load_dwordx4 v[100:103], v2, s[68:71], s83 offen offset:3072 sc1
    s_add_u32 s83, s95, 4096
    buffer_load_dwordx4 v[104:107], v2, s[68:71], s83 offen offset:2048 sc1
    s_add_u32 s83, s95, 4096
    buffer_load_dwordx4 v[108:111], v2, s[68:71], s83 offen offset:3072 sc1
    s_add_u32 s83, s95, 8192
    buffer_load_dwordx4 v[112:115], v2, s[68:71], s83 offen offset:2048 sc1
    s_add_u32 s83, s95, 8192
    buffer_load_dwordx4 v[116:119], v2, s[68:71], s83 offen offset:3072 sc1
    s_add_u32 s83, s95, 12288
    buffer_load_dwordx4 v[120:123], v2, s[68:71], s83 offen offset:2048 sc1
    s_add_u32 s83, s95, 12288
    buffer_load_dwordx4 v[124:127], v2, s[68:71], s83 offen offset:3072 sc1
    s_add_u32 s83, s95, 16384
    buffer_load_dwordx4 v[128:131], v2, s[68:71], s83 offen offset:2048 sc1
    s_add_u32 s83, s95, 16384
    buffer_load_dwordx4 v[132:135], v2, s[68:71], s83 offen offset:3072 sc1
    s_add_u32 s83, s95, 20480
    buffer_load_dwordx4 v[136:139], v2, s[68:71], s83 offen offset:2048 sc1
    s_add_u32 s83, s95, 20480
    buffer_load_dwordx4 v[140:143], v2, s[68:71], s83 offen offset:3072 sc1
    s_add_u32 s83, s95, 24576
    buffer_load_dwordx4 v[144:147], v2, s[68:71], s83 offen offset:2048 sc1
    s_add_u32 s83, s95, 24576
    buffer_load_dwordx4 v[148:151], v2, s[68:71], s83 offen offset:3072 sc1
    s_add_u32 s83, s95, 28672
    buffer_load_dwordx4 v[152:155], v2, s[68:71], s83 offen offset:2048 sc1
    s_add_u32 s83, s95, 28672
    buffer_load_dwordx4 v[156:159], v2, s[68:71], s83 offen offset:3072 sc1
    s_add_u32 s96, s96, 1
    s_waitcnt vmcnt(0)
    v_max3_u32 v254, v96, v100, v104
    v_max_u32 v254, v254, v108
    v_cmp_eq_u32 vcc, -1, v254
    s_nop 1
    s_cbranch_vccz L_redo_95_x
    s_cmp_lt_u32 s96, 50000
    s_cbranch_scc1 L_redo_95_l
L_redo_95_x:
    s_nop 3
    s_branch L_back_96

L_redo_97:
    s_nop 15
    s_mov_b32 s96, 0
L_redo_97_l:
    s_add_u32 s83, s95, 8192
    buffer_load_dwordx4 v[112:115], v2, s[68:71], s83 offen offset:2048 sc1
    s_add_u32 s83, s95, 8192
    buffer_load_dwordx4 v[116:119], v2, s[68:71], s83 offen offset:3072 sc1
    s_add_u32 s83, s95, 12288
    buffer_load_dwordx4 v[120:123], v2, s[68:71], s83 offen offset:2048 sc1
    s_add_u32 s83, s95, 12288
    buffer_load_dwordx4 v[124:127], v2, s[68:71], s83 offen offset:3072 sc1
    s_add_u32 s83, s95, 16384
    buffer_load_dwordx4 v[128:131], v2, s[68:71], s83 offen offset:2048 sc1
    s_add_u32 s83, s95, 16384
    buffer_load_dwordx4 v[132:135], v2, s[68:71], s83 offen offset:3072 sc1
    s_add_u32 s83, s95, 20480
    buffer_load_dwordx4 v[136:139], v2, s[68:71], s83 offen offset:2048 sc1
    s_add_u32 s83, s95, 20480
    buffer_load_dwordx4 v[140:143], v2, s[68:71], s83 offen offset:3072 sc1
    s_add_u32 s83, s95, 24576
    buffer_load_dwordx4 v[144:147], v2, s[68:71], s83 offen offset:2048 sc1
    s_add_u32 s83, s95, 24576
    buffer_load_dwordx4 v[148:151], v2, s[68:71], s83 offen offset:3072 sc1
    s_add_u32 s83, s95, 28672
    buffer_load_dwordx4 v[152:155], v2, s[68:71], s83 offen offset:2048 sc1
    s_add_u32 s83, s95, 28672
    buffer_load_dwordx4 v[156:159], v2, s[68:71], s83 offen offset:3072 sc1
    s_add_u32 s96, s96, 1
    s_waitcnt vmcnt(0)
    v_max3_u32 v254, v112, v116, v120
    v_max_u32 v254, v254, v124
    v_cmp_eq_u32 vcc, -1, v254
    s_nop 1
    s_cbranch_vccz L_redo_97_x
    s_cmp_lt_u32 s96, 50000
    s_cbranch_scc1 L_redo_97_l
L_redo_97_x:
    s_nop 3
    s_branch L_back_98

L_redo_99:
    s_nop 15
    s_mov_b32 s96, 0
L_redo_99_l:
    s_add_u32 s83, s95, 16384
    buffer_load_dwordx4 v[128:131], v2, s[68:71], s83 offen offset:2048 sc1
    s_add_u32 s83, s95, 16384
    buffer_load_dwordx4 v[132:135], v2, s[68:71], s83 offen offset:3072 sc1
    s_add_u32 s83, s95, 20480
    buffer_load_dwordx4 v[136:139], v2, s[68:71], s83 offen offset:2048 sc1
    s_add_u32 s83, s95, 20480
    buffer_load_dwordx4 v[140:143], v2, s[68:71], s83 offen offset:3072 sc1
    s_add_u32 s83, s95, 24576
    buffer_load_dwordx4 v[144:147], v2, s[68:71], s83 offen offset:2048 sc1
    s_add_u32 s83, s95, 24576
    buffer_load_dwordx4 v[148:151], v2, s[68:71], s83 offen offset:3072 sc1
    s_add_u32 s83, s95, 28672
    buffer_load_dwordx4 v[152:155], v2, s[68:71], s83 offen offset:2048 sc1
    s_add_u32 s83, s95, 28672
    buffer_load_dwordx4 v[156:159], v2, s[68:71], s83 offen offset:3072 sc1
    s_add_u32 s96, s96, 1
    s_waitcnt vmcnt(0)
    v_max3_u32 v254, v128, v132, v136
    v_max_u32 v254, v254, v140
    v_cmp_eq_u32 vcc, -1, v254
    s_nop 1
    s_cbranch_vccz L_redo_99_x
    s_cmp_lt_u32 s96, 50000
    s_cbranch_scc1 L_redo_99_l
L_redo_99_x:
    s_nop 3
    s_branch L_back_100

L_redo_101:
    s_nop 15
    s_mov_b32 s96, 0
L_redo_101_l:
    s_add_u32 s83, s95, 24576
    buffer_load_dwordx4 v[144:147], v2, s[68:71], s83 offen offset:2048 sc1
    s_add_u32 s83, s95, 24576
    buffer_load_dwordx4 v[148:151], v2, s[68:71], s83 offen offset:3072 sc1
    s_add_u32 s83, s95, 28672
    buffer_load_dwordx4 v[152:155], v2, s[68:71], s83 offen offset:2048 sc1
    s_add_u32 s83, s95, 28672
    buffer_load_dwordx4 v[156:159], v2, s[68:71], s83 offen offset:3072 sc1
    s_add_u32 s96, s96, 1
    s_waitcnt vmcnt(0)
    v_max3_u32 v254, v144, v148, v152
    v_max_u32 v254, v254, v156
    v_cmp_eq_u32 vcc, -1, v254
    s_nop 1
    s_cbranch_vccz L_redo_101_x
    s_cmp_lt_u32 s96, 50000
    s_cbranch_scc1 L_redo_101_l
L_redo_101_x:
    s_nop 3
    s_branch L_back_102

L_redo_106:
    s_nop 15
    s_mov_b32 s96, 0
L_redo_106_l:
    s_xor_b32 s80, s84, 0
    s_lshl_b32 s82, s77, 16
    s_lshl_b32 s81, s80, 15
    s_add_u32 s82, s82, s81
    s_lshl_b32 s81, s3, 13
    s_add_u32 s82, s82, s81
    s_add_u32 s82, s82, 4194304
    buffer_load_dwordx4 v[32:35], v2, s[68:71], s82 offen offset:0 sc1
    buffer_load_dwordx4 v[36:39], v2, s[68:71], s82 offen offset:1024 sc1
    s_xor_b32 s80, s84, 1
    s_lshl_b32 s82, s77, 16
    s_lshl_b32 s81, s80, 15
    s_add_u32 s82, s82, s81
    s_lshl_b32 s81, s3, 13
    s_add_u32 s82, s82, s81
    s_add_u32 s82, s82, 4194304
    buffer_load_dwordx4 v[64:67], v2, s[68:71], s82 offen offset:0 sc1
    buffer_load_dwordx4 v[68:71], v2, s[68:71], s82 offen offset:1024 sc1
    s_add_u32 s96, s96, 1
    s_waitcnt vmcnt(0)
    v_max3_u32 v9, v32, v64, v36
    v_max_u32 v9, v9, v68
    v_cmp_eq_u32 vcc, -1, v9
    s_nop 1
    s_cbranch_vccz L_redo_106_x
    s_cmp_lt_u32 s96, 50000
    s_cbranch_scc1 L_redo_106_l
L_redo_106_x:
    s_nop 3
    s_branch L_back_107

L_redo_108:
    s_nop 15
    s_mov_b32 s96, 0
L_redo_108_l:
    s_xor_b32 s80, s84, 0
    s_lshl_b32 s82, s77, 16
    s_lshl_b32 s81, s80, 15
    s_add_u32 s82, s82, s81
    s_lshl_b32 s81, s3, 13
    s_add_u32 s82, s82, s81
    s_add_u32 s82, s82, 4196352
    buffer_load_dwordx4 v[40:43], v2, s[68:71], s82 offen offset:0 sc1
    buffer_load_dwordx4 v[44:47], v2, s[68:71], s82 offen offset:1024 sc1
    s_xor_b32 s80, s84, 1
    s_lshl_b32 s82, s77, 16
    s_lshl_b32 s81, s80, 15
    s_add_u32 s82, s82, s81
    s_lshl_b32 s81, s3, 13
    s_add_u32 s82, s82, s81
    s_add_u32 s82, s82, 4196352
    buffer_load_dwordx4 v[72:75], v2, s[68:71], s82 offen offset:0 sc1
    buffer_load_dwordx4 v[76:79], v2, s[68:71], s82 offen offset:1024 sc1
    s_add_u32 s96, s96, 1
    s_waitcnt vmcnt(0)
    v_max3_u32 v9, v40, v72, v44
    v_max_u32 v9, v9, v76
    v_cmp_eq_u32 vcc, -1, v9
    s_nop 1
    s_cbranch_vccz L_redo_108_x
    s_cmp_lt_u32 s96, 50000
    s_cbranch_scc1 L_redo_108_l
L_redo_108_x:
    s_nop 3
    s_branch L_back_109

L_redo_110:
    s_nop 15
    s_mov_b32 s96, 0
L_redo_110_l:
    s_xor_b32 s80, s84, 0
    s_lshl_b32 s82, s77, 16
    s_lshl_b32 s81, s80, 15
    s_add_u32 s82, s82, s81
    s_lshl_b32 s81, s3, 13
    s_add_u32 s82, s82, s81
    s_add_u32 s82, s82, 4198400
    buffer_load_dwordx4 v[48:51], v2, s[68:71], s82 offen offset:0 sc1
    buffer_load_dwordx4 v[52:55], v2, s[68:71], s82 offen offset:1024 sc1
    s_xor_b32 s80, s84, 1
    s_lshl_b32 s82, s77, 16
    s_lshl_b32 s81, s80, 15
    s_add_u32 s82, s82, s81
    s_lshl_b32 s81, s3, 13
    s_add_u32 s82, s82, s81
    s_add_u32 s82, s82, 4198400
    buffer_load_dwordx4 v[80:83], v2, s[68:71], s82 offen offset:0 sc1
    buffer_load_dwordx4 v[84:87], v2, s[68:71], s82 offen offset:1024 sc1
    s_add_u32 s96, s96, 1
    s_waitcnt vmcnt(0)
    v_max3_u32 v9, v48, v80, v52
    v_max_u32 v9, v9, v84
    v_cmp_eq_u32 vcc, -1, v9
    s_nop 1
    s_cbranch_vccz L_redo_110_x
    s_cmp_lt_u32 s96, 50000
    s_cbranch_scc1 L_redo_110_l
L_redo_110_x:
    s_nop 3
    s_branch L_back_111

L_redo_112:
    s_nop 15
    s_mov_b32 s96, 0
L_redo_112_l:
    s_xor_b32 s80, s84, 0
    s_lshl_b32 s82, s77, 16
    s_lshl_b32 s81, s80, 15
    s_add_u32 s82, s82, s81
    s_lshl_b32 s81, s3, 13
    s_add_u32 s82, s82, s81
    s_add_u32 s82, s82, 4200448
    buffer_load_dwordx4 v[56:59], v2, s[68:71], s82 offen offset:0 sc1
    buffer_load_dwordx4 v[60:63], v2, s[68:71], s82 offen offset:1024 sc1
    s_xor_b32 s80, s84, 1
    s_lshl_b32 s82, s77, 16
    s_lshl_b32 s81, s80, 15
    s_add_u32 s82, s82, s81
    s_lshl_b32 s81, s3, 13
    s_add_u32 s82, s82, s81
    s_add_u32 s82, s82, 4200448
    buffer_load_dwordx4 v[88:91], v2, s[68:71], s82 offen offset:0 sc1
    buffer_load_dwordx4 v[92:95], v2, s[68:71], s82 offen offset:1024 sc1
    s_add_u32 s96, s96, 1
    s_waitcnt vmcnt(0)
    v_max3_u32 v9, v56, v88, v60
    v_max_u32 v9, v9, v92
    v_cmp_eq_u32 vcc, -1, v9
    s_nop 1
    s_cbranch_vccz L_redo_112_x
    s_cmp_lt_u32 s96, 50000
    s_cbranch_scc1 L_redo_112_l
L_redo_112_x:
    s_nop 3
    s_branch L_back_113

L_redo_118:
    s_nop 15
    s_mov_b32 s96, 0
L_redo_118_l:
    s_lshl_b32 s80, s75, 18
    s_lshl_b32 s81, s3, 15
    s_add_u32 s80, s80, s81
    s_add_u32 s80, s80, 8388608
    buffer_load_dwordx4 v[184:187], v2, s[68:71], s80 offen offset:0 sc1
    buffer_load_dwordx4 v[188:191], v2, s[68:71], s80 offen offset:1024 sc1
    buffer_load_dwordx4 v[192:195], v2, s[68:71], s80 offen offset:2048 sc1
    buffer_load_dwordx4 v[196:199], v2, s[68:71], s80 offen offset:3072 sc1
    s_lshl_b32 s80, s75, 18
    s_lshl_b32 s81, s3, 15
    s_add_u32 s80, s80, s81
    s_add_u32 s80, s80, 8392704
    buffer_load_dwordx4 v[200:203], v2, s[68:71], s80 offen offset:0 sc1
    buffer_load_dwordx4 v[204:207], v2, s[68:71], s80 offen offset:1024 sc1
    buffer_load_dwordx4 v[208:211], v2, s[68:71], s80 offen offset:2048 sc1
    buffer_load_dwordx4 v[212:215], v2, s[68:71], s80 offen offset:3072 sc1
    s_lshl_b32 s80, s75, 18
    s_lshl_b32 s81, s3, 15
    s_add_u32 s80, s80, s81
    s_add_u32 s80, s80, 8396800
    buffer_load_dwordx4 v[216:219], v2, s[68:71], s80 offen offset:0 sc1
    buffer_load_dwordx4 v[220:223], v2, s[68:71], s80 offen offset:1024 sc1
    buffer_load_dwordx4 v[224:227], v2, s[68:71], s80 offen offset:2048 sc1
    buffer_load_dwordx4 v[228:231], v2, s[68:71], s80 offen offset:3072 sc1
    s_lshl_b32 s80, s75, 18
    s_lshl_b32 s81, s3, 15
    s_add_u32 s80, s80, s81
    s_add_u32 s80, s80, 8400896
    buffer_load_dwordx4 v[232:235], v2, s[68:71], s80 offen offset:0 sc1
    buffer_load_dwordx4 v[236:239], v2, s[68:71], s80 offen offset:1024 sc1
    buffer_load_dwordx4 v[240:243], v2, s[68:71], s80 offen offset:2048 sc1
    buffer_load_dwordx4 v[244:247], v2, s[68:71], s80 offen offset:3072 sc1
    s_lshl_b32 s80, s75, 18
    s_lshl_b32 s81, s3, 15
    s_add_u32 s80, s80, s81
    s_add_u32 s80, s80, 8404992
    buffer_load_dwordx4 v[120:123], v2, s[68:71], s80 offen offset:0 sc1
    buffer_load_dwordx4 v[124:127], v2, s[68:71], s80 offen offset:1024 sc1
    s_add_u32 s96, s96, 1
    s_waitcnt vmcnt(0)
    v_max3_u32 v9, v184, v188, v192
    v_max_u32 v9, v9, v196
    v_cmp_eq_u32 vcc, -1, v9
    s_nop 1
    s_cbranch_vccz L_redo_118_x
    s_cmp_lt_u32 s96, 50000
    s_cbranch_scc1 L_redo_118_l
L_redo_118_x:
    s_nop 3
    s_branch L_back_119

L_redo_120:
    s_nop 15
    s_mov_b32 s96, 0
L_redo_120_l:
    s_lshl_b32 s80, s75, 18
    s_lshl_b32 s81, s3, 15
    s_add_u32 s80, s80, s81
    s_add_u32 s80, s80, 8392704
    buffer_load_dwordx4 v[200:203], v2, s[68:71], s80 offen offset:0 sc1
    buffer_load_dwordx4 v[204:207], v2, s[68:71], s80 offen offset:1024 sc1
    buffer_load_dwordx4 v[208:211], v2, s[68:71], s80 offen offset:2048 sc1
    buffer_load_dwordx4 v[212:215], v2, s[68:71], s80 offen offset:3072 sc1
    s_lshl_b32 s80, s75, 18
    s_lshl_b32 s81, s3, 15
    s_add_u32 s80, s80, s81
    s_add_u32 s80, s80, 8396800
    buffer_load_dwordx4 v[216:219], v2, s[68:71], s80 offen offset:0 sc1
    buffer_load_dwordx4 v[220:223], v2, s[68:71], s80 offen offset:1024 sc1
    buffer_load_dwordx4 v[224:227], v2, s[68:71], s80 offen offset:2048 sc1
    buffer_load_dwordx4 v[228:231], v2, s[68:71], s80 offen offset:3072 sc1
    s_lshl_b32 s80, s75, 18
    s_lshl_b32 s81, s3, 15
    s_add_u32 s80, s80, s81
    s_add_u32 s80, s80, 8400896
    buffer_load_dwordx4 v[232:235], v2, s[68:71], s80 offen offset:0 sc1
    buffer_load_dwordx4 v[236:239], v2, s[68:71], s80 offen offset:1024 sc1
    buffer_load_dwordx4 v[240:243], v2, s[68:71], s80 offen offset:2048 sc1
    buffer_load_dwordx4 v[244:247], v2, s[68:71], s80 offen offset:3072 sc1
    s_lshl_b32 s80, s75, 18
    s_lshl_b32 s81, s3, 15
    s_add_u32 s80, s80, s81
    s_add_u32 s80, s80, 8404992
    buffer_load_dwordx4 v[120:123], v2, s[68:71], s80 offen offset:0 sc1
    buffer_load_dwordx4 v[124:127], v2, s[68:71], s80 offen offset:1024 sc1
    buffer_load_dwordx4 v[184:187], v2, s[68:71], s80 offen offset:2048 sc1
    buffer_load_dwordx4 v[188:191], v2, s[68:71], s80 offen offset:3072 sc1
    s_lshl_b32 s80, s75, 18
    s_lshl_b32 s81, s3, 15
    s_add_u32 s80, s80, s81
    s_add_u32 s80, s80, 8409088
    buffer_load_dwordx4 v[192:195], v2, s[68:71], s80 offen offset:0 sc1
    s_add_u32 s96, s96, 1
    s_waitcnt vmcnt(0)
    v_max3_u32 v9, v200, v204, v208
    v_max_u32 v9, v9, v212
    v_cmp_eq_u32 vcc, -1, v9
    s_nop 1
    s_cbranch_vccz L_redo_120_x
    s_cmp_lt_u32 s96, 50000
    s_cbranch_scc1 L_redo_120_l
L_redo_120_x:
    s_nop 3
    s_branch L_back_121

L_redo_122:
    s_nop 15
    s_mov_b32 s96, 0
L_redo_122_l:
    s_lshl_b32 s80, s75, 18
    s_lshl_b32 s81, s3, 15
    s_add_u32 s80, s80, s81
    s_add_u32 s80, s80, 8396800
    buffer_load_dwordx4 v[216:219], v2, s[68:71], s80 offen offset:0 sc1
    buffer_load_dwordx4 v[220:223], v2, s[68:71], s80 offen offset:1024 sc1
    buffer_load_dwordx4 v[224:227], v2, s[68:71], s80 offen offset:2048 sc1
    buffer_load_dwordx4 v[228:231], v2, s[68:71], s80 offen offset:3072 sc1
    s_lshl_b32 s80, s75, 18
    s_lshl_b32 s81, s3, 15
    s_add_u32 s80, s80, s81
    s_add_u32 s80, s80, 8400896
    buffer_load_dwordx4 v[232:235], v2, s[68:71], s80 offen offset:0 sc1
    buffer_load_dwordx4 v[236:239], v2, s[68:71], s80 offen offset:1024 sc1
    buffer_load_dwordx4 v[240:243], v2, s[68:71], s80 offen offset:2048 sc1
    buffer_load_dwordx4 v[244:247], v2, s[68:71], s80 offen offset:3072 sc1
    s_lshl_b32 s80, s75, 18
    s_lshl_b32 s81, s3, 15
    s_add_u32 s80, s80, s81
    s_add_u32 s80, s80, 8404992
    buffer_load_dwordx4 v[120:123], v2, s[68:71], s80 offen offset:0 sc1
    buffer_load_dwordx4 v[124:127], v2, s[68:71], s80 offen offset:1024 sc1
    buffer_load_dwordx4 v[184:187], v2, s[68:71], s80 offen offset:2048 sc1
    buffer_load_dwordx4 v[188:191], v2, s[68:71], s80 offen offset:3072 sc1
    s_lshl_b32 s80, s75, 18
    s_lshl_b32 s81, s3, 15
    s_add_u32 s80, s80, s81
    s_add_u32 s80, s80, 8409088
    buffer_load_dwordx4 v[192:195], v2, s[68:71], s80 offen offset:0 sc1
    buffer_load_dwordx4 v[196:199], v2, s[68:71], s80 offen offset:1024 sc1
    buffer_load_dwordx4 v[200:203], v2, s[68:71], s80 offen offset:2048 sc1
    buffer_load_dwordx4 v[204:207], v2, s[68:71], s80 offen offset:3072 sc1
    s_lshl_b32 s80, s75, 18
    s_lshl_b32 s81, s3, 15
    s_add_u32 s80, s80, s81
    s_add_u32 s80, s80, 8413184
    buffer_load_dwordx4 v[208:211], v2, s[68:71], s80 offen offset:0 sc1
    s_add_u32 s96, s96, 1
    s_waitcnt vmcnt(0)
    v_max3_u32 v9, v216, v220, v224
    v_max_u32 v9, v9, v228
    v_cmp_eq_u32 vcc, -1, v9
    s_nop 1
    s_cbranch_vccz L_redo_122_x
    s_cmp_lt_u32 s96, 50000
    s_cbranch_scc1 L_redo_122_l
L_redo_122_x:
    s_nop 3
    s_branch L_back_123

L_redo_124:
    s_nop 15
    s_mov_b32 s96, 0
L_redo_124_l:
    s_lshl_b32 s80, s75, 18
    s_lshl_b32 s81, s3, 15
    s_add_u32 s80, s80, s81
    s_add_u32 s80, s80, 8400896
    buffer_load_dwordx4 v[232:235], v2, s[68:71], s80 offen offset:0 sc1
    buffer_load_dwordx4 v[236:239], v2, s[68:71], s80 offen offset:1024 sc1
    buffer_load_dwordx4 v[240:243], v2, s[68:71], s80 offen offset:2048 sc1
    buffer_load_dwordx4 v[244:247], v2, s[68:71], s80 offen offset:3072 sc1
    s_lshl_b32 s80, s75, 18
    s_lshl_b32 s81, s3, 15
    s_add_u32 s80, s80, s81
    s_add_u32 s80, s80, 8404992
    buffer_load_dwordx4 v[120:123], v2, s[68:71], s80 offen offset:0 sc1
    buffer_load_dwordx4 v[124:127], v2, s[68:71], s80 offen offset:1024 sc1
    buffer_load_dwordx4 v[184:187], v2, s[68:71], s80 offen offset:2048 sc1
    buffer_load_dwordx4 v[188:191], v2, s[68:71], s80 offen offset:3072 sc1
    s_lshl_b32 s80, s75, 18
    s_lshl_b32 s81, s3, 15
    s_add_u32 s80, s80, s81
    s_add_u32 s80, s80, 8409088
    buffer_load_dwordx4 v[192:195], v2, s[68:71], s80 offen offset:0 sc1
    buffer_load_dwordx4 v[196:199], v2, s[68:71], s80 offen offset:1024 sc1
    buffer_load_dwordx4 v[200:203], v2, s[68:71], s80 offen offset:2048 sc1
    buffer_load_dwordx4 v[204:207], v2, s[68:71], s80 offen offset:3072 sc1
    s_lshl_b32 s80, s75, 18
    s_lshl_b32 s81, s3, 15
    s_add_u32 s80, s80, s81
    s_add_u32 s80, s80, 8413184
    buffer_load_dwordx4 v[208:211], v2, s[68:71], s80 offen offset:0 sc1
    buffer_load_dwordx4 v[212:215], v2, s[68:71], s80 offen offset:1024 sc1
    buffer_load_dwordx4 v[216:219], v2, s[68:71], s80 offen offset:2048 sc1
    buffer_load_dwordx4 v[220:223], v2, s[68:71], s80 offen offset:3072 sc1
    s_lshl_b32 s80, s75, 18
    s_lshl_b32 s81, s3, 15
    s_add_u32 s80, s80, s81
    s_add_u32 s80, s80, 8417280
    buffer_load_dwordx4 v[224:227], v2, s[68:71], s80 offen offset:0 sc1
    s_add_u32 s96, s96, 1
    s_waitcnt vmcnt(0)
    v_max3_u32 v9, v232, v236, v240
    v_max_u32 v9, v9, v244
    v_cmp_eq_u32 vcc, -1, v9
    s_nop 1
    s_cbranch_vccz L_redo_124_x
    s_cmp_lt_u32 s96, 50000
    s_cbranch_scc1 L_redo_124_l
L_redo_124_x:
    s_nop 3
    s_branch L_back_125

L_redo_126:
    s_nop 15
    s_mov_b32 s96, 0
L_redo_126_l:
    s_lshl_b32 s80, s75, 18
    s_lshl_b32 s81, s3, 15
    s_add_u32 s80, s80, s81
    s_add_u32 s80, s80, 8404992
    buffer_load_dwordx4 v[120:123], v2, s[68:71], s80 offen offset:0 sc1
    buffer_load_dwordx4 v[124:127], v2, s[68:71], s80 offen offset:1024 sc1
    buffer_load_dwordx4 v[184:187], v2, s[68:71], s80 offen offset:2048 sc1
    buffer_load_dwordx4 v[188:191], v2, s[68:71], s80 offen offset:3072 sc1
    s_lshl_b32 s80, s75, 18
    s_lshl_b32 s81, s3, 15
    s_add_u32 s80, s80, s81
    s_add_u32 s80, s80, 8409088
    buffer_load_dwordx4 v[192:195], v2, s[68:71], s80 offen offset:0 sc1
    buffer_load_dwordx4 v[196:199], v2, s[68:71], s80 offen offset:1024 sc1
    buffer_load_dwordx4 v[200:203], v2, s[68:71], s80 offen offset:2048 sc1
    buffer_load_dwordx4 v[204:207], v2, s[68:71], s80 offen offset:3072 sc1
    s_lshl_b32 s80, s75, 18
    s_lshl_b32 s81, s3, 15
    s_add_u32 s80, s80, s81
    s_add_u32 s80, s80, 8413184
    buffer_load_dwordx4 v[208:211], v2, s[68:71], s80 offen offset:0 sc1
    buffer_load_dwordx4 v[212:215], v2, s[68:71], s80 offen offset:1024 sc1
    buffer_load_dwordx4 v[216:219], v2, s[68:71], s80 offen offset:2048 sc1
    buffer_load_dwordx4 v[220:223], v2, s[68:71], s80 offen offset:3072 sc1
    s_lshl_b32 s80, s75, 18
    s_lshl_b32 s81, s3, 15
    s_add_u32 s80, s80, s81
    s_add_u32 s80, s80, 8417280
    buffer_load_dwordx4 v[224:227], v2, s[68:71], s80 offen offset:0 sc1
    buffer_load_dwordx4 v[228:231], v2, s[68:71], s80 offen offset:1024 sc1
    buffer_load_dwordx4 v[232:235], v2, s[68:71], s80 offen offset:2048 sc1
    buffer_load_dwordx4 v[236:239], v2, s[68:71], s80 offen offset:3072 sc1
    s_lshl_b32 s80, s75, 18
    s_lshl_b32 s81, s3, 15
    s_add_u32 s80, s80, s81
    s_add_u32 s80, s80, 8519680
    buffer_load_dwordx4 v[240:243], v2, s[68:71], s80 offen offset:0 sc1
    s_add_u32 s96, s96, 1
    s_waitcnt vmcnt(0)
    v_max3_u32 v9, v120, v124, v184
    v_max_u32 v9, v9, v188
    v_cmp_eq_u32 vcc, -1, v9
    s_nop 1
    s_cbranch_vccz L_redo_126_x
    s_cmp_lt_u32 s96, 50000
    s_cbranch_scc1 L_redo_126_l
L_redo_126_x:
    s_nop 3
    s_branch L_back_127

L_redo_128:
    s_nop 15
    s_mov_b32 s96, 0
L_redo_128_l:
    s_lshl_b32 s80, s75, 18
    s_lshl_b32 s81, s3, 15
    s_add_u32 s80, s80, s81
    s_add_u32 s80, s80, 8409088
    buffer_load_dwordx4 v[192:195], v2, s[68:71], s80 offen offset:0 sc1
    buffer_load_dwordx4 v[196:199], v2, s[68:71], s80 offen offset:1024 sc1
    buffer_load_dwordx4 v[200:203], v2, s[68:71], s80 offen offset:2048 sc1
    buffer_load_dwordx4 v[204:207], v2, s[68:71], s80 offen offset:3072 sc1
    s_lshl_b32 s80, s75, 18
    s_lshl_b32 s81, s3, 15
    s_add_u32 s80, s80, s81
    s_add_u32 s80, s80, 8413184
    buffer_load_dwordx4 v[208:211], v2, s[68:71], s80 offen offset:0 sc1
    buffer_load_dwordx4 v[212:215], v2, s[68:71], s80 offen offset:1024 sc1
    buffer_load_dwordx4 v[216:219], v2, s[68:71], s80 offen offset:2048 sc1
    buffer_load_dwordx4 v[220:223], v2, s[68:71], s80 offen offset:3072 sc1
    s_lshl_b32 s80, s75, 18
    s_lshl_b32 s81, s3, 15
    s_add_u32 s80, s80, s81
    s_add_u32 s80, s80, 8417280
    buffer_load_dwordx4 v[224:227], v2, s[68:71], s80 offen offset:0 sc1
    buffer_load_dwordx4 v[228:231], v2, s[68:71], s80 offen offset:1024 sc1
    buffer_load_dwordx4 v[232:235], v2, s[68:71], s80 offen offset:2048 sc1
    buffer_load_dwordx4 v[236:239], v2, s[68:71], s80 offen offset:3072 sc1
    s_lshl_b32 s80, s75, 18
    s_lshl_b32 s81, s3, 15
    s_add_u32 s80, s80, s81
    s_add_u32 s80, s80, 8519680
    buffer_load_dwordx4 v[240:243], v2, s[68:71], s80 offen offset:0 sc1
    buffer_load_dwordx4 v[244:247], v2, s[68:71], s80 offen offset:1024 sc1
    buffer_load_dwordx4 v[120:123], v2, s[68:71], s80 offen offset:2048 sc1
    buffer_load_dwordx4 v[124:127], v2, s[68:71], s80 offen offset:3072 sc1
    s_lshl_b32 s80, s75, 18
    s_lshl_b32 s81, s3, 15
    s_add_u32 s80, s80, s81
    s_add_u32 s80, s80, 8523776
    buffer_load_dwordx4 v[184:187], v2, s[68:71], s80 offen offset:0 sc1
    s_add_u32 s96, s96, 1
    s_waitcnt vmcnt(0)
    v_max3_u32 v9, v192, v196, v200
    v_max_u32 v9, v9, v204
    v_cmp_eq_u32 vcc, -1, v9
    s_nop 1
    s_cbranch_vccz L_redo_128_x
    s_cmp_lt_u32 s96, 50000
    s_cbranch_scc1 L_redo_128_l
L_redo_128_x:
    s_nop 3
    s_branch L_back_129

L_redo_130:
    s_nop 15
    s_mov_b32 s96, 0
L_redo_130_l:
    s_lshl_b32 s80, s75, 18
    s_lshl_b32 s81, s3, 15
    s_add_u32 s80, s80, s81
    s_add_u32 s80, s80, 8413184
    buffer_load_dwordx4 v[208:211], v2, s[68:71], s80 offen offset:0 sc1
    buffer_load_dwordx4 v[212:215], v2, s[68:71], s80 offen offset:1024 sc1
    buffer_load_dwordx4 v[216:219], v2, s[68:71], s80 offen offset:2048 sc1
    buffer_load_dwordx4 v[220:223], v2, s[68:71], s80 offen offset:3072 sc1
    s_lshl_b32 s80, s75, 18
    s_lshl_b32 s81, s3, 15
    s_add_u32 s80, s80, s81
    s_add_u32 s80, s80, 8417280
    buffer_load_dwordx4 v[224:227], v2, s[68:71], s80 offen offset:0 sc1
    buffer_load_dwordx4 v[228:231], v2, s[68:71], s80 offen offset:1024 sc1
    buffer_load_dwordx4 v[232:235], v2, s[68:71], s80 offen offset:2048 sc1
    buffer_load_dwordx4 v[236:239], v2, s[68:71], s80 offen offset:3072 sc1
    s_lshl_b32 s80, s75, 18
    s_lshl_b32 s81, s3, 15
    s_add_u32 s80, s80, s81
    s_add_u32 s80, s80, 8519680
    buffer_load_dwordx4 v[240:243], v2, s[68:71], s80 offen offset:0 sc1
    buffer_load_dwordx4 v[244:247], v2, s[68:71], s80 offen offset:1024 sc1
    buffer_load_dwordx4 v[120:123], v2, s[68:71], s80 offen offset:2048 sc1
    buffer_load_dwordx4 v[124:127], v2, s[68:71], s80 offen offset:3072 sc1
    s_lshl_b32 s80, s75, 18
    s_lshl_b32 s81, s3, 15
    s_add_u32 s80, s80, s81
    s_add_u32 s80, s80, 8523776
    buffer_load_dwordx4 v[184:187], v2, s[68:71], s80 offen offset:0 sc1
    buffer_load_dwordx4 v[188:191], v2, s[68:71], s80 offen offset:1024 sc1
    buffer_load_dwordx4 v[192:195], v2, s[68:71], s80 offen offset:2048 sc1
    buffer_load_dwordx4 v[196:199], v2, s[68:71], s80 offen offset:3072 sc1
    s_lshl_b32 s80, s75, 18
    s_lshl_b32 s81, s3, 15
    s_add_u32 s80, s80, s81
    s_add_u32 s80, s80, 8527872
    buffer_load_dwordx4 v[200:203], v2, s[68:71], s80 offen offset:0 sc1
    s_add_u32 s96, s96, 1
    s_waitcnt vmcnt(0)
    v_max3_u32 v9, v208, v212, v216
    v_max_u32 v9, v9, v220
    v_cmp_eq_u32 vcc, -1, v9
    s_nop 1
    s_cbranch_vccz L_redo_130_x
    s_cmp_lt_u32 s96, 50000
    s_cbranch_scc1 L_redo_130_l
L_redo_130_x:
    s_nop 3
    s_branch L_back_131

L_redo_132:
    s_nop 15
    s_mov_b32 s96, 0
L_redo_132_l:
    s_lshl_b32 s80, s75, 18
    s_lshl_b32 s81, s3, 15
    s_add_u32 s80, s80, s81
    s_add_u32 s80, s80, 8417280
    buffer_load_dwordx4 v[224:227], v2, s[68:71], s80 offen offset:0 sc1
    buffer_load_dwordx4 v[228:231], v2, s[68:71], s80 offen offset:1024 sc1
    buffer_load_dwordx4 v[232:235], v2, s[68:71], s80 offen offset:2048 sc1
    buffer_load_dwordx4 v[236:239], v2, s[68:71], s80 offen offset:3072 sc1
    s_lshl_b32 s80, s75, 18
    s_lshl_b32 s81, s3, 15
    s_add_u32 s80, s80, s81
    s_add_u32 s80, s80, 8519680
    buffer_load_dwordx4 v[240:243], v2, s[68:71], s80 offen offset:0 sc1
    buffer_load_dwordx4 v[244:247], v2, s[68:71], s80 offen offset:1024 sc1
    buffer_load_dwordx4 v[120:123], v2, s[68:71], s80 offen offset:2048 sc1
    buffer_load_dwordx4 v[124:127], v2, s[68:71], s80 offen offset:3072 sc1
    s_lshl_b32 s80, s75, 18
    s_lshl_b32 s81, s3, 15
    s_add_u32 s80, s80, s81
    s_add_u32 s80, s80, 8523776
    buffer_load_dwordx4 v[184:187], v2, s[68:71], s80 offen offset:0 sc1
    buffer_load_dwordx4 v[188:191], v2, s[68:71], s80 offen offset:1024 sc1
    buffer_load_dwordx4 v[192:195], v2, s[68:71], s80 offen offset:2048 sc1
    buffer_load_dwordx4 v[196:199], v2, s[68:71], s80 offen offset:3072 sc1
    s_lshl_b32 s80, s75, 18
    s_lshl_b32 s81, s3, 15
    s_add_u32 s80, s80, s81
    s_add_u32 s80, s80, 8527872
    buffer_load_dwordx4 v[200:203], v2, s[68:71], s80 offen offset:0 sc1
    buffer_load_dwordx4 v[204:207], v2, s[68:71], s80 offen offset:1024 sc1
    buffer_load_dwordx4 v[208:211], v2, s[68:71], s80 offen offset:2048 sc1
    buffer_load_dwordx4 v[212:215], v2, s[68:71], s80 offen offset:3072 sc1
    s_lshl_b32 s80, s75, 18
    s_lshl_b32 s81, s3, 15
    s_add_u32 s80, s80, s81
    s_add_u32 s80, s80, 8531968
    buffer_load_dwordx4 v[216:219], v2, s[68:71], s80 offen offset:0 sc1
    s_add_u32 s96, s96, 1
    s_waitcnt vmcnt(0)
    v_max3_u32 v9, v224, v228, v232
    v_max_u32 v9, v9, v236
    v_cmp_eq_u32 vcc, -1, v9
    s_nop 1
    s_cbranch_vccz L_redo_132_x
    s_cmp_lt_u32 s96, 50000
    s_cbranch_scc1 L_redo_132_l
L_redo_132_x:
    s_nop 3
    s_branch L_back_133

L_redo_134:
    s_nop 15
    s_mov_b32 s96, 0
L_redo_134_l:
    s_lshl_b32 s80, s75, 18
    s_lshl_b32 s81, s3, 15
    s_add_u32 s80, s80, s81
    s_add_u32 s80, s80, 8519680
    buffer_load_dwordx4 v[240:243], v2, s[68:71], s80 offen offset:0 sc1
    buffer_load_dwordx4 v[244:247], v2, s[68:71], s80 offen offset:1024 sc1
    buffer_load_dwordx4 v[120:123], v2, s[68:71], s80 offen offset:2048 sc1
    buffer_load_dwordx4 v[124:127], v2, s[68:71], s80 offen offset:3072 sc1
    s_lshl_b32 s80, s75, 18
    s_lshl_b32 s81, s3, 15
    s_add_u32 s80, s80, s81
    s_add_u32 s80, s80, 8523776
    buffer_load_dwordx4 v[184:187], v2, s[68:71], s80 offen offset:0 sc1
    buffer_load_dwordx4 v[188:191], v2, s[68:71], s80 offen offset:1024 sc1
    buffer_load_dwordx4 v[192:195], v2, s[68:71], s80 offen offset:2048 sc1
    buffer_load_dwordx4 v[196:199], v2, s[68:71], s80 offen offset:3072 sc1
    s_lshl_b32 s80, s75, 18
    s_lshl_b32 s81, s3, 15
    s_add_u32 s80, s80, s81
    s_add_u32 s80, s80, 8527872
    buffer_load_dwordx4 v[200:203], v2, s[68:71], s80 offen offset:0 sc1
    buffer_load_dwordx4 v[204:207], v2, s[68:71], s80 offen offset:1024 sc1
    buffer_load_dwordx4 v[208:211], v2, s[68:71], s80 offen offset:2048 sc1
    buffer_load_dwordx4 v[212:215], v2, s[68:71], s80 offen offset:3072 sc1
    s_lshl_b32 s80, s75, 18
    s_lshl_b32 s81, s3, 15
    s_add_u32 s80, s80, s81
    s_add_u32 s80, s80, 8531968
    buffer_load_dwordx4 v[216:219], v2, s[68:71], s80 offen offset:0 sc1
    buffer_load_dwordx4 v[220:223], v2, s[68:71], s80 offen offset:1024 sc1
    buffer_load_dwordx4 v[224:227], v2, s[68:71], s80 offen offset:2048 sc1
    buffer_load_dwordx4 v[228:231], v2, s[68:71], s80 offen offset:3072 sc1
    s_lshl_b32 s80, s75, 18
    s_lshl_b32 s81, s3, 15
    s_add_u32 s80, s80, s81
    s_add_u32 s80, s80, 8536064
    buffer_load_dwordx4 v[232:235], v2, s[68:71], s80 offen offset:0 sc1
    buffer_load_dwordx4 v[236:239], v2, s[68:71], s80 offen offset:1024 sc1
    s_add_u32 s96, s96, 1
    s_waitcnt vmcnt(0)
    v_max3_u32 v9, v240, v244, v120
    v_max_u32 v9, v9, v124
    v_cmp_eq_u32 vcc, -1, v9
    s_nop 1
    s_cbranch_vccz L_redo_134_x
    s_cmp_lt_u32 s96, 50000
    s_cbranch_scc1 L_redo_134_l
L_redo_134_x:
    s_nop 3
    s_branch L_back_135

L_redo_136:
    s_nop 15
    s_mov_b32 s96, 0
L_redo_136_l:
    s_lshl_b32 s80, s75, 18
    s_lshl_b32 s81, s3, 15
    s_add_u32 s80, s80, s81
    s_add_u32 s80, s80, 8523776
    buffer_load_dwordx4 v[184:187], v2, s[68:71], s80 offen offset:0 sc1
    buffer_load_dwordx4 v[188:191], v2, s[68:71], s80 offen offset:1024 sc1
    buffer_load_dwordx4 v[192:195], v2, s[68:71], s80 offen offset:2048 sc1
    buffer_load_dwordx4 v[196:199], v2, s[68:71], s80 offen offset:3072 sc1
    s_lshl_b32 s80, s75, 18
    s_lshl_b32 s81, s3, 15
    s_add_u32 s80, s80, s81
    s_add_u32 s80, s80, 8527872
    buffer_load_dwordx4 v[200:203], v2, s[68:71], s80 offen offset:0 sc1
    buffer_load_dwordx4 v[204:207], v2, s[68:71], s80 offen offset:1024 sc1
    buffer_load_dwordx4 v[208:211], v2, s[68:71], s80 offen offset:2048 sc1
    buffer_load_dwordx4 v[212:215], v2, s[68:71], s80 offen offset:3072 sc1
    s_lshl_b32 s80, s75, 18
    s_lshl_b32 s81, s3, 15
    s_add_u32 s80, s80, s81
    s_add_u32 s80, s80, 8531968
    buffer_load_dwordx4 v[216:219], v2, s[68:71], s80 offen offset:0 sc1
    buffer_load_dwordx4 v[220:223], v2, s[68:71], s80 offen offset:1024 sc1
    buffer_load_dwordx4 v[224:227], v2, s[68:71], s80 offen offset:2048 sc1
    buffer_load_dwordx4 v[228:231], v2, s[68:71], s80 offen offset:3072 sc1
    s_lshl_b32 s80, s75, 18
    s_lshl_b32 s81, s3, 15
    s_add_u32 s80, s80, s81
    s_add_u32 s80, s80, 8536064
    buffer_load_dwordx4 v[232:235], v2, s[68:71], s80 offen offset:0 sc1
    buffer_load_dwordx4 v[236:239], v2, s[68:71], s80 offen offset:1024 sc1
    buffer_load_dwordx4 v[240:243], v2, s[68:71], s80 offen offset:2048 sc1
    buffer_load_dwordx4 v[244:247], v2, s[68:71], s80 offen offset:3072 sc1
    s_lshl_b32 s80, s75, 18
    s_lshl_b32 s81, s3, 15
    s_add_u32 s80, s80, s81
    s_add_u32 s80, s80, 8540160
    buffer_load_dwordx4 v[120:123], v2, s[68:71], s80 offen offset:0 sc1
    s_add_u32 s96, s96, 1
    s_waitcnt vmcnt(0)
    v_max3_u32 v9, v184, v188, v192
    v_max_u32 v9, v9, v196
    v_cmp_eq_u32 vcc, -1, v9
    s_nop 1
    s_cbranch_vccz L_redo_136_x
    s_cmp_lt_u32 s96, 50000
    s_cbranch_scc1 L_redo_136_l
L_redo_136_x:
    s_nop 3
    s_branch L_back_137

L_redo_138:
    s_nop 15
    s_mov_b32 s96, 0
L_redo_138_l:
    s_lshl_b32 s80, s75, 18
    s_lshl_b32 s81, s3, 15
    s_add_u32 s80, s80, s81
    s_add_u32 s80, s80, 8527872
    buffer_load_dwordx4 v[200:203], v2, s[68:71], s80 offen offset:0 sc1
    buffer_load_dwordx4 v[204:207], v2, s[68:71], s80 offen offset:1024 sc1
    buffer_load_dwordx4 v[208:211], v2, s[68:71], s80 offen offset:2048 sc1
    buffer_load_dwordx4 v[212:215], v2, s[68:71], s80 offen offset:3072 sc1
    s_lshl_b32 s80, s75, 18
    s_lshl_b32 s81, s3, 15
    s_add_u32 s80, s80, s81
    s_add_u32 s80, s80, 8531968
    buffer_load_dwordx4 v[216:219], v2, s[68:71], s80 offen offset:0 sc1
    buffer_load_dwordx4 v[220:223], v2, s[68:71], s80 offen offset:1024 sc1
    buffer_load_dwordx4 v[224:227], v2, s[68:71], s80 offen offset:2048 sc1
    buffer_load_dwordx4 v[228:231], v2, s[68:71], s80 offen offset:3072 sc1
    s_lshl_b32 s80, s75, 18
    s_lshl_b32 s81, s3, 15
    s_add_u32 s80, s80, s81
    s_add_u32 s80, s80, 8536064
    buffer_load_dwordx4 v[232:235], v2, s[68:71], s80 offen offset:0 sc1
    buffer_load_dwordx4 v[236:239], v2, s[68:71], s80 offen offset:1024 sc1
    buffer_load_dwordx4 v[240:243], v2, s[68:71], s80 offen offset:2048 sc1
    buffer_load_dwordx4 v[244:247], v2, s[68:71], s80 offen offset:3072 sc1
    s_lshl_b32 s80, s75, 18
    s_lshl_b32 s81, s3, 15
    s_add_u32 s80, s80, s81
    s_add_u32 s80, s80, 8540160
    buffer_load_dwordx4 v[120:123], v2, s[68:71], s80 offen offset:0 sc1
    buffer_load_dwordx4 v[124:127], v2, s[68:71], s80 offen offset:1024 sc1
    buffer_load_dwordx4 v[184:187], v2, s[68:71], s80 offen offset:2048 sc1
    buffer_load_dwordx4 v[188:191], v2, s[68:71], s80 offen offset:3072 sc1
    s_lshl_b32 s80, s75, 18
    s_lshl_b32 s81, s3, 15
    s_add_u32 s80, s80, s81
    s_add_u32 s80, s80, 8544256
    buffer_load_dwordx4 v[192:195], v2, s[68:71], s80 offen offset:0 sc1
    s_add_u32 s96, s96, 1
    s_waitcnt vmcnt(0)
    v_max3_u32 v9, v200, v204, v208
    v_max_u32 v9, v9, v212
    v_cmp_eq_u32 vcc, -1, v9
    s_nop 1
    s_cbranch_vccz L_redo_138_x
    s_cmp_lt_u32 s96, 50000
    s_cbranch_scc1 L_redo_138_l
L_redo_138_x:
    s_nop 3
    s_branch L_back_139

L_redo_140:
    s_nop 15
    s_mov_b32 s96, 0
L_redo_140_l:
    s_lshl_b32 s80, s75, 18
    s_lshl_b32 s81, s3, 15
    s_add_u32 s80, s80, s81
    s_add_u32 s80, s80, 8531968
    buffer_load_dwordx4 v[216:219], v2, s[68:71], s80 offen offset:0 sc1
    buffer_load_dwordx4 v[220:223], v2, s[68:71], s80 offen offset:1024 sc1
    buffer_load_dwordx4 v[224:227], v2, s[68:71], s80 offen offset:2048 sc1
    buffer_load_dwordx4 v[228:231], v2, s[68:71], s80 offen offset:3072 sc1
    s_lshl_b32 s80, s75, 18
    s_lshl_b32 s81, s3, 15
    s_add_u32 s80, s80, s81
    s_add_u32 s80, s80, 8536064
    buffer_load_dwordx4 v[232:235], v2, s[68:71], s80 offen offset:0 sc1
    buffer_load_dwordx4 v[236:239], v2, s[68:71], s80 offen offset:1024 sc1
    buffer_load_dwordx4 v[240:243], v2, s[68:71], s80 offen offset:2048 sc1
    buffer_load_dwordx4 v[244:247], v2, s[68:71], s80 offen offset:3072 sc1
    s_lshl_b32 s80, s75, 18
    s_lshl_b32 s81, s3, 15
    s_add_u32 s80, s80, s81
    s_add_u32 s80, s80, 8540160
    buffer_load_dwordx4 v[120:123], v2, s[68:71], s80 offen offset:0 sc1
    buffer_load_dwordx4 v[124:127], v2, s[68:71], s80 offen offset:1024 sc1
    buffer_load_dwordx4 v[184:187], v2, s[68:71], s80 offen offset:2048 sc1
    buffer_load_dwordx4 v[188:191], v2, s[68:71], s80 offen offset:3072 sc1
    s_lshl_b32 s80, s75, 18
    s_lshl_b32 s81, s3, 15
    s_add_u32 s80, s80, s81
    s_add_u32 s80, s80, 8544256
    buffer_load_dwordx4 v[192:195], v2, s[68:71], s80 offen offset:0 sc1
    buffer_load_dwordx4 v[196:199], v2, s[68:71], s80 offen offset:1024 sc1
    buffer_load_dwordx4 v[200:203], v2, s[68:71], s80 offen offset:2048 sc1
    buffer_load_dwordx4 v[204:207], v2, s[68:71], s80 offen offset:3072 sc1
    s_lshl_b32 s80, s75, 18
    s_lshl_b32 s81, s3, 15
    s_add_u32 s80, s80, s81
    s_add_u32 s80, s80, 8548352
    buffer_load_dwordx4 v[208:211], v2, s[68:71], s80 offen offset:0 sc1
    s_add_u32 s96, s96, 1
    s_waitcnt vmcnt(0)
    v_max3_u32 v9, v216, v220, v224
    v_max_u32 v9, v9, v228
    v_cmp_eq_u32 vcc, -1, v9
    s_nop 1
    s_cbranch_vccz L_redo_140_x
    s_cmp_lt_u32 s96, 50000
    s_cbranch_scc1 L_redo_140_l
L_redo_140_x:
    s_nop 3
    s_branch L_back_141

L_redo_142:
    s_nop 15
    s_mov_b32 s96, 0
L_redo_142_l:
    s_lshl_b32 s80, s75, 18
    s_lshl_b32 s81, s3, 15
    s_add_u32 s80, s80, s81
    s_add_u32 s80, s80, 8536064
    buffer_load_dwordx4 v[232:235], v2, s[68:71], s80 offen offset:0 sc1
    buffer_load_dwordx4 v[236:239], v2, s[68:71], s80 offen offset:1024 sc1
    buffer_load_dwordx4 v[240:243], v2, s[68:71], s80 offen offset:2048 sc1
    buffer_load_dwordx4 v[244:247], v2, s[68:71], s80 offen offset:3072 sc1
    s_lshl_b32 s80, s75, 18
    s_lshl_b32 s81, s3, 15
    s_add_u32 s80, s80, s81
    s_add_u32 s80, s80, 8540160
    buffer_load_dwordx4 v[120:123], v2, s[68:71], s80 offen offset:0 sc1
    buffer_load_dwordx4 v[124:127], v2, s[68:71], s80 offen offset:1024 sc1
    buffer_load_dwordx4 v[184:187], v2, s[68:71], s80 offen offset:2048 sc1
    buffer_load_dwordx4 v[188:191], v2, s[68:71], s80 offen offset:3072 sc1
    s_lshl_b32 s80, s75, 18
    s_lshl_b32 s81, s3, 15
    s_add_u32 s80, s80, s81
    s_add_u32 s80, s80, 8544256
    buffer_load_dwordx4 v[192:195], v2, s[68:71], s80 offen offset:0 sc1
    buffer_load_dwordx4 v[196:199], v2, s[68:71], s80 offen offset:1024 sc1
    buffer_load_dwordx4 v[200:203], v2, s[68:71], s80 offen offset:2048 sc1
    buffer_load_dwordx4 v[204:207], v2, s[68:71], s80 offen offset:3072 sc1
    s_lshl_b32 s80, s75, 18
    s_lshl_b32 s81, s3, 15
    s_add_u32 s80, s80, s81
    s_add_u32 s80, s80, 8548352
    buffer_load_dwordx4 v[208:211], v2, s[68:71], s80 offen offset:0 sc1
    buffer_load_dwordx4 v[212:215], v2, s[68:71], s80 offen offset:1024 sc1
    buffer_load_dwordx4 v[216:219], v2, s[68:71], s80 offen offset:2048 sc1
    buffer_load_dwordx4 v[220:223], v2, s[68:71], s80 offen offset:3072 sc1
    s_add_u32 s96, s96, 1
    s_waitcnt vmcnt(0)
    v_max3_u32 v9, v232, v236, v240
    v_max_u32 v9, v9, v244
    v_cmp_eq_u32 vcc, -1, v9
    s_nop 1
    s_cbranch_vccz L_redo_142_x
    s_cmp_lt_u32 s96, 50000
    s_cbranch_scc1 L_redo_142_l
L_redo_142_x:
    s_nop 3
    s_branch L_back_143

L_redo_144:
    s_nop 15
    s_mov_b32 s96, 0
L_redo_144_l:
    s_lshl_b32 s80, s75, 18
    s_lshl_b32 s81, s3, 15
    s_add_u32 s80, s80, s81
    s_add_u32 s80, s80, 8540160
    buffer_load_dwordx4 v[120:123], v2, s[68:71], s80 offen offset:0 sc1
    buffer_load_dwordx4 v[124:127], v2, s[68:71], s80 offen offset:1024 sc1
    buffer_load_dwordx4 v[184:187], v2, s[68:71], s80 offen offset:2048 sc1
    buffer_load_dwordx4 v[188:191], v2, s[68:71], s80 offen offset:3072 sc1
    s_lshl_b32 s80, s75, 18
    s_lshl_b32 s81, s3, 15
    s_add_u32 s80, s80, s81
    s_add_u32 s80, s80, 8544256
    buffer_load_dwordx4 v[192:195], v2, s[68:71], s80 offen offset:0 sc1
    buffer_load_dwordx4 v[196:199], v2, s[68:71], s80 offen offset:1024 sc1
    buffer_load_dwordx4 v[200:203], v2, s[68:71], s80 offen offset:2048 sc1
    buffer_load_dwordx4 v[204:207], v2, s[68:71], s80 offen offset:3072 sc1
    s_lshl_b32 s80, s75, 18
    s_lshl_b32 s81, s3, 15
    s_add_u32 s80, s80, s81
    s_add_u32 s80, s80, 8548352
    buffer_load_dwordx4 v[208:211], v2, s[68:71], s80 offen offset:0 sc1
    buffer_load_dwordx4 v[212:215], v2, s[68:71], s80 offen offset:1024 sc1
    buffer_load_dwordx4 v[216:219], v2, s[68:71], s80 offen offset:2048 sc1
    buffer_load_dwordx4 v[220:223], v2, s[68:71], s80 offen offset:3072 sc1
    s_add_u32 s96, s96, 1
    s_waitcnt vmcnt(0)
    v_max3_u32 v9, v120, v124, v184
    v_max_u32 v9, v9, v188
    v_cmp_eq_u32 vcc, -1, v9
    s_nop 1
    s_cbranch_vccz L_redo_144_x
    s_cmp_lt_u32 s96, 50000
    s_cbranch_scc1 L_redo_144_l
L_redo_144_x:
    s_nop 3
    s_branch L_back_145

L_redo_146:
    s_nop 15
    s_mov_b32 s96, 0
L_redo_146_l:
    s_lshl_b32 s80, s75, 18
    s_lshl_b32 s81, s3, 15
    s_add_u32 s80, s80, s81
    s_add_u32 s80, s80, 8544256
    buffer_load_dwordx4 v[192:195], v2, s[68:71], s80 offen offset:0 sc1
    buffer_load_dwordx4 v[196:199], v2, s[68:71], s80 offen offset:1024 sc1
    buffer_load_dwordx4 v[200:203], v2, s[68:71], s80 offen offset:2048 sc1
    buffer_load_dwordx4 v[204:207], v2, s[68:71], s80 offen offset:3072 sc1
    s_lshl_b32 s80, s75, 18
    s_lshl_b32 s81, s3, 15
    s_add_u32 s80, s80, s81
    s_add_u32 s80, s80, 8548352
    buffer_load_dwordx4 v[208:211], v2, s[68:71], s80 offen offset:0 sc1
    buffer_load_dwordx4 v[212:215], v2, s[68:71], s80 offen offset:1024 sc1
    buffer_load_dwordx4 v[216:219], v2, s[68:71], s80 offen offset:2048 sc1
    buffer_load_dwordx4 v[220:223], v2, s[68:71], s80 offen offset:3072 sc1
    s_add_u32 s96, s96, 1
    s_waitcnt vmcnt(0)
    v_max3_u32 v9, v192, v196, v200
    v_max_u32 v9, v9, v204
    v_cmp_eq_u32 vcc, -1, v9
    s_nop 1
    s_cbranch_vccz L_redo_146_x
    s_cmp_lt_u32 s96, 50000
    s_cbranch_scc1 L_redo_146_l
L_redo_146_x:
    s_nop 3
    s_branch L_back_147

L_redo_148:
    s_nop 15
    s_mov_b32 s96, 0
L_redo_148_l:
    s_lshl_b32 s80, s75, 18
    s_lshl_b32 s81, s3, 15
    s_add_u32 s80, s80, s81
    s_add_u32 s80, s80, 8548352
    buffer_load_dwordx4 v[208:211], v2, s[68:71], s80 offen offset:0 sc1
    buffer_load_dwordx4 v[212:215], v2, s[68:71], s80 offen offset:1024 sc1
    buffer_load_dwordx4 v[216:219], v2, s[68:71], s80 offen offset:2048 sc1
    buffer_load_dwordx4 v[220:223], v2, s[68:71], s80 offen offset:3072 sc1
    s_mul_i32 s80, s76, 229376
    s_mul_i32 s81, s3, 28672
    s_add_u32 s80, s80, s81
    s_add_u32 s80, s80, 12582912
    buffer_load_dwordx4 v[224:227], v6, s[68:71], s80 offen offset:0 sc1
    buffer_load_dwordx4 v[228:231], v6, s[68:71], s80 offen offset:1024 sc1
    buffer_load_dwordx4 v[232:235], v6, s[68:71], s80 offen offset:2048 sc1
    buffer_load_dwordx4 v[236:239], v6, s[68:71], s80 offen offset:3072 sc1
    s_add_u32 s96, s96, 1
    s_waitcnt vmcnt(0)
    v_max3_u32 v9, v208, v212, v216
    v_max_u32 v9, v9, v220
    v_cmp_eq_u32 vcc, -1, v9
    s_nop 1
    s_cbranch_vccz L_redo_148_x
    s_cmp_lt_u32 s96, 50000
    s_cbranch_scc1 L_redo_148_l
L_redo_148_x:
    s_nop 3
    s_branch L_back_149

L_redo_153:
    s_nop 15
    s_mov_b32 s96, 0
L_redo_153_l:
    s_mul_i32 s80, s76, 229376
    s_mul_i32 s81, s3, 28672
    s_add_u32 s80, s80, s81
    s_add_u32 s80, s80, 12582912
    buffer_load_dwordx4 v[224:227], v6, s[68:71], s80 offen offset:0 sc1
    buffer_load_dwordx4 v[228:231], v6, s[68:71], s80 offen offset:1024 sc1
    buffer_load_dwordx4 v[232:235], v6, s[68:71], s80 offen offset:2048 sc1
    buffer_load_dwordx4 v[236:239], v6, s[68:71], s80 offen offset:3072 sc1
    s_mul_i32 s80, s76, 229376
    s_mul_i32 s81, s3, 28672
    s_add_u32 s80, s80, s81
    s_add_u32 s80, s80, 12587008
    buffer_load_dwordx4 v[240:243], v6, s[68:71], s80 offen offset:0 sc1
    buffer_load_dwordx4 v[244:247], v6, s[68:71], s80 offen offset:1024 sc1
    buffer_load_dwordx4 v[120:123], v6, s[68:71], s80 offen offset:2048 sc1
    buffer_load_dwordx4 v[124:127], v6, s[68:71], s80 offen offset:3072 sc1
    s_mul_i32 s80, s76, 229376
    s_mul_i32 s81, s3, 28672
    s_add_u32 s80, s80, s81
    s_add_u32 s80, s80, 12591104
    buffer_load_dwordx4 v[184:187], v6, s[68:71], s80 offen offset:0 sc1
    buffer_load_dwordx4 v[188:191], v6, s[68:71], s80 offen offset:1024 sc1
    buffer_load_dwordx4 v[192:195], v6, s[68:71], s80 offen offset:2048 sc1
    buffer_load_dwordx4 v[196:199], v6, s[68:71], s80 offen offset:3072 sc1
    s_mul_i32 s80, s76, 229376
    s_mul_i32 s81, s3, 28672
    s_add_u32 s80, s80, s81
    s_add_u32 s80, s80, 12595200
    buffer_load_dwordx4 v[200:203], v6, s[68:71], s80 offen offset:0 sc1
    buffer_load_dwordx4 v[204:207], v6, s[68:71], s80 offen offset:1024 sc1
    buffer_load_dwordx4 v[208:211], v6, s[68:71], s80 offen offset:2048 sc1
    buffer_load_dwordx4 v[212:215], v6, s[68:71], s80 offen offset:3072 sc1
    s_mul_i32 s80, s76, 229376
    s_mul_i32 s81, s3, 28672
    s_add_u32 s80, s80, s81
    s_add_u32 s80, s80, 12599296
    buffer_load_dwordx4 v[216:219], v6, s[68:71], s80 offen offset:0 sc1
    buffer_load_dwordx4 v[220:223], v6, s[68:71], s80 offen offset:1024 sc1
    s_add_u32 s96, s96, 1
    s_waitcnt vmcnt(0)
    v_max3_u32 v9, v224, v228, v232
    v_max_u32 v9, v9, v236
    v_cmp_eq_u32 vcc, -1, v9
    s_nop 1
    s_cbranch_vccz L_redo_153_x
    s_cmp_lt_u32 s96, 50000
    s_cbranch_scc1 L_redo_153_l
L_redo_153_x:
    s_nop 3
    s_branch L_back_154

L_redo_155:
    s_nop 15
    s_mov_b32 s96, 0
L_redo_155_l:
    s_mul_i32 s80, s76, 229376
    s_mul_i32 s81, s3, 28672
    s_add_u32 s80, s80, s81
    s_add_u32 s80, s80, 12587008
    buffer_load_dwordx4 v[240:243], v6, s[68:71], s80 offen offset:0 sc1
    buffer_load_dwordx4 v[244:247], v6, s[68:71], s80 offen offset:1024 sc1
    buffer_load_dwordx4 v[120:123], v6, s[68:71], s80 offen offset:2048 sc1
    buffer_load_dwordx4 v[124:127], v6, s[68:71], s80 offen offset:3072 sc1
    s_mul_i32 s80, s76, 229376
    s_mul_i32 s81, s3, 28672
    s_add_u32 s80, s80, s81
    s_add_u32 s80, s80, 12591104
    buffer_load_dwordx4 v[184:187], v6, s[68:71], s80 offen offset:0 sc1
    buffer_load_dwordx4 v[188:191], v6, s[68:71], s80 offen offset:1024 sc1
    buffer_load_dwordx4 v[192:195], v6, s[68:71], s80 offen offset:2048 sc1
    buffer_load_dwordx4 v[196:199], v6, s[68:71], s80 offen offset:3072 sc1
    s_mul_i32 s80, s76, 229376
    s_mul_i32 s81, s3, 28672
    s_add_u32 s80, s80, s81
    s_add_u32 s80, s80, 12595200
    buffer_load_dwordx4 v[200:203], v6, s[68:71], s80 offen offset:0 sc1
    buffer_load_dwordx4 v[204:207], v6, s[68:71], s80 offen offset:1024 sc1
    buffer_load_dwordx4 v[208:211], v6, s[68:71], s80 offen offset:2048 sc1
    buffer_load_dwordx4 v[212:215], v6, s[68:71], s80 offen offset:3072 sc1
    s_mul_i32 s80, s76, 229376
    s_mul_i32 s81, s3, 28672
    s_add_u32 s80, s80, s81
    s_add_u32 s80, s80, 12599296
    buffer_load_dwordx4 v[216:219], v6, s[68:71], s80 offen offset:0 sc1
    buffer_load_dwordx4 v[220:223], v6, s[68:71], s80 offen offset:1024 sc1
    buffer_load_dwordx4 v[224:227], v6, s[68:71], s80 offen offset:2048 sc1
    buffer_load_dwordx4 v[228:231], v6, s[68:71], s80 offen offset:3072 sc1
    s_mul_i32 s80, s76, 229376
    s_mul_i32 s81, s3, 28672
    s_add_u32 s80, s80, s81
    s_add_u32 s80, s80, 12603392
    buffer_load_dwordx4 v[232:235], v6, s[68:71], s80 offen offset:0 sc1
    s_add_u32 s96, s96, 1
    s_waitcnt vmcnt(0)
    v_max3_u32 v9, v240, v244, v120
    v_max_u32 v9, v9, v124
    v_cmp_eq_u32 vcc, -1, v9
    s_nop 1
    s_cbranch_vccz L_redo_155_x
    s_cmp_lt_u32 s96, 50000
    s_cbranch_scc1 L_redo_155_l
L_redo_155_x:
    s_nop 3
    s_branch L_back_156

L_redo_157:
    s_nop 15
    s_mov_b32 s96, 0
L_redo_157_l:
    s_mul_i32 s80, s76, 229376
    s_mul_i32 s81, s3, 28672
    s_add_u32 s80, s80, s81
    s_add_u32 s80, s80, 12591104
    buffer_load_dwordx4 v[184:187], v6, s[68:71], s80 offen offset:0 sc1
    buffer_load_dwordx4 v[188:191], v6, s[68:71], s80 offen offset:1024 sc1
    buffer_load_dwordx4 v[192:195], v6, s[68:71], s80 offen offset:2048 sc1
    buffer_load_dwordx4 v[196:199], v6, s[68:71], s80 offen offset:3072 sc1
    s_mul_i32 s80, s76, 229376
    s_mul_i32 s81, s3, 28672
    s_add_u32 s80, s80, s81
    s_add_u32 s80, s80, 12595200
    buffer_load_dwordx4 v[200:203], v6, s[68:71], s80 offen offset:0 sc1
    buffer_load_dwordx4 v[204:207], v6, s[68:71], s80 offen offset:1024 sc1
    buffer_load_dwordx4 v[208:211], v6, s[68:71], s80 offen offset:2048 sc1
    buffer_load_dwordx4 v[212:215], v6, s[68:71], s80 offen offset:3072 sc1
    s_mul_i32 s80, s76, 229376
    s_mul_i32 s81, s3, 28672
    s_add_u32 s80, s80, s81
    s_add_u32 s80, s80, 12599296
    buffer_load_dwordx4 v[216:219], v6, s[68:71], s80 offen offset:0 sc1
    buffer_load_dwordx4 v[220:223], v6, s[68:71], s80 offen offset:1024 sc1
    buffer_load_dwordx4 v[224:227], v6, s[68:71], s80 offen offset:2048 sc1
    buffer_load_dwordx4 v[228:231], v6, s[68:71], s80 offen offset:3072 sc1
    s_mul_i32 s80, s76, 229376
    s_mul_i32 s81, s3, 28672
    s_add_u32 s80, s80, s81
    s_add_u32 s80, s80, 12603392
    buffer_load_dwordx4 v[232:235], v6, s[68:71], s80 offen offset:0 sc1
    buffer_load_dwordx4 v[236:239], v6, s[68:71], s80 offen offset:1024 sc1
    buffer_load_dwordx4 v[240:243], v6, s[68:71], s80 offen offset:2048 sc1
    buffer_load_dwordx4 v[244:247], v6, s[68:71], s80 offen offset:3072 sc1
    s_mul_i32 s80, s76, 229376
    s_mul_i32 s81, s3, 28672
    s_add_u32 s80, s80, s81
    s_add_u32 s80, s80, 12607488
    buffer_load_dwordx4 v[120:123], v6, s[68:71], s80 offen offset:0 sc1
    s_add_u32 s96, s96, 1
    s_waitcnt vmcnt(0)
    v_max3_u32 v9, v184, v188, v192
    v_max_u32 v9, v9, v196
    v_cmp_eq_u32 vcc, -1, v9
    s_nop 1
    s_cbranch_vccz L_redo_157_x
    s_cmp_lt_u32 s96, 50000
    s_cbranch_scc1 L_redo_157_l
L_redo_157_x:
    s_nop 3
    s_branch L_back_158

L_redo_159:
    s_nop 15
    s_mov_b32 s96, 0
L_redo_159_l:
    s_mul_i32 s80, s76, 229376
    s_mul_i32 s81, s3, 28672
    s_add_u32 s80, s80, s81
    s_add_u32 s80, s80, 12595200
    buffer_load_dwordx4 v[200:203], v6, s[68:71], s80 offen offset:0 sc1
    buffer_load_dwordx4 v[204:207], v6, s[68:71], s80 offen offset:1024 sc1
    buffer_load_dwordx4 v[208:211], v6, s[68:71], s80 offen offset:2048 sc1
    buffer_load_dwordx4 v[212:215], v6, s[68:71], s80 offen offset:3072 sc1
    s_mul_i32 s80, s76, 229376
    s_mul_i32 s81, s3, 28672
    s_add_u32 s80, s80, s81
    s_add_u32 s80, s80, 12599296
    buffer_load_dwordx4 v[216:219], v6, s[68:71], s80 offen offset:0 sc1
    buffer_load_dwordx4 v[220:223], v6, s[68:71], s80 offen offset:1024 sc1
    buffer_load_dwordx4 v[224:227], v6, s[68:71], s80 offen offset:2048 sc1
    buffer_load_dwordx4 v[228:231], v6, s[68:71], s80 offen offset:3072 sc1
    s_mul_i32 s80, s76, 229376
    s_mul_i32 s81, s3, 28672
    s_add_u32 s80, s80, s81
    s_add_u32 s80, s80, 12603392
    buffer_load_dwordx4 v[232:235], v6, s[68:71], s80 offen offset:0 sc1
    buffer_load_dwordx4 v[236:239], v6, s[68:71], s80 offen offset:1024 sc1
    buffer_load_dwordx4 v[240:243], v6, s[68:71], s80 offen offset:2048 sc1
    buffer_load_dwordx4 v[244:247], v6, s[68:71], s80 offen offset:3072 sc1
    s_mul_i32 s80, s76, 229376
    s_mul_i32 s81, s3, 28672
    s_add_u32 s80, s80, s81
    s_add_u32 s80, s80, 12607488
    buffer_load_dwordx4 v[120:123], v6, s[68:71], s80 offen offset:0 sc1
    buffer_load_dwordx4 v[124:127], v6, s[68:71], s80 offen offset:1024 sc1
    buffer_load_dwordx4 v[184:187], v6, s[68:71], s80 offen offset:2048 sc1
    buffer_load_dwordx4 v[188:191], v6, s[68:71], s80 offen offset:3072 sc1
    s_add_u32 s96, s96, 1
    s_waitcnt vmcnt(0)
    v_max3_u32 v9, v200, v204, v208
    v_max_u32 v9, v9, v212
    v_cmp_eq_u32 vcc, -1, v9
    s_nop 1
    s_cbranch_vccz L_redo_159_x
    s_cmp_lt_u32 s96, 50000
    s_cbranch_scc1 L_redo_159_l
L_redo_159_x:
    s_nop 3
    s_branch L_back_160

L_redo_161:
    s_nop 15
    s_mov_b32 s96, 0
L_redo_161_l:
    s_mul_i32 s80, s76, 229376
    s_mul_i32 s81, s3, 28672
    s_add_u32 s80, s80, s81
    s_add_u32 s80, s80, 12599296
    buffer_load_dwordx4 v[216:219], v6, s[68:71], s80 offen offset:0 sc1
    buffer_load_dwordx4 v[220:223], v6, s[68:71], s80 offen offset:1024 sc1
    buffer_load_dwordx4 v[224:227], v6, s[68:71], s80 offen offset:2048 sc1
    buffer_load_dwordx4 v[228:231], v6, s[68:71], s80 offen offset:3072 sc1
    s_mul_i32 s80, s76, 229376
    s_mul_i32 s81, s3, 28672
    s_add_u32 s80, s80, s81
    s_add_u32 s80, s80, 12603392
    buffer_load_dwordx4 v[232:235], v6, s[68:71], s80 offen offset:0 sc1
    buffer_load_dwordx4 v[236:239], v6, s[68:71], s80 offen offset:1024 sc1
    buffer_load_dwordx4 v[240:243], v6, s[68:71], s80 offen offset:2048 sc1
    buffer_load_dwordx4 v[244:247], v6, s[68:71], s80 offen offset:3072 sc1
    s_mul_i32 s80, s76, 229376
    s_mul_i32 s81, s3, 28672
    s_add_u32 s80, s80, s81
    s_add_u32 s80, s80, 12607488
    buffer_load_dwordx4 v[120:123], v6, s[68:71], s80 offen offset:0 sc1
    buffer_load_dwordx4 v[124:127], v6, s[68:71], s80 offen offset:1024 sc1
    buffer_load_dwordx4 v[184:187], v6, s[68:71], s80 offen offset:2048 sc1
    buffer_load_dwordx4 v[188:191], v6, s[68:71], s80 offen offset:3072 sc1
    s_add_u32 s96, s96, 1
    s_waitcnt vmcnt(0)
    v_max3_u32 v9, v216, v220, v224
    v_max_u32 v9, v9, v228
    v_cmp_eq_u32 vcc, -1, v9
    s_nop 1
    s_cbranch_vccz L_redo_161_x
    s_cmp_lt_u32 s96, 50000
    s_cbranch_scc1 L_redo_161_l
L_redo_161_x:
    s_nop 3
    s_branch L_back_162

L_redo_163:
    s_nop 15
    s_mov_b32 s96, 0
L_redo_163_l:
    s_mul_i32 s80, s76, 229376
    s_mul_i32 s81, s3, 28672
    s_add_u32 s80, s80, s81
    s_add_u32 s80, s80, 12603392
    buffer_load_dwordx4 v[232:235], v6, s[68:71], s80 offen offset:0 sc1
    buffer_load_dwordx4 v[236:239], v6, s[68:71], s80 offen offset:1024 sc1
    buffer_load_dwordx4 v[240:243], v6, s[68:71], s80 offen offset:2048 sc1
    buffer_load_dwordx4 v[244:247], v6, s[68:71], s80 offen offset:3072 sc1
    s_mul_i32 s80, s76, 229376
    s_mul_i32 s81, s3, 28672
    s_add_u32 s80, s80, s81
    s_add_u32 s80, s80, 12607488
    buffer_load_dwordx4 v[120:123], v6, s[68:71], s80 offen offset:0 sc1
    buffer_load_dwordx4 v[124:127], v6, s[68:71], s80 offen offset:1024 sc1
    buffer_load_dwordx4 v[184:187], v6, s[68:71], s80 offen offset:2048 sc1
    buffer_load_dwordx4 v[188:191], v6, s[68:71], s80 offen offset:3072 sc1
    s_add_u32 s96, s96, 1
    s_waitcnt vmcnt(0)
    v_max3_u32 v9, v232, v236, v240
    v_max_u32 v9, v9, v244
    v_cmp_eq_u32 vcc, -1, v9
    s_nop 1
    s_cbranch_vccz L_redo_163_x
    s_cmp_lt_u32 s96, 50000
    s_cbranch_scc1 L_redo_163_l
L_redo_163_x:
    s_nop 3
    s_branch L_back_164

L_redo_165:
    s_nop 15
    s_mov_b32 s96, 0
L_redo_165_l:
    s_mul_i32 s80, s76, 229376
    s_mul_i32 s81, s3, 28672
    s_add_u32 s80, s80, s81
    s_add_u32 s80, s80, 12607488
    buffer_load_dwordx4 v[120:123], v6, s[68:71], s80 offen offset:0 sc1
    buffer_load_dwordx4 v[124:127], v6, s[68:71], s80 offen offset:1024 sc1
    buffer_load_dwordx4 v[184:187], v6, s[68:71], s80 offen offset:2048 sc1
    buffer_load_dwordx4 v[188:191], v6, s[68:71], s80 offen offset:3072 sc1
    s_add_u32 s96, s96, 1
    s_waitcnt vmcnt(0)
    v_max3_u32 v9, v120, v124, v184
    v_max_u32 v9, v9, v188
    v_cmp_eq_u32 vcc, -1, v9
    s_nop 1
    s_cbranch_vccz L_redo_165_x
    s_cmp_lt_u32 s96, 50000
    s_cbranch_scc1 L_redo_165_l
L_redo_165_x:
    s_nop 3
    s_branch L_back_166

L_redo_167:
    s_nop 15
    s_mov_b32 s96, 0
L_redo_167_l:
    s_mul_i32 s80, s76, 229376
    s_mul_i32 s81, s3, 28672
    s_add_u32 s80, s80, s81
    s_add_u32 s80, s80, 12697600
    buffer_load_dwordx4 v[192:195], v6, s[68:71], s80 offen offset:0 sc1
    buffer_load_dwordx4 v[196:199], v6, s[68:71], s80 offen offset:1024 sc1
    buffer_load_dwordx4 v[200:203], v6, s[68:71], s80 offen offset:2048 sc1
    buffer_load_dwordx4 v[204:207], v6, s[68:71], s80 offen offset:3072 sc1
    s_mul_i32 s80, s76, 229376
    s_mul_i32 s81, s3, 28672
    s_add_u32 s80, s80, s81
    s_add_u32 s80, s80, 12701696
    buffer_load_dwordx4 v[208:211], v6, s[68:71], s80 offen offset:0 sc1
    buffer_load_dwordx4 v[212:215], v6, s[68:71], s80 offen offset:1024 sc1
    buffer_load_dwordx4 v[216:219], v6, s[68:71], s80 offen offset:2048 sc1
    buffer_load_dwordx4 v[220:223], v6, s[68:71], s80 offen offset:3072 sc1
    s_mul_i32 s80, s76, 229376
    s_mul_i32 s81, s3, 28672
    s_add_u32 s80, s80, s81
    s_add_u32 s80, s80, 12705792
    buffer_load_dwordx4 v[224:227], v6, s[68:71], s80 offen offset:0 sc1
    buffer_load_dwordx4 v[228:231], v6, s[68:71], s80 offen offset:1024 sc1
    buffer_load_dwordx4 v[232:235], v6, s[68:71], s80 offen offset:2048 sc1
    buffer_load_dwordx4 v[236:239], v6, s[68:71], s80 offen offset:3072 sc1
    s_mul_i32 s80, s76, 229376
    s_mul_i32 s81, s3, 28672
    s_add_u32 s80, s80, s81
    s_add_u32 s80, s80, 12709888
    buffer_load_dwordx4 v[240:243], v6, s[68:71], s80 offen offset:0 sc1
    buffer_load_dwordx4 v[244:247], v6, s[68:71], s80 offen offset:1024 sc1
    buffer_load_dwordx4 v[120:123], v6, s[68:71], s80 offen offset:2048 sc1
    buffer_load_dwordx4 v[124:127], v6, s[68:71], s80 offen offset:3072 sc1
    s_mul_i32 s80, s76, 229376
    s_mul_i32 s81, s3, 28672
    s_add_u32 s80, s80, s81
    s_add_u32 s80, s80, 12713984
    buffer_load_dwordx4 v[184:187], v6, s[68:71], s80 offen offset:0 sc1
    buffer_load_dwordx4 v[188:191], v6, s[68:71], s80 offen offset:1024 sc1
    s_add_u32 s96, s96, 1
    s_waitcnt vmcnt(0)
    v_max3_u32 v9, v192, v196, v200
    v_max_u32 v9, v9, v204
    v_cmp_eq_u32 vcc, -1, v9
    s_nop 1
    s_cbranch_vccz L_redo_167_x
    s_cmp_lt_u32 s96, 50000
    s_cbranch_scc1 L_redo_167_l
L_redo_167_x:
    s_nop 3
    s_branch L_back_168

L_redo_169:
    s_nop 15
    s_mov_b32 s96, 0
L_redo_169_l:
    s_mul_i32 s80, s76, 229376
    s_mul_i32 s81, s3, 28672
    s_add_u32 s80, s80, s81
    s_add_u32 s80, s80, 12701696
    buffer_load_dwordx4 v[208:211], v6, s[68:71], s80 offen offset:0 sc1
    buffer_load_dwordx4 v[212:215], v6, s[68:71], s80 offen offset:1024 sc1
    buffer_load_dwordx4 v[216:219], v6, s[68:71], s80 offen offset:2048 sc1
    buffer_load_dwordx4 v[220:223], v6, s[68:71], s80 offen offset:3072 sc1
    s_mul_i32 s80, s76, 229376
    s_mul_i32 s81, s3, 28672
    s_add_u32 s80, s80, s81
    s_add_u32 s80, s80, 12705792
    buffer_load_dwordx4 v[224:227], v6, s[68:71], s80 offen offset:0 sc1
    buffer_load_dwordx4 v[228:231], v6, s[68:71], s80 offen offset:1024 sc1
    buffer_load_dwordx4 v[232:235], v6, s[68:71], s80 offen offset:2048 sc1
    buffer_load_dwordx4 v[236:239], v6, s[68:71], s80 offen offset:3072 sc1
    s_mul_i32 s80, s76, 229376
    s_mul_i32 s81, s3, 28672
    s_add_u32 s80, s80, s81
    s_add_u32 s80, s80, 12709888
    buffer_load_dwordx4 v[240:243], v6, s[68:71], s80 offen offset:0 sc1
    buffer_load_dwordx4 v[244:247], v6, s[68:71], s80 offen offset:1024 sc1
    buffer_load_dwordx4 v[120:123], v6, s[68:71], s80 offen offset:2048 sc1
    buffer_load_dwordx4 v[124:127], v6, s[68:71], s80 offen offset:3072 sc1
    s_mul_i32 s80, s76, 229376
    s_mul_i32 s81, s3, 28672
    s_add_u32 s80, s80, s81
    s_add_u32 s80, s80, 12713984
    buffer_load_dwordx4 v[184:187], v6, s[68:71], s80 offen offset:0 sc1
    buffer_load_dwordx4 v[188:191], v6, s[68:71], s80 offen offset:1024 sc1
    buffer_load_dwordx4 v[192:195], v6, s[68:71], s80 offen offset:2048 sc1
    buffer_load_dwordx4 v[196:199], v6, s[68:71], s80 offen offset:3072 sc1
    s_mul_i32 s80, s76, 229376
    s_mul_i32 s81, s3, 28672
    s_add_u32 s80, s80, s81
    s_add_u32 s80, s80, 12718080
    buffer_load_dwordx4 v[200:203], v6, s[68:71], s80 offen offset:0 sc1
    s_add_u32 s96, s96, 1
    s_waitcnt vmcnt(0)
    v_max3_u32 v9, v208, v212, v216
    v_max_u32 v9, v9, v220
    v_cmp_eq_u32 vcc, -1, v9
    s_nop 1
    s_cbranch_vccz L_redo_169_x
    s_cmp_lt_u32 s96, 50000
    s_cbranch_scc1 L_redo_169_l
L_redo_169_x:
    s_nop 3
    s_branch L_back_170

L_redo_171:
    s_nop 15
    s_mov_b32 s96, 0
L_redo_171_l:
    s_mul_i32 s80, s76, 229376
    s_mul_i32 s81, s3, 28672
    s_add_u32 s80, s80, s81
    s_add_u32 s80, s80, 12705792
    buffer_load_dwordx4 v[224:227], v6, s[68:71], s80 offen offset:0 sc1
    buffer_load_dwordx4 v[228:231], v6, s[68:71], s80 offen offset:1024 sc1
    buffer_load_dwordx4 v[232:235], v6, s[68:71], s80 offen offset:2048 sc1
    buffer_load_dwordx4 v[236:239], v6, s[68:71], s80 offen offset:3072 sc1
    s_mul_i32 s80, s76, 229376
    s_mul_i32 s81, s3, 28672
    s_add_u32 s80, s80, s81
    s_add_u32 s80, s80, 12709888
    buffer_load_dwordx4 v[240:243], v6, s[68:71], s80 offen offset:0 sc1
    buffer_load_dwordx4 v[244:247], v6, s[68:71], s80 offen offset:1024 sc1
    buffer_load_dwordx4 v[120:123], v6, s[68:71], s80 offen offset:2048 sc1
    buffer_load_dwordx4 v[124:127], v6, s[68:71], s80 offen offset:3072 sc1
    s_mul_i32 s80, s76, 229376
    s_mul_i32 s81, s3, 28672
    s_add_u32 s80, s80, s81
    s_add_u32 s80, s80, 12713984
    buffer_load_dwordx4 v[184:187], v6, s[68:71], s80 offen offset:0 sc1
    buffer_load_dwordx4 v[188:191], v6, s[68:71], s80 offen offset:1024 sc1
    buffer_load_dwordx4 v[192:195], v6, s[68:71], s80 offen offset:2048 sc1
    buffer_load_dwordx4 v[196:199], v6, s[68:71], s80 offen offset:3072 sc1
    s_mul_i32 s80, s76, 229376
    s_mul_i32 s81, s3, 28672
    s_add_u32 s80, s80, s81
    s_add_u32 s80, s80, 12718080
    buffer_load_dwordx4 v[200:203], v6, s[68:71], s80 offen offset:0 sc1
    buffer_load_dwordx4 v[204:207], v6, s[68:71], s80 offen offset:1024 sc1
    buffer_load_dwordx4 v[208:211], v6, s[68:71], s80 offen offset:2048 sc1
    buffer_load_dwordx4 v[212:215], v6, s[68:71], s80 offen offset:3072 sc1
    s_mul_i32 s80, s76, 229376
    s_mul_i32 s81, s3, 28672
    s_add_u32 s80, s80, s81
    s_add_u32 s80, s80, 12722176
    buffer_load_dwordx4 v[216:219], v6, s[68:71], s80 offen offset:0 sc1
    s_add_u32 s96, s96, 1
    s_waitcnt vmcnt(0)
    v_max3_u32 v9, v224, v228, v232
    v_max_u32 v9, v9, v236
    v_cmp_eq_u32 vcc, -1, v9
    s_nop 1
    s_cbranch_vccz L_redo_171_x
    s_cmp_lt_u32 s96, 50000
    s_cbranch_scc1 L_redo_171_l
L_redo_171_x:
    s_nop 3
    s_branch L_back_172

L_redo_173:
    s_nop 15
    s_mov_b32 s96, 0
L_redo_173_l:
    s_mul_i32 s80, s76, 229376
    s_mul_i32 s81, s3, 28672
    s_add_u32 s80, s80, s81
    s_add_u32 s80, s80, 12709888
    buffer_load_dwordx4 v[240:243], v6, s[68:71], s80 offen offset:0 sc1
    buffer_load_dwordx4 v[244:247], v6, s[68:71], s80 offen offset:1024 sc1
    buffer_load_dwordx4 v[120:123], v6, s[68:71], s80 offen offset:2048 sc1
    buffer_load_dwordx4 v[124:127], v6, s[68:71], s80 offen offset:3072 sc1
    s_mul_i32 s80, s76, 229376
    s_mul_i32 s81, s3, 28672
    s_add_u32 s80, s80, s81
    s_add_u32 s80, s80, 12713984
    buffer_load_dwordx4 v[184:187], v6, s[68:71], s80 offen offset:0 sc1
    buffer_load_dwordx4 v[188:191], v6, s[68:71], s80 offen offset:1024 sc1
    buffer_load_dwordx4 v[192:195], v6, s[68:71], s80 offen offset:2048 sc1
    buffer_load_dwordx4 v[196:199], v6, s[68:71], s80 offen offset:3072 sc1
    s_mul_i32 s80, s76, 229376
    s_mul_i32 s81, s3, 28672
    s_add_u32 s80, s80, s81
    s_add_u32 s80, s80, 12718080
    buffer_load_dwordx4 v[200:203], v6, s[68:71], s80 offen offset:0 sc1
    buffer_load_dwordx4 v[204:207], v6, s[68:71], s80 offen offset:1024 sc1
    buffer_load_dwordx4 v[208:211], v6, s[68:71], s80 offen offset:2048 sc1
    buffer_load_dwordx4 v[212:215], v6, s[68:71], s80 offen offset:3072 sc1
    s_mul_i32 s80, s76, 229376
    s_mul_i32 s81, s3, 28672
    s_add_u32 s80, s80, s81
    s_add_u32 s80, s80, 12722176
    buffer_load_dwordx4 v[216:219], v6, s[68:71], s80 offen offset:0 sc1
    buffer_load_dwordx4 v[220:223], v6, s[68:71], s80 offen offset:1024 sc1
    buffer_load_dwordx4 v[224:227], v6, s[68:71], s80 offen offset:2048 sc1
    buffer_load_dwordx4 v[228:231], v6, s[68:71], s80 offen offset:3072 sc1
    s_add_u32 s96, s96, 1
    s_waitcnt vmcnt(0)
    v_max3_u32 v9, v240, v244, v120
    v_max_u32 v9, v9, v124
    v_cmp_eq_u32 vcc, -1, v9
    s_nop 1
    s_cbranch_vccz L_redo_173_x
    s_cmp_lt_u32 s96, 50000
    s_cbranch_scc1 L_redo_173_l
L_redo_173_x:
    s_nop 3
    s_branch L_back_174

L_redo_175:
    s_nop 15
    s_mov_b32 s96, 0
L_redo_175_l:
    s_mul_i32 s80, s76, 229376
    s_mul_i32 s81, s3, 28672
    s_add_u32 s80, s80, s81
    s_add_u32 s80, s80, 12713984
    buffer_load_dwordx4 v[184:187], v6, s[68:71], s80 offen offset:0 sc1
    buffer_load_dwordx4 v[188:191], v6, s[68:71], s80 offen offset:1024 sc1
    buffer_load_dwordx4 v[192:195], v6, s[68:71], s80 offen offset:2048 sc1
    buffer_load_dwordx4 v[196:199], v6, s[68:71], s80 offen offset:3072 sc1
    s_mul_i32 s80, s76, 229376
    s_mul_i32 s81, s3, 28672
    s_add_u32 s80, s80, s81
    s_add_u32 s80, s80, 12718080
    buffer_load_dwordx4 v[200:203], v6, s[68:71], s80 offen offset:0 sc1
    buffer_load_dwordx4 v[204:207], v6, s[68:71], s80 offen offset:1024 sc1
    buffer_load_dwordx4 v[208:211], v6, s[68:71], s80 offen offset:2048 sc1
    buffer_load_dwordx4 v[212:215], v6, s[68:71], s80 offen offset:3072 sc1
    s_mul_i32 s80, s76, 229376
    s_mul_i32 s81, s3, 28672
    s_add_u32 s80, s80, s81
    s_add_u32 s80, s80, 12722176
    buffer_load_dwordx4 v[216:219], v6, s[68:71], s80 offen offset:0 sc1
    buffer_load_dwordx4 v[220:223], v6, s[68:71], s80 offen offset:1024 sc1
    buffer_load_dwordx4 v[224:227], v6, s[68:71], s80 offen offset:2048 sc1
    buffer_load_dwordx4 v[228:231], v6, s[68:71], s80 offen offset:3072 sc1
    s_add_u32 s96, s96, 1
    s_waitcnt vmcnt(0)
    v_max3_u32 v9, v184, v188, v192
    v_max_u32 v9, v9, v196
    v_cmp_eq_u32 vcc, -1, v9
    s_nop 1
    s_cbranch_vccz L_redo_175_x
    s_cmp_lt_u32 s96, 50000
    s_cbranch_scc1 L_redo_175_l
L_redo_175_x:
    s_nop 3
    s_branch L_back_176

L_redo_177:
    s_nop 15
    s_mov_b32 s96, 0
L_redo_177_l:
    s_mul_i32 s80, s76, 229376
    s_mul_i32 s81, s3, 28672
    s_add_u32 s80, s80, s81
    s_add_u32 s80, s80, 12718080
    buffer_load_dwordx4 v[200:203], v6, s[68:71], s80 offen offset:0 sc1
    buffer_load_dwordx4 v[204:207], v6, s[68:71], s80 offen offset:1024 sc1
    buffer_load_dwordx4 v[208:211], v6, s[68:71], s80 offen offset:2048 sc1
    buffer_load_dwordx4 v[212:215], v6, s[68:71], s80 offen offset:3072 sc1
    s_mul_i32 s80, s76, 229376
    s_mul_i32 s81, s3, 28672
    s_add_u32 s80, s80, s81
    s_add_u32 s80, s80, 12722176
    buffer_load_dwordx4 v[216:219], v6, s[68:71], s80 offen offset:0 sc1
    buffer_load_dwordx4 v[220:223], v6, s[68:71], s80 offen offset:1024 sc1
    buffer_load_dwordx4 v[224:227], v6, s[68:71], s80 offen offset:2048 sc1
    buffer_load_dwordx4 v[228:231], v6, s[68:71], s80 offen offset:3072 sc1
    s_add_u32 s96, s96, 1
    s_waitcnt vmcnt(0)
    v_max3_u32 v9, v200, v204, v208
    v_max_u32 v9, v9, v212
    v_cmp_eq_u32 vcc, -1, v9
    s_nop 1
    s_cbranch_vccz L_redo_177_x
    s_cmp_lt_u32 s96, 50000
    s_cbranch_scc1 L_redo_177_l
L_redo_177_x:
    s_nop 3
    s_branch L_back_178

L_redo_179:
    s_nop 15
    s_mov_b32 s96, 0
L_redo_179_l:
    s_mul_i32 s80, s76, 229376
    s_mul_i32 s81, s3, 28672
    s_add_u32 s80, s80, s81
    s_add_u32 s80, s80, 12722176
    buffer_load_dwordx4 v[216:219], v6, s[68:71], s80 offen offset:0 sc1
    buffer_load_dwordx4 v[220:223], v6, s[68:71], s80 offen offset:1024 sc1
    buffer_load_dwordx4 v[224:227], v6, s[68:71], s80 offen offset:2048 sc1
    buffer_load_dwordx4 v[228:231], v6, s[68:71], s80 offen offset:3072 sc1
    s_add_u32 s96, s96, 1
    s_waitcnt vmcnt(0)
    v_max3_u32 v9, v216, v220, v224
    v_max_u32 v9, v9, v228
    v_cmp_eq_u32 vcc, -1, v9
    s_nop 1
    s_cbranch_vccz L_redo_179_x
    s_cmp_lt_u32 s96, 50000
    s_cbranch_scc1 L_redo_179_l
L_redo_179_x:
    s_nop 3
    s_branch L_back_180

.section .rodata,"a"
.p2align 6
.amdhsa_kernel interleave_layers__linear_attn_block__mixer_token_mlp__prompt_kernel
  .amdhsa_next_free_vgpr 512
  .amdhsa_next_free_sgpr 102
  .amdhsa_accum_offset 256
  .amdhsa_group_segment_fixed_size 0
  .amdhsa_kernarg_size 88
  .amdhsa_user_sgpr_count 2
  .amdhsa_user_sgpr_kernarg_segment_ptr 1
  .amdhsa_system_sgpr_workgroup_id_x 1
  .amdhsa_float_denorm_mode_32 3
.end_amdhsa_kernel
```
